```python
import torch

def _softmax(x, axis=-1):
    return torch.softmax(x, dim=axis)
def _gelu(x):
    return torch.nn.functional.gelu(x, approximate="tanh")
def _silu(x):
    return torch.nn.functional.silu(x)
def _sigmoid(x):
    return torch.sigmoid(x)
def _layernorm(x, axis=-1, eps=1e-5):
    m = x.mean(dim=axis, keepdim=True)
    v = x.var(dim=axis, keepdim=True, unbiased=False)
    return (x - m) / torch.sqrt(v + eps)
def _scatter_add(tgt, idx, src, axis=0):
    return tgt.clone().index_add_(axis, idx, src)
def _segment_sum(src, seg, n):
    out = torch.zeros((n,) + src.shape[1:], dtype=src.dtype)
    return out.index_add_(0, seg, src)
def _pad(x, pw):
    flat = tuple(v for pair in reversed(pw) for v in pair)
    return torch.nn.functional.pad(x, flat)

kernel_name = 'parallel_sum__ssm_conv_s5__glu_gated_geglu__prompt'

def setup_inputs():

    _w = (lambda a: (lambda t: t.to(torch.bfloat16) if t.is_floating_point() else t)(torch.as_tensor(a)))
    def _A_setup():
        B, S, D = 1, 2048, 1024
        P = D
        Lambda_re = -0.5 * (lambda _x: torch.exp(torch.as_tensor(_x)))((lambda *s: torch.randn(*s, dtype=torch.bfloat16) * 0.2)(P))
        Lambda_im = (lambda *s: torch.randn(*s, dtype=torch.bfloat16) * 0.8)(P) * 1.0
        B_re = (lambda *s: torch.randn(*s, dtype=torch.bfloat16) * 0.2)(P, D) * (D ** -0.5)
        B_im = (lambda *s: torch.randn(*s, dtype=torch.bfloat16) * 0.2)(P, D) * (D ** -0.5)
        C_re = (lambda *s: torch.randn(*s, dtype=torch.bfloat16) * 0.2)(D, P) * (P ** -0.5)
        C_im = (lambda *s: torch.randn(*s, dtype=torch.bfloat16) * 0.2)(D, P) * (P ** -0.5)
        log_dt = (lambda *s: torch.randn(*s, dtype=torch.bfloat16) * 0.2)(P) * 0.3 - 2.0
        Dskip = (lambda *s: torch.randn(*s, dtype=torch.bfloat16) * 0.05)(D)
        return {
            "x": _w((lambda *s: torch.randn(*s, dtype=torch.bfloat16) * 0.05)(B, S, D)),
            "Lambda_re": _w(Lambda_re),
            "Lambda_im": _w(Lambda_im),
            "B_re": _w(B_re),
            "B_im": _w(B_im),
            "C_re": _w(C_re),
            "C_im": _w(C_im),
            "log_dt": _w(log_dt),
            "Dskip": _w(Dskip),
        }
    _A_in = _A_setup()

    def _B_setup():
        B, S, Dm, Df = 1, 2048, 1024, 3584
        return {
            "x": _w((lambda *s: torch.randn(*s, dtype=torch.bfloat16) * 0.05)(B, S, Dm)),
            "w_gate": _w((lambda *s: torch.randn(*s, dtype=torch.bfloat16) * 0.4)(Dm, Df) * (Dm ** -0.5)),
            "w_up": _w((lambda *s: torch.randn(*s, dtype=torch.bfloat16) * 0.4)(Dm, Df) * (Dm ** -0.5)),
            "w_down": _w((lambda *s: torch.randn(*s, dtype=torch.bfloat16) * 0.4)(Df, Dm) * (Df ** -0.5)),
        }
    _B_in = _B_setup()

    return {
        "A_x": _A_in["x"],
        "A_Lambda_re": _A_in["Lambda_re"],
        "A_Lambda_im": _A_in["Lambda_im"],
        "A_B_re": _A_in["B_re"],
        "A_B_im": _A_in["B_im"],
        "A_C_re": _A_in["C_re"],
        "A_C_im": _A_in["C_im"],
        "A_log_dt": _A_in["log_dt"],
        "A_Dskip": _A_in["Dskip"],
        "B_x": _B_in["x"],
        "B_w_gate": _B_in["w_gate"],
        "B_w_up": _B_in["w_up"],
        "B_w_down": _B_in["w_down"],
    }

def reference(A_x, A_Lambda_re, A_Lambda_im, A_B_re, A_B_im, A_C_re, A_C_im, A_log_dt, A_Dskip, B_x, B_w_gate, B_w_up, B_w_down):
    def _A_ref(x, Lambda_re, Lambda_im, B_re, B_im, C_re, C_im, log_dt, Dskip):
        Bsz, L, H = x.shape
        Lam = Lambda_re + 1j * Lambda_im
        Bmat = B_re + 1j * B_im
        Cmat = C_re + 1j * C_im
        dt = torch.exp(log_dt)
        Lam_bar = torch.exp(dt * Lam)
        B_bar = ((Lam_bar - 1.0) / Lam)[:, None] * Bmat
        Bu = torch.einsum("bld,pd->blp", x + 0j, B_bar)
        h = torch.zeros_like(Bu[:, 0, :])
        hs = []
        for t in range(L):
            h = Lam_bar[None, :] * h + Bu[:, t, :]
            hs.append(h)
        hseq = torch.stack(hs, 1)
        y = 2.0 * torch.einsum("blp,dp->bld", hseq, Cmat).real + x * Dskip[None, None, :]
        return y

    def _B_ref(x, w_gate, w_up, w_down):
        g = torch.einsum("bsd,df->bsf", x, w_gate)
        u = torch.einsum("bsd,df->bsf", x, w_up)
        h = _gelu(g) * u
        return torch.einsum("bsf,fd->bsd", h, w_down)

    x = A_x
    xn = _layernorm(x, axis=-1)
    return x + _A_ref(xn, A_Lambda_re, A_Lambda_im, A_B_re, A_B_im, A_C_re, A_C_im, A_log_dt, A_Dskip) + _B_ref(xn, B_w_gate, B_w_up, B_w_down)
```

```asm
; @launch grid=(256,1,1) block=(256,1,1) lds=163840
.amdgcn_target "amdgcn-amd-amdhsa--gfx950"
.text
.globl parallel_sum__ssm_conv_s5__glu_gated_geglu__prompt_kernel
.p2align 8
.type parallel_sum__ssm_conv_s5__glu_gated_geglu__prompt_kernel,@function
parallel_sum__ssm_conv_s5__glu_gated_geglu__prompt_kernel:
s_cmp_ge_u32 s2, 256
s_cbranch_scc1 L_end
s_load_dwordx2 s[4:5], s[0:1], 0
s_load_dwordx2 s[6:7], s[0:1], 120
s_load_dwordx4 s[12:15], s[0:1], 80
s_load_dwordx4 s[24:27], s[0:1], 24
s_load_dwordx4 s[96:99], s[0:1], 8
s_load_dwordx4 s[92:95], s[0:1], 56
s_load_dwordx4 s[84:87], s[0:1], 96
s_load_dwordx4 s[88:91], s[0:1], 40
s_getpc_b64 s[82:83]
L_pc:
s_lshr_b32 s64, s2, 3
s_mul_i32 s64, s64, 28
v_add_u32 v3, s64, v0
v_cmp_gt_u32 vcc, 64, v0
s_nop 1
v_cndmask_b32 v2, v3, v0, vcc
v_lshlrev_b32 v2, 7, v2
v_min_u32 v2, L_codeend-L_pc-4, v2
v_mov_b32 v3, 0
v_lshl_add_u64 v[2:3], v[2:3], 0, s[82:83]
v_cmp_gt_u32 vcc, 92, v0
s_nop 0
s_and_saveexec_b64 s[66:67], vcc
s_cbranch_execz L_nocp
global_load_dword a246, v[2:3], off
L_nocp:
s_mov_b64 exec, -1
v_lshrrev_b32 v1, 6, v0
v_and_b32 v0, 63, v0
v_readfirstlane_b32 s62, v1
v_lshlrev_b32 v1, 4, v0
s_mov_b32 s79, 0x200000
s_bfe_u32 s52, s2, 0x20001
s_and_b32 s64, s2, 1
s_lshl_b32 s64, s64, 2
s_lshr_b32 s61, s2, 6
s_add_u32 s61, s61, s64
s_bfe_u32 s53, s2, 0x30003
s_lshl_b32 s60, s52, 3
s_add_u32 s60, s60, s53
s_lshl_b32 s63, s61, 2
s_add_u32 s63, s63, s62
s_and_b32 s64, s2, 1
s_lshl_b32 s64, s64, 1
s_lshr_b32 s65, s62, 1
s_add_u32 s64, s64, s65
s_lshl_b32 s64, s64, 4
s_lshl_b32 s65, s52, 1
s_add_u32 s64, s64, s65
s_lshr_b32 s66, s2, 3
s_lshl_b32 s65, s66, 6
s_add_u32 s64, s64, s65
s_lshl_b32 s67, s64, 11
s_and_b32 s68, s62, 1
s_lshl_b32 s65, s68, 8
s_add_u32 s67, s67, s65
v_and_b32 v48, 15, v0
v_bfe_u32 v56, v0, 1, 1
v_and_b32 v57, 1, v0
v_lshl_add_u32 v56, v57, 3, v56
v_lshrrev_b32 v57, 2, v0
v_lshlrev_b32 v40, 11, v56
v_lshl_add_u32 v40, v57, 4, v40
s_mov_b32 s10, 4194304
s_mov_b32 s11, 0x20000
s_waitcnt lgkmcnt(0)
s_mov_b32 s8, s4
s_and_b32 s9, s5, 0xffff
buffer_load_dwordx4 v[64:67], v40, s[8:11], s67 offen offset:0
buffer_load_dwordx4 v[68:71], v40, s[8:11], s67 offen offset:512
buffer_load_dwordx4 v[72:75], v40, s[8:11], s67 offen offset:1024
buffer_load_dwordx4 v[76:79], v40, s[8:11], s67 offen offset:1536
s_add_u32 s70, s6, 0x1a48000
s_addc_u32 s71, s7, 0
s_load_dword s3, s[70:71], 0
s_mov_b32 s16, s14
s_and_b32 s17, s15, 0xffff
s_mov_b32 s18, 7340032
s_mov_b32 s19, 0x20000
s_and_b32 s13, s13, 0xffff
s_mov_b32 s14, 7340032
s_mov_b32 s15, 0x20000
s_mov_b32 s28, s26
s_and_b32 s29, s27, 0xffff
s_mov_b32 s30, 2097152
s_mov_b32 s31, 0x20000
s_and_b32 s25, s25, 0xffff
s_mov_b32 s26, 2097152
s_mov_b32 s27, 0x20000
s_cmp_ge_u32 s62, 2
s_cselect_b32 s20, s16, s12
s_cselect_b32 s21, s17, s13
s_mov_b32 s22, 7340032
s_mov_b32 s23, 0x20000
s_add_u32 s36, s6, 0x1a00000
s_addc_u32 s37, s7, 0
s_and_b32 s37, s37, 0xffff
s_mov_b32 s38, 0xf0000
s_mov_b32 s39, 0x20000
v_lshrrev_b32 v49, 4, v0
v_and_b32 v60, 31, v0
v_lshlrev_b32 v60, 2, v60
s_lshl_b32 s81, s63, 7
s_add_u32 s81, s81, 0x60000
v_and_b32 v63, 7, v0
v_lshlrev_b32 v63, 6, v63
s_lshl_b32 s75, s63, 11
s_lshl_b32 s65, s52, 9
s_add_u32 s75, s75, s65
s_add_u32 s75, s75, 0x50000
v_mov_b32 v41, -1
v_lshlrev_b32 v42, 2, v0
s_xor_b32 s69, s2, 0xf8
s_lshl_b32 s69, s69, 10
s_lshl_b32 s65, s62, 8
s_add_u32 s69, s69, s65
buffer_store_dword v41, v42, s[36:39], s69 offen sc0 sc1
s_lshl_b32 s70, s66, 1
s_and_b32 s65, s2, 1
s_add_u32 s70, s70, s65
s_mul_i32 s69, s70, 7168
s_mul_i32 s65, s52, 1792
s_add_u32 s69, s69, s65
v_and_b32 v40, 31, v0
v_min_u32 v40, 13, v40
v_lshl_add_u32 v44, v40, 7, s69
v_and_b32 v45, 3, v0
s_lshl_b32 s69, s52, 8
s_lshl_b32 s65, s70, 2
s_add_u32 s69, s69, s65
v_add_u32 v45, s69, v45
v_lshlrev_b32 v45, 11, v45
s_mov_b32 s69, 458752
s_cmp_ge_u32 s62, 2
s_cselect_b64 vcc, -1, 0
v_cndmask_b32 v13, v44, v45, vcc
s_cselect_b32 s76, 128, s69
s_cselect_b32 s40, s24, s12
s_cselect_b32 s41, s25, s13
s_cselect_b32 s69, s28, s16
s_cselect_b32 s65, s29, s17
s_cselect_b32 s42, s26, s14
s_bitcmp1_b32 s62, 0
s_cselect_b32 s40, s69, s40
s_cselect_b32 s41, s65, s41
s_mov_b32 s43, 0x20000
s_mov_b32 s77, 0
buffer_load_dword a246, v13, s[40:43], s77 offen
s_add_u32 s77, s77, s76
buffer_load_dword a246, v13, s[40:43], s77 offen
s_add_u32 s77, s77, s76
buffer_load_dword a246, v13, s[40:43], s77 offen
s_add_u32 s77, s77, s76
s_and_b32 s71, s60, 1
s_lshl_b32 s71, s71, 1
s_mul_i32 s72, s60, 224
s_and_b32 s73, s62, 1
s_add_u32 s73, s73, 12
s_add_u32 s69, s62, 0
s_lshl_b32 s69, s69, 6
v_add_u32 v40, s69, v0
v_mul_u32_u24 v44, 4682, v40
v_lshrrev_b32 v44, 16, v44
v_mul_u32_u24 v45, 14, v44
v_sub_u32 v45, v40, v45
v_add_u32 v45, s71, v45
v_subrev_u32 v43, 14, v45
v_min_u32 v45, v45, v43
v_lshrrev_b32 v43, 1, v44
v_xor_b32 v43, v43, v44
v_and_b32 v43, 4, v43
v_mul_u32_u24 v43, 3, v43
v_xor_b32 v44, v44, v43
v_mul_u32_u24 v44, 7168, v44
v_lshl_add_u32 v44, v45, 4, v44
v_add_u32 v6, s72, v44
s_add_u32 s69, s62, 4
s_lshl_b32 s69, s69, 6
v_add_u32 v40, s69, v0
v_mul_u32_u24 v44, 4682, v40
v_lshrrev_b32 v44, 16, v44
v_mul_u32_u24 v45, 14, v44
v_sub_u32 v45, v40, v45
v_add_u32 v45, s71, v45
v_subrev_u32 v43, 14, v45
v_min_u32 v45, v45, v43
v_lshrrev_b32 v43, 1, v44
v_xor_b32 v43, v43, v44
v_and_b32 v43, 4, v43
v_mul_u32_u24 v43, 3, v43
v_xor_b32 v44, v44, v43
v_mul_u32_u24 v44, 7168, v44
v_lshl_add_u32 v44, v45, 4, v44
v_add_u32 v7, s72, v44
s_add_u32 s69, s62, 8
s_lshl_b32 s69, s69, 6
v_add_u32 v40, s69, v0
v_mul_u32_u24 v44, 4682, v40
v_lshrrev_b32 v44, 16, v44
v_mul_u32_u24 v45, 14, v44
v_sub_u32 v45, v40, v45
v_add_u32 v45, s71, v45
v_subrev_u32 v43, 14, v45
v_min_u32 v45, v45, v43
v_lshrrev_b32 v43, 1, v44
v_xor_b32 v43, v43, v44
v_and_b32 v43, 4, v43
v_mul_u32_u24 v43, 3, v43
v_xor_b32 v44, v44, v43
v_mul_u32_u24 v44, 7168, v44
v_lshl_add_u32 v44, v45, 4, v44
v_add_u32 v8, s72, v44
s_lshl_b32 s69, s73, 6
v_add_u32 v40, s69, v0
v_mul_u32_u24 v44, 4682, v40
v_lshrrev_b32 v44, 16, v44
v_mul_u32_u24 v45, 14, v44
v_sub_u32 v45, v40, v45
v_add_u32 v45, s71, v45
v_subrev_u32 v43, 14, v45
v_min_u32 v45, v45, v43
v_lshrrev_b32 v43, 1, v44
v_xor_b32 v43, v43, v44
v_and_b32 v43, 4, v43
v_mul_u32_u24 v43, 3, v43
v_xor_b32 v44, v44, v43
v_mul_u32_u24 v44, 7168, v44
v_lshl_add_u32 v44, v45, 4, v44
v_add_u32 v9, s72, v44
v_lshrrev_b32 v50, 3, v0
s_lshl_b32 s69, s62, 3
v_add_u32 v40, s69, v50
v_bfe_u32 v44, v40, 1, 3
v_and_b32 v51, 7, v0
v_xor_b32 v44, v44, v51
v_lshlrev_b32 v47, 11, v40
v_lshl_add_u32 v47, v44, 4, v47
s_lshl_b32 s69, s60, 16
v_add_u32 v10, s69, v47
s_lshl_b32 s54, s62, 10
s_lshl_b32 s55, s73, 10
s_cmp_ge_u32 s62, 2
s_cselect_b32 s69, 14336, 0
s_add_u32 s55, s55, s69
s_add_u32 s56, s54, 131072
s_lshl_b32 s65, s62, 9
s_add_u32 s65, s65, 57344
v_lshl_add_u32 v52, v0, 3, s65
v_xor_b32 v54, 512, v52
v_lshlrev_b32 v55, 12, v49
v_lshrrev_b32 v44, 2, v48
v_lshl_add_u32 v55, v44, 8, v55
v_and_b32 v44, 48, v1
v_add_u32 v55, v55, v44
s_lshl_b32 s70, s66, 17
s_lshl_b32 s67, s52, 10
s_add_u32 s70, s70, s67
s_and_b32 s67, s2, 1
s_lshl_b32 s67, s67, 7
s_add_u32 s70, s70, s67
s_lshr_b32 s67, s62, 1
s_lshl_b32 s67, s67, 6
s_add_u32 s70, s70, s67
s_lshl_b32 s67, s68, 14
s_add_u32 s70, s70, s67
s_add_u32 s71, s70, 32768
s_add_u32 s72, s70, 65536
s_add_u32 s73, s70, 98304
s_lshl_b32 s74, s2, 7
s_lshr_b32 s67, s62, 1
s_lshl_b32 s67, s67, 6
s_add_u32 s74, s74, s67
s_add_u32 s74, s74, 0x40000
s_add_u32 s48, s6, 0x0
s_addc_u32 s49, s7, 0
s_and_b32 s49, s49, 0xffff
s_mov_b32 s50, 0x400000
s_mov_b32 s51, 0x20000
v_lshrrev_b32 v40, 1, v48
v_xor_b32 v40, v40, v49
v_lshlrev_b32 v40, 4, v40
v_lshl_add_u32 v40, v48, 7, v40
v_add_u32 v3, 131072, v40
v_xor_b32 v4, 64, v3
v_lshrrev_b32 v40, 1, v49
v_lshlrev_b32 v40, 4, v40
v_and_b32 v41, 1, v49
v_lshlrev_b32 v41, 2, v41
v_lshrrev_b32 v50, 2, v48
v_add3_u32 v11, v40, v41, v50
v_mul_u32_u24 v40, 224, v11
v_and_b32 v51, 3, v0
v_lshl_add_u32 v2, v51, 3, v40
v_add_u32 v5, 0x10000, v2
s_lshl_b32 s65, s63, 17
s_add_u32 s8, s6, s65
s_addc_u32 s9, s7, 0
s_and_b32 s9, s9, 0xffff
s_mov_b32 s10, 0x20000
s_lshl_b32 s83, s2, 4
s_lshl_b32 s65, s62, 2
s_add_u32 s83, s83, s65
s_and_b32 s82, s2, 7
s_lshl_b32 s82, s82, 6
s_lshl_b32 s65, s66, 11
s_add_u32 s82, s82, s65
s_lshl_b32 s65, s62, 9
s_add_u32 s82, s82, s65
s_add_u32 s82, s82, 0x50000
s_add_u32 s83, s83, 0x60000
s_waitcnt vmcnt(7)
v_lshlrev_b32 v80, 16, v64
v_and_b32 v81, 0xffff0000, v64
v_lshlrev_b32 v82, 16, v65
v_and_b32 v83, 0xffff0000, v65
v_lshlrev_b32 v84, 16, v66
v_and_b32 v85, 0xffff0000, v66
v_lshlrev_b32 v86, 16, v67
v_and_b32 v87, 0xffff0000, v67
v_pk_add_f32 v[144:145], v[80:81], v[82:83]
v_pk_add_f32 v[146:147], v[84:85], v[86:87]
s_waitcnt vmcnt(6)
v_lshlrev_b32 v88, 16, v68
v_and_b32 v89, 0xffff0000, v68
v_lshlrev_b32 v90, 16, v69
v_and_b32 v91, 0xffff0000, v69
v_lshlrev_b32 v92, 16, v70
v_and_b32 v93, 0xffff0000, v70
v_lshlrev_b32 v94, 16, v71
v_and_b32 v95, 0xffff0000, v71
v_pk_add_f32 v[144:145], v[144:145], v[88:89]
v_pk_add_f32 v[146:147], v[146:147], v[90:91]
v_pk_add_f32 v[144:145], v[144:145], v[92:93]
v_pk_add_f32 v[146:147], v[146:147], v[94:95]
s_waitcnt vmcnt(5)
v_lshlrev_b32 v96, 16, v72
v_and_b32 v97, 0xffff0000, v72
v_lshlrev_b32 v98, 16, v73
v_and_b32 v99, 0xffff0000, v73
v_lshlrev_b32 v100, 16, v74
v_and_b32 v101, 0xffff0000, v74
v_lshlrev_b32 v102, 16, v75
v_and_b32 v103, 0xffff0000, v75
v_pk_add_f32 v[144:145], v[144:145], v[96:97]
v_pk_add_f32 v[146:147], v[146:147], v[98:99]
v_pk_add_f32 v[144:145], v[144:145], v[100:101]
v_pk_add_f32 v[146:147], v[146:147], v[102:103]
s_waitcnt vmcnt(4)
v_lshlrev_b32 v104, 16, v76
v_and_b32 v105, 0xffff0000, v76
v_lshlrev_b32 v106, 16, v77
v_and_b32 v107, 0xffff0000, v77
v_lshlrev_b32 v108, 16, v78
v_and_b32 v109, 0xffff0000, v78
v_lshlrev_b32 v110, 16, v79
v_and_b32 v111, 0xffff0000, v79
v_pk_add_f32 v[144:145], v[144:145], v[104:105]
v_pk_add_f32 v[146:147], v[146:147], v[106:107]
v_pk_add_f32 v[144:145], v[144:145], v[108:109]
v_pk_add_f32 v[146:147], v[146:147], v[110:111]
v_pk_add_f32 v[144:145], v[144:145], v[146:147]
v_add_f32 v144, v144, v145
s_nop 1
v_add_f32_dpp v144, v144, v144 row_ror:4 row_mask:0xf bank_mask:0xf
s_nop 1
v_add_f32_dpp v144, v144, v144 row_ror:8 row_mask:0xf bank_mask:0xf
v_mov_b32 v145, v144
s_nop 1
v_permlane16_swap_b32 v144, v145
v_add_f32 v144, v144, v145
v_mov_b32 v145, v144
s_nop 1
v_permlane32_swap_b32 v144, v145
v_add_f32 v144, v144, v145
v_mul_f32 v28, 0x3b000000, v144
v_pk_add_f32 v[112:113], v[80:81], v[28:29] op_sel_hi:[1,0] neg_lo:[0,1] neg_hi:[0,1]
v_pk_add_f32 v[114:115], v[82:83], v[28:29] op_sel_hi:[1,0] neg_lo:[0,1] neg_hi:[0,1]
v_pk_add_f32 v[116:117], v[84:85], v[28:29] op_sel_hi:[1,0] neg_lo:[0,1] neg_hi:[0,1]
v_pk_add_f32 v[118:119], v[86:87], v[28:29] op_sel_hi:[1,0] neg_lo:[0,1] neg_hi:[0,1]
v_pk_add_f32 v[120:121], v[88:89], v[28:29] op_sel_hi:[1,0] neg_lo:[0,1] neg_hi:[0,1]
v_pk_add_f32 v[122:123], v[90:91], v[28:29] op_sel_hi:[1,0] neg_lo:[0,1] neg_hi:[0,1]
v_pk_add_f32 v[124:125], v[92:93], v[28:29] op_sel_hi:[1,0] neg_lo:[0,1] neg_hi:[0,1]
v_pk_add_f32 v[126:127], v[94:95], v[28:29] op_sel_hi:[1,0] neg_lo:[0,1] neg_hi:[0,1]
v_pk_add_f32 v[128:129], v[96:97], v[28:29] op_sel_hi:[1,0] neg_lo:[0,1] neg_hi:[0,1]
v_pk_add_f32 v[130:131], v[98:99], v[28:29] op_sel_hi:[1,0] neg_lo:[0,1] neg_hi:[0,1]
v_pk_add_f32 v[132:133], v[100:101], v[28:29] op_sel_hi:[1,0] neg_lo:[0,1] neg_hi:[0,1]
v_pk_add_f32 v[134:135], v[102:103], v[28:29] op_sel_hi:[1,0] neg_lo:[0,1] neg_hi:[0,1]
v_pk_add_f32 v[136:137], v[104:105], v[28:29] op_sel_hi:[1,0] neg_lo:[0,1] neg_hi:[0,1]
v_pk_add_f32 v[138:139], v[106:107], v[28:29] op_sel_hi:[1,0] neg_lo:[0,1] neg_hi:[0,1]
v_pk_add_f32 v[140:141], v[108:109], v[28:29] op_sel_hi:[1,0] neg_lo:[0,1] neg_hi:[0,1]
v_pk_add_f32 v[142:143], v[110:111], v[28:29] op_sel_hi:[1,0] neg_lo:[0,1] neg_hi:[0,1]
v_pk_mul_f32 v[144:145], v[112:113], v[112:113]
v_pk_mul_f32 v[146:147], v[114:115], v[114:115]
v_pk_fma_f32 v[144:145], v[116:117], v[116:117], v[144:145]
v_pk_fma_f32 v[146:147], v[118:119], v[118:119], v[146:147]
v_pk_fma_f32 v[144:145], v[120:121], v[120:121], v[144:145]
v_pk_fma_f32 v[146:147], v[122:123], v[122:123], v[146:147]
v_pk_fma_f32 v[144:145], v[124:125], v[124:125], v[144:145]
v_pk_fma_f32 v[146:147], v[126:127], v[126:127], v[146:147]
v_pk_fma_f32 v[144:145], v[128:129], v[128:129], v[144:145]
v_pk_fma_f32 v[146:147], v[130:131], v[130:131], v[146:147]
v_pk_fma_f32 v[144:145], v[132:133], v[132:133], v[144:145]
v_pk_fma_f32 v[146:147], v[134:135], v[134:135], v[146:147]
v_pk_fma_f32 v[144:145], v[136:137], v[136:137], v[144:145]
v_pk_fma_f32 v[146:147], v[138:139], v[138:139], v[146:147]
v_pk_fma_f32 v[144:145], v[140:141], v[140:141], v[144:145]
v_pk_fma_f32 v[146:147], v[142:143], v[142:143], v[146:147]
v_pk_add_f32 v[144:145], v[144:145], v[146:147]
v_add_f32 v144, v144, v145
s_nop 1
v_add_f32_dpp v144, v144, v144 row_ror:4 row_mask:0xf bank_mask:0xf
s_nop 1
v_add_f32_dpp v144, v144, v144 row_ror:8 row_mask:0xf bank_mask:0xf
v_mov_b32 v145, v144
s_nop 1
v_permlane16_swap_b32 v144, v145
v_add_f32 v144, v144, v145
v_mov_b32 v145, v144
s_nop 1
v_permlane32_swap_b32 v144, v145
v_add_f32 v144, v144, v145
v_mul_f32 v29, 0x3b000000, v144
ds_write_b64 v52, v[28:29]
s_waitcnt lgkmcnt(0)
s_barrier
ds_read_b64 v[144:145], v54
s_mul_i32 s3, s3, 0x9E3779B1
s_add_u32 s3, s3, 0x7F4A7C15
v_mov_b32 v56, s3
s_waitcnt lgkmcnt(0)
v_sub_f32 v146, v28, v144
v_pk_add_f32 v[28:29], v[28:29], v[144:145]
v_mul_f32 v146, 0.5, v146
v_pk_mul_f32 v[28:29], v[28:29], 0.5 op_sel_hi:[1,0]
v_fmac_f32 v29, v146, v146
v_cvt_pk_bf16_f32 v144, v28, v29
v_lshlrev_b32 v28, 16, v144
v_and_b32 v29, 0xffff0000, v144
v_add_f32 v29, 0x3727c5ac, v29
v_cvt_pk_bf16_f32 v29, v29, v29
v_and_b32 v29, 0xffff0000, v29
v_sqrt_f32 v29, v29
s_nop 0
v_cvt_pk_bf16_f32 v29, v29, v29
v_and_b32 v29, 0xffff0000, v29
v_rcp_f32 v29, v29
s_nop 0
v_pk_add_f32 v[80:81], v[80:81], v[28:29] op_sel_hi:[1,0] neg_lo:[0,1] neg_hi:[0,1]
v_pk_add_f32 v[82:83], v[82:83], v[28:29] op_sel_hi:[1,0] neg_lo:[0,1] neg_hi:[0,1]
v_pk_add_f32 v[84:85], v[84:85], v[28:29] op_sel_hi:[1,0] neg_lo:[0,1] neg_hi:[0,1]
v_pk_add_f32 v[86:87], v[86:87], v[28:29] op_sel_hi:[1,0] neg_lo:[0,1] neg_hi:[0,1]
v_cvt_pk_bf16_f32 v64, v80, v81
v_cvt_pk_bf16_f32 v65, v82, v83
v_cvt_pk_bf16_f32 v66, v84, v85
v_cvt_pk_bf16_f32 v67, v86, v87
v_lshlrev_b32 v80, 16, v64
v_and_b32 v81, 0xffff0000, v64
v_lshlrev_b32 v82, 16, v65
v_and_b32 v83, 0xffff0000, v65
v_lshlrev_b32 v84, 16, v66
v_and_b32 v85, 0xffff0000, v66
v_lshlrev_b32 v86, 16, v67
v_and_b32 v87, 0xffff0000, v67
v_pk_mul_f32 v[80:81], v[80:81], v[28:29] op_sel:[0,1] op_sel_hi:[1,1]
v_pk_mul_f32 v[82:83], v[82:83], v[28:29] op_sel:[0,1] op_sel_hi:[1,1]
v_pk_mul_f32 v[84:85], v[84:85], v[28:29] op_sel:[0,1] op_sel_hi:[1,1]
v_pk_mul_f32 v[86:87], v[86:87], v[28:29] op_sel:[0,1] op_sel_hi:[1,1]
v_cvt_pk_bf16_f32 v64, v80, v81
v_cvt_pk_bf16_f32 v65, v82, v83
v_cvt_pk_bf16_f32 v66, v84, v85
v_cvt_pk_bf16_f32 v67, v86, v87
buffer_store_dwordx4 v[64:67], v55, s[48:51], s70 offen sc0 sc1
v_pk_add_f32 v[88:89], v[88:89], v[28:29] op_sel_hi:[1,0] neg_lo:[0,1] neg_hi:[0,1]
v_pk_add_f32 v[90:91], v[90:91], v[28:29] op_sel_hi:[1,0] neg_lo:[0,1] neg_hi:[0,1]
v_pk_add_f32 v[92:93], v[92:93], v[28:29] op_sel_hi:[1,0] neg_lo:[0,1] neg_hi:[0,1]
v_pk_add_f32 v[94:95], v[94:95], v[28:29] op_sel_hi:[1,0] neg_lo:[0,1] neg_hi:[0,1]
v_cvt_pk_bf16_f32 v68, v88, v89
v_cvt_pk_bf16_f32 v69, v90, v91
v_cvt_pk_bf16_f32 v70, v92, v93
v_cvt_pk_bf16_f32 v71, v94, v95
v_lshlrev_b32 v88, 16, v68
v_and_b32 v89, 0xffff0000, v68
v_lshlrev_b32 v90, 16, v69
v_and_b32 v91, 0xffff0000, v69
v_lshlrev_b32 v92, 16, v70
v_and_b32 v93, 0xffff0000, v70
v_lshlrev_b32 v94, 16, v71
v_and_b32 v95, 0xffff0000, v71
v_pk_mul_f32 v[88:89], v[88:89], v[28:29] op_sel:[0,1] op_sel_hi:[1,1]
v_pk_mul_f32 v[90:91], v[90:91], v[28:29] op_sel:[0,1] op_sel_hi:[1,1]
v_pk_mul_f32 v[92:93], v[92:93], v[28:29] op_sel:[0,1] op_sel_hi:[1,1]
v_pk_mul_f32 v[94:95], v[94:95], v[28:29] op_sel:[0,1] op_sel_hi:[1,1]
v_cvt_pk_bf16_f32 v16, v88, v89
v_cvt_pk_bf16_f32 v17, v90, v91
v_cvt_pk_bf16_f32 v18, v92, v93
v_cvt_pk_bf16_f32 v19, v94, v95
v_pk_add_f32 v[96:97], v[96:97], v[28:29] op_sel_hi:[1,0] neg_lo:[0,1] neg_hi:[0,1]
v_pk_add_f32 v[98:99], v[98:99], v[28:29] op_sel_hi:[1,0] neg_lo:[0,1] neg_hi:[0,1]
v_pk_add_f32 v[100:101], v[100:101], v[28:29] op_sel_hi:[1,0] neg_lo:[0,1] neg_hi:[0,1]
v_pk_add_f32 v[102:103], v[102:103], v[28:29] op_sel_hi:[1,0] neg_lo:[0,1] neg_hi:[0,1]
v_cvt_pk_bf16_f32 v72, v96, v97
v_cvt_pk_bf16_f32 v73, v98, v99
v_cvt_pk_bf16_f32 v74, v100, v101
v_cvt_pk_bf16_f32 v75, v102, v103
v_lshlrev_b32 v96, 16, v72
v_and_b32 v97, 0xffff0000, v72
v_lshlrev_b32 v98, 16, v73
v_and_b32 v99, 0xffff0000, v73
v_lshlrev_b32 v100, 16, v74
v_and_b32 v101, 0xffff0000, v74
v_lshlrev_b32 v102, 16, v75
v_and_b32 v103, 0xffff0000, v75
v_pk_mul_f32 v[96:97], v[96:97], v[28:29] op_sel:[0,1] op_sel_hi:[1,1]
v_pk_mul_f32 v[98:99], v[98:99], v[28:29] op_sel:[0,1] op_sel_hi:[1,1]
v_pk_mul_f32 v[100:101], v[100:101], v[28:29] op_sel:[0,1] op_sel_hi:[1,1]
v_pk_mul_f32 v[102:103], v[102:103], v[28:29] op_sel:[0,1] op_sel_hi:[1,1]
v_cvt_pk_bf16_f32 v20, v96, v97
v_cvt_pk_bf16_f32 v21, v98, v99
v_cvt_pk_bf16_f32 v22, v100, v101
v_cvt_pk_bf16_f32 v23, v102, v103
v_pk_add_f32 v[104:105], v[104:105], v[28:29] op_sel_hi:[1,0] neg_lo:[0,1] neg_hi:[0,1]
v_pk_add_f32 v[106:107], v[106:107], v[28:29] op_sel_hi:[1,0] neg_lo:[0,1] neg_hi:[0,1]
v_pk_add_f32 v[108:109], v[108:109], v[28:29] op_sel_hi:[1,0] neg_lo:[0,1] neg_hi:[0,1]
v_pk_add_f32 v[110:111], v[110:111], v[28:29] op_sel_hi:[1,0] neg_lo:[0,1] neg_hi:[0,1]
v_cvt_pk_bf16_f32 v76, v104, v105
v_cvt_pk_bf16_f32 v77, v106, v107
v_cvt_pk_bf16_f32 v78, v108, v109
v_cvt_pk_bf16_f32 v79, v110, v111
v_lshlrev_b32 v104, 16, v76
v_and_b32 v105, 0xffff0000, v76
v_lshlrev_b32 v106, 16, v77
v_and_b32 v107, 0xffff0000, v77
v_lshlrev_b32 v108, 16, v78
v_and_b32 v109, 0xffff0000, v78
v_lshlrev_b32 v110, 16, v79
v_and_b32 v111, 0xffff0000, v79
v_pk_mul_f32 v[104:105], v[104:105], v[28:29] op_sel:[0,1] op_sel_hi:[1,1]
v_pk_mul_f32 v[106:107], v[106:107], v[28:29] op_sel:[0,1] op_sel_hi:[1,1]
v_pk_mul_f32 v[108:109], v[108:109], v[28:29] op_sel:[0,1] op_sel_hi:[1,1]
v_pk_mul_f32 v[110:111], v[110:111], v[28:29] op_sel:[0,1] op_sel_hi:[1,1]
v_cvt_pk_bf16_f32 v24, v104, v105
v_cvt_pk_bf16_f32 v25, v106, v107
v_cvt_pk_bf16_f32 v26, v108, v109
v_cvt_pk_bf16_f32 v27, v110, v111
s_waitcnt vmcnt(0)
s_barrier
s_mov_b64 exec, 15
buffer_store_dwordx4 v[56:59], v1, s[36:39], s82 offen sc0 sc1
s_mov_b64 exec, -1
s_mov_b32 s57, 0
s_add_u32 m0, s54, 0
s_nop 0
buffer_load_dwordx4 v6, s[12:15], s57 offen lds
s_add_u32 m0, s54, 4096
s_nop 0
buffer_load_dwordx4 v7, s[12:15], s57 offen lds
s_add_u32 m0, s54, 8192
s_nop 0
buffer_load_dwordx4 v8, s[12:15], s57 offen lds
s_add_u32 m0, s55, 0
s_nop 0
buffer_load_dwordx4 v9, s[20:23], s57 offen lds
s_add_u32 m0, s54, 14336
s_nop 0
buffer_load_dwordx4 v6, s[16:19], s57 offen lds
s_add_u32 m0, s54, 18432
s_nop 0
buffer_load_dwordx4 v7, s[16:19], s57 offen lds
s_add_u32 m0, s54, 22528
s_nop 0
buffer_load_dwordx4 v8, s[16:19], s57 offen lds
s_mov_b32 s58, 0
s_add_u32 m0, s56, 0
s_nop 0
buffer_load_dwordx4 v10, s[24:27], s58 offen lds
s_add_u32 m0, s56, 4096
s_nop 0
buffer_load_dwordx4 v10, s[28:31], s58 offen lds
s_mov_b64 exec, 0
s_cmp_eq_u32 s62, 1
s_cbranch_scc1 L_tr1
s_cmp_eq_u32 s62, 2
s_cbranch_scc1 L_tr2
s_cmp_eq_u32 s62, 3
s_cbranch_scc1 L_tr3
s_branch L_tr0
L_trret:
s_mov_b64 exec, -1
buffer_load_dword v61, v63, s[36:39], s75 offen sc0 sc1
s_mov_b32 s57, 458752
s_add_u32 m0, s54, 28672
s_nop 0
buffer_load_dwordx4 v6, s[12:15], s57 offen lds
s_add_u32 m0, s54, 32768
s_nop 0
buffer_load_dwordx4 v7, s[12:15], s57 offen lds
s_add_u32 m0, s54, 36864
s_nop 0
buffer_load_dwordx4 v8, s[12:15], s57 offen lds
s_add_u32 m0, s55, 28672
s_nop 0
buffer_load_dwordx4 v9, s[20:23], s57 offen lds
s_add_u32 m0, s54, 43008
s_nop 0
buffer_load_dwordx4 v6, s[16:19], s57 offen lds
s_add_u32 m0, s54, 47104
s_nop 0
buffer_load_dwordx4 v7, s[16:19], s57 offen lds
s_add_u32 m0, s54, 51200
s_nop 0
buffer_load_dwordx4 v8, s[16:19], s57 offen lds
s_movk_i32 s58, 128
s_add_u32 m0, s56, 8192
s_nop 0
buffer_load_dwordx4 v10, s[24:27], s58 offen lds
s_add_u32 m0, s56, 12288
s_nop 0
buffer_load_dwordx4 v10, s[28:31], s58 offen lds
s_branch L_main
P1_retry:
P1_r2:
s_cmp_eq_u32 s79, 0
s_cbranch_scc1 P1_ok
s_sub_u32 s79, s79, 1
s_sleep 1
buffer_load_dword v61, v63, s[36:39], s75 offen sc0 sc1
s_waitcnt vmcnt(0)
s_branch P1_chk
P1c_retry:
P1c_r2:
s_cmp_eq_u32 s79, 0
s_cbranch_scc1 P1c_ok
s_sub_u32 s79, s79, 1
s_sleep 1
buffer_load_dword v61, v60, s[36:39], s81 offen sc0 sc1
s_waitcnt vmcnt(0)
s_branch P1c_chk
P1b_retry:
P1b_r2:
s_cmp_eq_u32 s79, 0
s_cbranch_scc1 P1b_ok
s_sub_u32 s79, s79, 1
s_sleep 1
buffer_load_dword v44, v43, s[36:39], s71 offen sc0 sc1
s_waitcnt vmcnt(0)
s_branch P1b_chk
PAG_retry:
s_mov_b32 s57, 57344
buffer_load_dwordx4 a[60:63], v5, s[40:43], s57 offen sc0 sc1
s_mov_b32 s57, 49152
buffer_load_dwordx4 a[56:59], v5, s[40:43], s57 offen sc0 sc1
s_mov_b32 s57, 40960
buffer_load_dwordx4 a[52:55], v5, s[40:43], s57 offen sc0 sc1
s_mov_b32 s57, 32768
buffer_load_dwordx4 a[48:51], v5, s[40:43], s57 offen sc0 sc1
s_movk_i32 s57, 24576
buffer_load_dwordx4 a[44:47], v5, s[40:43], s57 offen sc0 sc1
s_movk_i32 s57, 16384
buffer_load_dwordx4 a[40:43], v5, s[40:43], s57 offen sc0 sc1
s_movk_i32 s57, 8192
buffer_load_dwordx4 a[36:39], v5, s[40:43], s57 offen sc0 sc1
s_mov_b32 s57, 0
buffer_load_dwordx4 a[32:35], v5, s[40:43], s57 offen sc0 sc1
s_waitcnt vmcnt(0)
v_accvgpr_read_b32 v52, a60
v_accvgpr_read_b32 v53, a61
v_accvgpr_read_b32 v54, a62
v_accvgpr_read_b32 v55, a63
v_max3_u32 v56, v52, v53, v54
v_max_u32 v56, v56, v55
v_accvgpr_read_b32 v48, a56
v_accvgpr_read_b32 v49, a57
v_accvgpr_read_b32 v50, a58
v_accvgpr_read_b32 v51, a59
v_max3_u32 v56, v56, v48, v49
v_max3_u32 v56, v56, v50, v51
v_fmac_f32 v48, v32, v52
v_fmac_f32 v50, v32, v54
v_fmac_f32 v49, v33, v53
v_fmac_f32 v51, v33, v55
v_fma_f32 v48, -v34, v54, v48
v_fmac_f32 v50, v34, v52
v_fma_f32 v49, -v35, v55, v49
v_fmac_f32 v51, v35, v53
v_accvgpr_read_b32 v52, a52
v_accvgpr_read_b32 v53, a53
v_accvgpr_read_b32 v54, a54
v_accvgpr_read_b32 v55, a55
v_max3_u32 v56, v56, v52, v53
v_max3_u32 v56, v56, v54, v55
v_fmac_f32 v52, v32, v48
v_fmac_f32 v54, v32, v50
v_fmac_f32 v53, v33, v49
v_fmac_f32 v55, v33, v51
v_fma_f32 v52, -v34, v50, v52
v_fmac_f32 v54, v34, v48
v_fma_f32 v53, -v35, v51, v53
v_fmac_f32 v55, v35, v49
v_accvgpr_read_b32 v48, a48
v_accvgpr_read_b32 v49, a49
v_accvgpr_read_b32 v50, a50
v_accvgpr_read_b32 v51, a51
v_max3_u32 v56, v56, v48, v49
v_max3_u32 v56, v56, v50, v51
v_fmac_f32 v48, v32, v52
v_fmac_f32 v50, v32, v54
v_fmac_f32 v49, v33, v53
v_fmac_f32 v51, v33, v55
v_fma_f32 v48, -v34, v54, v48
v_fmac_f32 v50, v34, v52
v_fma_f32 v49, -v35, v55, v49
v_fmac_f32 v51, v35, v53
v_accvgpr_read_b32 v52, a44
v_accvgpr_read_b32 v53, a45
v_accvgpr_read_b32 v54, a46
v_accvgpr_read_b32 v55, a47
v_max3_u32 v56, v56, v52, v53
v_max3_u32 v56, v56, v54, v55
v_fmac_f32 v52, v32, v48
v_fmac_f32 v54, v32, v50
v_fmac_f32 v53, v33, v49
v_fmac_f32 v55, v33, v51
v_fma_f32 v52, -v34, v50, v52
v_fmac_f32 v54, v34, v48
v_fma_f32 v53, -v35, v51, v53
v_fmac_f32 v55, v35, v49
v_accvgpr_read_b32 v48, a40
v_accvgpr_read_b32 v49, a41
v_accvgpr_read_b32 v50, a42
v_accvgpr_read_b32 v51, a43
v_max3_u32 v56, v56, v48, v49
v_max3_u32 v56, v56, v50, v51
v_fmac_f32 v48, v32, v52
v_fmac_f32 v50, v32, v54
v_fmac_f32 v49, v33, v53
v_fmac_f32 v51, v33, v55
v_fma_f32 v48, -v34, v54, v48
v_fmac_f32 v50, v34, v52
v_fma_f32 v49, -v35, v55, v49
v_fmac_f32 v51, v35, v53
v_accvgpr_read_b32 v52, a36
v_accvgpr_read_b32 v53, a37
v_accvgpr_read_b32 v54, a38
v_accvgpr_read_b32 v55, a39
v_max3_u32 v56, v56, v52, v53
v_max3_u32 v56, v56, v54, v55
v_fmac_f32 v52, v32, v48
v_fmac_f32 v54, v32, v50
v_fmac_f32 v53, v33, v49
v_fmac_f32 v55, v33, v51
v_fma_f32 v52, -v34, v50, v52
v_fmac_f32 v54, v34, v48
v_fma_f32 v53, -v35, v51, v53
v_fmac_f32 v55, v35, v49
v_accvgpr_read_b32 v48, a32
v_accvgpr_read_b32 v49, a33
v_accvgpr_read_b32 v50, a34
v_accvgpr_read_b32 v51, a35
v_max3_u32 v56, v56, v48, v49
v_max3_u32 v56, v56, v50, v51
v_fmac_f32 v48, v32, v52
v_fmac_f32 v50, v32, v54
v_fmac_f32 v49, v33, v53
v_fmac_f32 v51, v33, v55
v_fma_f32 v48, -v34, v54, v48
v_fmac_f32 v50, v34, v52
v_fma_f32 v49, -v35, v55, v49
v_fmac_f32 v51, v35, v53
v_cmp_eq_u32 vcc, -1, v56
s_nop 0
s_and_b64 vcc, vcc, exec
s_cbranch_scc0 PAG_ok
s_cmp_eq_u32 s79, 0
s_cbranch_scc1 PAG_ok
s_sub_u32 s79, s79, 1
s_sleep 1
s_branch PAG_retry
FX:
buffer_load_dword v39, v32, s[36:39], s69 offen sc0 sc1
s_waitcnt vmcnt(0)
v_cmp_eq_u32 vcc, s3, v39
s_nop 0
s_and_b32 s29, vcc_lo, s28
s_andn2_b32 s28, s28, s29
s_bitcmp1_b32 s29, 1
s_cbranch_scc0 FX_n1
buffer_load_dwordx4 v[164:167], v1, s[40:43], s70 offen offset:0 sc0 sc1
buffer_load_dwordx4 v[172:175], v1, s[40:43], s70 offen offset:1024 sc0 sc1
buffer_load_dwordx4 v[180:183], v1, s[40:43], s70 offen offset:2048 sc0 sc1
buffer_load_dwordx4 v[188:191], v1, s[40:43], s70 offen offset:3072 sc0 sc1
FX_n1:
s_bitcmp1_b32 s29, 2
s_cbranch_scc0 FX_n2
buffer_load_dwordx4 v[196:199], v1, s[40:43], s71 offen offset:0 sc0 sc1
buffer_load_dwordx4 v[204:207], v1, s[40:43], s71 offen offset:1024 sc0 sc1
buffer_load_dwordx4 v[212:215], v1, s[40:43], s71 offen offset:2048 sc0 sc1
buffer_load_dwordx4 v[220:223], v1, s[40:43], s71 offen offset:3072 sc0 sc1
FX_n2:
s_bitcmp1_b32 s29, 0
s_cbranch_scc0 FX_n0
buffer_load_dwordx4 v[228:231], v1, s[40:43], s72 offen offset:0 sc0 sc1
buffer_load_dwordx4 v[236:239], v1, s[40:43], s72 offen offset:1024 sc0 sc1
FX_n0:
s_cmp_eq_u32 s28, 0
s_cbranch_scc1 FX_done
s_cmp_eq_u32 s79, 0
s_cbranch_scc1 FX_done
s_sub_u32 s79, s79, 1
s_branch FX
FX_done:
buffer_load_dword v39, v32, s[36:39], s69 offen sc0 sc1
s_waitcnt vmcnt(0)
s_branch FX_ret
P43_retry:
P43_r2:
s_cmp_eq_u32 s79, 0
s_cbranch_scc1 P43_ok
s_sub_u32 s79, s79, 1
s_sleep 1
buffer_load_dword v39, v32, s[36:39], s69 offen sc0 sc1
s_waitcnt vmcnt(0)
s_branch P43_chk
P3a0_retry:
P3a0_r2:
s_cmp_eq_u32 s79, 0
s_cbranch_scc1 P3a0_ok
s_sub_u32 s79, s79, 1
s_sleep 1
buffer_load_dword v13, v12, s[36:39], s68 offen offset:96 sc0 sc1
s_waitcnt vmcnt(0)
s_branch P3a0_chk
P3a_retry:
P3a_r2:
s_cmp_eq_u32 s79, 0
s_cbranch_scc1 P3a_ok
s_sub_u32 s79, s79, 1
s_sleep 1
buffer_load_dword v13, v12, s[36:39], s68 offen offset:0 sc0 sc1
s_waitcnt vmcnt(0)
s_branch P3a_chk
P3b_retry:
P3b_r2:
s_cmp_eq_u32 s79, 0
s_cbranch_scc1 P3b_ok
s_sub_u32 s79, s79, 1
s_sleep 1
buffer_load_dword v13, v12, s[36:39], s68 offen offset:32 sc0 sc1
s_waitcnt vmcnt(0)
s_branch P3b_chk
P3c_retry:
P3c_r2:
s_cmp_eq_u32 s79, 0
s_cbranch_scc1 P3c_ok
s_sub_u32 s79, s79, 1
s_sleep 1
buffer_load_dword v13, v12, s[36:39], s68 offen offset:64 sc0 sc1
s_waitcnt vmcnt(0)
s_branch P3c_chk
.p2align 12
L_main:
L_tr0:
s_cbranch_execz L_tr4
s_waitcnt vmcnt(9)
P1_chk:
v_cmp_ne_u32 vcc, s3, v61
s_nop 0
s_and_b64 vcc, vcc, exec
s_cbranch_scc1 P1_retry
P1_ok:
s_mov_b32 s59, 0
buffer_load_dwordx4 a[96:99], v1, s[8:11], s59 offen offset:0 sc1
buffer_load_dwordx4 a[100:103], v1, s[8:11], s59 offen offset:1024 sc1
buffer_load_dwordx4 a[104:107], v1, s[8:11], s59 offen offset:2048 sc1
buffer_load_dwordx4 a[108:111], v1, s[8:11], s59 offen offset:3072 sc1
s_barrier
ds_read_b64_tr_b16 a[208:209], v2 offset:0
ds_read_b64_tr_b16 a[210:211], v2 offset:1792
ds_read_b64_tr_b16 a[212:213], v2 offset:14336
ds_read_b64_tr_b16 a[214:215], v2 offset:16128
ds_read_b64_tr_b16 a[216:217], v2 offset:32
ds_read_b64_tr_b16 a[218:219], v2 offset:1824
ds_read_b64_tr_b16 a[220:221], v2 offset:14368
ds_read_b64_tr_b16 a[222:223], v2 offset:16160
ds_read_b64_tr_b16 a[224:225], v2 offset:64
ds_read_b64_tr_b16 a[226:227], v2 offset:1856
s_waitcnt vmcnt(0) lgkmcnt(8)
v_mfma_f32_16x16x32_bf16 v[128:131], a[208:211], a[96:99], 0
s_movk_i32 s59, 4096
v_mfma_f32_16x16x32_bf16 v[132:135], a[208:211], a[100:103], 0
buffer_load_dwordx4 a[112:115], v1, s[8:11], s59 offen offset:0 sc1
v_mfma_f32_16x16x32_bf16 v[136:139], a[208:211], a[104:107], 0
v_mfma_f32_16x16x32_bf16 v[140:143], a[208:211], a[108:111], 0
s_waitcnt lgkmcnt(6)
ds_read_b64_tr_b16 a[228:229], v2 offset:14400
ds_read_b64_tr_b16 a[230:231], v2 offset:16192
v_mfma_f32_16x16x32_bf16 v[156:159], a[212:215], a[108:111], 0
v_mfma_f32_16x16x32_bf16 v[152:155], a[212:215], a[104:107], 0
buffer_load_dwordx4 a[116:119], v1, s[8:11], s59 offen offset:1024 sc1
v_mfma_f32_16x16x32_bf16 v[148:151], a[212:215], a[100:103], 0
v_mfma_f32_16x16x32_bf16 v[144:147], a[212:215], a[96:99], 0
s_waitcnt lgkmcnt(6)
ds_read_b64_tr_b16 a[232:233], v2 offset:96
ds_read_b64_tr_b16 a[234:235], v2 offset:1888
v_mfma_f32_16x16x32_bf16 v[160:163], a[216:219], a[96:99], 0
v_mfma_f32_16x16x32_bf16 v[164:167], a[216:219], a[100:103], 0
buffer_load_dwordx4 a[120:123], v1, s[8:11], s59 offen offset:2048 sc1
v_mfma_f32_16x16x32_bf16 v[168:171], a[216:219], a[104:107], 0
v_mfma_f32_16x16x32_bf16 v[172:175], a[216:219], a[108:111], 0
s_waitcnt lgkmcnt(6)
ds_read_b64_tr_b16 a[236:237], v2 offset:14432
ds_read_b64_tr_b16 a[238:239], v2 offset:16224
v_mfma_f32_16x16x32_bf16 v[188:191], a[220:223], a[108:111], 0
v_mfma_f32_16x16x32_bf16 v[184:187], a[220:223], a[104:107], 0
buffer_load_dwordx4 a[124:127], v1, s[8:11], s59 offen offset:3072 sc1
v_mfma_f32_16x16x32_bf16 v[180:183], a[220:223], a[100:103], 0
s_mov_b32 s57, 917504
s_add_u32 m0, s54, 65536
v_mfma_f32_16x16x32_bf16 v[176:179], a[220:223], a[96:99], 0
s_waitcnt lgkmcnt(6)
ds_read_b64_tr_b16 a[208:209], v2 offset:128
ds_read_b64_tr_b16 a[210:211], v2 offset:1920
v_mfma_f32_16x16x32_bf16 v[192:195], a[224:227], a[96:99], 0
v_mfma_f32_16x16x32_bf16 v[196:199], a[224:227], a[100:103], 0
v_mfma_f32_16x16x32_bf16 v[200:203], a[224:227], a[104:107], 0
buffer_load_dwordx4 v6, s[12:15], s57 offen lds
v_mfma_f32_16x16x32_bf16 v[204:207], a[224:227], a[108:111], 0
s_waitcnt lgkmcnt(6)
ds_read_b64_tr_b16 a[212:213], v2 offset:14464
ds_read_b64_tr_b16 a[214:215], v2 offset:16256
v_mfma_f32_16x16x32_bf16 v[220:223], a[228:231], a[108:111], 0
s_movk_i32 s59, 8192
v_mfma_f32_16x16x32_bf16 v[216:219], a[228:231], a[104:107], 0
v_mfma_f32_16x16x32_bf16 v[212:215], a[228:231], a[100:103], 0
buffer_load_dwordx4 a[128:131], v1, s[8:11], s59 offen offset:0 sc1
v_mfma_f32_16x16x32_bf16 v[208:211], a[228:231], a[96:99], 0
s_waitcnt lgkmcnt(6)
ds_read_b64_tr_b16 a[216:217], v2 offset:160
ds_read_b64_tr_b16 a[218:219], v2 offset:1952
v_mfma_f32_16x16x32_bf16 v[224:227], a[232:235], a[96:99], 0
v_mfma_f32_16x16x32_bf16 v[228:231], a[232:235], a[100:103], 0
v_mfma_f32_16x16x32_bf16 v[232:235], a[232:235], a[104:107], 0
v_mfma_f32_16x16x32_bf16 v[236:239], a[232:235], a[108:111], 0
s_waitcnt lgkmcnt(6)
ds_read_b64_tr_b16 a[220:221], v2 offset:14496
ds_read_b64_tr_b16 a[222:223], v2 offset:16288
v_mfma_f32_16x16x32_bf16 v[252:255], a[236:239], a[108:111], 0
v_mfma_f32_16x16x32_bf16 v[248:251], a[236:239], a[104:107], 0
v_mfma_f32_16x16x32_bf16 v[244:247], a[236:239], a[100:103], 0
v_mfma_f32_16x16x32_bf16 v[240:243], a[236:239], a[96:99], 0
s_waitcnt lgkmcnt(6)
ds_read_b64_tr_b16 a[224:225], v2 offset:192
ds_read_b64_tr_b16 a[226:227], v2 offset:1984
v_mfma_f32_16x16x32_bf16 a[0:3], a[208:211], a[96:99], 0
v_mfma_f32_16x16x32_bf16 a[4:7], a[208:211], a[100:103], 0
buffer_load_dwordx4 a[132:135], v1, s[8:11], s59 offen offset:1024 sc1
v_mfma_f32_16x16x32_bf16 a[8:11], a[208:211], a[104:107], 0
v_mfma_f32_16x16x32_bf16 a[12:15], a[208:211], a[108:111], 0
s_waitcnt lgkmcnt(6)
ds_read_b64_tr_b16 a[228:229], v2 offset:14528
ds_read_b64_tr_b16 a[230:231], v2 offset:16320
v_mfma_f32_16x16x32_bf16 a[28:31], a[212:215], a[108:111], 0
v_mfma_f32_16x16x32_bf16 a[24:27], a[212:215], a[104:107], 0
buffer_load_dwordx4 a[136:139], v1, s[8:11], s59 offen offset:2048 sc1
v_mfma_f32_16x16x32_bf16 a[20:23], a[212:215], a[100:103], 0
v_mfma_f32_16x16x32_bf16 a[16:19], a[212:215], a[96:99], 0
s_waitcnt lgkmcnt(6)
ds_read_b128 a[232:235], v3 offset:0
v_mfma_f32_16x16x32_bf16 a[32:35], a[216:219], a[96:99], 0
v_mfma_f32_16x16x32_bf16 a[36:39], a[216:219], a[100:103], 0
v_mfma_f32_16x16x32_bf16 a[40:43], a[216:219], a[104:107], 0
buffer_load_dwordx4 a[140:143], v1, s[8:11], s59 offen offset:3072 sc1
v_mfma_f32_16x16x32_bf16 a[44:47], a[216:219], a[108:111], 0
s_waitcnt lgkmcnt(5)
ds_read_b128 a[236:239], v3 offset:4096
s_movk_i32 s59, 12288
v_mfma_f32_16x16x32_bf16 a[60:63], a[220:223], a[108:111], 0
v_mfma_f32_16x16x32_bf16 a[56:59], a[220:223], a[104:107], 0
v_mfma_f32_16x16x32_bf16 a[52:55], a[220:223], a[100:103], 0
buffer_load_dwordx4 a[144:147], v1, s[8:11], s59 offen offset:0 sc1
v_mfma_f32_16x16x32_bf16 a[48:51], a[220:223], a[96:99], 0
s_waitcnt lgkmcnt(4)
ds_read_b128 a[208:211], v3 offset:2048
v_mfma_f32_16x16x32_bf16 a[64:67], a[224:227], a[96:99], 0
v_mfma_f32_16x16x32_bf16 a[68:71], a[224:227], a[100:103], 0
v_mfma_f32_16x16x32_bf16 a[72:75], a[224:227], a[104:107], 0
v_mfma_f32_16x16x32_bf16 a[76:79], a[224:227], a[108:111], 0
s_waitcnt lgkmcnt(3)
ds_read_b128 a[212:215], v3 offset:6144
v_mfma_f32_16x16x32_bf16 a[92:95], a[228:231], a[108:111], 0
buffer_load_dwordx4 a[148:151], v1, s[8:11], s59 offen offset:1024 sc1
v_mfma_f32_16x16x32_bf16 a[88:91], a[228:231], a[104:107], 0
v_mfma_f32_16x16x32_bf16 a[84:87], a[228:231], a[100:103], 0
v_mfma_f32_16x16x32_bf16 a[80:83], a[228:231], a[96:99], 0
s_waitcnt lgkmcnt(3)
ds_read_b64_tr_b16 a[216:217], v2 offset:7168
ds_read_b64_tr_b16 a[218:219], v2 offset:8960
v_mfma_f32_16x16x32_bf16 v[64:67], a[96:99], a[232:235], 0
buffer_load_dwordx4 a[152:155], v1, s[8:11], s59 offen offset:2048 sc1
v_mfma_f32_16x16x32_bf16 v[68:71], a[100:103], a[232:235], 0
v_mfma_f32_16x16x32_bf16 v[72:75], a[104:107], a[232:235], 0
v_mfma_f32_16x16x32_bf16 v[76:79], a[108:111], a[232:235], 0
s_waitcnt lgkmcnt(4)
ds_read_b64_tr_b16 a[220:221], v2 offset:21504
ds_read_b64_tr_b16 a[222:223], v2 offset:23296
v_mfma_f32_16x16x32_bf16 v[108:111], a[108:111], a[236:239], 0
buffer_load_dwordx4 a[156:159], v1, s[8:11], s59 offen offset:3072 sc1
v_mfma_f32_16x16x32_bf16 v[104:107], a[104:107], a[236:239], 0
s_add_u32 m0, s54, 69632
v_mfma_f32_16x16x32_bf16 v[100:103], a[100:103], a[236:239], 0
v_mfma_f32_16x16x32_bf16 v[96:99], a[96:99], a[236:239], 0
s_waitcnt lgkmcnt(5)
ds_read_b64_tr_b16 a[224:225], v2 offset:7200
ds_read_b64_tr_b16 a[226:227], v2 offset:8992
v_mfma_f32_16x16x32_bf16 v[80:83], a[96:99], a[208:211], 0
v_mfma_f32_16x16x32_bf16 v[84:87], a[100:103], a[208:211], 0
v_mfma_f32_16x16x32_bf16 v[88:91], a[104:107], a[208:211], 0
v_mfma_f32_16x16x32_bf16 v[92:95], a[108:111], a[208:211], 0
s_waitcnt lgkmcnt(6)
ds_read_b64_tr_b16 a[228:229], v2 offset:21536
ds_read_b64_tr_b16 a[230:231], v2 offset:23328
v_mfma_f32_16x16x32_bf16 v[124:127], a[108:111], a[212:215], 0
v_mfma_f32_16x16x32_bf16 v[120:123], a[104:107], a[212:215], 0
buffer_load_dwordx4 v7, s[12:15], s57 offen lds
v_mfma_f32_16x16x32_bf16 v[116:119], a[100:103], a[212:215], 0
v_mfma_f32_16x16x32_bf16 v[112:115], a[96:99], a[212:215], 0
s_waitcnt vmcnt(10) lgkmcnt(6)
ds_read_b64_tr_b16 a[232:233], v2 offset:7232
ds_read_b64_tr_b16 a[234:235], v2 offset:9024
v_mfma_f32_16x16x32_bf16 v[128:131], a[216:219], a[112:115], v[128:131]
v_mfma_f32_16x16x32_bf16 v[132:135], a[216:219], a[116:119], v[132:135]
v_mfma_f32_16x16x32_bf16 v[136:139], a[216:219], a[120:123], v[136:139]
buffer_load_dword a246, v13, s[40:43], s77 offen
v_mfma_f32_16x16x32_bf16 v[140:143], a[216:219], a[124:127], v[140:143]
s_waitcnt lgkmcnt(6)
ds_read_b64_tr_b16 a[236:237], v2 offset:21568
ds_read_b64_tr_b16 a[238:239], v2 offset:23360
v_mfma_f32_16x16x32_bf16 v[156:159], a[220:223], a[124:127], v[156:159]
s_add_u32 s77, s77, s76
v_mfma_f32_16x16x32_bf16 v[152:155], a[220:223], a[120:123], v[152:155]
v_mfma_f32_16x16x32_bf16 v[148:151], a[220:223], a[116:119], v[148:151]
buffer_load_dword a246, v13, s[40:43], s77 offen
v_mfma_f32_16x16x32_bf16 v[144:147], a[220:223], a[112:115], v[144:147]
s_waitcnt lgkmcnt(6)
ds_read_b64_tr_b16 a[208:209], v2 offset:7264
ds_read_b64_tr_b16 a[210:211], v2 offset:9056
v_mfma_f32_16x16x32_bf16 v[160:163], a[224:227], a[112:115], v[160:163]
s_add_u32 s77, s77, s76
s_add_u32 m0, s54, 73728
v_mfma_f32_16x16x32_bf16 v[164:167], a[224:227], a[116:119], v[164:167]
v_mfma_f32_16x16x32_bf16 v[168:171], a[224:227], a[120:123], v[168:171]
v_mfma_f32_16x16x32_bf16 v[172:175], a[224:227], a[124:127], v[172:175]
s_waitcnt lgkmcnt(6)
ds_read_b64_tr_b16 a[212:213], v2 offset:21600
ds_read_b64_tr_b16 a[214:215], v2 offset:23392
v_mfma_f32_16x16x32_bf16 v[188:191], a[228:231], a[124:127], v[188:191]
v_mfma_f32_16x16x32_bf16 v[184:187], a[228:231], a[120:123], v[184:187]
v_mfma_f32_16x16x32_bf16 v[180:183], a[228:231], a[116:119], v[180:183]
v_mfma_f32_16x16x32_bf16 v[176:179], a[228:231], a[112:115], v[176:179]
s_waitcnt lgkmcnt(6)
ds_read_b64_tr_b16 a[216:217], v2 offset:7296
ds_read_b64_tr_b16 a[218:219], v2 offset:9088
v_mfma_f32_16x16x32_bf16 v[192:195], a[232:235], a[112:115], v[192:195]
buffer_load_dwordx4 v8, s[12:15], s57 offen lds
v_mfma_f32_16x16x32_bf16 v[196:199], a[232:235], a[116:119], v[196:199]
s_movk_i32 s59, 16384
v_mfma_f32_16x16x32_bf16 v[200:203], a[232:235], a[120:123], v[200:203]
v_mfma_f32_16x16x32_bf16 v[204:207], a[232:235], a[124:127], v[204:207]
s_waitcnt lgkmcnt(6)
ds_read_b64_tr_b16 a[220:221], v2 offset:21632
ds_read_b64_tr_b16 a[222:223], v2 offset:23424
v_mfma_f32_16x16x32_bf16 v[220:223], a[236:239], a[124:127], v[220:223]
buffer_load_dwordx4 a[192:195], v1, s[8:11], s59 offen offset:0 sc1
v_mfma_f32_16x16x32_bf16 v[216:219], a[236:239], a[120:123], v[216:219]
s_add_u32 m0, s55, 65536
v_mfma_f32_16x16x32_bf16 v[212:215], a[236:239], a[116:119], v[212:215]
v_mfma_f32_16x16x32_bf16 v[208:211], a[236:239], a[112:115], v[208:211]
s_waitcnt lgkmcnt(6)
ds_read_b64_tr_b16 a[224:225], v2 offset:7328
ds_read_b64_tr_b16 a[226:227], v2 offset:9120
v_mfma_f32_16x16x32_bf16 v[224:227], a[208:211], a[112:115], v[224:227]
v_mfma_f32_16x16x32_bf16 v[228:231], a[208:211], a[116:119], v[228:231]
v_mfma_f32_16x16x32_bf16 v[232:235], a[208:211], a[120:123], v[232:235]
v_mfma_f32_16x16x32_bf16 v[236:239], a[208:211], a[124:127], v[236:239]
s_waitcnt lgkmcnt(6)
ds_read_b64_tr_b16 a[228:229], v2 offset:21664
ds_read_b64_tr_b16 a[230:231], v2 offset:23456
v_mfma_f32_16x16x32_bf16 v[252:255], a[212:215], a[124:127], v[252:255]
v_mfma_f32_16x16x32_bf16 v[248:251], a[212:215], a[120:123], v[248:251]
v_mfma_f32_16x16x32_bf16 v[244:247], a[212:215], a[116:119], v[244:247]
v_mfma_f32_16x16x32_bf16 v[240:243], a[212:215], a[112:115], v[240:243]
s_waitcnt lgkmcnt(6)
ds_read_b64_tr_b16 a[232:233], v2 offset:7360
ds_read_b64_tr_b16 a[234:235], v2 offset:9152
v_mfma_f32_16x16x32_bf16 a[0:3], a[216:219], a[112:115], a[0:3]
v_mfma_f32_16x16x32_bf16 a[4:7], a[216:219], a[116:119], a[4:7]
v_mfma_f32_16x16x32_bf16 a[8:11], a[216:219], a[120:123], a[8:11]
buffer_load_dwordx4 v9, s[20:23], s57 offen lds
v_mfma_f32_16x16x32_bf16 a[12:15], a[216:219], a[124:127], a[12:15]
s_waitcnt lgkmcnt(6)
ds_read_b64_tr_b16 a[236:237], v2 offset:21696
ds_read_b64_tr_b16 a[238:239], v2 offset:23488
v_mfma_f32_16x16x32_bf16 a[28:31], a[220:223], a[124:127], a[28:31]
v_mfma_f32_16x16x32_bf16 a[24:27], a[220:223], a[120:123], a[24:27]
v_mfma_f32_16x16x32_bf16 a[20:23], a[220:223], a[116:119], a[20:23]
buffer_load_dwordx4 a[196:199], v1, s[8:11], s59 offen offset:1024 sc1
v_mfma_f32_16x16x32_bf16 a[16:19], a[220:223], a[112:115], a[16:19]
s_waitcnt lgkmcnt(6)
ds_read_b128 a[208:211], v4 offset:0
ds_read_b128 a[212:215], v4 offset:4096
v_mfma_f32_16x16x32_bf16 a[32:35], a[224:227], a[112:115], a[32:35]
v_mfma_f32_16x16x32_bf16 a[36:39], a[224:227], a[116:119], a[36:39]
v_mfma_f32_16x16x32_bf16 a[40:43], a[224:227], a[120:123], a[40:43]
v_mfma_f32_16x16x32_bf16 a[44:47], a[224:227], a[124:127], a[44:47]
s_waitcnt lgkmcnt(6)
ds_read_b128 a[216:219], v4 offset:2048
ds_read_b128 a[220:223], v4 offset:6144
v_mfma_f32_16x16x32_bf16 a[60:63], a[228:231], a[124:127], a[60:63]
v_mfma_f32_16x16x32_bf16 a[56:59], a[228:231], a[120:123], a[56:59]
v_mfma_f32_16x16x32_bf16 a[52:55], a[228:231], a[116:119], a[52:55]
v_mfma_f32_16x16x32_bf16 a[48:51], a[228:231], a[112:115], a[48:51]
s_waitcnt lgkmcnt(6)
v_mfma_f32_16x16x32_bf16 a[64:67], a[232:235], a[112:115], a[64:67]
v_mfma_f32_16x16x32_bf16 a[68:71], a[232:235], a[116:119], a[68:71]
v_mfma_f32_16x16x32_bf16 a[72:75], a[232:235], a[120:123], a[72:75]
v_mfma_f32_16x16x32_bf16 a[76:79], a[232:235], a[124:127], a[76:79]
s_waitcnt lgkmcnt(4)
v_mfma_f32_16x16x32_bf16 a[92:95], a[236:239], a[124:127], a[92:95]
v_mfma_f32_16x16x32_bf16 a[88:91], a[236:239], a[120:123], a[88:91]
v_mfma_f32_16x16x32_bf16 a[84:87], a[236:239], a[116:119], a[84:87]
s_waitcnt lgkmcnt(0)
s_barrier
v_mfma_f32_16x16x32_bf16 a[80:83], a[236:239], a[112:115], a[80:83]
s_waitcnt lgkmcnt(3)
ds_read_b64_tr_b16 a[224:225], v2 offset:28672
ds_read_b64_tr_b16 a[226:227], v2 offset:30464
v_mfma_f32_16x16x32_bf16 v[64:67], a[112:115], a[208:211], v[64:67]
v_mfma_f32_16x16x32_bf16 v[68:71], a[116:119], a[208:211], v[68:71]
v_mfma_f32_16x16x32_bf16 v[72:75], a[120:123], a[208:211], v[72:75]
s_mov_b64 exec, 15
buffer_store_dwordx4 v[28:31], v1, s[36:39], s74 offen sc0 sc1
s_mov_b64 exec, -1
v_mfma_f32_16x16x32_bf16 v[76:79], a[124:127], a[208:211], v[76:79]
s_waitcnt lgkmcnt(4)
ds_read_b64_tr_b16 a[228:229], v2 offset:35840
ds_read_b64_tr_b16 a[230:231], v2 offset:37632
v_mfma_f32_16x16x32_bf16 v[108:111], a[124:127], a[212:215], v[108:111]
v_mfma_f32_16x16x32_bf16 v[104:107], a[120:123], a[212:215], v[104:107]
v_mfma_f32_16x16x32_bf16 v[100:103], a[116:119], a[212:215], v[100:103]
buffer_store_dwordx4 v[16:19], v55, s[48:51], s71 offen sc0 sc1
s_add_u32 m0, s54, 79872
v_mfma_f32_16x16x32_bf16 v[96:99], a[112:115], a[212:215], v[96:99]
s_waitcnt lgkmcnt(5)
ds_read_b64_tr_b16 a[232:233], v2 offset:43008
ds_read_b64_tr_b16 a[234:235], v2 offset:44800
v_mfma_f32_16x16x32_bf16 v[80:83], a[112:115], a[216:219], v[80:83]
v_mfma_f32_16x16x32_bf16 v[84:87], a[116:119], a[216:219], v[84:87]
v_mfma_f32_16x16x32_bf16 v[88:91], a[120:123], a[216:219], v[88:91]
v_mfma_f32_16x16x32_bf16 v[92:95], a[124:127], a[216:219], v[92:95]
s_waitcnt lgkmcnt(6)
ds_read_b64_tr_b16 a[236:237], v2 offset:50176
ds_read_b64_tr_b16 a[238:239], v2 offset:51968
v_mfma_f32_16x16x32_bf16 v[124:127], a[124:127], a[220:223], v[124:127]
v_mfma_f32_16x16x32_bf16 v[120:123], a[120:123], a[220:223], v[120:123]
v_mfma_f32_16x16x32_bf16 v[116:119], a[116:119], a[220:223], v[116:119]
v_mfma_f32_16x16x32_bf16 v[112:115], a[112:115], a[220:223], v[112:115]
s_waitcnt vmcnt(9) lgkmcnt(4)
ds_read_b64_tr_b16 a[208:209], v2 offset:28704
ds_read_b64_tr_b16 a[210:211], v2 offset:30496
v_mfma_f32_16x16x32_bf16 v[128:131], a[224:227], a[128:131], v[128:131]
v_mfma_f32_16x16x32_bf16 v[128:131], a[228:231], a[144:147], v[128:131]
v_mfma_f32_16x16x32_bf16 v[132:135], a[224:227], a[132:135], v[132:135]
v_mfma_f32_16x16x32_bf16 v[132:135], a[228:231], a[148:151], v[132:135]
s_waitcnt lgkmcnt(6)
ds_read_b64_tr_b16 a[212:213], v2 offset:35872
ds_read_b64_tr_b16 a[214:215], v2 offset:37664
v_mfma_f32_16x16x32_bf16 v[136:139], a[224:227], a[136:139], v[136:139]
v_mfma_f32_16x16x32_bf16 v[136:139], a[228:231], a[152:155], v[136:139]
v_mfma_f32_16x16x32_bf16 v[140:143], a[224:227], a[140:143], v[140:143]
buffer_load_dwordx4 v6, s[16:19], s57 offen lds
v_mfma_f32_16x16x32_bf16 v[140:143], a[228:231], a[156:159], v[140:143]
s_waitcnt lgkmcnt(4)
ds_read_b64_tr_b16 a[216:217], v2 offset:43040
ds_read_b64_tr_b16 a[218:219], v2 offset:44832
v_mfma_f32_16x16x32_bf16 v[156:159], a[232:235], a[140:143], v[156:159]
v_mfma_f32_16x16x32_bf16 v[156:159], a[236:239], a[156:159], v[156:159]
v_mfma_f32_16x16x32_bf16 v[152:155], a[232:235], a[136:139], v[152:155]
buffer_load_dwordx4 a[200:203], v1, s[8:11], s59 offen offset:2048 sc1
v_mfma_f32_16x16x32_bf16 v[152:155], a[236:239], a[152:155], v[152:155]
s_waitcnt lgkmcnt(6)
ds_read_b64_tr_b16 a[220:221], v2 offset:50208
ds_read_b64_tr_b16 a[222:223], v2 offset:52000
v_mfma_f32_16x16x32_bf16 v[148:151], a[232:235], a[132:135], v[148:151]
s_add_u32 m0, s54, 83968
v_mfma_f32_16x16x32_bf16 v[148:151], a[236:239], a[148:151], v[148:151]
v_mfma_f32_16x16x32_bf16 v[144:147], a[232:235], a[128:131], v[144:147]
v_mfma_f32_16x16x32_bf16 v[144:147], a[236:239], a[144:147], v[144:147]
s_waitcnt lgkmcnt(4)
ds_read_b64_tr_b16 a[224:225], v2 offset:28736
ds_read_b64_tr_b16 a[226:227], v2 offset:30528
v_mfma_f32_16x16x32_bf16 v[160:163], a[208:211], a[128:131], v[160:163]
buffer_load_dwordx4 v7, s[16:19], s57 offen lds
v_mfma_f32_16x16x32_bf16 v[160:163], a[212:215], a[144:147], v[160:163]
s_add_u32 m0, s54, 88064
v_mfma_f32_16x16x32_bf16 v[164:167], a[208:211], a[132:135], v[164:167]
v_mfma_f32_16x16x32_bf16 v[164:167], a[212:215], a[148:151], v[164:167]
s_waitcnt lgkmcnt(6)
ds_read_b64_tr_b16 a[228:229], v2 offset:35904
ds_read_b64_tr_b16 a[230:231], v2 offset:37696
v_mfma_f32_16x16x32_bf16 v[168:171], a[208:211], a[136:139], v[168:171]
buffer_load_dwordx4 v8, s[16:19], s57 offen lds
v_mfma_f32_16x16x32_bf16 v[168:171], a[212:215], a[152:155], v[168:171]
v_mfma_f32_16x16x32_bf16 v[172:175], a[208:211], a[140:143], v[172:175]
v_mfma_f32_16x16x32_bf16 v[172:175], a[212:215], a[156:159], v[172:175]
s_waitcnt lgkmcnt(4)
ds_read_b64_tr_b16 a[232:233], v2 offset:43072
ds_read_b64_tr_b16 a[234:235], v2 offset:44864
v_mfma_f32_16x16x32_bf16 v[188:191], a[216:219], a[140:143], v[188:191]
buffer_store_dwordx4 v[20:23], v55, s[48:51], s72 offen sc0 sc1
s_movk_i32 s58, 256
v_mfma_f32_16x16x32_bf16 v[188:191], a[220:223], a[156:159], v[188:191]
s_add_u32 m0, s56, 16384
v_mfma_f32_16x16x32_bf16 v[184:187], a[216:219], a[136:139], v[184:187]
v_mfma_f32_16x16x32_bf16 v[184:187], a[220:223], a[152:155], v[184:187]
s_waitcnt lgkmcnt(6)
ds_read_b64_tr_b16 a[236:237], v2 offset:50240
ds_read_b64_tr_b16 a[238:239], v2 offset:52032
v_mfma_f32_16x16x32_bf16 v[180:183], a[216:219], a[132:135], v[180:183]
v_mfma_f32_16x16x32_bf16 v[180:183], a[220:223], a[148:151], v[180:183]
v_mfma_f32_16x16x32_bf16 v[176:179], a[216:219], a[128:131], v[176:179]
v_mfma_f32_16x16x32_bf16 v[176:179], a[220:223], a[144:147], v[176:179]
s_waitcnt lgkmcnt(4)
ds_read_b64_tr_b16 a[208:209], v2 offset:28768
ds_read_b64_tr_b16 a[210:211], v2 offset:30560
v_mfma_f32_16x16x32_bf16 v[192:195], a[224:227], a[128:131], v[192:195]
v_mfma_f32_16x16x32_bf16 v[192:195], a[228:231], a[144:147], v[192:195]
v_mfma_f32_16x16x32_bf16 v[196:199], a[224:227], a[132:135], v[196:199]
v_mfma_f32_16x16x32_bf16 v[196:199], a[228:231], a[148:151], v[196:199]
s_waitcnt lgkmcnt(6)
ds_read_b64_tr_b16 a[212:213], v2 offset:35936
ds_read_b64_tr_b16 a[214:215], v2 offset:37728
v_mfma_f32_16x16x32_bf16 v[200:203], a[224:227], a[136:139], v[200:203]
v_mfma_f32_16x16x32_bf16 v[200:203], a[228:231], a[152:155], v[200:203]
v_mfma_f32_16x16x32_bf16 v[204:207], a[224:227], a[140:143], v[204:207]
v_mfma_f32_16x16x32_bf16 v[204:207], a[228:231], a[156:159], v[204:207]
s_waitcnt lgkmcnt(4)
ds_read_b64_tr_b16 a[216:217], v2 offset:43104
ds_read_b64_tr_b16 a[218:219], v2 offset:44896
v_mfma_f32_16x16x32_bf16 v[220:223], a[232:235], a[140:143], v[220:223]
buffer_load_dwordx4 v10, s[24:27], s58 offen lds
v_mfma_f32_16x16x32_bf16 v[220:223], a[236:239], a[156:159], v[220:223]
s_add_u32 m0, s56, 20480
v_mfma_f32_16x16x32_bf16 v[216:219], a[232:235], a[136:139], v[216:219]
v_mfma_f32_16x16x32_bf16 v[216:219], a[236:239], a[152:155], v[216:219]
s_waitcnt lgkmcnt(6)
ds_read_b64_tr_b16 a[220:221], v2 offset:50272
ds_read_b64_tr_b16 a[222:223], v2 offset:52064
v_mfma_f32_16x16x32_bf16 v[212:215], a[232:235], a[132:135], v[212:215]
buffer_load_dwordx4 v10, s[28:31], s58 offen lds
v_mfma_f32_16x16x32_bf16 v[212:215], a[236:239], a[148:151], v[212:215]
v_mfma_f32_16x16x32_bf16 v[208:211], a[232:235], a[128:131], v[208:211]
v_mfma_f32_16x16x32_bf16 v[208:211], a[236:239], a[144:147], v[208:211]
s_waitcnt lgkmcnt(4)
ds_read_b64_tr_b16 a[224:225], v2 offset:28800
ds_read_b64_tr_b16 a[226:227], v2 offset:30592
v_mfma_f32_16x16x32_bf16 v[224:227], a[208:211], a[128:131], v[224:227]
v_mfma_f32_16x16x32_bf16 v[224:227], a[212:215], a[144:147], v[224:227]
buffer_load_dwordx4 a[204:207], v1, s[8:11], s59 offen offset:3072 sc1
v_mfma_f32_16x16x32_bf16 v[228:231], a[208:211], a[132:135], v[228:231]
s_movk_i32 s59, 20480
v_mfma_f32_16x16x32_bf16 v[228:231], a[212:215], a[148:151], v[228:231]
s_waitcnt lgkmcnt(6)
ds_read_b64_tr_b16 a[228:229], v2 offset:35968
ds_read_b64_tr_b16 a[230:231], v2 offset:37760
v_mfma_f32_16x16x32_bf16 v[232:235], a[208:211], a[136:139], v[232:235]
v_mfma_f32_16x16x32_bf16 v[232:235], a[212:215], a[152:155], v[232:235]
buffer_load_dwordx4 a[96:99], v1, s[8:11], s59 offen offset:0 sc1
v_mfma_f32_16x16x32_bf16 v[236:239], a[208:211], a[140:143], v[236:239]
v_mfma_f32_16x16x32_bf16 v[236:239], a[212:215], a[156:159], v[236:239]
s_waitcnt lgkmcnt(4)
ds_read_b64_tr_b16 a[232:233], v2 offset:43136
ds_read_b64_tr_b16 a[234:235], v2 offset:44928
v_mfma_f32_16x16x32_bf16 v[252:255], a[216:219], a[140:143], v[252:255]
v_mfma_f32_16x16x32_bf16 v[252:255], a[220:223], a[156:159], v[252:255]
v_mfma_f32_16x16x32_bf16 v[248:251], a[216:219], a[136:139], v[248:251]
buffer_store_dwordx4 v[24:27], v55, s[48:51], s73 offen sc0 sc1
v_mfma_f32_16x16x32_bf16 v[248:251], a[220:223], a[152:155], v[248:251]
s_waitcnt lgkmcnt(6)
ds_read_b64_tr_b16 a[236:237], v2 offset:50304
ds_read_b64_tr_b16 a[238:239], v2 offset:52096
v_mfma_f32_16x16x32_bf16 v[244:247], a[216:219], a[132:135], v[244:247]
v_mfma_f32_16x16x32_bf16 v[244:247], a[220:223], a[148:151], v[244:247]
v_mfma_f32_16x16x32_bf16 v[240:243], a[216:219], a[128:131], v[240:243]
v_mfma_f32_16x16x32_bf16 v[240:243], a[220:223], a[144:147], v[240:243]
s_waitcnt lgkmcnt(4)
ds_read_b64_tr_b16 a[208:209], v2 offset:28832
ds_read_b64_tr_b16 a[210:211], v2 offset:30624
v_mfma_f32_16x16x32_bf16 a[0:3], a[224:227], a[128:131], a[0:3]
v_mfma_f32_16x16x32_bf16 a[0:3], a[228:231], a[144:147], a[0:3]
v_mfma_f32_16x16x32_bf16 a[4:7], a[224:227], a[132:135], a[4:7]
v_mfma_f32_16x16x32_bf16 a[4:7], a[228:231], a[148:151], a[4:7]
s_waitcnt lgkmcnt(6)
ds_read_b64_tr_b16 a[212:213], v2 offset:36000
ds_read_b64_tr_b16 a[214:215], v2 offset:37792
v_mfma_f32_16x16x32_bf16 a[8:11], a[224:227], a[136:139], a[8:11]
v_mfma_f32_16x16x32_bf16 a[8:11], a[228:231], a[152:155], a[8:11]
v_mfma_f32_16x16x32_bf16 a[12:15], a[224:227], a[140:143], a[12:15]
v_mfma_f32_16x16x32_bf16 a[12:15], a[228:231], a[156:159], a[12:15]
s_waitcnt lgkmcnt(4)
ds_read_b64_tr_b16 a[216:217], v2 offset:43168
ds_read_b64_tr_b16 a[218:219], v2 offset:44960
v_mfma_f32_16x16x32_bf16 a[28:31], a[232:235], a[140:143], a[28:31]
v_mfma_f32_16x16x32_bf16 a[28:31], a[236:239], a[156:159], a[28:31]
v_mfma_f32_16x16x32_bf16 a[24:27], a[232:235], a[136:139], a[24:27]
buffer_load_dwordx4 a[100:103], v1, s[8:11], s59 offen offset:1024 sc1
v_mfma_f32_16x16x32_bf16 a[24:27], a[236:239], a[152:155], a[24:27]
s_waitcnt lgkmcnt(6)
ds_read_b64_tr_b16 a[220:221], v2 offset:50336
ds_read_b64_tr_b16 a[222:223], v2 offset:52128
v_mfma_f32_16x16x32_bf16 a[20:23], a[232:235], a[132:135], a[20:23]
v_mfma_f32_16x16x32_bf16 a[20:23], a[236:239], a[148:151], a[20:23]
v_mfma_f32_16x16x32_bf16 a[16:19], a[232:235], a[128:131], a[16:19]
buffer_load_dwordx4 a[104:107], v1, s[8:11], s59 offen offset:2048 sc1
v_mfma_f32_16x16x32_bf16 a[16:19], a[236:239], a[144:147], a[16:19]
s_waitcnt lgkmcnt(4)
ds_read_b64_tr_b16 a[224:225], v2 offset:28864
ds_read_b64_tr_b16 a[226:227], v2 offset:30656
v_mfma_f32_16x16x32_bf16 a[32:35], a[208:211], a[128:131], a[32:35]
v_mfma_f32_16x16x32_bf16 a[32:35], a[212:215], a[144:147], a[32:35]
v_mfma_f32_16x16x32_bf16 a[36:39], a[208:211], a[132:135], a[36:39]
v_mfma_f32_16x16x32_bf16 a[36:39], a[212:215], a[148:151], a[36:39]
s_waitcnt lgkmcnt(6)
ds_read_b64_tr_b16 a[228:229], v2 offset:36032
ds_read_b64_tr_b16 a[230:231], v2 offset:37824
v_mfma_f32_16x16x32_bf16 a[40:43], a[208:211], a[136:139], a[40:43]
buffer_load_dwordx4 a[108:111], v1, s[8:11], s59 offen offset:3072 sc1
v_mfma_f32_16x16x32_bf16 a[40:43], a[212:215], a[152:155], a[40:43]
s_mov_b32 s57, 1376256
s_add_u32 m0, s54, 94208
v_mfma_f32_16x16x32_bf16 a[44:47], a[208:211], a[140:143], a[44:47]
v_mfma_f32_16x16x32_bf16 a[44:47], a[212:215], a[156:159], a[44:47]
s_waitcnt lgkmcnt(4)
ds_read_b64_tr_b16 a[232:233], v2 offset:43200
ds_read_b64_tr_b16 a[234:235], v2 offset:44992
v_mfma_f32_16x16x32_bf16 a[60:63], a[216:219], a[140:143], a[60:63]
buffer_load_dwordx4 v6, s[12:15], s57 offen lds
v_mfma_f32_16x16x32_bf16 a[60:63], a[220:223], a[156:159], a[60:63]
s_movk_i32 s59, 24576
v_mfma_f32_16x16x32_bf16 a[56:59], a[216:219], a[136:139], a[56:59]
v_mfma_f32_16x16x32_bf16 a[56:59], a[220:223], a[152:155], a[56:59]
s_waitcnt lgkmcnt(6)
ds_read_b64_tr_b16 a[236:237], v2 offset:50368
ds_read_b64_tr_b16 a[238:239], v2 offset:52160
v_mfma_f32_16x16x32_bf16 a[52:55], a[216:219], a[132:135], a[52:55]
buffer_load_dwordx4 a[112:115], v1, s[8:11], s59 offen offset:0 sc1
v_mfma_f32_16x16x32_bf16 a[52:55], a[220:223], a[148:151], a[52:55]
s_add_u32 m0, s54, 98304
v_mfma_f32_16x16x32_bf16 a[48:51], a[216:219], a[128:131], a[48:51]
v_mfma_f32_16x16x32_bf16 a[48:51], a[220:223], a[144:147], a[48:51]
s_waitcnt lgkmcnt(4)
ds_read_b128 a[208:211], v3 offset:8192
v_mfma_f32_16x16x32_bf16 a[64:67], a[224:227], a[128:131], a[64:67]
buffer_load_dwordx4 v7, s[12:15], s57 offen lds
v_mfma_f32_16x16x32_bf16 a[64:67], a[228:231], a[144:147], a[64:67]
v_mfma_f32_16x16x32_bf16 a[68:71], a[224:227], a[132:135], a[68:71]
v_mfma_f32_16x16x32_bf16 a[68:71], a[228:231], a[148:151], a[68:71]
ds_read_b128 a[212:215], v4 offset:8192
v_mfma_f32_16x16x32_bf16 a[72:75], a[224:227], a[136:139], a[72:75]
v_mfma_f32_16x16x32_bf16 a[72:75], a[228:231], a[152:155], a[72:75]
v_mfma_f32_16x16x32_bf16 a[76:79], a[224:227], a[140:143], a[76:79]
v_mfma_f32_16x16x32_bf16 a[76:79], a[228:231], a[156:159], a[76:79]
s_waitcnt lgkmcnt(2)
ds_read_b128 a[216:219], v3 offset:12288
v_mfma_f32_16x16x32_bf16 a[92:95], a[232:235], a[140:143], a[92:95]
v_mfma_f32_16x16x32_bf16 a[92:95], a[236:239], a[156:159], a[92:95]
v_mfma_f32_16x16x32_bf16 a[88:91], a[232:235], a[136:139], a[88:91]
v_mfma_f32_16x16x32_bf16 a[88:91], a[236:239], a[152:155], a[88:91]
ds_read_b128 a[220:223], v4 offset:12288
v_mfma_f32_16x16x32_bf16 a[84:87], a[232:235], a[132:135], a[84:87]
v_mfma_f32_16x16x32_bf16 a[84:87], a[236:239], a[148:151], a[84:87]
v_mfma_f32_16x16x32_bf16 a[80:83], a[232:235], a[128:131], a[80:83]
buffer_load_dwordx4 a[116:119], v1, s[8:11], s59 offen offset:1024 sc1
v_mfma_f32_16x16x32_bf16 a[80:83], a[236:239], a[144:147], a[80:83]
s_waitcnt lgkmcnt(2)
ds_read_b128 a[224:227], v3 offset:10240
ds_read_b128 a[228:231], v4 offset:10240
v_mfma_f32_16x16x32_bf16 v[64:67], a[128:131], a[208:211], v[64:67]
s_add_u32 m0, s54, 102400
v_mfma_f32_16x16x32_bf16 v[64:67], a[144:147], a[212:215], v[64:67]
v_mfma_f32_16x16x32_bf16 v[68:71], a[132:135], a[208:211], v[68:71]
buffer_load_dwordx4 v8, s[12:15], s57 offen lds
v_mfma_f32_16x16x32_bf16 v[68:71], a[148:151], a[212:215], v[68:71]
s_waitcnt lgkmcnt(4)
ds_read_b128 a[232:235], v3 offset:14336
ds_read_b128 a[236:239], v4 offset:14336
v_mfma_f32_16x16x32_bf16 v[72:75], a[136:139], a[208:211], v[72:75]
v_mfma_f32_16x16x32_bf16 v[72:75], a[152:155], a[212:215], v[72:75]
v_mfma_f32_16x16x32_bf16 v[76:79], a[140:143], a[208:211], v[76:79]
v_mfma_f32_16x16x32_bf16 v[76:79], a[156:159], a[212:215], v[76:79]
s_waitcnt lgkmcnt(4)
v_mfma_f32_16x16x32_bf16 v[108:111], a[140:143], a[216:219], v[108:111]
buffer_load_dwordx4 a[120:123], v1, s[8:11], s59 offen offset:2048 sc1
v_mfma_f32_16x16x32_bf16 v[108:111], a[156:159], a[220:223], v[108:111]
s_add_u32 m0, s55, 94208
v_mfma_f32_16x16x32_bf16 v[104:107], a[136:139], a[216:219], v[104:107]
v_mfma_f32_16x16x32_bf16 v[104:107], a[152:155], a[220:223], v[104:107]
v_mfma_f32_16x16x32_bf16 v[100:103], a[132:135], a[216:219], v[100:103]
buffer_load_dwordx4 v9, s[20:23], s57 offen lds
v_mfma_f32_16x16x32_bf16 v[100:103], a[148:151], a[220:223], v[100:103]
v_mfma_f32_16x16x32_bf16 v[96:99], a[128:131], a[216:219], v[96:99]
s_waitcnt vmcnt(13) lgkmcnt(0)
s_barrier
v_mfma_f32_16x16x32_bf16 v[96:99], a[144:147], a[220:223], v[96:99]
s_waitcnt lgkmcnt(2)
ds_read_b64_tr_b16 a[208:209], v5 offset:0
ds_read_b64_tr_b16 a[210:211], v5 offset:1792
v_mfma_f32_16x16x32_bf16 v[80:83], a[128:131], a[224:227], v[80:83]
s_waitcnt vmcnt(10)
v_mfma_f32_16x16x32_bf16 v[80:83], a[144:147], a[228:231], v[80:83]
s_mov_b64 exec, 1
buffer_store_dword v56, v1, s[36:39], s83 offen sc0 sc1
s_mov_b64 exec, -1
v_mfma_f32_16x16x32_bf16 v[84:87], a[132:135], a[224:227], v[84:87]
s_add_u32 m0, s54, 108544
s_movk_i32 s34, 2048
s_mov_b32 s35, 0x20000
v_mfma_f32_16x16x32_bf16 v[84:87], a[148:151], a[228:231], v[84:87]
s_waitcnt lgkmcnt(4)
ds_read_b64_tr_b16 a[212:213], v5 offset:7168
ds_read_b64_tr_b16 a[214:215], v5 offset:8960
L_tr1:
s_cbranch_execz L_tr5
v_mfma_f32_16x16x32_bf16 v[88:91], a[136:139], a[224:227], v[88:91]
s_lshl_b32 s69, s60, 5
v_add_u32 v40, s69, v48
v_lshlrev_b32 v40, 1, v40
v_mfma_f32_16x16x32_bf16 v[88:91], a[152:155], a[228:231], v[88:91]
buffer_load_dwordx4 v6, s[16:19], s57 offen lds
v_mfma_f32_16x16x32_bf16 v[92:95], a[140:143], a[224:227], v[92:95]
s_lshl_b32 s68, s53, 7
s_lshl_b32 s66, s52, 5
s_add_u32 s68, s68, s66
v_mfma_f32_16x16x32_bf16 v[92:95], a[156:159], a[228:231], v[92:95]
s_waitcnt lgkmcnt(4)
ds_read_b64_tr_b16 a[216:217], v5 offset:14336
ds_read_b64_tr_b16 a[218:219], v5 offset:16128
v_mfma_f32_16x16x32_bf16 v[124:127], a[140:143], a[232:235], v[124:127]
v_lshl_add_u32 v41, v49, 2, s68
v_accvgpr_write_b32 a255, v41
v_mfma_f32_16x16x32_bf16 v[124:127], a[156:159], a[236:239], v[124:127]
v_lshlrev_b32 v41, 1, v41
s_mov_b32 s48, s4
v_mfma_f32_16x16x32_bf16 v[120:123], a[136:139], a[232:235], v[120:123]
s_and_b32 s49, s5, 0xffff
s_mov_b32 s50, 4194304
s_mov_b32 s51, 0x20000
v_mfma_f32_16x16x32_bf16 v[120:123], a[152:155], a[236:239], v[120:123]
s_waitcnt lgkmcnt(6)
ds_read_b64_tr_b16 a[220:221], v5 offset:21504
ds_read_b64_tr_b16 a[222:223], v5 offset:23296
v_mfma_f32_16x16x32_bf16 v[116:119], a[132:135], a[232:235], v[116:119]
s_lshl_b32 s66, s63, 2
s_add_u32 s66, s66, s52
s_lshl_b32 s66, s66, 7
v_mfma_f32_16x16x32_bf16 v[116:119], a[148:151], a[236:239], v[116:119]
s_add_u32 s66, s66, 0x70000
v_and_b32 v42, 0, v0
v_lshl_add_u32 v42, v42, 7, s66
v_mfma_f32_16x16x32_bf16 v[112:115], a[128:131], a[232:235], v[112:115]
s_lshl_b32 s66, s61, 3
s_add_u32 s66, s66, s53
s_lshl_b32 s66, s66, 2
v_mfma_f32_16x16x32_bf16 v[112:115], a[144:147], a[236:239], v[112:115]
s_waitcnt vmcnt(9) lgkmcnt(4)
ds_read_b64_tr_b16 a[224:225], v5 offset:32
ds_read_b64_tr_b16 a[226:227], v5 offset:1824
v_mfma_f32_16x16x32_bf16 v[128:131], a[208:211], a[192:195], v[128:131]
s_add_u32 s66, s66, s62
s_lshl_b32 s66, s66, 10
s_lshl_b32 s67, s52, 8
v_mfma_f32_16x16x32_bf16 v[128:131], a[212:215], a[96:99], v[128:131]
s_add_u32 s66, s66, s67
s_add_u32 s66, s66, 0xb0000
v_writelane_b32 v42, s66, 0
v_mfma_f32_16x16x32_bf16 v[132:135], a[208:211], a[196:199], v[132:135]
buffer_load_dwordx4 a[124:127], v1, s[8:11], s59 offen offset:3072 sc1
v_mfma_f32_16x16x32_bf16 v[132:135], a[212:215], a[100:103], v[132:135]
s_waitcnt lgkmcnt(6)
ds_read_b64_tr_b16 a[228:229], v5 offset:7200
ds_read_b64_tr_b16 a[230:231], v5 offset:8992
v_mfma_f32_16x16x32_bf16 v[136:139], a[208:211], a[200:203], v[136:139]
s_add_u32 m0, s54, 112640
s_add_u32 s66, s66, 0
v_writelane_b32 v42, s66, 1
v_mfma_f32_16x16x32_bf16 v[136:139], a[212:215], a[104:107], v[136:139]
s_lshl_b32 s68, s68, 1
s_lshl_b32 s66, s63, 17
s_add_u32 s68, s68, s66
v_mfma_f32_16x16x32_bf16 v[140:143], a[208:211], a[204:207], v[140:143]
buffer_load_dwordx4 v7, s[16:19], s57 offen lds
v_mfma_f32_16x16x32_bf16 v[140:143], a[212:215], a[108:111], v[140:143]
s_waitcnt lgkmcnt(4)
ds_read_b64_tr_b16 a[232:233], v5 offset:14368
ds_read_b64_tr_b16 a[234:235], v5 offset:16160
v_mfma_f32_16x16x32_bf16 v[156:159], a[216:219], a[204:207], v[156:159]
s_movk_i32 s59, 28672
v_bfe_u32 v12, v0, 2, 1
v_lshlrev_b32 v12, 3, v12
v_mfma_f32_16x16x32_bf16 v[156:159], a[220:223], a[108:111], v[156:159]
v_lshl_add_u32 v12, v49, 4, v12
v_bfe_u32 v43, v0, 3, 1
v_mfma_f32_16x16x32_bf16 v[152:155], a[216:219], a[200:203], v[152:155]
v_add_u32 v12, v12, v43
v_lshl_add_u32 v12, v12, 11, s68
v_mfma_f32_16x16x32_bf16 v[152:155], a[220:223], a[104:107], v[152:155]
s_waitcnt lgkmcnt(6)
ds_read_b64_tr_b16 a[236:237], v5 offset:21536
ds_read_b64_tr_b16 a[238:239], v5 offset:23328
v_mfma_f32_16x16x32_bf16 v[148:151], a[216:219], a[196:199], v[148:151]
buffer_load_dwordx4 a[128:131], v1, s[8:11], s59 offen offset:0 sc1
v_mfma_f32_16x16x32_bf16 v[148:151], a[220:223], a[100:103], v[148:151]
s_add_u32 m0, s54, 116736
v_lshl_add_u32 v12, v51, 4, v12
s_lshr_b32 s66, s62, 1
v_mfma_f32_16x16x32_bf16 v[144:147], a[216:219], a[192:195], v[144:147]
s_lshl_b32 s66, s66, 16
s_and_b32 s71, s62, 1
s_lshl_b32 s71, s71, 12
v_mfma_f32_16x16x32_bf16 v[144:147], a[220:223], a[96:99], v[144:147]
s_waitcnt lgkmcnt(4)
ds_read_b64_tr_b16 a[208:209], v5 offset:64
ds_read_b64_tr_b16 a[210:211], v5 offset:1856
v_mfma_f32_16x16x32_bf16 v[160:163], a[224:227], a[192:195], v[160:163]
buffer_load_dwordx4 v8, s[16:19], s57 offen lds
v_mfma_f32_16x16x32_bf16 v[160:163], a[228:231], a[96:99], v[160:163]
s_movk_i32 s58, 384
s_add_u32 m0, s56, 24576
s_add_u32 s71, s71, s66
v_mfma_f32_16x16x32_bf16 v[164:167], a[224:227], a[196:199], v[164:167]
s_add_u32 s71, s71, 57344
v_mfma_f32_16x16x32_bf16 v[164:167], a[228:231], a[100:103], v[164:167]
s_waitcnt lgkmcnt(6)
ds_read_b64_tr_b16 a[212:213], v5 offset:7232
ds_read_b64_tr_b16 a[214:215], v5 offset:9024
v_mfma_f32_16x16x32_bf16 v[168:171], a[224:227], a[200:203], v[168:171]
buffer_load_dwordx4 v10, s[24:27], s58 offen lds
v_mfma_f32_16x16x32_bf16 v[168:171], a[228:231], a[104:107], v[168:171]
s_add_u32 m0, s56, 28672
v_mfma_f32_16x16x32_bf16 v[172:175], a[224:227], a[204:207], v[172:175]
v_mfma_f32_16x16x32_bf16 v[172:175], a[228:231], a[108:111], v[172:175]
s_waitcnt lgkmcnt(4)
ds_read_b64_tr_b16 a[216:217], v5 offset:14400
ds_read_b64_tr_b16 a[218:219], v5 offset:16192
v_mfma_f32_16x16x32_bf16 v[188:191], a[232:235], a[204:207], v[188:191]
buffer_load_dwordx4 v10, s[28:31], s58 offen lds
v_mfma_f32_16x16x32_bf16 v[188:191], a[236:239], a[108:111], v[188:191]
v_mfma_f32_16x16x32_bf16 v[184:187], a[232:235], a[200:203], v[184:187]
v_mfma_f32_16x16x32_bf16 v[184:187], a[236:239], a[104:107], v[184:187]
s_waitcnt lgkmcnt(6)
ds_read_b64_tr_b16 a[220:221], v5 offset:21568
ds_read_b64_tr_b16 a[222:223], v5 offset:23360
v_mfma_f32_16x16x32_bf16 v[180:183], a[232:235], a[196:199], v[180:183]
v_mfma_f32_16x16x32_bf16 v[180:183], a[236:239], a[100:103], v[180:183]
v_mfma_f32_16x16x32_bf16 v[176:179], a[232:235], a[192:195], v[176:179]
v_mfma_f32_16x16x32_bf16 v[176:179], a[236:239], a[96:99], v[176:179]
s_waitcnt lgkmcnt(4)
ds_read_b64_tr_b16 a[224:225], v5 offset:96
ds_read_b64_tr_b16 a[226:227], v5 offset:1888
v_mfma_f32_16x16x32_bf16 v[192:195], a[208:211], a[192:195], v[192:195]
v_mfma_f32_16x16x32_bf16 v[192:195], a[212:215], a[96:99], v[192:195]
v_mfma_f32_16x16x32_bf16 v[196:199], a[208:211], a[196:199], v[196:199]
v_mfma_f32_16x16x32_bf16 v[196:199], a[212:215], a[100:103], v[196:199]
s_waitcnt lgkmcnt(6)
ds_read_b64_tr_b16 a[228:229], v5 offset:7264
ds_read_b64_tr_b16 a[230:231], v5 offset:9056
v_mfma_f32_16x16x32_bf16 v[200:203], a[208:211], a[200:203], v[200:203]
v_mfma_f32_16x16x32_bf16 v[200:203], a[212:215], a[104:107], v[200:203]
v_mfma_f32_16x16x32_bf16 v[204:207], a[208:211], a[204:207], v[204:207]
buffer_load_dwordx4 a[132:135], v1, s[8:11], s59 offen offset:1024 sc1
v_mfma_f32_16x16x32_bf16 v[204:207], a[212:215], a[108:111], v[204:207]
s_waitcnt lgkmcnt(4)
ds_read_b64_tr_b16 a[232:233], v5 offset:14432
ds_read_b64_tr_b16 a[234:235], v5 offset:16224
v_mfma_f32_16x16x32_bf16 v[220:223], a[216:219], a[204:207], v[220:223]
v_mfma_f32_16x16x32_bf16 v[220:223], a[220:223], a[108:111], v[220:223]
v_mfma_f32_16x16x32_bf16 v[216:219], a[216:219], a[200:203], v[216:219]
buffer_load_dwordx4 a[136:139], v1, s[8:11], s59 offen offset:2048 sc1
v_mfma_f32_16x16x32_bf16 v[216:219], a[220:223], a[104:107], v[216:219]
s_waitcnt lgkmcnt(6)
ds_read_b64_tr_b16 a[236:237], v5 offset:21600
ds_read_b64_tr_b16 a[238:239], v5 offset:23392
v_mfma_f32_16x16x32_bf16 v[212:215], a[216:219], a[196:199], v[212:215]
v_mfma_f32_16x16x32_bf16 v[212:215], a[220:223], a[100:103], v[212:215]
v_mfma_f32_16x16x32_bf16 v[208:211], a[216:219], a[192:195], v[208:211]
v_mfma_f32_16x16x32_bf16 v[208:211], a[220:223], a[96:99], v[208:211]
s_waitcnt lgkmcnt(4)
ds_read_b64_tr_b16 a[208:209], v5 offset:128
ds_read_b64_tr_b16 a[210:211], v5 offset:1920
v_mfma_f32_16x16x32_bf16 v[224:227], a[224:227], a[192:195], v[224:227]
buffer_load_dwordx4 a[140:143], v1, s[8:11], s59 offen offset:3072 sc1
v_mfma_f32_16x16x32_bf16 v[224:227], a[228:231], a[96:99], v[224:227]
s_mov_b32 s57, 1835008
s_add_u32 m0, s54, 0
v_mfma_f32_16x16x32_bf16 v[228:231], a[224:227], a[196:199], v[228:231]
v_mfma_f32_16x16x32_bf16 v[228:231], a[228:231], a[100:103], v[228:231]
s_waitcnt lgkmcnt(6)
ds_read_b64_tr_b16 a[212:213], v5 offset:7296
ds_read_b64_tr_b16 a[214:215], v5 offset:9088
v_mfma_f32_16x16x32_bf16 v[232:235], a[224:227], a[200:203], v[232:235]
buffer_load_dwordx4 v6, s[12:15], s57 offen lds
v_mfma_f32_16x16x32_bf16 v[232:235], a[228:231], a[104:107], v[232:235]
s_add_u32 m0, s54, 4096
v_mfma_f32_16x16x32_bf16 v[236:239], a[224:227], a[204:207], v[236:239]
v_mfma_f32_16x16x32_bf16 v[236:239], a[228:231], a[108:111], v[236:239]
s_waitcnt lgkmcnt(4)
ds_read_b64_tr_b16 a[216:217], v5 offset:14464
ds_read_b64_tr_b16 a[218:219], v5 offset:16256
v_mfma_f32_16x16x32_bf16 v[252:255], a[232:235], a[204:207], v[252:255]
buffer_load_dwordx4 v7, s[12:15], s57 offen lds
v_mfma_f32_16x16x32_bf16 v[252:255], a[236:239], a[108:111], v[252:255]
s_add_u32 m0, s54, 8192
v_mfma_f32_16x16x32_bf16 v[248:251], a[232:235], a[200:203], v[248:251]
v_mfma_f32_16x16x32_bf16 v[248:251], a[236:239], a[104:107], v[248:251]
s_waitcnt lgkmcnt(6)
ds_read_b64_tr_b16 a[220:221], v5 offset:21632
ds_read_b64_tr_b16 a[222:223], v5 offset:23424
v_mfma_f32_16x16x32_bf16 v[244:247], a[232:235], a[196:199], v[244:247]
buffer_load_dwordx4 v8, s[12:15], s57 offen lds
v_mfma_f32_16x16x32_bf16 v[244:247], a[236:239], a[100:103], v[244:247]
v_mfma_f32_16x16x32_bf16 v[240:243], a[232:235], a[192:195], v[240:243]
v_mfma_f32_16x16x32_bf16 v[240:243], a[236:239], a[96:99], v[240:243]
s_waitcnt lgkmcnt(4)
ds_read_b64_tr_b16 a[224:225], v5 offset:160
ds_read_b64_tr_b16 a[226:227], v5 offset:1952
v_mfma_f32_16x16x32_bf16 a[0:3], a[208:211], a[192:195], a[0:3]
v_mfma_f32_16x16x32_bf16 a[0:3], a[212:215], a[96:99], a[0:3]
v_mfma_f32_16x16x32_bf16 a[4:7], a[208:211], a[196:199], a[4:7]
v_mfma_f32_16x16x32_bf16 a[4:7], a[212:215], a[100:103], a[4:7]
s_waitcnt lgkmcnt(6)
ds_read_b64_tr_b16 a[228:229], v5 offset:7328
ds_read_b64_tr_b16 a[230:231], v5 offset:9120
v_mfma_f32_16x16x32_bf16 a[8:11], a[208:211], a[200:203], a[8:11]
v_mfma_f32_16x16x32_bf16 a[8:11], a[212:215], a[104:107], a[8:11]
v_mfma_f32_16x16x32_bf16 a[12:15], a[208:211], a[204:207], a[12:15]
v_mfma_f32_16x16x32_bf16 a[12:15], a[212:215], a[108:111], a[12:15]
s_waitcnt lgkmcnt(4)
ds_read_b64_tr_b16 a[232:233], v5 offset:14496
ds_read_b64_tr_b16 a[234:235], v5 offset:16288
v_mfma_f32_16x16x32_bf16 a[28:31], a[216:219], a[204:207], a[28:31]
v_mfma_f32_16x16x32_bf16 a[28:31], a[220:223], a[108:111], a[28:31]
v_mfma_f32_16x16x32_bf16 a[24:27], a[216:219], a[200:203], a[24:27]
v_mfma_f32_16x16x32_bf16 a[24:27], a[220:223], a[104:107], a[24:27]
s_waitcnt lgkmcnt(6)
ds_read_b64_tr_b16 a[236:237], v5 offset:21664
ds_read_b64_tr_b16 a[238:239], v5 offset:23456
v_mfma_f32_16x16x32_bf16 a[20:23], a[216:219], a[196:199], a[20:23]
v_mfma_f32_16x16x32_bf16 a[20:23], a[220:223], a[100:103], a[20:23]
v_mfma_f32_16x16x32_bf16 a[16:19], a[216:219], a[192:195], a[16:19]
v_mfma_f32_16x16x32_bf16 a[16:19], a[220:223], a[96:99], a[16:19]
s_waitcnt lgkmcnt(4)
ds_read_b64_tr_b16 a[208:209], v5 offset:192
ds_read_b64_tr_b16 a[210:211], v5 offset:1984
v_mfma_f32_16x16x32_bf16 a[32:35], a[224:227], a[192:195], a[32:35]
buffer_load_dword a246, v13, s[40:43], s77 offen
v_mfma_f32_16x16x32_bf16 a[32:35], a[228:231], a[96:99], a[32:35]
s_add_u32 s77, s77, s76
v_mfma_f32_16x16x32_bf16 a[36:39], a[224:227], a[196:199], a[36:39]
v_mfma_f32_16x16x32_bf16 a[36:39], a[228:231], a[100:103], a[36:39]
s_waitcnt lgkmcnt(6)
ds_read_b64_tr_b16 a[212:213], v5 offset:7360
ds_read_b64_tr_b16 a[214:215], v5 offset:9152
v_mfma_f32_16x16x32_bf16 a[40:43], a[224:227], a[200:203], a[40:43]
buffer_load_dword a246, v13, s[40:43], s77 offen
v_mfma_f32_16x16x32_bf16 a[40:43], a[228:231], a[104:107], a[40:43]
s_add_u32 s77, s77, s76
v_mfma_f32_16x16x32_bf16 a[44:47], a[224:227], a[204:207], a[44:47]
v_mfma_f32_16x16x32_bf16 a[44:47], a[228:231], a[108:111], a[44:47]
s_waitcnt lgkmcnt(4)
ds_read_b64_tr_b16 a[216:217], v5 offset:14528
ds_read_b64_tr_b16 a[218:219], v5 offset:16320
v_mfma_f32_16x16x32_bf16 a[60:63], a[232:235], a[204:207], a[60:63]
s_mov_b32 s32, s96
s_and_b32 s33, s97, 0xffff
v_mfma_f32_16x16x32_bf16 a[60:63], a[236:239], a[108:111], a[60:63]
buffer_load_ushort v16, v40, s[32:35], 0 offen offset:0
v_mfma_f32_16x16x32_bf16 a[56:59], a[232:235], a[200:203], a[56:59]
v_mfma_f32_16x16x32_bf16 a[56:59], a[236:239], a[104:107], a[56:59]
s_waitcnt lgkmcnt(6)
ds_read_b64_tr_b16 a[220:221], v5 offset:21696
ds_read_b64_tr_b16 a[222:223], v5 offset:23488
v_mfma_f32_16x16x32_bf16 a[52:55], a[232:235], a[196:199], a[52:55]
v_mfma_f32_16x16x32_bf16 a[52:55], a[236:239], a[100:103], a[52:55]
buffer_load_ushort v17, v40, s[32:35], 0 offen offset:32
v_mfma_f32_16x16x32_bf16 a[48:51], a[232:235], a[192:195], a[48:51]
s_mov_b32 s32, s98
s_and_b32 s33, s99, 0xffff
v_mfma_f32_16x16x32_bf16 a[48:51], a[236:239], a[96:99], a[48:51]
s_waitcnt lgkmcnt(4)
ds_read_b128 a[224:227], v3 offset:16384
v_mfma_f32_16x16x32_bf16 a[64:67], a[208:211], a[192:195], a[64:67]
v_mfma_f32_16x16x32_bf16 a[64:67], a[212:215], a[96:99], a[64:67]
buffer_load_ushort v18, v40, s[32:35], 0 offen offset:0
v_mfma_f32_16x16x32_bf16 a[68:71], a[208:211], a[196:199], a[68:71]
v_mfma_f32_16x16x32_bf16 a[68:71], a[212:215], a[100:103], a[68:71]
ds_read_b128 a[228:231], v4 offset:16384
v_mfma_f32_16x16x32_bf16 a[72:75], a[208:211], a[200:203], a[72:75]
v_mfma_f32_16x16x32_bf16 a[72:75], a[212:215], a[104:107], a[72:75]
buffer_load_ushort v19, v40, s[32:35], 0 offen offset:32
v_mfma_f32_16x16x32_bf16 a[76:79], a[208:211], a[204:207], a[76:79]
s_mov_b32 s32, s92
s_and_b32 s33, s93, 0xffff
v_mfma_f32_16x16x32_bf16 a[76:79], a[212:215], a[108:111], a[76:79]
s_waitcnt lgkmcnt(2)
ds_read_b128 a[232:235], v3 offset:20480
v_mfma_f32_16x16x32_bf16 a[92:95], a[216:219], a[204:207], a[92:95]
v_mfma_f32_16x16x32_bf16 a[92:95], a[220:223], a[108:111], a[92:95]
buffer_load_ushort v20, v40, s[32:35], 0 offen offset:0
v_mfma_f32_16x16x32_bf16 a[88:91], a[216:219], a[200:203], a[88:91]
v_mfma_f32_16x16x32_bf16 a[88:91], a[220:223], a[104:107], a[88:91]
ds_read_b128 a[236:239], v4 offset:20480
v_mfma_f32_16x16x32_bf16 a[84:87], a[216:219], a[196:199], a[84:87]
v_mfma_f32_16x16x32_bf16 a[84:87], a[220:223], a[100:103], a[84:87]
buffer_load_ushort v21, v40, s[32:35], 0 offen offset:32
v_mfma_f32_16x16x32_bf16 a[80:83], a[216:219], a[192:195], a[80:83]
s_mov_b32 s32, s94
s_and_b32 s33, s95, 0xffff
v_mfma_f32_16x16x32_bf16 a[80:83], a[220:223], a[96:99], a[80:83]
s_waitcnt lgkmcnt(2)
ds_read_b128 a[208:211], v3 offset:18432
ds_read_b128 a[212:215], v4 offset:18432
v_mfma_f32_16x16x32_bf16 v[64:67], a[192:195], a[224:227], v[64:67]
v_mfma_f32_16x16x32_bf16 v[64:67], a[96:99], a[228:231], v[64:67]
buffer_load_dwordx2 a[248:249], v41, s[32:35], 0 offen offset:0
v_mfma_f32_16x16x32_bf16 v[68:71], a[196:199], a[224:227], v[68:71]
v_mfma_f32_16x16x32_bf16 v[68:71], a[100:103], a[228:231], v[68:71]
s_waitcnt lgkmcnt(4)
ds_read_b128 a[216:219], v3 offset:22528
ds_read_b128 a[220:223], v4 offset:22528
v_mfma_f32_16x16x32_bf16 v[72:75], a[200:203], a[224:227], v[72:75]
v_mfma_f32_16x16x32_bf16 v[72:75], a[104:107], a[228:231], v[72:75]
buffer_load_dwordx2 a[250:251], v41, s[32:35], 0 offen offset:32
v_mfma_f32_16x16x32_bf16 v[76:79], a[204:207], a[224:227], v[76:79]
v_mfma_f32_16x16x32_bf16 v[76:79], a[108:111], a[228:231], v[76:79]
s_waitcnt lgkmcnt(4)
v_mfma_f32_16x16x32_bf16 v[108:111], a[204:207], a[232:235], v[108:111]
v_mfma_f32_16x16x32_bf16 v[108:111], a[108:111], a[236:239], v[108:111]
buffer_load_dword a246, v42, s[36:39], 0 offen sc0 sc1
v_mfma_f32_16x16x32_bf16 v[104:107], a[200:203], a[232:235], v[104:107]
s_add_u32 m0, s55, 0
v_subrev_u32 v40, 131072, v3
v_accvgpr_write_b32 a253, v40
v_mfma_f32_16x16x32_bf16 v[104:107], a[104:107], a[236:239], v[104:107]
s_mul_i32 s69, s62, 8192
s_add_u32 s69, s69, 133120
v_and_b32 v41, 1, v49
v_mfma_f32_16x16x32_bf16 v[100:103], a[196:199], a[232:235], v[100:103]
v_xor_b32 v41, v41, v51
v_lshlrev_b32 v40, 5, v11
v_mfma_f32_16x16x32_bf16 v[100:103], a[100:103], a[236:239], v[100:103]
buffer_load_dwordx4 v9, s[20:23], s57 offen lds
v_mfma_f32_16x16x32_bf16 v[96:99], a[192:195], a[232:235], v[96:99]
s_waitcnt vmcnt(18) lgkmcnt(0)
s_barrier
s_add_u32 m0, s54, 14336
v_mfma_f32_16x16x32_bf16 v[96:99], a[96:99], a[236:239], v[96:99]
s_waitcnt lgkmcnt(2)
ds_read_b64_tr_b16 a[224:225], v5 offset:28672
ds_read_b64_tr_b16 a[226:227], v5 offset:30464
v_mfma_f32_16x16x32_bf16 v[80:83], a[192:195], a[208:211], v[80:83]
v_lshl_add_u32 v40, v41, 3, v40
v_add_u32 v40, s69, v40
v_mfma_f32_16x16x32_bf16 v[80:83], a[96:99], a[212:215], v[80:83]
buffer_load_dwordx4 v6, s[16:19], s57 offen lds
v_mfma_f32_16x16x32_bf16 v[84:87], a[196:199], a[208:211], v[84:87]
v_accvgpr_write_b32 a244, v40
v_lshrrev_b32 v40, 1, v48
v_mfma_f32_16x16x32_bf16 v[84:87], a[100:103], a[212:215], v[84:87]
s_waitcnt lgkmcnt(4)
ds_read_b64_tr_b16 a[228:229], v5 offset:35840
ds_read_b64_tr_b16 a[230:231], v5 offset:37632
v_mfma_f32_16x16x32_bf16 v[88:91], a[200:203], a[208:211], v[88:91]
v_xor_b32 v40, v40, v48
v_and_b32 v40, 4, v40
v_mfma_f32_16x16x32_bf16 v[88:91], a[104:107], a[212:215], v[88:91]
v_mul_u32_u24 v40, 3, v40
v_xor_b32 v40, v40, v48
v_mfma_f32_16x16x32_bf16 v[92:95], a[204:207], a[208:211], v[92:95]
v_lshrrev_b32 v41, 2, v40
v_xor_b32 v41, v41, v49
v_mfma_f32_16x16x32_bf16 v[92:95], a[108:111], a[212:215], v[92:95]
s_waitcnt lgkmcnt(4)
ds_read_b64_tr_b16 a[232:233], v5 offset:43008
ds_read_b64_tr_b16 a[234:235], v5 offset:44800
v_mfma_f32_16x16x32_bf16 v[124:127], a[204:207], a[216:219], v[124:127]
v_lshlrev_b32 v40, 5, v40
v_lshl_add_u32 v40, v41, 3, v40
v_mfma_f32_16x16x32_bf16 v[124:127], a[108:111], a[220:223], v[124:127]
v_add_u32 v40, s69, v40
v_accvgpr_write_b32 a243, v40
v_mfma_f32_16x16x32_bf16 v[120:123], a[200:203], a[216:219], v[120:123]
v_lshrrev_b32 v40, 2, v0
v_and_b32 v41, 7, v40
v_mfma_f32_16x16x32_bf16 v[120:123], a[104:107], a[220:223], v[120:123]
s_waitcnt lgkmcnt(6)
ds_read_b64_tr_b16 a[236:237], v5 offset:50176
ds_read_b64_tr_b16 a[238:239], v5 offset:51968
v_mfma_f32_16x16x32_bf16 v[116:119], a[196:199], a[216:219], v[116:119]
v_lshlrev_b32 v41, 5, v41
v_lshl_add_u32 v41, v40, 8, v41
v_mfma_f32_16x16x32_bf16 v[116:119], a[100:103], a[220:223], v[116:119]
v_lshl_add_u32 v41, v51, 3, v41
v_accvgpr_write_b32 a242, v41
v_mfma_f32_16x16x32_bf16 v[112:115], a[192:195], a[216:219], v[112:115]
buffer_load_dword v61, v60, s[36:39], s81 offen sc0 sc1
v_mfma_f32_16x16x32_bf16 v[112:115], a[96:99], a[220:223], v[112:115]
s_waitcnt vmcnt(17) lgkmcnt(4)
ds_read_b64_tr_b16 a[208:209], v5 offset:28704
ds_read_b64_tr_b16 a[210:211], v5 offset:30496
v_mfma_f32_16x16x32_bf16 v[128:131], a[224:227], a[112:115], v[128:131]
s_add_u32 m0, s54, 18432
s_lshl_b32 s68, s62, 2
v_add_u32 v40, s68, v49
v_mfma_f32_16x16x32_bf16 v[128:131], a[228:231], a[128:131], v[128:131]
v_and_b32 v41, 7, v40
v_bfe_u32 v51, v0, 1, 3
v_mfma_f32_16x16x32_bf16 v[132:135], a[224:227], a[116:119], v[132:135]
buffer_load_dwordx4 v7, s[16:19], s57 offen lds
v_mfma_f32_16x16x32_bf16 v[132:135], a[228:231], a[132:135], v[132:135]
s_waitcnt lgkmcnt(6)
ds_read_b64_tr_b16 a[212:213], v5 offset:35872
ds_read_b64_tr_b16 a[214:215], v5 offset:37664
v_mfma_f32_16x16x32_bf16 v[136:139], a[224:227], a[120:123], v[136:139]
s_add_u32 m0, s54, 22528
v_xor_b32 v41, v41, v51
s_lshl_b32 s66, s52, 1
v_mfma_f32_16x16x32_bf16 v[136:139], a[228:231], a[136:139], v[136:139]
v_xor_b32 v41, s66, v41
v_lshlrev_b32 v41, 5, v41
v_mfma_f32_16x16x32_bf16 v[140:143], a[224:227], a[124:127], v[140:143]
v_and_b32 v51, 1, v0
v_lshl_add_u32 v41, v51, 4, v41
v_mfma_f32_16x16x32_bf16 v[140:143], a[228:231], a[140:143], v[140:143]
s_waitcnt lgkmcnt(4)
ds_read_b64_tr_b16 a[216:217], v5 offset:43040
ds_read_b64_tr_b16 a[218:219], v5 offset:44832
v_mfma_f32_16x16x32_bf16 v[156:159], a[232:235], a[124:127], v[156:159]
buffer_load_dwordx4 v8, s[16:19], s57 offen lds
v_mfma_f32_16x16x32_bf16 v[156:159], a[236:239], a[140:143], v[156:159]
s_movk_i32 s58, 512
s_add_u32 m0, s56, 0
s_mul_i32 s67, s52, 896
v_mfma_f32_16x16x32_bf16 v[152:155], a[232:235], a[120:123], v[152:155]
v_add_u32 v40, s67, v40
v_lshl_add_u32 v40, v40, 11, v41
v_mfma_f32_16x16x32_bf16 v[152:155], a[236:239], a[136:139], v[152:155]
s_waitcnt lgkmcnt(6)
ds_read_b64_tr_b16 a[220:221], v5 offset:50208
ds_read_b64_tr_b16 a[222:223], v5 offset:52000
v_mfma_f32_16x16x32_bf16 v[148:151], a[232:235], a[116:119], v[148:151]
buffer_load_dwordx4 v10, s[24:27], s58 offen lds
v_mfma_f32_16x16x32_bf16 v[148:151], a[236:239], a[132:135], v[148:151]
s_mov_b32 s70, 0
s_add_u32 m0, s71, 0
s_lshl_b32 s67, s53, 8
v_mfma_f32_16x16x32_bf16 v[144:147], a[232:235], a[112:115], v[144:147]
v_add_u32 v40, s67, v40
v_accvgpr_write_b32 a240, v40
v_mfma_f32_16x16x32_bf16 v[144:147], a[236:239], a[128:131], v[144:147]
s_waitcnt lgkmcnt(4)
ds_read_b64_tr_b16 a[224:225], v5 offset:28736
ds_read_b64_tr_b16 a[226:227], v5 offset:30528
v_mfma_f32_16x16x32_bf16 v[160:163], a[208:211], a[112:115], v[160:163]
s_lshl_b32 s68, s53, 18
s_lshl_b32 s66, s52, 9
s_add_u32 s68, s68, s66
v_mfma_f32_16x16x32_bf16 v[160:163], a[212:215], a[128:131], v[160:163]
v_add_u32 v40, s68, v47
v_accvgpr_write_b32 a252, v40
v_mfma_f32_16x16x32_bf16 v[164:167], a[208:211], a[116:119], v[164:167]
v_lshlrev_b32 v40, 4, v50
v_lshl_add_u32 v40, v51, 3, v40
v_mfma_f32_16x16x32_bf16 v[164:167], a[212:215], a[132:135], v[164:167]
s_waitcnt lgkmcnt(6)
ds_read_b64_tr_b16 a[228:229], v5 offset:35904
ds_read_b64_tr_b16 a[230:231], v5 offset:37696
v_mfma_f32_16x16x32_bf16 v[168:171], a[208:211], a[120:123], v[168:171]
v_bfe_u32 v41, v48, 1, 1
s_lshl_b32 s68, s63, 6
v_mfma_f32_16x16x32_bf16 v[168:171], a[212:215], a[136:139], v[168:171]
buffer_load_dwordx4 v12, s[48:51], s70 offen lds
v_mfma_f32_16x16x32_bf16 v[172:175], a[208:211], a[124:127], v[172:175]
s_add_u32 m0, s56, 4096
v_add3_u32 v40, v40, v41, s68
v_accvgpr_write_b32 a254, v40
v_mfma_f32_16x16x32_bf16 v[172:175], a[212:215], a[140:143], v[172:175]
s_waitcnt lgkmcnt(4)
ds_read_b64_tr_b16 a[232:233], v5 offset:43072
ds_read_b64_tr_b16 a[234:235], v5 offset:44864
v_mfma_f32_16x16x32_bf16 v[188:191], a[216:219], a[124:127], v[188:191]
s_sub_u32 s68, 32, s63
s_lshl_b32 s68, s68, 13
s_lshl_b32 s66, s60, 8
v_mfma_f32_16x16x32_bf16 v[188:191], a[220:223], a[140:143], v[188:191]
buffer_load_dwordx4 v10, s[28:31], s58 offen lds
v_mfma_f32_16x16x32_bf16 v[184:187], a[216:219], a[120:123], v[184:187]
s_movk_i32 s70, 4096
s_add_u32 m0, s71, 1024
s_add_u32 s68, s68, s66
v_mfma_f32_16x16x32_bf16 v[184:187], a[220:223], a[136:139], v[184:187]
s_waitcnt lgkmcnt(6)
ds_read_b64_tr_b16 a[236:237], v5 offset:50240
ds_read_b64_tr_b16 a[238:239], v5 offset:52032
v_mfma_f32_16x16x32_bf16 v[180:183], a[216:219], a[116:119], v[180:183]
v_lshl_add_u32 v40, v48, 4, s68
v_lshl_add_u32 v40, v49, 16, v40
v_mfma_f32_16x16x32_bf16 v[180:183], a[220:223], a[132:135], v[180:183]
v_accvgpr_write_b32 a245, v40
s_lshr_b32 s67, s2, 0
v_mfma_f32_16x16x32_bf16 v[176:179], a[216:219], a[112:115], v[176:179]
s_lshl_b32 s68, s67, 1
s_and_b32 s66, s62, 1
s_add_u32 s68, s68, s66
v_mfma_f32_16x16x32_bf16 v[176:179], a[220:223], a[128:131], v[176:179]
s_waitcnt lgkmcnt(4)
ds_read_b64_tr_b16 a[208:209], v5 offset:28768
ds_read_b64_tr_b16 a[210:211], v5 offset:30560
v_mfma_f32_16x16x32_bf16 v[192:195], a[224:227], a[112:115], v[192:195]
s_mul_i32 s68, s68, 3584
s_mul_i32 s66, s67, 2048
v_mfma_f32_16x16x32_bf16 v[192:195], a[228:231], a[128:131], v[192:195]
s_cmp_ge_u32 s62, 2
s_cselect_b32 s68, s66, s68
s_cselect_b32 s66, 15, 27
v_mfma_f32_16x16x32_bf16 v[196:199], a[224:227], a[116:119], v[196:199]
v_min_u32 v40, s66, v0
v_lshl_add_u32 v14, v40, 7, s68
v_mfma_f32_16x16x32_bf16 v[196:199], a[228:231], a[132:135], v[196:199]
s_waitcnt lgkmcnt(6)
ds_read_b64_tr_b16 a[212:213], v5 offset:35936
ds_read_b64_tr_b16 a[214:215], v5 offset:37728
v_mfma_f32_16x16x32_bf16 v[200:203], a[224:227], a[120:123], v[200:203]
s_bitcmp1_b32 s62, 0
s_cselect_b32 s68, s90, s88
s_cselect_b32 s66, s91, s89
v_mfma_f32_16x16x32_bf16 v[200:203], a[228:231], a[136:139], v[200:203]
s_cmp_ge_u32 s62, 2
s_cselect_b32 s44, s68, s84
s_cselect_b32 s45, s66, s85
v_mfma_f32_16x16x32_bf16 v[204:207], a[224:227], a[124:127], v[204:207]
s_mov_b32 s67, 7340032
s_mov_b32 s68, 1835008
v_mfma_f32_16x16x32_bf16 v[204:207], a[228:231], a[140:143], v[204:207]
s_waitcnt lgkmcnt(4)
ds_read_b64_tr_b16 a[216:217], v5 offset:43104
ds_read_b64_tr_b16 a[218:219], v5 offset:44896
v_mfma_f32_16x16x32_bf16 v[220:223], a[232:235], a[124:127], v[220:223]
buffer_load_dwordx4 v12, s[48:51], s70 offen lds
v_mfma_f32_16x16x32_bf16 v[220:223], a[236:239], a[140:143], v[220:223]
s_cmp_ge_u32 s62, 2
s_cselect_b32 s46, 2097152, s67
s_cselect_b32 s80, 524288, s68
v_mfma_f32_16x16x32_bf16 v[216:219], a[232:235], a[120:123], v[216:219]
s_and_b32 s45, s45, 0xffff
s_mov_b32 s47, 0x20000
s_mov_b32 s78, 0
v_mfma_f32_16x16x32_bf16 v[216:219], a[236:239], a[136:139], v[216:219]
s_waitcnt lgkmcnt(6)
ds_read_b64_tr_b16 a[220:221], v5 offset:50272
ds_read_b64_tr_b16 a[222:223], v5 offset:52064
v_mfma_f32_16x16x32_bf16 v[212:215], a[232:235], a[116:119], v[212:215]
s_waitcnt vmcnt(6)
v_mfma_f32_16x16x32_bf16 v[212:215], a[236:239], a[132:135], v[212:215]
P1c_chk:
v_cmp_ne_u32 vcc, s3, v61
s_nop 0
s_and_b64 vcc, vcc, exec
s_cbranch_scc1 P1c_retry
P1c_ok:
v_mfma_f32_16x16x32_bf16 v[208:211], a[232:235], a[112:115], v[208:211]
s_mov_b32 s59, 32768
v_mfma_f32_16x16x32_bf16 v[208:211], a[236:239], a[128:131], v[208:211]
s_waitcnt lgkmcnt(4)
ds_read_b64_tr_b16 a[224:225], v5 offset:28800
ds_read_b64_tr_b16 a[226:227], v5 offset:30592
v_mfma_f32_16x16x32_bf16 v[224:227], a[208:211], a[112:115], v[224:227]
buffer_load_dwordx4 a[144:147], v1, s[8:11], s59 offen offset:0 sc1
v_mfma_f32_16x16x32_bf16 v[224:227], a[212:215], a[128:131], v[224:227]
v_mfma_f32_16x16x32_bf16 v[228:231], a[208:211], a[116:119], v[228:231]
v_mfma_f32_16x16x32_bf16 v[228:231], a[212:215], a[132:135], v[228:231]
s_waitcnt lgkmcnt(6)
ds_read_b64_tr_b16 a[228:229], v5 offset:35968
ds_read_b64_tr_b16 a[230:231], v5 offset:37760
v_mfma_f32_16x16x32_bf16 v[232:235], a[208:211], a[120:123], v[232:235]
buffer_load_dwordx4 a[148:151], v1, s[8:11], s59 offen offset:1024 sc1
v_mfma_f32_16x16x32_bf16 v[232:235], a[212:215], a[136:139], v[232:235]
v_mfma_f32_16x16x32_bf16 v[236:239], a[208:211], a[124:127], v[236:239]
v_mfma_f32_16x16x32_bf16 v[236:239], a[212:215], a[140:143], v[236:239]
s_waitcnt lgkmcnt(4)
ds_read_b64_tr_b16 a[232:233], v5 offset:43136
ds_read_b64_tr_b16 a[234:235], v5 offset:44928
v_mfma_f32_16x16x32_bf16 v[252:255], a[216:219], a[124:127], v[252:255]
buffer_load_dwordx4 a[152:155], v1, s[8:11], s59 offen offset:2048 sc1
v_mfma_f32_16x16x32_bf16 v[252:255], a[220:223], a[140:143], v[252:255]
s_movk_i32 s70, 8192
s_add_u32 m0, s71, 2048
v_mfma_f32_16x16x32_bf16 v[248:251], a[216:219], a[120:123], v[248:251]
v_mfma_f32_16x16x32_bf16 v[248:251], a[220:223], a[136:139], v[248:251]
s_waitcnt lgkmcnt(6)
ds_read_b64_tr_b16 a[236:237], v5 offset:50304
ds_read_b64_tr_b16 a[238:239], v5 offset:52096
v_mfma_f32_16x16x32_bf16 v[244:247], a[216:219], a[116:119], v[244:247]
buffer_load_dwordx4 v12, s[48:51], s70 offen lds
v_mfma_f32_16x16x32_bf16 v[244:247], a[220:223], a[132:135], v[244:247]
v_mfma_f32_16x16x32_bf16 v[240:243], a[216:219], a[112:115], v[240:243]
v_mfma_f32_16x16x32_bf16 v[240:243], a[220:223], a[128:131], v[240:243]
s_waitcnt lgkmcnt(4)
ds_read_b64_tr_b16 a[208:209], v5 offset:28832
ds_read_b64_tr_b16 a[210:211], v5 offset:30624
v_mfma_f32_16x16x32_bf16 a[0:3], a[224:227], a[112:115], a[0:3]
buffer_load_dwordx4 a[156:159], v1, s[8:11], s59 offen offset:3072 sc1
v_mfma_f32_16x16x32_bf16 a[0:3], a[228:231], a[128:131], a[0:3]
L_tr2:
s_cbranch_execz L_tr6
s_mov_b32 s59, 36864
v_mfma_f32_16x16x32_bf16 a[4:7], a[224:227], a[116:119], a[4:7]
v_mfma_f32_16x16x32_bf16 a[4:7], a[228:231], a[132:135], a[4:7]
s_waitcnt lgkmcnt(6)
ds_read_b64_tr_b16 a[212:213], v5 offset:36000
ds_read_b64_tr_b16 a[214:215], v5 offset:37792
v_mfma_f32_16x16x32_bf16 a[8:11], a[224:227], a[120:123], a[8:11]
v_lshlrev_b32 v40, 16, v16
v_lshlrev_b32 v41, 16, v17
v_mfma_f32_16x16x32_bf16 a[8:11], a[228:231], a[136:139], a[8:11]
v_lshlrev_b32 v42, 16, v18
v_lshlrev_b32 v43, 16, v19
v_mfma_f32_16x16x32_bf16 a[12:15], a[224:227], a[124:127], a[12:15]
v_lshlrev_b32 v44, 16, v20
v_lshlrev_b32 v45, 16, v21
v_mfma_f32_16x16x32_bf16 a[12:15], a[228:231], a[140:143], a[12:15]
s_waitcnt lgkmcnt(4)
ds_read_b64_tr_b16 a[216:217], v5 offset:43168
ds_read_b64_tr_b16 a[218:219], v5 offset:44960
v_mfma_f32_16x16x32_bf16 a[28:31], a[232:235], a[124:127], a[28:31]
v_mul_f32 v44, 0x3fb8aa3b, v44
v_mul_f32 v45, 0x3fb8aa3b, v45
v_mfma_f32_16x16x32_bf16 a[28:31], a[236:239], a[140:143], a[28:31]
v_exp_f32 v44, v44
v_mfma_f32_16x16x32_bf16 a[24:27], a[232:235], a[120:123], a[24:27]
v_exp_f32 v45, v45
v_mfma_f32_16x16x32_bf16 a[24:27], a[236:239], a[136:139], a[24:27]
s_waitcnt lgkmcnt(6)
ds_read_b64_tr_b16 a[220:221], v5 offset:50336
ds_read_b64_tr_b16 a[222:223], v5 offset:52128
v_mfma_f32_16x16x32_bf16 a[20:23], a[232:235], a[116:119], a[20:23]
buffer_load_dwordx4 a[192:195], v1, s[8:11], s59 offen offset:0 sc1
v_mfma_f32_16x16x32_bf16 a[20:23], a[236:239], a[132:135], a[20:23]
s_movk_i32 s70, 12288
s_add_u32 m0, s71, 3072
v_cvt_pk_bf16_f32 v45, v44, v45
v_mfma_f32_16x16x32_bf16 a[16:19], a[232:235], a[112:115], a[16:19]
v_lshlrev_b32 v44, 16, v45
v_and_b32 v45, 0xffff0000, v45
v_mfma_f32_16x16x32_bf16 a[16:19], a[236:239], a[128:131], a[16:19]
s_waitcnt lgkmcnt(4)
ds_read_b64_tr_b16 a[224:225], v5 offset:28864
ds_read_b64_tr_b16 a[226:227], v5 offset:30656
v_mfma_f32_16x16x32_bf16 a[32:35], a[208:211], a[112:115], a[32:35]
buffer_load_dwordx4 v12, s[48:51], s70 offen lds
v_mfma_f32_16x16x32_bf16 a[32:35], a[212:215], a[128:131], a[32:35]
v_mul_f32 v24, v44, v40
v_mul_f32 v26, v44, v42
v_mfma_f32_16x16x32_bf16 a[36:39], a[208:211], a[116:119], a[36:39]
v_mul_f32 v25, v45, v41
v_mul_f32 v27, v45, v43
v_mfma_f32_16x16x32_bf16 a[36:39], a[212:215], a[132:135], a[36:39]
s_waitcnt lgkmcnt(6)
ds_read_b64_tr_b16 a[228:229], v5 offset:36032
ds_read_b64_tr_b16 a[230:231], v5 offset:37824
v_mfma_f32_16x16x32_bf16 a[40:43], a[208:211], a[120:123], a[40:43]
v_mul_f32 v24, 0x3fb8aa3b, v24
v_mul_f32 v25, 0x3fb8aa3b, v25
v_mfma_f32_16x16x32_bf16 a[40:43], a[212:215], a[136:139], a[40:43]
buffer_load_dwordx4 a[196:199], v1, s[8:11], s59 offen offset:1024 sc1
v_mfma_f32_16x16x32_bf16 a[44:47], a[208:211], a[124:127], a[44:47]
v_exp_f32 v24, v24
v_mfma_f32_16x16x32_bf16 a[44:47], a[212:215], a[140:143], a[44:47]
s_waitcnt lgkmcnt(4)
ds_read_b64_tr_b16 a[232:233], v5 offset:43200
ds_read_b64_tr_b16 a[234:235], v5 offset:44992
v_mfma_f32_16x16x32_bf16 a[60:63], a[216:219], a[124:127], a[60:63]
v_exp_f32 v25, v25
v_mfma_f32_16x16x32_bf16 a[60:63], a[220:223], a[140:143], a[60:63]
buffer_load_dwordx4 a[200:203], v1, s[8:11], s59 offen offset:2048 sc1
v_mfma_f32_16x16x32_bf16 a[56:59], a[216:219], a[120:123], a[56:59]
v_mul_f32 v26, 0.15915494, v26
v_rndne_f32 v52, v26
v_mfma_f32_16x16x32_bf16 a[56:59], a[220:223], a[136:139], a[56:59]
s_waitcnt lgkmcnt(6)
ds_read_b64_tr_b16 a[236:237], v5 offset:50368
ds_read_b64_tr_b16 a[238:239], v5 offset:52160
v_mfma_f32_16x16x32_bf16 a[52:55], a[216:219], a[116:119], a[52:55]
v_sub_f32 v26, v26, v52
v_mul_f32 v27, 0.15915494, v27
v_mfma_f32_16x16x32_bf16 a[52:55], a[220:223], a[132:135], a[52:55]
v_rndne_f32 v53, v27
v_sub_f32 v27, v27, v53
v_mfma_f32_16x16x32_bf16 a[48:51], a[216:219], a[112:115], a[48:51]
buffer_load_dwordx4 a[204:207], v1, s[8:11], s59 offen offset:3072 sc1
v_mfma_f32_16x16x32_bf16 a[48:51], a[220:223], a[128:131], a[48:51]
s_waitcnt lgkmcnt(4)
ds_read_b128 a[208:211], v3 offset:24576
s_mov_b32 s57, 2293760
v_mfma_f32_16x16x32_bf16 a[64:67], a[224:227], a[112:115], a[64:67]
s_add_u32 m0, s54, 28672
v_cos_f32 v52, v26
v_mfma_f32_16x16x32_bf16 a[64:67], a[228:231], a[128:131], a[64:67]
v_sin_f32 v54, v26
v_mfma_f32_16x16x32_bf16 a[68:71], a[224:227], a[116:119], a[68:71]
buffer_load_dwordx4 v6, s[12:15], s57 offen lds
v_mfma_f32_16x16x32_bf16 a[68:71], a[228:231], a[132:135], a[68:71]
ds_read_b128 a[212:215], v4 offset:24576
s_mov_b32 s59, 40960
v_mfma_f32_16x16x32_bf16 a[72:75], a[224:227], a[120:123], a[72:75]
v_cos_f32 v53, v27
v_mfma_f32_16x16x32_bf16 a[72:75], a[228:231], a[136:139], a[72:75]
v_sin_f32 v55, v27
v_mfma_f32_16x16x32_bf16 a[76:79], a[224:227], a[124:127], a[76:79]
v_mul_f32 v16, v24, v52
v_mul_f32 v54, v24, v54
v_mfma_f32_16x16x32_bf16 a[76:79], a[228:231], a[140:143], a[76:79]
s_waitcnt lgkmcnt(2)
ds_read_b128 a[216:219], v3 offset:28672
v_add_f32 v52, -1.0, v16
v_mfma_f32_16x16x32_bf16 a[92:95], a[232:235], a[124:127], a[92:95]
v_mul_f32 v17, v25, v53
v_mul_f32 v55, v25, v55
v_mfma_f32_16x16x32_bf16 a[92:95], a[236:239], a[140:143], a[92:95]
v_add_f32 v53, -1.0, v17
v_mul_f32 v24, v40, v40
v_mfma_f32_16x16x32_bf16 a[88:91], a[232:235], a[120:123], a[88:91]
v_fmac_f32 v24, v42, v42
v_mfma_f32_16x16x32_bf16 a[88:91], a[236:239], a[136:139], a[88:91]
ds_read_b128 a[220:223], v4 offset:28672
v_mfma_f32_16x16x32_bf16 a[84:87], a[232:235], a[116:119], a[84:87]
v_rcp_f32 v24, v24
v_mfma_f32_16x16x32_bf16 a[84:87], a[236:239], a[132:135], a[84:87]
v_mul_f32 v25, v41, v41
v_fmac_f32 v25, v43, v43
v_mfma_f32_16x16x32_bf16 a[80:83], a[232:235], a[112:115], a[80:83]
v_rcp_f32 v25, v25
v_mfma_f32_16x16x32_bf16 a[80:83], a[236:239], a[128:131], a[80:83]
s_waitcnt lgkmcnt(2)
ds_read_b128 a[224:227], v3 offset:26624
ds_read_b128 a[228:231], v4 offset:26624
v_mfma_f32_16x16x32_bf16 v[64:67], a[112:115], a[208:211], v[64:67]
buffer_load_dwordx4 a[96:99], v1, s[8:11], s59 offen offset:0 sc1
v_mfma_f32_16x16x32_bf16 v[64:67], a[128:131], a[212:215], v[64:67]
s_add_u32 m0, s54, 32768
v_mul_f32 v26, v52, v40
v_fmac_f32 v26, v54, v42
v_mfma_f32_16x16x32_bf16 v[68:71], a[116:119], a[208:211], v[68:71]
v_mul_f32 v27, v53, v41
v_fmac_f32 v27, v55, v43
v_mfma_f32_16x16x32_bf16 v[68:71], a[132:135], a[212:215], v[68:71]
s_waitcnt lgkmcnt(4)
ds_read_b128 a[232:235], v3 offset:30720
ds_read_b128 a[236:239], v4 offset:30720
v_mfma_f32_16x16x32_bf16 v[72:75], a[120:123], a[208:211], v[72:75]
buffer_load_dwordx4 v7, s[12:15], s57 offen lds
v_mfma_f32_16x16x32_bf16 v[72:75], a[136:139], a[212:215], v[72:75]
v_mul_f32 v56, v54, v40
v_fma_f32 v56, -v52, v42, v56
v_mfma_f32_16x16x32_bf16 v[76:79], a[124:127], a[208:211], v[76:79]
v_mul_f32 v57, v55, v41
v_fma_f32 v57, -v53, v43, v57
v_mfma_f32_16x16x32_bf16 v[76:79], a[140:143], a[212:215], v[76:79]
s_waitcnt lgkmcnt(4)
v_add_f32 v24, v24, v24
v_mul_f32 v20, v26, v24
v_mfma_f32_16x16x32_bf16 v[108:111], a[124:127], a[216:219], v[108:111]
v_mul_f32 v22, v56, v24
v_sub_f32 v18, 0, v54
v_mfma_f32_16x16x32_bf16 v[108:111], a[140:143], a[220:223], v[108:111]
buffer_load_dwordx4 a[100:103], v1, s[8:11], s59 offen offset:1024 sc1
v_mfma_f32_16x16x32_bf16 v[104:107], a[120:123], a[216:219], v[104:107]
s_add_u32 m0, s54, 36864
v_add_f32 v25, v25, v25
v_mul_f32 v21, v27, v25
v_mfma_f32_16x16x32_bf16 v[104:107], a[136:139], a[220:223], v[104:107]
v_mul_f32 v23, v57, v25
v_sub_f32 v19, 0, v55
v_mfma_f32_16x16x32_bf16 v[100:103], a[116:119], a[216:219], v[100:103]
v_mul_f32 v52, v18, v18
v_mul_f32 v54, v16, v18
v_mfma_f32_16x16x32_bf16 v[100:103], a[132:135], a[220:223], v[100:103]
buffer_load_dwordx4 v8, s[12:15], s57 offen lds
v_mfma_f32_16x16x32_bf16 v[96:99], a[112:115], a[216:219], v[96:99]
s_waitcnt vmcnt(16) lgkmcnt(0)
s_barrier
v_fma_f32 v24, v16, v16, -v52
v_mfma_f32_16x16x32_bf16 v[96:99], a[128:131], a[220:223], v[96:99]
s_waitcnt lgkmcnt(2)
ds_read_b64_tr_b16 a[208:209], v2 offset:0
ds_read_b64_tr_b16 a[210:211], v2 offset:1792
v_mfma_f32_16x16x32_bf16 v[80:83], a[112:115], a[224:227], v[80:83]
v_add_f32 v26, v54, v54
v_mul_f32 v53, v19, v19
v_mfma_f32_16x16x32_bf16 v[80:83], a[128:131], a[228:231], v[80:83]
v_mul_f32 v55, v17, v19
v_fma_f32 v25, v17, v17, -v53
v_mfma_f32_16x16x32_bf16 v[84:87], a[116:119], a[224:227], v[84:87]
buffer_load_dwordx4 a[104:107], v1, s[8:11], s59 offen offset:2048 sc1
v_mfma_f32_16x16x32_bf16 v[84:87], a[132:135], a[228:231], v[84:87]
s_waitcnt lgkmcnt(4)
ds_read_b64_tr_b16 a[212:213], v2 offset:7168
ds_read_b64_tr_b16 a[214:215], v2 offset:8960
v_mfma_f32_16x16x32_bf16 v[88:91], a[120:123], a[224:227], v[88:91]
s_add_u32 m0, s55, 28672
v_add_f32 v27, v55, v55
v_mul_f32 v52, v26, v26
v_mfma_f32_16x16x32_bf16 v[88:91], a[136:139], a[228:231], v[88:91]
v_mul_f32 v54, v24, v26
v_fma_f32 v24, v24, v24, -v52
v_mfma_f32_16x16x32_bf16 v[92:95], a[124:127], a[224:227], v[92:95]
buffer_load_dwordx4 v9, s[20:23], s57 offen lds
v_mfma_f32_16x16x32_bf16 v[92:95], a[140:143], a[228:231], v[92:95]
s_waitcnt lgkmcnt(4)
ds_read_b64_tr_b16 a[216:217], v2 offset:14336
ds_read_b64_tr_b16 a[218:219], v2 offset:16128
v_mfma_f32_16x16x32_bf16 v[124:127], a[124:127], a[232:235], v[124:127]
v_add_f32 v26, v54, v54
v_mul_f32 v53, v27, v27
v_mfma_f32_16x16x32_bf16 v[124:127], a[140:143], a[236:239], v[124:127]
v_mul_f32 v55, v25, v27
v_fma_f32 v25, v25, v25, -v53
v_mfma_f32_16x16x32_bf16 v[120:123], a[120:123], a[232:235], v[120:123]
v_add_f32 v27, v55, v55
v_mul_f32 v52, v26, v26
v_mfma_f32_16x16x32_bf16 v[120:123], a[136:139], a[236:239], v[120:123]
s_waitcnt lgkmcnt(6)
ds_read_b64_tr_b16 a[220:221], v2 offset:21504
ds_read_b64_tr_b16 a[222:223], v2 offset:23296
v_mfma_f32_16x16x32_bf16 v[116:119], a[116:119], a[232:235], v[116:119]
v_mul_f32 v54, v24, v26
v_fma_f32 v24, v24, v24, -v52
v_mfma_f32_16x16x32_bf16 v[116:119], a[132:135], a[236:239], v[116:119]
v_add_f32 v26, v54, v54
v_mul_f32 v53, v27, v27
v_mfma_f32_16x16x32_bf16 v[112:115], a[112:115], a[232:235], v[112:115]
v_mul_f32 v55, v25, v27
v_fma_f32 v25, v25, v25, -v53
v_mfma_f32_16x16x32_bf16 v[112:115], a[128:131], a[236:239], v[112:115]
s_waitcnt vmcnt(7) lgkmcnt(4)
ds_read_b64_tr_b16 a[224:225], v2 offset:32
ds_read_b64_tr_b16 a[226:227], v2 offset:1824
v_mfma_f32_16x16x32_bf16 v[128:131], a[208:211], a[144:147], v[128:131]
v_add_f32 v27, v55, v55
v_mul_f32 v52, v26, v26
v_mfma_f32_16x16x32_bf16 v[128:131], a[212:215], a[192:195], v[128:131]
v_mul_f32 v54, v24, v26
v_fma_f32 v28, v24, v24, -v52
v_mfma_f32_16x16x32_bf16 v[132:135], a[208:211], a[148:151], v[132:135]
v_add_f32 v30, v54, v54
v_mul_f32 v53, v27, v27
v_mfma_f32_16x16x32_bf16 v[132:135], a[212:215], a[196:199], v[132:135]
s_waitcnt lgkmcnt(6)
ds_read_b64_tr_b16 a[228:229], v2 offset:7200
ds_read_b64_tr_b16 a[230:231], v2 offset:8992
v_mfma_f32_16x16x32_bf16 v[136:139], a[208:211], a[152:155], v[136:139]
buffer_load_dwordx4 a[108:111], v1, s[8:11], s59 offen offset:3072 sc1
v_mfma_f32_16x16x32_bf16 v[136:139], a[212:215], a[200:203], v[136:139]
s_add_u32 m0, s54, 43008
v_mul_f32 v55, v25, v27
v_fma_f32 v29, v25, v25, -v53
v_mfma_f32_16x16x32_bf16 v[140:143], a[208:211], a[156:159], v[140:143]
v_add_f32 v31, v55, v55
v_mul_f32 v52, v30, v30
v_mfma_f32_16x16x32_bf16 v[140:143], a[212:215], a[204:207], v[140:143]
s_waitcnt lgkmcnt(4)
ds_read_b64_tr_b16 a[232:233], v2 offset:14368
ds_read_b64_tr_b16 a[234:235], v2 offset:16160
v_mfma_f32_16x16x32_bf16 v[156:159], a[216:219], a[156:159], v[156:159]
buffer_load_dwordx4 v6, s[16:19], s57 offen lds
v_mfma_f32_16x16x32_bf16 v[156:159], a[220:223], a[204:207], v[156:159]
s_mov_b32 s59, 45056
v_mul_f32 v54, v28, v30
v_fma_f32 v32, v28, v28, -v52
v_mfma_f32_16x16x32_bf16 v[152:155], a[216:219], a[152:155], v[152:155]
v_add_f32 v34, v54, v54
v_mul_f32 v53, v31, v31
v_mfma_f32_16x16x32_bf16 v[152:155], a[220:223], a[200:203], v[152:155]
s_waitcnt lgkmcnt(6)
ds_read_b64_tr_b16 a[236:237], v2 offset:21536
ds_read_b64_tr_b16 a[238:239], v2 offset:23328
v_mfma_f32_16x16x32_bf16 v[148:151], a[216:219], a[148:151], v[148:151]
v_mul_f32 v55, v29, v31
v_fma_f32 v33, v29, v29, -v53
v_mfma_f32_16x16x32_bf16 v[148:151], a[220:223], a[196:199], v[148:151]
buffer_load_dwordx4 a[112:115], v1, s[8:11], s59 offen offset:0 sc1
v_mfma_f32_16x16x32_bf16 v[144:147], a[216:219], a[144:147], v[144:147]
s_add_u32 m0, s54, 47104
v_add_f32 v35, v55, v55
v_mul_f32 v52, v34, v34
v_mfma_f32_16x16x32_bf16 v[144:147], a[220:223], a[192:195], v[144:147]
s_waitcnt lgkmcnt(4)
ds_read_b64_tr_b16 a[208:209], v2 offset:64
ds_read_b64_tr_b16 a[210:211], v2 offset:1856
v_mfma_f32_16x16x32_bf16 v[160:163], a[224:227], a[144:147], v[160:163]
v_mul_f32 v54, v32, v34
v_fma_f32 v32, v32, v32, -v52
v_mfma_f32_16x16x32_bf16 v[160:163], a[228:231], a[192:195], v[160:163]
buffer_load_dwordx4 v7, s[16:19], s57 offen lds
v_mfma_f32_16x16x32_bf16 v[164:167], a[224:227], a[148:151], v[164:167]
s_add_u32 m0, s54, 51200
v_add_f32 v34, v54, v54
v_mul_f32 v53, v35, v35
v_mfma_f32_16x16x32_bf16 v[164:167], a[228:231], a[196:199], v[164:167]
s_waitcnt lgkmcnt(6)
ds_read_b64_tr_b16 a[212:213], v2 offset:7232
ds_read_b64_tr_b16 a[214:215], v2 offset:9024
v_mfma_f32_16x16x32_bf16 v[168:171], a[224:227], a[152:155], v[168:171]
v_mul_f32 v55, v33, v35
v_fma_f32 v33, v33, v33, -v53
v_mfma_f32_16x16x32_bf16 v[168:171], a[228:231], a[200:203], v[168:171]
v_add_f32 v35, v55, v55
v_mul_f32 v52, v34, v34
v_mfma_f32_16x16x32_bf16 v[172:175], a[224:227], a[156:159], v[172:175]
v_mul_f32 v54, v32, v34
v_fma_f32 v36, v32, v32, -v52
v_mfma_f32_16x16x32_bf16 v[172:175], a[228:231], a[204:207], v[172:175]
s_waitcnt lgkmcnt(4)
ds_read_b64_tr_b16 a[216:217], v2 offset:14400
ds_read_b64_tr_b16 a[218:219], v2 offset:16192
v_mfma_f32_16x16x32_bf16 v[188:191], a[232:235], a[156:159], v[188:191]
v_add_f32 v38, v54, v54
v_mul_f32 v53, v35, v35
v_mfma_f32_16x16x32_bf16 v[188:191], a[236:239], a[204:207], v[188:191]
v_mul_f32 v55, v33, v35
v_fma_f32 v37, v33, v33, -v53
v_mfma_f32_16x16x32_bf16 v[184:187], a[232:235], a[152:155], v[184:187]
v_add_f32 v39, v55, v55
v_mul_f32 v52, v38, v38
v_mfma_f32_16x16x32_bf16 v[184:187], a[236:239], a[200:203], v[184:187]
s_waitcnt lgkmcnt(6)
ds_read_b64_tr_b16 a[220:221], v2 offset:21568
ds_read_b64_tr_b16 a[222:223], v2 offset:23360
v_mfma_f32_16x16x32_bf16 v[180:183], a[232:235], a[148:151], v[180:183]
buffer_load_dwordx4 v8, s[16:19], s57 offen lds
v_mfma_f32_16x16x32_bf16 v[180:183], a[236:239], a[196:199], v[180:183]
s_movk_i32 s58, 640
s_add_u32 m0, s56, 8192
v_mul_f32 v54, v36, v38
v_mfma_f32_16x16x32_bf16 v[176:179], a[232:235], a[144:147], v[176:179]
v_fma_f32 v36, v36, v36, -v52
v_add_f32 v38, v54, v54
v_mfma_f32_16x16x32_bf16 v[176:179], a[236:239], a[192:195], v[176:179]
s_waitcnt lgkmcnt(4)
ds_read_b64_tr_b16 a[224:225], v2 offset:96
ds_read_b64_tr_b16 a[226:227], v2 offset:1888
v_mfma_f32_16x16x32_bf16 v[192:195], a[208:211], a[144:147], v[192:195]
buffer_load_dwordx4 v10, s[24:27], s58 offen lds
v_mfma_f32_16x16x32_bf16 v[192:195], a[212:215], a[192:195], v[192:195]
s_add_u32 m0, s56, 12288
v_mul_f32 v53, v39, v39
v_mul_f32 v55, v37, v39
v_mfma_f32_16x16x32_bf16 v[196:199], a[208:211], a[148:151], v[196:199]
v_fma_f32 v37, v37, v37, -v53
v_add_f32 v39, v55, v55
v_mfma_f32_16x16x32_bf16 v[196:199], a[212:215], a[196:199], v[196:199]
s_waitcnt lgkmcnt(6)
ds_read_b64_tr_b16 a[228:229], v2 offset:7264
ds_read_b64_tr_b16 a[230:231], v2 offset:9056
v_mfma_f32_16x16x32_bf16 v[200:203], a[208:211], a[152:155], v[200:203]
v_mul_f32 v52, v38, v38
v_mul_f32 v54, v36, v38
v_mfma_f32_16x16x32_bf16 v[200:203], a[212:215], a[200:203], v[200:203]
v_fma_f32 v36, v36, v36, -v52
v_add_f32 v38, v54, v54
v_mfma_f32_16x16x32_bf16 v[204:207], a[208:211], a[156:159], v[204:207]
v_mul_f32 v53, v39, v39
v_mul_f32 v55, v37, v39
v_mfma_f32_16x16x32_bf16 v[204:207], a[212:215], a[204:207], v[204:207]
s_waitcnt lgkmcnt(4)
ds_read_b64_tr_b16 a[232:233], v2 offset:14432
ds_read_b64_tr_b16 a[234:235], v2 offset:16224
v_mfma_f32_16x16x32_bf16 v[220:223], a[216:219], a[156:159], v[220:223]
buffer_load_dwordx4 v10, s[28:31], s58 offen lds
v_mfma_f32_16x16x32_bf16 v[220:223], a[220:223], a[204:207], v[220:223]
v_fma_f32 v37, v37, v37, -v53
v_add_f32 v39, v55, v55
v_mfma_f32_16x16x32_bf16 v[216:219], a[216:219], a[152:155], v[216:219]
v_lshlrev_b32 v11, 6, v48
v_lshl_add_u32 v11, v49, 3, v11
v_mfma_f32_16x16x32_bf16 v[216:219], a[220:223], a[200:203], v[216:219]
s_waitcnt lgkmcnt(6)
ds_read_b64_tr_b16 a[236:237], v2 offset:21600
ds_read_b64_tr_b16 a[238:239], v2 offset:23392
v_mfma_f32_16x16x32_bf16 v[212:215], a[216:219], a[148:151], v[212:215]
buffer_load_dwordx4 a[116:119], v1, s[8:11], s59 offen offset:1024 sc1
v_mfma_f32_16x16x32_bf16 v[212:215], a[220:223], a[196:199], v[212:215]
v_add_u32 v11, s71, v11
v_and_b32 v50, 0xf0, v1
v_mfma_f32_16x16x32_bf16 v[208:211], a[216:219], a[144:147], v[208:211]
s_lshl_b32 s66, s63, 10
s_add_u32 s66, s66, 0x40000
v_mfma_f32_16x16x32_bf16 v[208:211], a[220:223], a[192:195], v[208:211]
s_waitcnt lgkmcnt(4)
ds_read_b64_tr_b16 a[208:209], v2 offset:128
ds_read_b64_tr_b16 a[210:211], v2 offset:1920
v_mfma_f32_16x16x32_bf16 v[224:227], a[224:227], a[144:147], v[224:227]
v_accvgpr_read_b32 v40, a248
v_accvgpr_read_b32 v41, a249
v_mfma_f32_16x16x32_bf16 v[224:227], a[228:231], a[192:195], v[224:227]
buffer_load_dwordx4 a[120:123], v1, s[8:11], s59 offen offset:2048 sc1
v_mfma_f32_16x16x32_bf16 v[228:231], a[224:227], a[148:151], v[228:231]
v_accvgpr_read_b32 v42, a250
v_accvgpr_read_b32 v43, a251
v_mfma_f32_16x16x32_bf16 v[228:231], a[228:231], a[196:199], v[228:231]
s_waitcnt lgkmcnt(6)
ds_read_b64_tr_b16 a[212:213], v2 offset:7296
ds_read_b64_tr_b16 a[214:215], v2 offset:9088
v_mfma_f32_16x16x32_bf16 v[232:235], a[224:227], a[152:155], v[232:235]
v_mfma_f32_16x16x32_bf16 v[232:235], a[228:231], a[200:203], v[232:235]
buffer_load_dwordx4 a[124:127], v1, s[8:11], s59 offen offset:3072 sc1
v_mfma_f32_16x16x32_bf16 v[236:239], a[224:227], a[156:159], v[236:239]
s_mov_b32 s57, 2752512
s_add_u32 m0, s54, 65536
v_mfma_f32_16x16x32_bf16 v[236:239], a[228:231], a[204:207], v[236:239]
s_waitcnt lgkmcnt(4)
ds_read_b64_tr_b16 a[216:217], v2 offset:14464
ds_read_b64_tr_b16 a[218:219], v2 offset:16256
v_mfma_f32_16x16x32_bf16 v[252:255], a[232:235], a[156:159], v[252:255]
buffer_load_dwordx2 v[44:45], v50, s[36:39], s66 offen offset:0 sc1
v_mfma_f32_16x16x32_bf16 v[252:255], a[236:239], a[204:207], v[252:255]
v_mfma_f32_16x16x32_bf16 v[248:251], a[232:235], a[152:155], v[248:251]
v_mfma_f32_16x16x32_bf16 v[248:251], a[236:239], a[200:203], v[248:251]
s_waitcnt lgkmcnt(6)
ds_read_b64_tr_b16 a[220:221], v2 offset:21632
ds_read_b64_tr_b16 a[222:223], v2 offset:23424
v_mfma_f32_16x16x32_bf16 v[244:247], a[232:235], a[148:151], v[244:247]
v_mfma_f32_16x16x32_bf16 v[244:247], a[236:239], a[196:199], v[244:247]
v_mfma_f32_16x16x32_bf16 v[240:243], a[232:235], a[144:147], v[240:243]
v_mfma_f32_16x16x32_bf16 v[240:243], a[236:239], a[192:195], v[240:243]
s_waitcnt lgkmcnt(4)
ds_read_b64_tr_b16 a[224:225], v2 offset:160
ds_read_b64_tr_b16 a[226:227], v2 offset:1952
v_mfma_f32_16x16x32_bf16 a[0:3], a[208:211], a[144:147], a[0:3]
buffer_load_dwordx4 v6, s[12:15], s57 offen lds
v_mfma_f32_16x16x32_bf16 a[0:3], a[212:215], a[192:195], a[0:3]
s_mov_b32 s59, 49152
v_mfma_f32_16x16x32_bf16 a[4:7], a[208:211], a[148:151], a[4:7]
v_mfma_f32_16x16x32_bf16 a[4:7], a[212:215], a[196:199], a[4:7]
s_waitcnt lgkmcnt(6)
ds_read_b64_tr_b16 a[228:229], v2 offset:7328
ds_read_b64_tr_b16 a[230:231], v2 offset:9120
v_mfma_f32_16x16x32_bf16 a[8:11], a[208:211], a[152:155], a[8:11]
buffer_load_dwordx4 a[128:131], v1, s[8:11], s59 offen offset:0 sc1
v_mfma_f32_16x16x32_bf16 a[8:11], a[212:215], a[200:203], a[8:11]
v_mfma_f32_16x16x32_bf16 a[12:15], a[208:211], a[156:159], a[12:15]
v_mfma_f32_16x16x32_bf16 a[12:15], a[212:215], a[204:207], a[12:15]
s_waitcnt lgkmcnt(4)
ds_read_b64_tr_b16 a[232:233], v2 offset:14496
ds_read_b64_tr_b16 a[234:235], v2 offset:16288
v_mfma_f32_16x16x32_bf16 a[28:31], a[216:219], a[156:159], a[28:31]
buffer_load_dword a246, v13, s[40:43], s77 offen
v_mfma_f32_16x16x32_bf16 a[28:31], a[220:223], a[204:207], a[28:31]
s_add_u32 s77, s77, s76
v_mfma_f32_16x16x32_bf16 a[24:27], a[216:219], a[152:155], a[24:27]
v_mfma_f32_16x16x32_bf16 a[24:27], a[220:223], a[200:203], a[24:27]
s_waitcnt lgkmcnt(6)
ds_read_b64_tr_b16 a[236:237], v2 offset:21664
ds_read_b64_tr_b16 a[238:239], v2 offset:23456
v_mfma_f32_16x16x32_bf16 a[20:23], a[216:219], a[148:151], a[20:23]
buffer_load_dword a246, v13, s[40:43], s77 offen
v_mfma_f32_16x16x32_bf16 a[20:23], a[220:223], a[196:199], a[20:23]
s_add_u32 s77, s77, s76
v_mfma_f32_16x16x32_bf16 a[16:19], a[216:219], a[144:147], a[16:19]
v_mfma_f32_16x16x32_bf16 a[16:19], a[220:223], a[192:195], a[16:19]
s_waitcnt lgkmcnt(4)
ds_read_b64_tr_b16 a[208:209], v2 offset:192
ds_read_b64_tr_b16 a[210:211], v2 offset:1984
v_mfma_f32_16x16x32_bf16 a[32:35], a[224:227], a[144:147], a[32:35]
v_mfma_f32_16x16x32_bf16 a[32:35], a[228:231], a[192:195], a[32:35]
v_mfma_f32_16x16x32_bf16 a[36:39], a[224:227], a[148:151], a[36:39]
v_mfma_f32_16x16x32_bf16 a[36:39], a[228:231], a[196:199], a[36:39]
s_waitcnt lgkmcnt(6)
ds_read_b64_tr_b16 a[212:213], v2 offset:7360
ds_read_b64_tr_b16 a[214:215], v2 offset:9152
v_mfma_f32_16x16x32_bf16 a[40:43], a[224:227], a[152:155], a[40:43]
v_mfma_f32_16x16x32_bf16 a[40:43], a[228:231], a[200:203], a[40:43]
v_mfma_f32_16x16x32_bf16 a[44:47], a[224:227], a[156:159], a[44:47]
v_mfma_f32_16x16x32_bf16 a[44:47], a[228:231], a[204:207], a[44:47]
s_waitcnt lgkmcnt(4)
ds_read_b64_tr_b16 a[216:217], v2 offset:14528
ds_read_b64_tr_b16 a[218:219], v2 offset:16320
v_mfma_f32_16x16x32_bf16 a[60:63], a[232:235], a[156:159], a[60:63]
v_mfma_f32_16x16x32_bf16 a[60:63], a[236:239], a[204:207], a[60:63]
v_mfma_f32_16x16x32_bf16 a[56:59], a[232:235], a[152:155], a[56:59]
buffer_load_dword a246, v14, s[44:47], s78 offen
v_mfma_f32_16x16x32_bf16 a[56:59], a[236:239], a[200:203], a[56:59]
s_waitcnt lgkmcnt(6)
ds_read_b64_tr_b16 a[220:221], v2 offset:21696
ds_read_b64_tr_b16 a[222:223], v2 offset:23488
v_mfma_f32_16x16x32_bf16 a[52:55], a[232:235], a[148:151], a[52:55]
s_add_u32 s78, s78, s80
s_add_u32 m0, s54, 69632
v_mfma_f32_16x16x32_bf16 a[52:55], a[236:239], a[196:199], a[52:55]
v_mfma_f32_16x16x32_bf16 a[48:51], a[232:235], a[144:147], a[48:51]
v_mfma_f32_16x16x32_bf16 a[48:51], a[236:239], a[192:195], a[48:51]
s_waitcnt lgkmcnt(4)
ds_read_b128 a[224:227], v3 offset:0
v_mfma_f32_16x16x32_bf16 a[64:67], a[208:211], a[144:147], a[64:67]
v_mfma_f32_16x16x32_bf16 a[64:67], a[212:215], a[192:195], a[64:67]
v_mfma_f32_16x16x32_bf16 a[68:71], a[208:211], a[148:151], a[68:71]
v_mfma_f32_16x16x32_bf16 a[68:71], a[212:215], a[196:199], a[68:71]
ds_read_b128 a[228:231], v4 offset:0
v_mfma_f32_16x16x32_bf16 a[72:75], a[208:211], a[152:155], a[72:75]
buffer_load_dwordx4 v7, s[12:15], s57 offen lds
v_mfma_f32_16x16x32_bf16 a[72:75], a[212:215], a[200:203], a[72:75]
v_mfma_f32_16x16x32_bf16 a[76:79], a[208:211], a[156:159], a[76:79]
v_mfma_f32_16x16x32_bf16 a[76:79], a[212:215], a[204:207], a[76:79]
s_waitcnt lgkmcnt(2)
ds_read_b128 a[232:235], v3 offset:4096
v_mfma_f32_16x16x32_bf16 a[92:95], a[216:219], a[156:159], a[92:95]
buffer_load_dwordx4 a[132:135], v1, s[8:11], s59 offen offset:1024 sc1
v_mfma_f32_16x16x32_bf16 a[92:95], a[220:223], a[204:207], a[92:95]
s_add_u32 m0, s54, 73728
v_mfma_f32_16x16x32_bf16 a[88:91], a[216:219], a[152:155], a[88:91]
v_mfma_f32_16x16x32_bf16 a[88:91], a[220:223], a[200:203], a[88:91]
ds_read_b128 a[236:239], v4 offset:4096
v_mfma_f32_16x16x32_bf16 a[84:87], a[216:219], a[148:151], a[84:87]
v_mfma_f32_16x16x32_bf16 a[84:87], a[220:223], a[196:199], a[84:87]
v_mfma_f32_16x16x32_bf16 a[80:83], a[216:219], a[144:147], a[80:83]
v_mfma_f32_16x16x32_bf16 a[80:83], a[220:223], a[192:195], a[80:83]
s_waitcnt lgkmcnt(2)
ds_read_b128 a[208:211], v3 offset:2048
ds_read_b128 a[212:215], v4 offset:2048
v_mfma_f32_16x16x32_bf16 v[64:67], a[144:147], a[224:227], v[64:67]
v_mfma_f32_16x16x32_bf16 v[64:67], a[192:195], a[228:231], v[64:67]
v_mfma_f32_16x16x32_bf16 v[68:71], a[148:151], a[224:227], v[68:71]
v_mfma_f32_16x16x32_bf16 v[68:71], a[196:199], a[228:231], v[68:71]
s_waitcnt lgkmcnt(4)
ds_read_b128 a[216:219], v3 offset:6144
ds_read_b128 a[220:223], v4 offset:6144
v_mfma_f32_16x16x32_bf16 v[72:75], a[152:155], a[224:227], v[72:75]
v_mfma_f32_16x16x32_bf16 v[72:75], a[200:203], a[228:231], v[72:75]
v_mfma_f32_16x16x32_bf16 v[76:79], a[156:159], a[224:227], v[76:79]
v_mfma_f32_16x16x32_bf16 v[76:79], a[204:207], a[228:231], v[76:79]
s_waitcnt lgkmcnt(4)
v_mfma_f32_16x16x32_bf16 v[108:111], a[156:159], a[232:235], v[108:111]
v_mfma_f32_16x16x32_bf16 v[108:111], a[204:207], a[236:239], v[108:111]
v_mfma_f32_16x16x32_bf16 v[104:107], a[152:155], a[232:235], v[104:107]
v_mfma_f32_16x16x32_bf16 v[104:107], a[200:203], a[236:239], v[104:107]
v_mfma_f32_16x16x32_bf16 v[100:103], a[148:151], a[232:235], v[100:103]
v_mfma_f32_16x16x32_bf16 v[100:103], a[196:199], a[236:239], v[100:103]
v_mfma_f32_16x16x32_bf16 v[96:99], a[144:147], a[232:235], v[96:99]
s_waitcnt vmcnt(11) lgkmcnt(0)
s_barrier
v_mfma_f32_16x16x32_bf16 v[96:99], a[192:195], a[236:239], v[96:99]
s_waitcnt lgkmcnt(2)
ds_read_b64_tr_b16 a[224:225], v2 offset:28672
ds_read_b64_tr_b16 a[226:227], v2 offset:30464
v_mfma_f32_16x16x32_bf16 v[80:83], a[144:147], a[208:211], v[80:83]
v_mfma_f32_16x16x32_bf16 v[80:83], a[192:195], a[212:215], v[80:83]
v_mfma_f32_16x16x32_bf16 v[84:87], a[148:151], a[208:211], v[84:87]
v_mfma_f32_16x16x32_bf16 v[84:87], a[196:199], a[212:215], v[84:87]
s_waitcnt lgkmcnt(4)
ds_read_b64_tr_b16 a[228:229], v2 offset:35840
ds_read_b64_tr_b16 a[230:231], v2 offset:37632
v_mfma_f32_16x16x32_bf16 v[88:91], a[152:155], a[208:211], v[88:91]
v_mfma_f32_16x16x32_bf16 v[88:91], a[200:203], a[212:215], v[88:91]
v_mfma_f32_16x16x32_bf16 v[92:95], a[156:159], a[208:211], v[92:95]
v_mfma_f32_16x16x32_bf16 v[92:95], a[204:207], a[212:215], v[92:95]
s_waitcnt lgkmcnt(4)
ds_read_b64_tr_b16 a[232:233], v2 offset:43008
ds_read_b64_tr_b16 a[234:235], v2 offset:44800
v_mfma_f32_16x16x32_bf16 v[124:127], a[156:159], a[216:219], v[124:127]
v_mfma_f32_16x16x32_bf16 v[124:127], a[204:207], a[220:223], v[124:127]
v_mfma_f32_16x16x32_bf16 v[120:123], a[152:155], a[216:219], v[120:123]
v_mfma_f32_16x16x32_bf16 v[120:123], a[200:203], a[220:223], v[120:123]
s_waitcnt lgkmcnt(6)
ds_read_b64_tr_b16 a[236:237], v2 offset:50176
ds_read_b64_tr_b16 a[238:239], v2 offset:51968
v_mfma_f32_16x16x32_bf16 v[116:119], a[148:151], a[216:219], v[116:119]
buffer_load_dwordx4 v8, s[12:15], s57 offen lds
v_mfma_f32_16x16x32_bf16 v[116:119], a[196:199], a[220:223], v[116:119]
v_mfma_f32_16x16x32_bf16 v[112:115], a[144:147], a[216:219], v[112:115]
v_mfma_f32_16x16x32_bf16 v[112:115], a[192:195], a[220:223], v[112:115]
s_waitcnt vmcnt(9) lgkmcnt(4)
ds_read_b64_tr_b16 a[208:209], v2 offset:28704
ds_read_b64_tr_b16 a[210:211], v2 offset:30496
v_mfma_f32_16x16x32_bf16 v[128:131], a[224:227], a[96:99], v[128:131]
v_mfma_f32_16x16x32_bf16 v[128:131], a[228:231], a[112:115], v[128:131]
buffer_load_dwordx4 a[136:139], v1, s[8:11], s59 offen offset:2048 sc1
v_mfma_f32_16x16x32_bf16 v[132:135], a[224:227], a[100:103], v[132:135]
s_add_u32 m0, s55, 65536
v_mfma_f32_16x16x32_bf16 v[132:135], a[228:231], a[116:119], v[132:135]
s_waitcnt lgkmcnt(6)
ds_read_b64_tr_b16 a[212:213], v2 offset:35872
ds_read_b64_tr_b16 a[214:215], v2 offset:37664
v_mfma_f32_16x16x32_bf16 v[136:139], a[224:227], a[104:107], v[136:139]
v_mfma_f32_16x16x32_bf16 v[136:139], a[228:231], a[120:123], v[136:139]
v_mfma_f32_16x16x32_bf16 v[140:143], a[224:227], a[108:111], v[140:143]
v_mfma_f32_16x16x32_bf16 v[140:143], a[228:231], a[124:127], v[140:143]
s_waitcnt lgkmcnt(4)
ds_read_b64_tr_b16 a[216:217], v2 offset:43040
ds_read_b64_tr_b16 a[218:219], v2 offset:44832
v_mfma_f32_16x16x32_bf16 v[156:159], a[232:235], a[108:111], v[156:159]
v_mfma_f32_16x16x32_bf16 v[156:159], a[236:239], a[124:127], v[156:159]
v_mfma_f32_16x16x32_bf16 v[152:155], a[232:235], a[104:107], v[152:155]
buffer_load_dwordx4 v9, s[20:23], s57 offen lds
v_mfma_f32_16x16x32_bf16 v[152:155], a[236:239], a[120:123], v[152:155]
s_waitcnt lgkmcnt(6)
ds_read_b64_tr_b16 a[220:221], v2 offset:50208
ds_read_b64_tr_b16 a[222:223], v2 offset:52000
v_mfma_f32_16x16x32_bf16 v[148:151], a[232:235], a[100:103], v[148:151]
s_waitcnt vmcnt(10)
ds_read_b64 v[52:53], v11 offset:0
ds_read_b64 v[54:55], v11 offset:32
v_mfma_f32_16x16x32_bf16 v[148:151], a[236:239], a[116:119], v[148:151]
L_tr3:
s_cbranch_execz L_tr7
v_mfma_f32_16x16x32_bf16 v[144:147], a[232:235], a[96:99], v[144:147]
v_mfma_f32_16x16x32_bf16 v[144:147], a[236:239], a[112:115], v[144:147]
s_waitcnt lgkmcnt(6)
ds_read_b64_tr_b16 a[224:225], v2 offset:28736
ds_read_b64_tr_b16 a[226:227], v2 offset:30528
v_mfma_f32_16x16x32_bf16 v[160:163], a[208:211], a[96:99], v[160:163]
buffer_load_dwordx4 a[140:143], v1, s[8:11], s59 offen offset:3072 sc1
v_mfma_f32_16x16x32_bf16 v[160:163], a[212:215], a[112:115], v[160:163]
s_add_u32 m0, s54, 79872
v_mfma_f32_16x16x32_bf16 v[164:167], a[208:211], a[100:103], v[164:167]
v_mfma_f32_16x16x32_bf16 v[164:167], a[212:215], a[116:119], v[164:167]
s_waitcnt lgkmcnt(8)
ds_read_b64_tr_b16 a[228:229], v2 offset:35904
ds_read_b64_tr_b16 a[230:231], v2 offset:37696
v_mfma_f32_16x16x32_bf16 v[168:171], a[208:211], a[104:107], v[168:171]
buffer_load_dwordx4 v6, s[16:19], s57 offen lds
v_mfma_f32_16x16x32_bf16 v[168:171], a[212:215], a[120:123], v[168:171]
s_add_u32 m0, s54, 83968
v_mfma_f32_16x16x32_bf16 v[172:175], a[208:211], a[108:111], v[172:175]
s_waitcnt lgkmcnt(4)
v_lshlrev_b32 v56, 16, v52
v_and_b32 v57, 0xffff0000, v52
v_mfma_f32_16x16x32_bf16 v[172:175], a[212:215], a[124:127], v[172:175]
s_waitcnt lgkmcnt(6)
ds_read_b64_tr_b16 a[232:233], v2 offset:43072
ds_read_b64_tr_b16 a[234:235], v2 offset:44864
v_mfma_f32_16x16x32_bf16 v[188:191], a[216:219], a[108:111], v[188:191]
v_lshlrev_b32 v58, 16, v53
v_and_b32 v59, 0xffff0000, v53
v_mfma_f32_16x16x32_bf16 v[188:191], a[220:223], a[124:127], v[188:191]
v_sub_f32 v60, v56, v44
v_sub_f32 v61, v57, v44
v_mfma_f32_16x16x32_bf16 v[184:187], a[216:219], a[104:107], v[184:187]
v_sub_f32 v62, v58, v44
v_sub_f32 v63, v59, v44
v_mfma_f32_16x16x32_bf16 v[184:187], a[220:223], a[120:123], v[184:187]
s_waitcnt lgkmcnt(8)
ds_read_b64_tr_b16 a[236:237], v2 offset:50240
ds_read_b64_tr_b16 a[238:239], v2 offset:52032
v_mfma_f32_16x16x32_bf16 v[180:183], a[216:219], a[100:103], v[180:183]
v_cvt_pk_bf16_f32 v48, v60, v61
v_cvt_pk_bf16_f32 v49, v62, v63
v_mfma_f32_16x16x32_bf16 v[180:183], a[220:223], a[116:119], v[180:183]
v_lshlrev_b32 v60, 16, v48
v_and_b32 v61, 0xffff0000, v48
v_mfma_f32_16x16x32_bf16 v[176:179], a[216:219], a[96:99], v[176:179]
v_lshlrev_b32 v62, 16, v49
v_and_b32 v63, 0xffff0000, v49
v_mfma_f32_16x16x32_bf16 v[176:179], a[220:223], a[112:115], v[176:179]
s_waitcnt lgkmcnt(4)
ds_read_b64_tr_b16 a[208:209], v2 offset:28768
ds_read_b64_tr_b16 a[210:211], v2 offset:30560
v_mfma_f32_16x16x32_bf16 v[192:195], a[224:227], a[96:99], v[192:195]
v_mul_f32 v60, v60, v45
v_mul_f32 v61, v61, v45
v_mfma_f32_16x16x32_bf16 v[192:195], a[228:231], a[112:115], v[192:195]
buffer_load_dwordx4 v7, s[16:19], s57 offen lds
v_mfma_f32_16x16x32_bf16 v[196:199], a[224:227], a[100:103], v[196:199]
s_add_u32 m0, s54, 88064
v_mul_f32 v62, v62, v45
v_mul_f32 v63, v63, v45
v_mfma_f32_16x16x32_bf16 v[196:199], a[228:231], a[116:119], v[196:199]
s_waitcnt lgkmcnt(6)
ds_read_b64_tr_b16 a[212:213], v2 offset:35936
ds_read_b64_tr_b16 a[214:215], v2 offset:37728
v_mfma_f32_16x16x32_bf16 v[200:203], a[224:227], a[104:107], v[200:203]
v_cvt_pk_bf16_f32 v48, v60, v61
v_cvt_pk_bf16_f32 v49, v62, v63
v_mfma_f32_16x16x32_bf16 v[200:203], a[228:231], a[120:123], v[200:203]
buffer_load_dwordx4 v8, s[16:19], s57 offen lds
v_mfma_f32_16x16x32_bf16 v[204:207], a[224:227], a[108:111], v[204:207]
s_movk_i32 s58, 768
s_add_u32 m0, s56, 16384
v_lshlrev_b32 v60, 16, v48
v_mfma_f32_16x16x32_bf16 v[204:207], a[228:231], a[124:127], v[204:207]
s_waitcnt lgkmcnt(4)
ds_read_b64_tr_b16 a[216:217], v2 offset:43104
ds_read_b64_tr_b16 a[218:219], v2 offset:44896
v_mfma_f32_16x16x32_bf16 v[220:223], a[232:235], a[108:111], v[220:223]
v_and_b32 v61, 0xffff0000, v48
v_lshlrev_b32 v62, 16, v49
v_mfma_f32_16x16x32_bf16 v[220:223], a[236:239], a[124:127], v[220:223]
v_and_b32 v63, 0xffff0000, v49
v_lshlrev_b32 v46, 16, v40
v_mfma_f32_16x16x32_bf16 v[216:219], a[232:235], a[104:107], v[216:219]
v_and_b32 v47, 0xffff0000, v40
v_mul_f32 v60, v60, v46
v_mfma_f32_16x16x32_bf16 v[216:219], a[236:239], a[120:123], v[216:219]
s_waitcnt lgkmcnt(6)
ds_read_b64_tr_b16 a[220:221], v2 offset:50272
ds_read_b64_tr_b16 a[222:223], v2 offset:52064
v_mfma_f32_16x16x32_bf16 v[212:215], a[232:235], a[100:103], v[212:215]
v_mul_f32 v61, v61, v47
v_lshlrev_b32 v46, 16, v41
v_mfma_f32_16x16x32_bf16 v[212:215], a[236:239], a[116:119], v[212:215]
v_and_b32 v47, 0xffff0000, v41
v_mul_f32 v62, v62, v46
v_mfma_f32_16x16x32_bf16 v[208:211], a[232:235], a[96:99], v[208:211]
v_mul_f32 v63, v63, v47
v_cvt_pk_bf16_f32 v48, v60, v61
v_mfma_f32_16x16x32_bf16 v[208:211], a[236:239], a[112:115], v[208:211]
s_waitcnt lgkmcnt(4)
ds_read_b64_tr_b16 a[224:225], v2 offset:28800
ds_read_b64_tr_b16 a[226:227], v2 offset:30592
v_mfma_f32_16x16x32_bf16 v[224:227], a[208:211], a[96:99], v[224:227]
buffer_load_dwordx4 v10, s[24:27], s58 offen lds
v_mfma_f32_16x16x32_bf16 v[224:227], a[212:215], a[112:115], v[224:227]
s_add_u32 m0, s56, 20480
v_cvt_pk_bf16_f32 v49, v62, v63
v_lshlrev_b32 v60, 16, v48
v_mfma_f32_16x16x32_bf16 v[228:231], a[208:211], a[100:103], v[228:231]
v_and_b32 v61, 0xffff0000, v48
v_lshlrev_b32 v62, 16, v49
v_mfma_f32_16x16x32_bf16 v[228:231], a[212:215], a[116:119], v[228:231]
s_waitcnt lgkmcnt(6)
ds_read_b64_tr_b16 a[228:229], v2 offset:35968
ds_read_b64_tr_b16 a[230:231], v2 offset:37760
v_mfma_f32_16x16x32_bf16 v[232:235], a[208:211], a[104:107], v[232:235]
buffer_load_dwordx4 v10, s[28:31], s58 offen lds
v_mfma_f32_16x16x32_bf16 v[232:235], a[212:215], a[120:123], v[232:235]
s_mov_b32 s59, 53248
v_and_b32 v63, 0xffff0000, v49
v_add_f32 v56, v56, v60
v_mfma_f32_16x16x32_bf16 v[236:239], a[208:211], a[108:111], v[236:239]
v_add_f32 v57, v57, v61
v_add_f32 v58, v58, v62
v_mfma_f32_16x16x32_bf16 v[236:239], a[212:215], a[124:127], v[236:239]
s_waitcnt lgkmcnt(4)
ds_read_b64_tr_b16 a[232:233], v2 offset:43136
ds_read_b64_tr_b16 a[234:235], v2 offset:44928
v_mfma_f32_16x16x32_bf16 v[252:255], a[216:219], a[108:111], v[252:255]
buffer_load_dwordx4 a[144:147], v1, s[8:11], s59 offen offset:0 sc1
v_mfma_f32_16x16x32_bf16 v[252:255], a[220:223], a[124:127], v[252:255]
v_add_f32 v59, v59, v63
v_accvgpr_write_b32 a160, v56
v_mfma_f32_16x16x32_bf16 v[248:251], a[216:219], a[104:107], v[248:251]
v_accvgpr_write_b32 a161, v57
v_accvgpr_write_b32 a162, v58
v_mfma_f32_16x16x32_bf16 v[248:251], a[220:223], a[120:123], v[248:251]
s_waitcnt lgkmcnt(6)
ds_read_b64_tr_b16 a[236:237], v2 offset:50304
ds_read_b64_tr_b16 a[238:239], v2 offset:52096
v_mfma_f32_16x16x32_bf16 v[244:247], a[216:219], a[100:103], v[244:247]
buffer_load_dwordx4 a[148:151], v1, s[8:11], s59 offen offset:1024 sc1
v_mfma_f32_16x16x32_bf16 v[244:247], a[220:223], a[116:119], v[244:247]
v_accvgpr_write_b32 a163, v59
v_lshlrev_b32 v56, 16, v54
v_mfma_f32_16x16x32_bf16 v[240:243], a[216:219], a[96:99], v[240:243]
v_and_b32 v57, 0xffff0000, v54
v_lshlrev_b32 v58, 16, v55
v_mfma_f32_16x16x32_bf16 v[240:243], a[220:223], a[112:115], v[240:243]
s_waitcnt lgkmcnt(4)
ds_read_b64_tr_b16 a[208:209], v2 offset:28832
ds_read_b64_tr_b16 a[210:211], v2 offset:30624
v_mfma_f32_16x16x32_bf16 a[0:3], a[224:227], a[96:99], a[0:3]
v_and_b32 v59, 0xffff0000, v55
v_sub_f32 v60, v56, v44
v_mfma_f32_16x16x32_bf16 a[0:3], a[228:231], a[112:115], a[0:3]
v_sub_f32 v61, v57, v44
v_sub_f32 v62, v58, v44
v_mfma_f32_16x16x32_bf16 a[4:7], a[224:227], a[100:103], a[4:7]
v_sub_f32 v63, v59, v44
v_cvt_pk_bf16_f32 v48, v60, v61
v_mfma_f32_16x16x32_bf16 a[4:7], a[228:231], a[116:119], a[4:7]
s_waitcnt lgkmcnt(6)
ds_read_b64_tr_b16 a[212:213], v2 offset:36000
ds_read_b64_tr_b16 a[214:215], v2 offset:37792
v_mfma_f32_16x16x32_bf16 a[8:11], a[224:227], a[104:107], a[8:11]
v_cvt_pk_bf16_f32 v49, v62, v63
v_lshlrev_b32 v60, 16, v48
v_mfma_f32_16x16x32_bf16 a[8:11], a[228:231], a[120:123], a[8:11]
buffer_load_dwordx4 a[152:155], v1, s[8:11], s59 offen offset:2048 sc1
v_mfma_f32_16x16x32_bf16 a[12:15], a[224:227], a[108:111], a[12:15]
v_and_b32 v61, 0xffff0000, v48
v_lshlrev_b32 v62, 16, v49
v_mfma_f32_16x16x32_bf16 a[12:15], a[228:231], a[124:127], a[12:15]
s_waitcnt lgkmcnt(4)
ds_read_b64_tr_b16 a[216:217], v2 offset:43168
ds_read_b64_tr_b16 a[218:219], v2 offset:44960
v_mfma_f32_16x16x32_bf16 a[28:31], a[232:235], a[108:111], a[28:31]
v_and_b32 v63, 0xffff0000, v49
v_mul_f32 v60, v60, v45
v_mfma_f32_16x16x32_bf16 a[28:31], a[236:239], a[124:127], a[28:31]
buffer_load_dwordx4 a[156:159], v1, s[8:11], s59 offen offset:3072 sc1
v_mfma_f32_16x16x32_bf16 a[24:27], a[232:235], a[104:107], a[24:27]
s_mov_b32 s57, 3211264
s_add_u32 m0, s54, 94208
v_mul_f32 v61, v61, v45
v_mfma_f32_16x16x32_bf16 a[24:27], a[236:239], a[120:123], a[24:27]
s_waitcnt lgkmcnt(6)
ds_read_b64_tr_b16 a[220:221], v2 offset:50336
ds_read_b64_tr_b16 a[222:223], v2 offset:52128
v_mfma_f32_16x16x32_bf16 a[20:23], a[232:235], a[100:103], a[20:23]
v_mul_f32 v62, v62, v45
v_mul_f32 v63, v63, v45
v_mfma_f32_16x16x32_bf16 a[20:23], a[236:239], a[116:119], a[20:23]
v_cvt_pk_bf16_f32 v48, v60, v61
v_cvt_pk_bf16_f32 v49, v62, v63
v_mfma_f32_16x16x32_bf16 a[16:19], a[232:235], a[96:99], a[16:19]
buffer_load_dwordx4 v6, s[12:15], s57 offen lds
v_mfma_f32_16x16x32_bf16 a[16:19], a[236:239], a[112:115], a[16:19]
s_waitcnt lgkmcnt(4)
ds_read_b64_tr_b16 a[224:225], v2 offset:28864
ds_read_b64_tr_b16 a[226:227], v2 offset:30656
v_mfma_f32_16x16x32_bf16 a[32:35], a[208:211], a[96:99], a[32:35]
s_mov_b32 s59, 57344
v_lshlrev_b32 v60, 16, v48
v_and_b32 v61, 0xffff0000, v48
v_mfma_f32_16x16x32_bf16 a[32:35], a[212:215], a[112:115], a[32:35]
v_lshlrev_b32 v62, 16, v49
v_and_b32 v63, 0xffff0000, v49
v_mfma_f32_16x16x32_bf16 a[36:39], a[208:211], a[100:103], a[36:39]
v_lshlrev_b32 v46, 16, v42
v_and_b32 v47, 0xffff0000, v42
v_mfma_f32_16x16x32_bf16 a[36:39], a[212:215], a[116:119], a[36:39]
s_waitcnt lgkmcnt(6)
ds_read_b64_tr_b16 a[228:229], v2 offset:36032
ds_read_b64_tr_b16 a[230:231], v2 offset:37824
v_mfma_f32_16x16x32_bf16 a[40:43], a[208:211], a[104:107], a[40:43]
buffer_load_dwordx4 a[192:195], v1, s[8:11], s59 offen offset:0 sc1
v_mfma_f32_16x16x32_bf16 a[40:43], a[212:215], a[120:123], a[40:43]
s_add_u32 m0, s54, 98304
v_mul_f32 v60, v60, v46
v_mul_f32 v61, v61, v47
v_mfma_f32_16x16x32_bf16 a[44:47], a[208:211], a[108:111], a[44:47]
v_lshlrev_b32 v46, 16, v43
v_and_b32 v47, 0xffff0000, v43
v_mfma_f32_16x16x32_bf16 a[44:47], a[212:215], a[124:127], a[44:47]
s_waitcnt lgkmcnt(4)
ds_read_b64_tr_b16 a[232:233], v2 offset:43200
ds_read_b64_tr_b16 a[234:235], v2 offset:44992
v_mfma_f32_16x16x32_bf16 a[60:63], a[216:219], a[108:111], a[60:63]
v_mul_f32 v62, v62, v46
v_mul_f32 v63, v63, v47
v_mfma_f32_16x16x32_bf16 a[60:63], a[220:223], a[124:127], a[60:63]
v_cvt_pk_bf16_f32 v48, v60, v61
v_cvt_pk_bf16_f32 v49, v62, v63
v_mfma_f32_16x16x32_bf16 a[56:59], a[216:219], a[104:107], a[56:59]
v_lshlrev_b32 v60, 16, v48
v_and_b32 v61, 0xffff0000, v48
v_mfma_f32_16x16x32_bf16 a[56:59], a[220:223], a[120:123], a[56:59]
s_waitcnt lgkmcnt(6)
ds_read_b64_tr_b16 a[236:237], v2 offset:50368
ds_read_b64_tr_b16 a[238:239], v2 offset:52160
v_mfma_f32_16x16x32_bf16 a[52:55], a[216:219], a[100:103], a[52:55]
buffer_load_dwordx4 v7, s[12:15], s57 offen lds
v_mfma_f32_16x16x32_bf16 a[52:55], a[220:223], a[116:119], a[52:55]
v_lshlrev_b32 v62, 16, v49
v_and_b32 v63, 0xffff0000, v49
v_mfma_f32_16x16x32_bf16 a[48:51], a[216:219], a[96:99], a[48:51]
v_add_f32 v56, v56, v60
v_add_f32 v57, v57, v61
v_mfma_f32_16x16x32_bf16 a[48:51], a[220:223], a[112:115], a[48:51]
s_waitcnt lgkmcnt(4)
ds_read_b128 a[208:211], v3 offset:8192
v_add_f32 v58, v58, v62
v_mfma_f32_16x16x32_bf16 a[64:67], a[224:227], a[96:99], a[64:67]
buffer_load_dwordx4 a[196:199], v1, s[8:11], s59 offen offset:1024 sc1
v_mfma_f32_16x16x32_bf16 a[64:67], a[228:231], a[112:115], a[64:67]
s_add_u32 m0, s54, 102400
v_add_f32 v59, v59, v63
v_accvgpr_write_b32 a176, v56
v_mfma_f32_16x16x32_bf16 a[68:71], a[224:227], a[100:103], a[68:71]
v_accvgpr_write_b32 a177, v57
v_accvgpr_write_b32 a178, v58
v_mfma_f32_16x16x32_bf16 a[68:71], a[228:231], a[116:119], a[68:71]
ds_read_b128 a[212:215], v4 offset:8192
v_accvgpr_write_b32 a179, v59
v_mfma_f32_16x16x32_bf16 a[72:75], a[224:227], a[104:107], a[72:75]
buffer_load_dwordx2 v[44:45], v50, s[36:39], s66 offen offset:256 sc1
v_mfma_f32_16x16x32_bf16 a[72:75], a[228:231], a[120:123], a[72:75]
v_mfma_f32_16x16x32_bf16 a[76:79], a[224:227], a[108:111], a[76:79]
v_mfma_f32_16x16x32_bf16 a[76:79], a[228:231], a[124:127], a[76:79]
s_waitcnt lgkmcnt(2)
ds_read_b128 a[216:219], v3 offset:12288
v_mfma_f32_16x16x32_bf16 a[92:95], a[232:235], a[108:111], a[92:95]
v_mfma_f32_16x16x32_bf16 a[92:95], a[236:239], a[124:127], a[92:95]
buffer_load_dwordx4 v8, s[12:15], s57 offen lds
v_mfma_f32_16x16x32_bf16 a[88:91], a[232:235], a[104:107], a[88:91]
v_mfma_f32_16x16x32_bf16 a[88:91], a[236:239], a[120:123], a[88:91]
ds_read_b128 a[220:223], v4 offset:12288
v_mfma_f32_16x16x32_bf16 a[84:87], a[232:235], a[100:103], a[84:87]
v_mfma_f32_16x16x32_bf16 a[84:87], a[236:239], a[116:119], a[84:87]
buffer_load_dwordx4 a[200:203], v1, s[8:11], s59 offen offset:2048 sc1
v_mfma_f32_16x16x32_bf16 a[80:83], a[232:235], a[96:99], a[80:83]
s_add_u32 m0, s55, 94208
v_mfma_f32_16x16x32_bf16 a[80:83], a[236:239], a[112:115], a[80:83]
s_waitcnt lgkmcnt(2)
ds_read_b128 a[224:227], v3 offset:10240
ds_read_b128 a[228:231], v4 offset:10240
v_mfma_f32_16x16x32_bf16 v[64:67], a[96:99], a[208:211], v[64:67]
v_mfma_f32_16x16x32_bf16 v[64:67], a[112:115], a[212:215], v[64:67]
v_mfma_f32_16x16x32_bf16 v[68:71], a[100:103], a[208:211], v[68:71]
buffer_load_dwordx4 v9, s[20:23], s57 offen lds
v_mfma_f32_16x16x32_bf16 v[68:71], a[116:119], a[212:215], v[68:71]
s_waitcnt lgkmcnt(4)
ds_read_b128 a[232:235], v3 offset:14336
ds_read_b128 a[236:239], v4 offset:14336
v_mfma_f32_16x16x32_bf16 v[72:75], a[104:107], a[208:211], v[72:75]
v_mfma_f32_16x16x32_bf16 v[72:75], a[120:123], a[212:215], v[72:75]
v_mfma_f32_16x16x32_bf16 v[76:79], a[108:111], a[208:211], v[76:79]
v_mfma_f32_16x16x32_bf16 v[76:79], a[124:127], a[212:215], v[76:79]
s_waitcnt lgkmcnt(4)
v_mfma_f32_16x16x32_bf16 v[108:111], a[108:111], a[216:219], v[108:111]
buffer_load_dwordx4 a[204:207], v1, s[8:11], s59 offen offset:3072 sc1
v_mfma_f32_16x16x32_bf16 v[108:111], a[124:127], a[220:223], v[108:111]
s_add_u32 m0, s54, 108544
v_mfma_f32_16x16x32_bf16 v[104:107], a[104:107], a[216:219], v[104:107]
v_mfma_f32_16x16x32_bf16 v[104:107], a[120:123], a[220:223], v[104:107]
v_mfma_f32_16x16x32_bf16 v[100:103], a[100:103], a[216:219], v[100:103]
v_mfma_f32_16x16x32_bf16 v[100:103], a[116:119], a[220:223], v[100:103]
v_mfma_f32_16x16x32_bf16 v[96:99], a[96:99], a[216:219], v[96:99]
s_waitcnt vmcnt(13) lgkmcnt(0)
s_barrier
v_mfma_f32_16x16x32_bf16 v[96:99], a[112:115], a[220:223], v[96:99]
s_waitcnt lgkmcnt(2)
ds_read_b64_tr_b16 a[208:209], v5 offset:0
ds_read_b64_tr_b16 a[210:211], v5 offset:1792
v_mfma_f32_16x16x32_bf16 v[80:83], a[96:99], a[224:227], v[80:83]
buffer_load_dwordx4 v6, s[16:19], s57 offen lds
v_mfma_f32_16x16x32_bf16 v[80:83], a[112:115], a[228:231], v[80:83]
s_add_u32 m0, s54, 112640
v_mfma_f32_16x16x32_bf16 v[84:87], a[100:103], a[224:227], v[84:87]
v_mfma_f32_16x16x32_bf16 v[84:87], a[116:119], a[228:231], v[84:87]
s_waitcnt lgkmcnt(4)
ds_read_b64_tr_b16 a[212:213], v5 offset:7168
ds_read_b64_tr_b16 a[214:215], v5 offset:8960
v_mfma_f32_16x16x32_bf16 v[88:91], a[104:107], a[224:227], v[88:91]
v_mfma_f32_16x16x32_bf16 v[88:91], a[120:123], a[228:231], v[88:91]
v_mfma_f32_16x16x32_bf16 v[92:95], a[108:111], a[224:227], v[92:95]
v_mfma_f32_16x16x32_bf16 v[92:95], a[124:127], a[228:231], v[92:95]
s_waitcnt lgkmcnt(4)
ds_read_b64_tr_b16 a[216:217], v5 offset:14336
ds_read_b64_tr_b16 a[218:219], v5 offset:16128
v_mfma_f32_16x16x32_bf16 v[124:127], a[108:111], a[232:235], v[124:127]
v_mfma_f32_16x16x32_bf16 v[124:127], a[124:127], a[236:239], v[124:127]
v_mfma_f32_16x16x32_bf16 v[120:123], a[104:107], a[232:235], v[120:123]
v_mfma_f32_16x16x32_bf16 v[120:123], a[120:123], a[236:239], v[120:123]
s_waitcnt lgkmcnt(6)
ds_read_b64_tr_b16 a[220:221], v5 offset:21504
ds_read_b64_tr_b16 a[222:223], v5 offset:23296
v_mfma_f32_16x16x32_bf16 v[116:119], a[100:103], a[232:235], v[116:119]
v_mfma_f32_16x16x32_bf16 v[116:119], a[116:119], a[236:239], v[116:119]
buffer_load_dwordx4 v7, s[16:19], s57 offen lds
v_mfma_f32_16x16x32_bf16 v[112:115], a[96:99], a[232:235], v[112:115]
s_mov_b32 s59, 61440
v_mfma_f32_16x16x32_bf16 v[112:115], a[112:115], a[236:239], v[112:115]
s_waitcnt vmcnt(11) lgkmcnt(4)
ds_read_b64_tr_b16 a[224:225], v5 offset:32
ds_read_b64_tr_b16 a[226:227], v5 offset:1824
v_mfma_f32_16x16x32_bf16 v[128:131], a[208:211], a[128:131], v[128:131]
v_mfma_f32_16x16x32_bf16 v[128:131], a[212:215], a[144:147], v[128:131]
v_mfma_f32_16x16x32_bf16 v[132:135], a[208:211], a[132:135], v[132:135]
buffer_load_dwordx4 a[96:99], v1, s[8:11], s59 offen offset:0 sc1
v_mfma_f32_16x16x32_bf16 v[132:135], a[212:215], a[148:151], v[132:135]
s_waitcnt lgkmcnt(6)
ds_read_b64_tr_b16 a[228:229], v5 offset:7200
ds_read_b64_tr_b16 a[230:231], v5 offset:8992
v_mfma_f32_16x16x32_bf16 v[136:139], a[208:211], a[136:139], v[136:139]
s_add_u32 m0, s54, 116736
v_mfma_f32_16x16x32_bf16 v[136:139], a[212:215], a[152:155], v[136:139]
v_mfma_f32_16x16x32_bf16 v[140:143], a[208:211], a[140:143], v[140:143]
buffer_load_dwordx4 v8, s[16:19], s57 offen lds
v_mfma_f32_16x16x32_bf16 v[140:143], a[212:215], a[156:159], v[140:143]
s_waitcnt lgkmcnt(4)
ds_read_b64_tr_b16 a[232:233], v5 offset:14368
ds_read_b64_tr_b16 a[234:235], v5 offset:16160
v_mfma_f32_16x16x32_bf16 v[156:159], a[216:219], a[140:143], v[156:159]
v_mfma_f32_16x16x32_bf16 v[156:159], a[220:223], a[156:159], v[156:159]
v_mfma_f32_16x16x32_bf16 v[152:155], a[216:219], a[136:139], v[152:155]
v_mfma_f32_16x16x32_bf16 v[152:155], a[220:223], a[152:155], v[152:155]
s_waitcnt lgkmcnt(6)
ds_read_b64_tr_b16 a[236:237], v5 offset:21536
ds_read_b64_tr_b16 a[238:239], v5 offset:23328
v_mfma_f32_16x16x32_bf16 v[148:151], a[216:219], a[132:135], v[148:151]
buffer_load_dwordx4 a[100:103], v1, s[8:11], s59 offen offset:1024 sc1
v_mfma_f32_16x16x32_bf16 v[148:151], a[220:223], a[148:151], v[148:151]
s_movk_i32 s58, 896
s_add_u32 m0, s56, 24576
v_mfma_f32_16x16x32_bf16 v[144:147], a[216:219], a[128:131], v[144:147]
v_mfma_f32_16x16x32_bf16 v[144:147], a[220:223], a[144:147], v[144:147]
s_waitcnt lgkmcnt(4)
ds_read_b64_tr_b16 a[208:209], v5 offset:64
ds_read_b64_tr_b16 a[210:211], v5 offset:1856
v_mfma_f32_16x16x32_bf16 v[160:163], a[224:227], a[128:131], v[160:163]
buffer_load_dwordx4 v10, s[24:27], s58 offen lds
v_mfma_f32_16x16x32_bf16 v[160:163], a[228:231], a[144:147], v[160:163]
s_add_u32 m0, s56, 28672
v_mfma_f32_16x16x32_bf16 v[164:167], a[224:227], a[132:135], v[164:167]
v_mfma_f32_16x16x32_bf16 v[164:167], a[228:231], a[148:151], v[164:167]
s_waitcnt lgkmcnt(6)
ds_read_b64_tr_b16 a[212:213], v5 offset:7232
ds_read_b64_tr_b16 a[214:215], v5 offset:9024
v_mfma_f32_16x16x32_bf16 v[168:171], a[224:227], a[136:139], v[168:171]
buffer_load_dwordx4 v10, s[28:31], s58 offen lds
v_mfma_f32_16x16x32_bf16 v[168:171], a[228:231], a[152:155], v[168:171]
v_mfma_f32_16x16x32_bf16 v[172:175], a[224:227], a[140:143], v[172:175]
v_mfma_f32_16x16x32_bf16 v[172:175], a[228:231], a[156:159], v[172:175]
s_waitcnt lgkmcnt(4)
ds_read_b64_tr_b16 a[216:217], v5 offset:14400
ds_read_b64_tr_b16 a[218:219], v5 offset:16192
v_mfma_f32_16x16x32_bf16 v[188:191], a[232:235], a[140:143], v[188:191]
v_mfma_f32_16x16x32_bf16 v[188:191], a[236:239], a[156:159], v[188:191]
v_mfma_f32_16x16x32_bf16 v[184:187], a[232:235], a[136:139], v[184:187]
v_mfma_f32_16x16x32_bf16 v[184:187], a[236:239], a[152:155], v[184:187]
s_waitcnt lgkmcnt(6)
ds_read_b64_tr_b16 a[220:221], v5 offset:21568
ds_read_b64_tr_b16 a[222:223], v5 offset:23360
v_mfma_f32_16x16x32_bf16 v[180:183], a[232:235], a[132:135], v[180:183]
v_mfma_f32_16x16x32_bf16 v[180:183], a[236:239], a[148:151], v[180:183]
v_mfma_f32_16x16x32_bf16 v[176:179], a[232:235], a[128:131], v[176:179]
v_mfma_f32_16x16x32_bf16 v[176:179], a[236:239], a[144:147], v[176:179]
s_waitcnt lgkmcnt(4)
ds_read_b64_tr_b16 a[224:225], v5 offset:96
ds_read_b64_tr_b16 a[226:227], v5 offset:1888
v_mfma_f32_16x16x32_bf16 v[192:195], a[208:211], a[128:131], v[192:195]
v_mfma_f32_16x16x32_bf16 v[192:195], a[212:215], a[144:147], v[192:195]
buffer_load_dwordx4 a[104:107], v1, s[8:11], s59 offen offset:2048 sc1
v_mfma_f32_16x16x32_bf16 v[196:199], a[208:211], a[132:135], v[196:199]
v_mfma_f32_16x16x32_bf16 v[196:199], a[212:215], a[148:151], v[196:199]
s_waitcnt lgkmcnt(6)
ds_read_b64_tr_b16 a[228:229], v5 offset:7264
ds_read_b64_tr_b16 a[230:231], v5 offset:9056
v_mfma_f32_16x16x32_bf16 v[200:203], a[208:211], a[136:139], v[200:203]
v_mfma_f32_16x16x32_bf16 v[200:203], a[212:215], a[152:155], v[200:203]
v_mfma_f32_16x16x32_bf16 v[204:207], a[208:211], a[140:143], v[204:207]
buffer_load_dwordx4 a[108:111], v1, s[8:11], s59 offen offset:3072 sc1
v_mfma_f32_16x16x32_bf16 v[204:207], a[212:215], a[156:159], v[204:207]
s_waitcnt lgkmcnt(4)
ds_read_b64_tr_b16 a[232:233], v5 offset:14432
ds_read_b64_tr_b16 a[234:235], v5 offset:16224
v_mfma_f32_16x16x32_bf16 v[220:223], a[216:219], a[140:143], v[220:223]
s_mov_b32 s57, 3670016
s_add_u32 m0, s54, 0
v_mfma_f32_16x16x32_bf16 v[220:223], a[220:223], a[156:159], v[220:223]
v_mfma_f32_16x16x32_bf16 v[216:219], a[216:219], a[136:139], v[216:219]
buffer_load_dwordx4 v6, s[12:15], s57 offen lds
v_mfma_f32_16x16x32_bf16 v[216:219], a[220:223], a[152:155], v[216:219]
s_waitcnt lgkmcnt(6)
ds_read_b64_tr_b16 a[236:237], v5 offset:21600
ds_read_b64_tr_b16 a[238:239], v5 offset:23392
v_mfma_f32_16x16x32_bf16 v[212:215], a[216:219], a[132:135], v[212:215]
s_add_u32 m0, s54, 4096
v_mfma_f32_16x16x32_bf16 v[212:215], a[220:223], a[148:151], v[212:215]
v_mfma_f32_16x16x32_bf16 v[208:211], a[216:219], a[128:131], v[208:211]
v_mfma_f32_16x16x32_bf16 v[208:211], a[220:223], a[144:147], v[208:211]
s_waitcnt lgkmcnt(4)
ds_read_b64_tr_b16 a[208:209], v5 offset:128
ds_read_b64_tr_b16 a[210:211], v5 offset:1920
v_mfma_f32_16x16x32_bf16 v[224:227], a[224:227], a[128:131], v[224:227]
buffer_load_dwordx4 v7, s[12:15], s57 offen lds
v_mfma_f32_16x16x32_bf16 v[224:227], a[228:231], a[144:147], v[224:227]
s_add_u32 m0, s54, 8192
v_mfma_f32_16x16x32_bf16 v[228:231], a[224:227], a[132:135], v[228:231]
v_mfma_f32_16x16x32_bf16 v[228:231], a[228:231], a[148:151], v[228:231]
s_waitcnt lgkmcnt(6)
ds_read_b64_tr_b16 a[212:213], v5 offset:7296
ds_read_b64_tr_b16 a[214:215], v5 offset:9088
v_mfma_f32_16x16x32_bf16 v[232:235], a[224:227], a[136:139], v[232:235]
buffer_load_dwordx4 v8, s[12:15], s57 offen lds
v_mfma_f32_16x16x32_bf16 v[232:235], a[228:231], a[152:155], v[232:235]
s_mov_b32 s59, 65536
v_mfma_f32_16x16x32_bf16 v[236:239], a[224:227], a[140:143], v[236:239]
v_mfma_f32_16x16x32_bf16 v[236:239], a[228:231], a[156:159], v[236:239]
s_waitcnt lgkmcnt(4)
ds_read_b64_tr_b16 a[216:217], v5 offset:14464
ds_read_b64_tr_b16 a[218:219], v5 offset:16256
v_mfma_f32_16x16x32_bf16 v[252:255], a[232:235], a[140:143], v[252:255]
s_waitcnt vmcnt(16)
ds_read_b64 v[52:53], v11 offset:1024
ds_read_b64 v[54:55], v11 offset:1056
v_mfma_f32_16x16x32_bf16 v[252:255], a[236:239], a[156:159], v[252:255]
v_mfma_f32_16x16x32_bf16 v[248:251], a[232:235], a[136:139], v[248:251]
buffer_load_dwordx4 a[112:115], v1, s[8:11], s59 offen offset:0 sc1
v_mfma_f32_16x16x32_bf16 v[248:251], a[236:239], a[152:155], v[248:251]
s_waitcnt lgkmcnt(8)
ds_read_b64_tr_b16 a[220:221], v5 offset:21632
ds_read_b64_tr_b16 a[222:223], v5 offset:23424
v_mfma_f32_16x16x32_bf16 v[244:247], a[232:235], a[132:135], v[244:247]
v_mfma_f32_16x16x32_bf16 v[244:247], a[236:239], a[148:151], v[244:247]
v_mfma_f32_16x16x32_bf16 v[240:243], a[232:235], a[128:131], v[240:243]
v_mfma_f32_16x16x32_bf16 v[240:243], a[236:239], a[144:147], v[240:243]
s_waitcnt lgkmcnt(6)
ds_read_b64_tr_b16 a[224:225], v5 offset:160
ds_read_b64_tr_b16 a[226:227], v5 offset:1952
v_mfma_f32_16x16x32_bf16 a[0:3], a[208:211], a[128:131], a[0:3]
v_mfma_f32_16x16x32_bf16 a[0:3], a[212:215], a[144:147], a[0:3]
v_mfma_f32_16x16x32_bf16 a[4:7], a[208:211], a[132:135], a[4:7]
s_waitcnt lgkmcnt(4)
v_lshlrev_b32 v56, 16, v52
v_and_b32 v57, 0xffff0000, v52
v_mfma_f32_16x16x32_bf16 a[4:7], a[212:215], a[148:151], a[4:7]
s_waitcnt lgkmcnt(8)
ds_read_b64_tr_b16 a[228:229], v5 offset:7328
ds_read_b64_tr_b16 a[230:231], v5 offset:9120
v_mfma_f32_16x16x32_bf16 a[8:11], a[208:211], a[136:139], a[8:11]
v_lshlrev_b32 v58, 16, v53
v_and_b32 v59, 0xffff0000, v53
v_mfma_f32_16x16x32_bf16 a[8:11], a[212:215], a[152:155], a[8:11]
v_sub_f32 v60, v56, v44
v_sub_f32 v61, v57, v44
v_mfma_f32_16x16x32_bf16 a[12:15], a[208:211], a[140:143], a[12:15]
v_sub_f32 v62, v58, v44
v_sub_f32 v63, v59, v44
v_mfma_f32_16x16x32_bf16 a[12:15], a[212:215], a[156:159], a[12:15]
s_waitcnt lgkmcnt(4)
ds_read_b64_tr_b16 a[232:233], v5 offset:14496
ds_read_b64_tr_b16 a[234:235], v5 offset:16288
v_mfma_f32_16x16x32_bf16 a[28:31], a[216:219], a[140:143], a[28:31]
v_cvt_pk_bf16_f32 v48, v60, v61
v_cvt_pk_bf16_f32 v49, v62, v63
v_mfma_f32_16x16x32_bf16 a[28:31], a[220:223], a[156:159], a[28:31]
v_lshlrev_b32 v60, 16, v48
v_and_b32 v61, 0xffff0000, v48
v_mfma_f32_16x16x32_bf16 a[24:27], a[216:219], a[136:139], a[24:27]
buffer_load_dword a246, v13, s[40:43], s77 offen
v_mfma_f32_16x16x32_bf16 a[24:27], a[220:223], a[152:155], a[24:27]
s_waitcnt lgkmcnt(6)
ds_read_b64_tr_b16 a[236:237], v5 offset:21664
ds_read_b64_tr_b16 a[238:239], v5 offset:23456
v_mfma_f32_16x16x32_bf16 a[20:23], a[216:219], a[132:135], a[20:23]
s_add_u32 s77, s77, s76
v_lshlrev_b32 v62, 16, v49
v_and_b32 v63, 0xffff0000, v49
v_mfma_f32_16x16x32_bf16 a[20:23], a[220:223], a[148:151], a[20:23]
v_mul_f32 v60, v60, v45
v_mul_f32 v61, v61, v45
v_mfma_f32_16x16x32_bf16 a[16:19], a[216:219], a[128:131], a[16:19]
v_mul_f32 v62, v62, v45
v_mul_f32 v63, v63, v45
v_mfma_f32_16x16x32_bf16 a[16:19], a[220:223], a[144:147], a[16:19]
s_waitcnt lgkmcnt(4)
ds_read_b64_tr_b16 a[208:209], v5 offset:192
ds_read_b64_tr_b16 a[210:211], v5 offset:1984
v_mfma_f32_16x16x32_bf16 a[32:35], a[224:227], a[128:131], a[32:35]
buffer_load_dword a246, v13, s[40:43], s77 offen
v_mfma_f32_16x16x32_bf16 a[32:35], a[228:231], a[144:147], a[32:35]
s_add_u32 s77, s77, s76
v_cvt_pk_bf16_f32 v48, v60, v61
v_cvt_pk_bf16_f32 v49, v62, v63
v_mfma_f32_16x16x32_bf16 a[36:39], a[224:227], a[132:135], a[36:39]
v_lshlrev_b32 v60, 16, v48
v_and_b32 v61, 0xffff0000, v48
v_mfma_f32_16x16x32_bf16 a[36:39], a[228:231], a[148:151], a[36:39]
s_waitcnt lgkmcnt(6)
ds_read_b64_tr_b16 a[212:213], v5 offset:7360
ds_read_b64_tr_b16 a[214:215], v5 offset:9152
v_mfma_f32_16x16x32_bf16 a[40:43], a[224:227], a[136:139], a[40:43]
buffer_load_dword a246, v14, s[44:47], s78 offen
v_mfma_f32_16x16x32_bf16 a[40:43], a[228:231], a[152:155], a[40:43]
s_add_u32 s78, s78, s80
s_add_u32 m0, s55, 0
v_lshlrev_b32 v62, 16, v49
v_mfma_f32_16x16x32_bf16 a[44:47], a[224:227], a[140:143], a[44:47]
v_and_b32 v63, 0xffff0000, v49
v_lshlrev_b32 v46, 16, v40
v_mfma_f32_16x16x32_bf16 a[44:47], a[228:231], a[156:159], a[44:47]
s_waitcnt lgkmcnt(4)
ds_read_b64_tr_b16 a[216:217], v5 offset:14528
ds_read_b64_tr_b16 a[218:219], v5 offset:16320
v_mfma_f32_16x16x32_bf16 a[60:63], a[232:235], a[140:143], a[60:63]
buffer_load_dwordx4 v9, s[20:23], s57 offen lds
v_mfma_f32_16x16x32_bf16 a[60:63], a[236:239], a[156:159], a[60:63]
v_and_b32 v47, 0xffff0000, v40
v_mul_f32 v60, v60, v46
v_mfma_f32_16x16x32_bf16 a[56:59], a[232:235], a[136:139], a[56:59]
v_mul_f32 v61, v61, v47
v_lshlrev_b32 v46, 16, v41
v_mfma_f32_16x16x32_bf16 a[56:59], a[236:239], a[152:155], a[56:59]
s_waitcnt lgkmcnt(6)
ds_read_b64_tr_b16 a[220:221], v5 offset:21696
ds_read_b64_tr_b16 a[222:223], v5 offset:23488
v_mfma_f32_16x16x32_bf16 a[52:55], a[232:235], a[132:135], a[52:55]
v_and_b32 v47, 0xffff0000, v41
v_mul_f32 v62, v62, v46
v_mfma_f32_16x16x32_bf16 a[52:55], a[236:239], a[148:151], a[52:55]
L_tr4:
s_cbranch_execz L_tr8
v_mul_f32 v63, v63, v47
v_cvt_pk_bf16_f32 v48, v60, v61
v_mfma_f32_16x16x32_bf16 a[48:51], a[232:235], a[128:131], a[48:51]
buffer_load_dwordx4 a[116:119], v1, s[8:11], s59 offen offset:1024 sc1
v_mfma_f32_16x16x32_bf16 a[48:51], a[236:239], a[144:147], a[48:51]
s_waitcnt lgkmcnt(4)
ds_read_b128 a[224:227], v3 offset:16384
s_add_u32 m0, s54, 14336
v_mfma_f32_16x16x32_bf16 a[64:67], a[208:211], a[128:131], a[64:67]
v_cvt_pk_bf16_f32 v49, v62, v63
v_lshlrev_b32 v60, 16, v48
v_mfma_f32_16x16x32_bf16 a[64:67], a[212:215], a[144:147], a[64:67]
v_and_b32 v61, 0xffff0000, v48
v_lshlrev_b32 v62, 16, v49
v_mfma_f32_16x16x32_bf16 a[68:71], a[208:211], a[132:135], a[68:71]
v_and_b32 v63, 0xffff0000, v49
v_add_f32 v56, v56, v60
v_mfma_f32_16x16x32_bf16 a[68:71], a[212:215], a[148:151], a[68:71]
ds_read_b128 a[228:231], v4 offset:16384
v_add_f32 v57, v57, v61
v_mfma_f32_16x16x32_bf16 a[72:75], a[208:211], a[136:139], a[72:75]
v_add_f32 v58, v58, v62
v_add_f32 v59, v59, v63
v_mfma_f32_16x16x32_bf16 a[72:75], a[212:215], a[152:155], a[72:75]
v_accvgpr_write_b32 a164, v56
v_accvgpr_write_b32 a165, v57
v_mfma_f32_16x16x32_bf16 a[76:79], a[208:211], a[140:143], a[76:79]
v_accvgpr_write_b32 a166, v58
v_accvgpr_write_b32 a167, v59
v_mfma_f32_16x16x32_bf16 a[76:79], a[212:215], a[156:159], a[76:79]
s_waitcnt lgkmcnt(2)
ds_read_b128 a[232:235], v3 offset:20480
v_lshlrev_b32 v56, 16, v54
v_mfma_f32_16x16x32_bf16 a[92:95], a[216:219], a[140:143], a[92:95]
v_and_b32 v57, 0xffff0000, v54
v_lshlrev_b32 v58, 16, v55
v_mfma_f32_16x16x32_bf16 a[92:95], a[220:223], a[156:159], a[92:95]
v_and_b32 v59, 0xffff0000, v55
v_sub_f32 v60, v56, v44
v_mfma_f32_16x16x32_bf16 a[88:91], a[216:219], a[136:139], a[88:91]
v_sub_f32 v61, v57, v44
v_sub_f32 v62, v58, v44
v_mfma_f32_16x16x32_bf16 a[88:91], a[220:223], a[152:155], a[88:91]
ds_read_b128 a[236:239], v4 offset:20480
v_sub_f32 v63, v59, v44
v_mfma_f32_16x16x32_bf16 a[84:87], a[216:219], a[132:135], a[84:87]
v_cvt_pk_bf16_f32 v48, v60, v61
v_cvt_pk_bf16_f32 v49, v62, v63
v_mfma_f32_16x16x32_bf16 a[84:87], a[220:223], a[148:151], a[84:87]
v_lshlrev_b32 v60, 16, v48
v_and_b32 v61, 0xffff0000, v48
v_mfma_f32_16x16x32_bf16 a[80:83], a[216:219], a[128:131], a[80:83]
v_lshlrev_b32 v62, 16, v49
v_and_b32 v63, 0xffff0000, v49
v_mfma_f32_16x16x32_bf16 a[80:83], a[220:223], a[144:147], a[80:83]
s_waitcnt lgkmcnt(2)
ds_read_b128 a[208:211], v3 offset:18432
ds_read_b128 a[212:215], v4 offset:18432
v_mfma_f32_16x16x32_bf16 v[64:67], a[128:131], a[224:227], v[64:67]
v_mul_f32 v60, v60, v45
v_mul_f32 v61, v61, v45
v_mfma_f32_16x16x32_bf16 v[64:67], a[144:147], a[228:231], v[64:67]
v_mul_f32 v62, v62, v45
v_mul_f32 v63, v63, v45
v_mfma_f32_16x16x32_bf16 v[68:71], a[132:135], a[224:227], v[68:71]
v_cvt_pk_bf16_f32 v48, v60, v61
v_cvt_pk_bf16_f32 v49, v62, v63
v_mfma_f32_16x16x32_bf16 v[68:71], a[148:151], a[228:231], v[68:71]
s_waitcnt lgkmcnt(4)
ds_read_b128 a[216:219], v3 offset:22528
ds_read_b128 a[220:223], v4 offset:22528
v_mfma_f32_16x16x32_bf16 v[72:75], a[136:139], a[224:227], v[72:75]
v_lshlrev_b32 v60, 16, v48
v_and_b32 v61, 0xffff0000, v48
v_mfma_f32_16x16x32_bf16 v[72:75], a[152:155], a[228:231], v[72:75]
v_lshlrev_b32 v62, 16, v49
v_and_b32 v63, 0xffff0000, v49
v_mfma_f32_16x16x32_bf16 v[76:79], a[140:143], a[224:227], v[76:79]
v_lshlrev_b32 v46, 16, v42
v_and_b32 v47, 0xffff0000, v42
v_mfma_f32_16x16x32_bf16 v[76:79], a[156:159], a[228:231], v[76:79]
s_waitcnt lgkmcnt(4)
v_mul_f32 v60, v60, v46
v_mul_f32 v61, v61, v47
v_mfma_f32_16x16x32_bf16 v[108:111], a[140:143], a[232:235], v[108:111]
v_lshlrev_b32 v46, 16, v43
v_and_b32 v47, 0xffff0000, v43
v_mfma_f32_16x16x32_bf16 v[108:111], a[156:159], a[236:239], v[108:111]
v_mul_f32 v62, v62, v46
v_mul_f32 v63, v63, v47
v_mfma_f32_16x16x32_bf16 v[104:107], a[136:139], a[232:235], v[104:107]
v_cvt_pk_bf16_f32 v48, v60, v61
v_cvt_pk_bf16_f32 v49, v62, v63
v_mfma_f32_16x16x32_bf16 v[104:107], a[152:155], a[236:239], v[104:107]
v_lshlrev_b32 v60, 16, v48
v_and_b32 v61, 0xffff0000, v48
v_mfma_f32_16x16x32_bf16 v[100:103], a[132:135], a[232:235], v[100:103]
v_lshlrev_b32 v62, 16, v49
v_and_b32 v63, 0xffff0000, v49
v_mfma_f32_16x16x32_bf16 v[100:103], a[148:151], a[236:239], v[100:103]
v_add_f32 v56, v56, v60
v_add_f32 v57, v57, v61
v_mfma_f32_16x16x32_bf16 v[96:99], a[128:131], a[232:235], v[96:99]
s_waitcnt vmcnt(11) lgkmcnt(0)
s_barrier
v_add_f32 v58, v58, v62
v_mfma_f32_16x16x32_bf16 v[96:99], a[144:147], a[236:239], v[96:99]
s_waitcnt lgkmcnt(2)
ds_read_b64_tr_b16 a[224:225], v5 offset:28672
ds_read_b64_tr_b16 a[226:227], v5 offset:30464
v_mfma_f32_16x16x32_bf16 v[80:83], a[128:131], a[208:211], v[80:83]
v_add_f32 v59, v59, v63
v_accvgpr_write_b32 a180, v56
v_mfma_f32_16x16x32_bf16 v[80:83], a[144:147], a[212:215], v[80:83]
v_accvgpr_write_b32 a181, v57
v_accvgpr_write_b32 a182, v58
v_mfma_f32_16x16x32_bf16 v[84:87], a[132:135], a[208:211], v[84:87]
v_accvgpr_write_b32 a183, v59
v_mfma_f32_16x16x32_bf16 v[84:87], a[148:151], a[212:215], v[84:87]
s_waitcnt lgkmcnt(4)
ds_read_b64_tr_b16 a[228:229], v5 offset:35840
ds_read_b64_tr_b16 a[230:231], v5 offset:37632
v_mfma_f32_16x16x32_bf16 v[88:91], a[136:139], a[208:211], v[88:91]
buffer_load_dwordx2 v[44:45], v50, s[36:39], s66 offen offset:512 sc1
v_mfma_f32_16x16x32_bf16 v[88:91], a[152:155], a[212:215], v[88:91]
v_mfma_f32_16x16x32_bf16 v[92:95], a[140:143], a[208:211], v[92:95]
v_mfma_f32_16x16x32_bf16 v[92:95], a[156:159], a[212:215], v[92:95]
s_waitcnt lgkmcnt(4)
ds_read_b64_tr_b16 a[232:233], v5 offset:43008
ds_read_b64_tr_b16 a[234:235], v5 offset:44800
v_mfma_f32_16x16x32_bf16 v[124:127], a[140:143], a[216:219], v[124:127]
v_mfma_f32_16x16x32_bf16 v[124:127], a[156:159], a[220:223], v[124:127]
v_mfma_f32_16x16x32_bf16 v[120:123], a[136:139], a[216:219], v[120:123]
v_mfma_f32_16x16x32_bf16 v[120:123], a[152:155], a[220:223], v[120:123]
s_waitcnt lgkmcnt(6)
ds_read_b64_tr_b16 a[236:237], v5 offset:50176
ds_read_b64_tr_b16 a[238:239], v5 offset:51968
v_mfma_f32_16x16x32_bf16 v[116:119], a[132:135], a[216:219], v[116:119]
v_mfma_f32_16x16x32_bf16 v[116:119], a[148:151], a[220:223], v[116:119]
v_mfma_f32_16x16x32_bf16 v[112:115], a[128:131], a[216:219], v[112:115]
v_mfma_f32_16x16x32_bf16 v[112:115], a[144:147], a[220:223], v[112:115]
s_waitcnt vmcnt(10) lgkmcnt(4)
ds_read_b64_tr_b16 a[208:209], v5 offset:28704
ds_read_b64_tr_b16 a[210:211], v5 offset:30496
v_mfma_f32_16x16x32_bf16 v[128:131], a[224:227], a[192:195], v[128:131]
buffer_load_dwordx4 v6, s[16:19], s57 offen lds
v_mfma_f32_16x16x32_bf16 v[128:131], a[228:231], a[96:99], v[128:131]
v_mfma_f32_16x16x32_bf16 v[132:135], a[224:227], a[196:199], v[132:135]
v_mfma_f32_16x16x32_bf16 v[132:135], a[228:231], a[100:103], v[132:135]
s_waitcnt lgkmcnt(6)
ds_read_b64_tr_b16 a[212:213], v5 offset:35872
ds_read_b64_tr_b16 a[214:215], v5 offset:37664
v_mfma_f32_16x16x32_bf16 v[136:139], a[224:227], a[200:203], v[136:139]
buffer_load_dwordx4 a[120:123], v1, s[8:11], s59 offen offset:2048 sc1
v_mfma_f32_16x16x32_bf16 v[136:139], a[228:231], a[104:107], v[136:139]
s_add_u32 m0, s54, 18432
v_mfma_f32_16x16x32_bf16 v[140:143], a[224:227], a[204:207], v[140:143]
v_mfma_f32_16x16x32_bf16 v[140:143], a[228:231], a[108:111], v[140:143]
s_waitcnt lgkmcnt(4)
ds_read_b64_tr_b16 a[216:217], v5 offset:43040
ds_read_b64_tr_b16 a[218:219], v5 offset:44832
v_mfma_f32_16x16x32_bf16 v[156:159], a[232:235], a[204:207], v[156:159]
buffer_load_dwordx4 v7, s[16:19], s57 offen lds
v_mfma_f32_16x16x32_bf16 v[156:159], a[236:239], a[108:111], v[156:159]
v_mfma_f32_16x16x32_bf16 v[152:155], a[232:235], a[200:203], v[152:155]
v_mfma_f32_16x16x32_bf16 v[152:155], a[236:239], a[104:107], v[152:155]
s_waitcnt lgkmcnt(6)
ds_read_b64_tr_b16 a[220:221], v5 offset:50208
ds_read_b64_tr_b16 a[222:223], v5 offset:52000
v_mfma_f32_16x16x32_bf16 v[148:151], a[232:235], a[196:199], v[148:151]
buffer_load_dwordx4 a[124:127], v1, s[8:11], s59 offen offset:3072 sc1
v_mfma_f32_16x16x32_bf16 v[148:151], a[236:239], a[100:103], v[148:151]
s_add_u32 m0, s54, 22528
v_mfma_f32_16x16x32_bf16 v[144:147], a[232:235], a[192:195], v[144:147]
v_mfma_f32_16x16x32_bf16 v[144:147], a[236:239], a[96:99], v[144:147]
s_waitcnt lgkmcnt(4)
ds_read_b64_tr_b16 a[224:225], v5 offset:28736
ds_read_b64_tr_b16 a[226:227], v5 offset:30528
v_mfma_f32_16x16x32_bf16 v[160:163], a[208:211], a[192:195], v[160:163]
v_mfma_f32_16x16x32_bf16 v[160:163], a[212:215], a[96:99], v[160:163]
buffer_load_dwordx4 v8, s[16:19], s57 offen lds
v_mfma_f32_16x16x32_bf16 v[164:167], a[208:211], a[196:199], v[164:167]
s_movk_i32 s58, 1024
s_add_u32 m0, s56, 0
v_mfma_f32_16x16x32_bf16 v[164:167], a[212:215], a[100:103], v[164:167]
s_waitcnt lgkmcnt(6)
ds_read_b64_tr_b16 a[228:229], v5 offset:35904
ds_read_b64_tr_b16 a[230:231], v5 offset:37696
v_mfma_f32_16x16x32_bf16 v[168:171], a[208:211], a[200:203], v[168:171]
v_mfma_f32_16x16x32_bf16 v[168:171], a[212:215], a[104:107], v[168:171]
buffer_load_dwordx4 v10, s[24:27], s58 offen lds
v_mfma_f32_16x16x32_bf16 v[172:175], a[208:211], a[204:207], v[172:175]
s_add_u32 m0, s56, 4096
v_mfma_f32_16x16x32_bf16 v[172:175], a[212:215], a[108:111], v[172:175]
s_waitcnt lgkmcnt(4)
ds_read_b64_tr_b16 a[232:233], v5 offset:43072
ds_read_b64_tr_b16 a[234:235], v5 offset:44864
v_mfma_f32_16x16x32_bf16 v[188:191], a[216:219], a[204:207], v[188:191]
v_mfma_f32_16x16x32_bf16 v[188:191], a[220:223], a[108:111], v[188:191]
v_mfma_f32_16x16x32_bf16 v[184:187], a[216:219], a[200:203], v[184:187]
v_mfma_f32_16x16x32_bf16 v[184:187], a[220:223], a[104:107], v[184:187]
s_waitcnt lgkmcnt(6)
ds_read_b64_tr_b16 a[236:237], v5 offset:50240
ds_read_b64_tr_b16 a[238:239], v5 offset:52032
v_mfma_f32_16x16x32_bf16 v[180:183], a[216:219], a[196:199], v[180:183]
v_mfma_f32_16x16x32_bf16 v[180:183], a[220:223], a[100:103], v[180:183]
v_mfma_f32_16x16x32_bf16 v[176:179], a[216:219], a[192:195], v[176:179]
v_mfma_f32_16x16x32_bf16 v[176:179], a[220:223], a[96:99], v[176:179]
s_waitcnt lgkmcnt(4)
ds_read_b64_tr_b16 a[208:209], v5 offset:28768
ds_read_b64_tr_b16 a[210:211], v5 offset:30560
v_mfma_f32_16x16x32_bf16 v[192:195], a[224:227], a[192:195], v[192:195]
v_mfma_f32_16x16x32_bf16 v[192:195], a[228:231], a[96:99], v[192:195]
v_mfma_f32_16x16x32_bf16 v[196:199], a[224:227], a[196:199], v[196:199]
v_mfma_f32_16x16x32_bf16 v[196:199], a[228:231], a[100:103], v[196:199]
s_waitcnt lgkmcnt(6)
ds_read_b64_tr_b16 a[212:213], v5 offset:35936
ds_read_b64_tr_b16 a[214:215], v5 offset:37728
v_mfma_f32_16x16x32_bf16 v[200:203], a[224:227], a[200:203], v[200:203]
buffer_load_dwordx4 v10, s[28:31], s58 offen lds
v_mfma_f32_16x16x32_bf16 v[200:203], a[228:231], a[104:107], v[200:203]
s_mov_b32 s59, 69632
v_mfma_f32_16x16x32_bf16 v[204:207], a[224:227], a[204:207], v[204:207]
v_mfma_f32_16x16x32_bf16 v[204:207], a[228:231], a[108:111], v[204:207]
s_waitcnt lgkmcnt(4)
ds_read_b64_tr_b16 a[216:217], v5 offset:43104
ds_read_b64_tr_b16 a[218:219], v5 offset:44896
v_mfma_f32_16x16x32_bf16 v[220:223], a[232:235], a[204:207], v[220:223]
buffer_load_dwordx4 a[128:131], v1, s[8:11], s59 offen offset:0 sc1
v_mfma_f32_16x16x32_bf16 v[220:223], a[236:239], a[108:111], v[220:223]
v_mfma_f32_16x16x32_bf16 v[216:219], a[232:235], a[200:203], v[216:219]
v_mfma_f32_16x16x32_bf16 v[216:219], a[236:239], a[104:107], v[216:219]
s_waitcnt lgkmcnt(6)
ds_read_b64_tr_b16 a[220:221], v5 offset:50272
ds_read_b64_tr_b16 a[222:223], v5 offset:52064
v_mfma_f32_16x16x32_bf16 v[212:215], a[232:235], a[196:199], v[212:215]
buffer_load_dwordx4 a[132:135], v1, s[8:11], s59 offen offset:1024 sc1
v_mfma_f32_16x16x32_bf16 v[212:215], a[236:239], a[100:103], v[212:215]
v_mfma_f32_16x16x32_bf16 v[208:211], a[232:235], a[192:195], v[208:211]
v_mfma_f32_16x16x32_bf16 v[208:211], a[236:239], a[96:99], v[208:211]
s_waitcnt lgkmcnt(4)
ds_read_b64_tr_b16 a[224:225], v5 offset:28800
ds_read_b64_tr_b16 a[226:227], v5 offset:30592
v_mfma_f32_16x16x32_bf16 v[224:227], a[208:211], a[192:195], v[224:227]
buffer_load_dwordx4 a[136:139], v1, s[8:11], s59 offen offset:2048 sc1
v_mfma_f32_16x16x32_bf16 v[224:227], a[212:215], a[96:99], v[224:227]
v_mfma_f32_16x16x32_bf16 v[228:231], a[208:211], a[196:199], v[228:231]
v_mfma_f32_16x16x32_bf16 v[228:231], a[212:215], a[100:103], v[228:231]
s_waitcnt lgkmcnt(6)
ds_read_b64_tr_b16 a[228:229], v5 offset:35968
ds_read_b64_tr_b16 a[230:231], v5 offset:37760
v_mfma_f32_16x16x32_bf16 v[232:235], a[208:211], a[200:203], v[232:235]
v_mfma_f32_16x16x32_bf16 v[232:235], a[212:215], a[104:107], v[232:235]
buffer_load_dwordx4 a[140:143], v1, s[8:11], s59 offen offset:3072 sc1
v_mfma_f32_16x16x32_bf16 v[236:239], a[208:211], a[204:207], v[236:239]
s_mov_b32 s57, 4128768
s_add_u32 m0, s54, 28672
v_mfma_f32_16x16x32_bf16 v[236:239], a[212:215], a[108:111], v[236:239]
s_waitcnt lgkmcnt(4)
ds_read_b64_tr_b16 a[232:233], v5 offset:43136
ds_read_b64_tr_b16 a[234:235], v5 offset:44928
v_mfma_f32_16x16x32_bf16 v[252:255], a[216:219], a[204:207], v[252:255]
v_mfma_f32_16x16x32_bf16 v[252:255], a[220:223], a[108:111], v[252:255]
buffer_load_dwordx4 v6, s[12:15], s57 offen lds
v_mfma_f32_16x16x32_bf16 v[248:251], a[216:219], a[200:203], v[248:251]
s_mov_b32 s59, 73728
v_mfma_f32_16x16x32_bf16 v[248:251], a[220:223], a[104:107], v[248:251]
s_waitcnt lgkmcnt(6)
ds_read_b64_tr_b16 a[236:237], v5 offset:50304
ds_read_b64_tr_b16 a[238:239], v5 offset:52096
v_mfma_f32_16x16x32_bf16 v[244:247], a[216:219], a[196:199], v[244:247]
v_mfma_f32_16x16x32_bf16 v[244:247], a[220:223], a[100:103], v[244:247]
v_mfma_f32_16x16x32_bf16 v[240:243], a[216:219], a[192:195], v[240:243]
buffer_load_dwordx4 a[144:147], v1, s[8:11], s59 offen offset:0 sc1
v_mfma_f32_16x16x32_bf16 v[240:243], a[220:223], a[96:99], v[240:243]
s_waitcnt lgkmcnt(4)
ds_read_b64_tr_b16 a[208:209], v5 offset:28832
ds_read_b64_tr_b16 a[210:211], v5 offset:30624
v_mfma_f32_16x16x32_bf16 a[0:3], a[224:227], a[192:195], a[0:3]
s_add_u32 m0, s54, 32768
v_mfma_f32_16x16x32_bf16 a[0:3], a[228:231], a[96:99], a[0:3]
v_mfma_f32_16x16x32_bf16 a[4:7], a[224:227], a[196:199], a[4:7]
v_mfma_f32_16x16x32_bf16 a[4:7], a[228:231], a[100:103], a[4:7]
s_waitcnt lgkmcnt(6)
ds_read_b64_tr_b16 a[212:213], v5 offset:36000
ds_read_b64_tr_b16 a[214:215], v5 offset:37792
v_mfma_f32_16x16x32_bf16 a[8:11], a[224:227], a[200:203], a[8:11]
v_mfma_f32_16x16x32_bf16 a[8:11], a[228:231], a[104:107], a[8:11]
v_mfma_f32_16x16x32_bf16 a[12:15], a[224:227], a[204:207], a[12:15]
v_mfma_f32_16x16x32_bf16 a[12:15], a[228:231], a[108:111], a[12:15]
s_waitcnt lgkmcnt(4)
ds_read_b64_tr_b16 a[216:217], v5 offset:43168
ds_read_b64_tr_b16 a[218:219], v5 offset:44960
v_mfma_f32_16x16x32_bf16 a[28:31], a[232:235], a[204:207], a[28:31]
v_mfma_f32_16x16x32_bf16 a[28:31], a[236:239], a[108:111], a[28:31]
v_mfma_f32_16x16x32_bf16 a[24:27], a[232:235], a[200:203], a[24:27]
v_mfma_f32_16x16x32_bf16 a[24:27], a[236:239], a[104:107], a[24:27]
s_waitcnt lgkmcnt(6)
ds_read_b64_tr_b16 a[220:221], v5 offset:50336
ds_read_b64_tr_b16 a[222:223], v5 offset:52128
v_mfma_f32_16x16x32_bf16 a[20:23], a[232:235], a[196:199], a[20:23]
buffer_load_dwordx4 v7, s[12:15], s57 offen lds
v_mfma_f32_16x16x32_bf16 a[20:23], a[236:239], a[100:103], a[20:23]
v_mfma_f32_16x16x32_bf16 a[16:19], a[232:235], a[192:195], a[16:19]
v_mfma_f32_16x16x32_bf16 a[16:19], a[236:239], a[96:99], a[16:19]
s_waitcnt lgkmcnt(4)
ds_read_b64_tr_b16 a[224:225], v5 offset:28864
ds_read_b64_tr_b16 a[226:227], v5 offset:30656
v_mfma_f32_16x16x32_bf16 a[32:35], a[208:211], a[192:195], a[32:35]
buffer_load_dwordx4 a[148:151], v1, s[8:11], s59 offen offset:1024 sc1
v_mfma_f32_16x16x32_bf16 a[32:35], a[212:215], a[96:99], a[32:35]
s_add_u32 m0, s54, 36864
v_mfma_f32_16x16x32_bf16 a[36:39], a[208:211], a[196:199], a[36:39]
v_mfma_f32_16x16x32_bf16 a[36:39], a[212:215], a[100:103], a[36:39]
s_waitcnt lgkmcnt(6)
ds_read_b64_tr_b16 a[228:229], v5 offset:36032
ds_read_b64_tr_b16 a[230:231], v5 offset:37824
v_mfma_f32_16x16x32_bf16 a[40:43], a[208:211], a[200:203], a[40:43]
buffer_load_dwordx4 v8, s[12:15], s57 offen lds
v_mfma_f32_16x16x32_bf16 a[40:43], a[212:215], a[104:107], a[40:43]
v_mfma_f32_16x16x32_bf16 a[44:47], a[208:211], a[204:207], a[44:47]
v_mfma_f32_16x16x32_bf16 a[44:47], a[212:215], a[108:111], a[44:47]
s_waitcnt lgkmcnt(4)
ds_read_b64_tr_b16 a[232:233], v5 offset:43200
ds_read_b64_tr_b16 a[234:235], v5 offset:44992
v_mfma_f32_16x16x32_bf16 a[60:63], a[216:219], a[204:207], a[60:63]
s_waitcnt vmcnt(16)
ds_read_b64 v[52:53], v11 offset:2048
ds_read_b64 v[54:55], v11 offset:2080
v_mfma_f32_16x16x32_bf16 a[60:63], a[220:223], a[108:111], a[60:63]
buffer_load_dwordx4 a[152:155], v1, s[8:11], s59 offen offset:2048 sc1
v_mfma_f32_16x16x32_bf16 a[56:59], a[216:219], a[200:203], a[56:59]
s_add_u32 m0, s55, 28672
v_mfma_f32_16x16x32_bf16 a[56:59], a[220:223], a[104:107], a[56:59]
s_waitcnt lgkmcnt(8)
ds_read_b64_tr_b16 a[236:237], v5 offset:50368
ds_read_b64_tr_b16 a[238:239], v5 offset:52160
v_mfma_f32_16x16x32_bf16 a[52:55], a[216:219], a[196:199], a[52:55]
v_mfma_f32_16x16x32_bf16 a[52:55], a[220:223], a[100:103], a[52:55]
buffer_load_dwordx4 v9, s[20:23], s57 offen lds
v_mfma_f32_16x16x32_bf16 a[48:51], a[216:219], a[192:195], a[48:51]
v_mfma_f32_16x16x32_bf16 a[48:51], a[220:223], a[96:99], a[48:51]
s_waitcnt lgkmcnt(6)
ds_read_b128 a[208:211], v3 offset:24576
v_mfma_f32_16x16x32_bf16 a[64:67], a[224:227], a[192:195], a[64:67]
v_mfma_f32_16x16x32_bf16 a[64:67], a[228:231], a[96:99], a[64:67]
v_mfma_f32_16x16x32_bf16 a[68:71], a[224:227], a[196:199], a[68:71]
buffer_load_dwordx4 a[156:159], v1, s[8:11], s59 offen offset:3072 sc1
v_mfma_f32_16x16x32_bf16 a[68:71], a[228:231], a[100:103], a[68:71]
ds_read_b128 a[212:215], v4 offset:24576
s_add_u32 m0, s54, 43008
v_mfma_f32_16x16x32_bf16 a[72:75], a[224:227], a[200:203], a[72:75]
s_waitcnt lgkmcnt(4)
v_lshlrev_b32 v56, 16, v52
v_and_b32 v57, 0xffff0000, v52
v_mfma_f32_16x16x32_bf16 a[72:75], a[228:231], a[104:107], a[72:75]
v_lshlrev_b32 v58, 16, v53
v_and_b32 v59, 0xffff0000, v53
v_mfma_f32_16x16x32_bf16 a[76:79], a[224:227], a[204:207], a[76:79]
v_sub_f32 v60, v56, v44
v_sub_f32 v61, v57, v44
v_mfma_f32_16x16x32_bf16 a[76:79], a[228:231], a[108:111], a[76:79]
s_waitcnt lgkmcnt(2)
ds_read_b128 a[216:219], v3 offset:28672
v_sub_f32 v62, v58, v44
v_mfma_f32_16x16x32_bf16 a[92:95], a[232:235], a[204:207], a[92:95]
v_sub_f32 v63, v59, v44
v_cvt_pk_bf16_f32 v48, v60, v61
v_mfma_f32_16x16x32_bf16 a[92:95], a[236:239], a[108:111], a[92:95]
v_cvt_pk_bf16_f32 v49, v62, v63
v_lshlrev_b32 v60, 16, v48
v_mfma_f32_16x16x32_bf16 a[88:91], a[232:235], a[200:203], a[88:91]
v_and_b32 v61, 0xffff0000, v48
v_lshlrev_b32 v62, 16, v49
v_mfma_f32_16x16x32_bf16 a[88:91], a[236:239], a[104:107], a[88:91]
ds_read_b128 a[220:223], v4 offset:28672
v_and_b32 v63, 0xffff0000, v49
v_mfma_f32_16x16x32_bf16 a[84:87], a[232:235], a[196:199], a[84:87]
v_mul_f32 v60, v60, v45
v_mul_f32 v61, v61, v45
v_mfma_f32_16x16x32_bf16 a[84:87], a[236:239], a[100:103], a[84:87]
v_mul_f32 v62, v62, v45
v_mul_f32 v63, v63, v45
v_mfma_f32_16x16x32_bf16 a[80:83], a[232:235], a[192:195], a[80:83]
v_cvt_pk_bf16_f32 v48, v60, v61
v_cvt_pk_bf16_f32 v49, v62, v63
v_mfma_f32_16x16x32_bf16 a[80:83], a[236:239], a[96:99], a[80:83]
s_waitcnt lgkmcnt(2)
ds_read_b128 a[224:227], v3 offset:26624
ds_read_b128 a[228:231], v4 offset:26624
v_mfma_f32_16x16x32_bf16 v[64:67], a[192:195], a[208:211], v[64:67]
buffer_load_dwordx4 v6, s[16:19], s57 offen lds
v_mfma_f32_16x16x32_bf16 v[64:67], a[96:99], a[212:215], v[64:67]
s_add_u32 m0, s54, 47104
v_lshlrev_b32 v60, 16, v48
v_and_b32 v61, 0xffff0000, v48
v_mfma_f32_16x16x32_bf16 v[68:71], a[196:199], a[208:211], v[68:71]
v_lshlrev_b32 v62, 16, v49
v_and_b32 v63, 0xffff0000, v49
v_mfma_f32_16x16x32_bf16 v[68:71], a[100:103], a[212:215], v[68:71]
s_waitcnt lgkmcnt(4)
ds_read_b128 a[232:235], v3 offset:30720
ds_read_b128 a[236:239], v4 offset:30720
v_mfma_f32_16x16x32_bf16 v[72:75], a[200:203], a[208:211], v[72:75]
v_lshlrev_b32 v46, 16, v40
v_and_b32 v47, 0xffff0000, v40
v_mfma_f32_16x16x32_bf16 v[72:75], a[104:107], a[212:215], v[72:75]
v_mul_f32 v60, v60, v46
v_mul_f32 v61, v61, v47
v_mfma_f32_16x16x32_bf16 v[76:79], a[204:207], a[208:211], v[76:79]
v_lshlrev_b32 v46, 16, v41
v_and_b32 v47, 0xffff0000, v41
v_mfma_f32_16x16x32_bf16 v[76:79], a[108:111], a[212:215], v[76:79]
s_waitcnt lgkmcnt(4)
v_mul_f32 v62, v62, v46
v_mul_f32 v63, v63, v47
v_mfma_f32_16x16x32_bf16 v[108:111], a[204:207], a[216:219], v[108:111]
v_cvt_pk_bf16_f32 v48, v60, v61
v_cvt_pk_bf16_f32 v49, v62, v63
v_mfma_f32_16x16x32_bf16 v[108:111], a[108:111], a[220:223], v[108:111]
buffer_load_dwordx4 v7, s[16:19], s57 offen lds
v_mfma_f32_16x16x32_bf16 v[104:107], a[200:203], a[216:219], v[104:107]
s_add_u32 m0, s54, 51200
v_lshlrev_b32 v60, 16, v48
v_and_b32 v61, 0xffff0000, v48
v_mfma_f32_16x16x32_bf16 v[104:107], a[104:107], a[220:223], v[104:107]
v_lshlrev_b32 v62, 16, v49
v_and_b32 v63, 0xffff0000, v49
v_mfma_f32_16x16x32_bf16 v[100:103], a[196:199], a[216:219], v[100:103]
v_add_f32 v56, v56, v60
v_add_f32 v57, v57, v61
v_mfma_f32_16x16x32_bf16 v[100:103], a[100:103], a[220:223], v[100:103]
buffer_load_dwordx4 v8, s[16:19], s57 offen lds
v_mfma_f32_16x16x32_bf16 v[96:99], a[192:195], a[216:219], v[96:99]
s_waitcnt vmcnt(15) lgkmcnt(0)
s_barrier
s_movk_i32 s58, 1152
v_mfma_f32_16x16x32_bf16 v[96:99], a[96:99], a[220:223], v[96:99]
s_waitcnt lgkmcnt(2)
ds_read_b64_tr_b16 a[208:209], v2 offset:0
ds_read_b64_tr_b16 a[210:211], v2 offset:1792
v_mfma_f32_16x16x32_bf16 v[80:83], a[192:195], a[224:227], v[80:83]
s_add_u32 m0, s56, 8192
v_add_f32 v58, v58, v62
v_add_f32 v59, v59, v63
v_mfma_f32_16x16x32_bf16 v[80:83], a[96:99], a[228:231], v[80:83]
v_accvgpr_write_b32 a168, v56
v_accvgpr_write_b32 a169, v57
v_mfma_f32_16x16x32_bf16 v[84:87], a[196:199], a[224:227], v[84:87]
buffer_load_dwordx4 v10, s[24:27], s58 offen lds
v_mfma_f32_16x16x32_bf16 v[84:87], a[100:103], a[228:231], v[84:87]
s_waitcnt lgkmcnt(4)
ds_read_b64_tr_b16 a[212:213], v2 offset:7168
ds_read_b64_tr_b16 a[214:215], v2 offset:8960
v_mfma_f32_16x16x32_bf16 v[88:91], a[200:203], a[224:227], v[88:91]
s_add_u32 m0, s56, 12288
v_accvgpr_write_b32 a170, v58
v_accvgpr_write_b32 a171, v59
v_mfma_f32_16x16x32_bf16 v[88:91], a[104:107], a[228:231], v[88:91]
v_lshlrev_b32 v56, 16, v54
v_and_b32 v57, 0xffff0000, v54
v_mfma_f32_16x16x32_bf16 v[92:95], a[204:207], a[224:227], v[92:95]
buffer_load_dwordx4 v10, s[28:31], s58 offen lds
v_mfma_f32_16x16x32_bf16 v[92:95], a[108:111], a[228:231], v[92:95]
s_waitcnt lgkmcnt(4)
ds_read_b64_tr_b16 a[216:217], v2 offset:14336
ds_read_b64_tr_b16 a[218:219], v2 offset:16128
v_mfma_f32_16x16x32_bf16 v[124:127], a[204:207], a[232:235], v[124:127]
s_mov_b32 s59, 77824
v_lshlrev_b32 v58, 16, v55
v_and_b32 v59, 0xffff0000, v55
v_mfma_f32_16x16x32_bf16 v[124:127], a[108:111], a[236:239], v[124:127]
v_sub_f32 v60, v56, v44
v_sub_f32 v61, v57, v44
v_mfma_f32_16x16x32_bf16 v[120:123], a[200:203], a[232:235], v[120:123]
v_sub_f32 v62, v58, v44
v_sub_f32 v63, v59, v44
v_mfma_f32_16x16x32_bf16 v[120:123], a[104:107], a[236:239], v[120:123]
s_waitcnt lgkmcnt(6)
ds_read_b64_tr_b16 a[220:221], v2 offset:21504
ds_read_b64_tr_b16 a[222:223], v2 offset:23296
v_mfma_f32_16x16x32_bf16 v[116:119], a[196:199], a[232:235], v[116:119]
v_cvt_pk_bf16_f32 v48, v60, v61
v_cvt_pk_bf16_f32 v49, v62, v63
v_mfma_f32_16x16x32_bf16 v[116:119], a[100:103], a[236:239], v[116:119]
v_lshlrev_b32 v60, 16, v48
v_and_b32 v61, 0xffff0000, v48
v_mfma_f32_16x16x32_bf16 v[112:115], a[192:195], a[232:235], v[112:115]
v_lshlrev_b32 v62, 16, v49
v_and_b32 v63, 0xffff0000, v49
v_mfma_f32_16x16x32_bf16 v[112:115], a[96:99], a[236:239], v[112:115]
s_waitcnt vmcnt(13) lgkmcnt(4)
ds_read_b64_tr_b16 a[224:225], v2 offset:32
ds_read_b64_tr_b16 a[226:227], v2 offset:1824
v_mfma_f32_16x16x32_bf16 v[128:131], a[208:211], a[112:115], v[128:131]
buffer_load_dwordx4 a[192:195], v1, s[8:11], s59 offen offset:0 sc1
v_mfma_f32_16x16x32_bf16 v[128:131], a[212:215], a[128:131], v[128:131]
s_mov_b32 s57, 4587520
s_add_u32 m0, s54, 65536
v_mul_f32 v60, v60, v45
v_mfma_f32_16x16x32_bf16 v[132:135], a[208:211], a[116:119], v[132:135]
v_mul_f32 v61, v61, v45
v_mul_f32 v62, v62, v45
v_mfma_f32_16x16x32_bf16 v[132:135], a[212:215], a[132:135], v[132:135]
s_waitcnt lgkmcnt(6)
ds_read_b64_tr_b16 a[228:229], v2 offset:7200
ds_read_b64_tr_b16 a[230:231], v2 offset:8992
v_mfma_f32_16x16x32_bf16 v[136:139], a[208:211], a[120:123], v[136:139]
buffer_load_dwordx4 v6, s[12:15], s57 offen lds
v_mfma_f32_16x16x32_bf16 v[136:139], a[212:215], a[136:139], v[136:139]
v_mul_f32 v63, v63, v45
v_cvt_pk_bf16_f32 v48, v60, v61
v_mfma_f32_16x16x32_bf16 v[140:143], a[208:211], a[124:127], v[140:143]
v_cvt_pk_bf16_f32 v49, v62, v63
v_lshlrev_b32 v60, 16, v48
v_mfma_f32_16x16x32_bf16 v[140:143], a[212:215], a[140:143], v[140:143]
s_waitcnt lgkmcnt(4)
ds_read_b64_tr_b16 a[232:233], v2 offset:14368
ds_read_b64_tr_b16 a[234:235], v2 offset:16160
v_mfma_f32_16x16x32_bf16 v[156:159], a[216:219], a[124:127], v[156:159]
v_and_b32 v61, 0xffff0000, v48
v_lshlrev_b32 v62, 16, v49
v_mfma_f32_16x16x32_bf16 v[156:159], a[220:223], a[140:143], v[156:159]
v_and_b32 v63, 0xffff0000, v49
v_lshlrev_b32 v46, 16, v42
v_mfma_f32_16x16x32_bf16 v[152:155], a[216:219], a[120:123], v[152:155]
v_and_b32 v47, 0xffff0000, v42
v_mul_f32 v60, v60, v46
v_mfma_f32_16x16x32_bf16 v[152:155], a[220:223], a[136:139], v[152:155]
s_waitcnt lgkmcnt(6)
ds_read_b64_tr_b16 a[236:237], v2 offset:21536
ds_read_b64_tr_b16 a[238:239], v2 offset:23328
v_mfma_f32_16x16x32_bf16 v[148:151], a[216:219], a[116:119], v[148:151]
v_mul_f32 v61, v61, v47
v_lshlrev_b32 v46, 16, v43
v_mfma_f32_16x16x32_bf16 v[148:151], a[220:223], a[132:135], v[148:151]
buffer_load_dwordx4 a[196:199], v1, s[8:11], s59 offen offset:1024 sc1
v_mfma_f32_16x16x32_bf16 v[144:147], a[216:219], a[112:115], v[144:147]
s_add_u32 m0, s54, 69632
v_and_b32 v47, 0xffff0000, v43
v_mul_f32 v62, v62, v46
v_mfma_f32_16x16x32_bf16 v[144:147], a[220:223], a[128:131], v[144:147]
s_waitcnt lgkmcnt(4)
ds_read_b64_tr_b16 a[208:209], v2 offset:64
ds_read_b64_tr_b16 a[210:211], v2 offset:1856
v_mfma_f32_16x16x32_bf16 v[160:163], a[224:227], a[112:115], v[160:163]
v_mul_f32 v63, v63, v47
v_cvt_pk_bf16_f32 v48, v60, v61
v_mfma_f32_16x16x32_bf16 v[160:163], a[228:231], a[128:131], v[160:163]
buffer_load_dwordx4 v7, s[12:15], s57 offen lds
v_mfma_f32_16x16x32_bf16 v[164:167], a[224:227], a[116:119], v[164:167]
v_cvt_pk_bf16_f32 v49, v62, v63
v_lshlrev_b32 v60, 16, v48
v_mfma_f32_16x16x32_bf16 v[164:167], a[228:231], a[132:135], v[164:167]
s_waitcnt lgkmcnt(6)
ds_read_b64_tr_b16 a[212:213], v2 offset:7232
ds_read_b64_tr_b16 a[214:215], v2 offset:9024
v_mfma_f32_16x16x32_bf16 v[168:171], a[224:227], a[120:123], v[168:171]
v_and_b32 v61, 0xffff0000, v48
v_lshlrev_b32 v62, 16, v49
v_mfma_f32_16x16x32_bf16 v[168:171], a[228:231], a[136:139], v[168:171]
v_and_b32 v63, 0xffff0000, v49
v_add_f32 v56, v56, v60
v_mfma_f32_16x16x32_bf16 v[172:175], a[224:227], a[124:127], v[172:175]
buffer_load_dwordx4 a[200:203], v1, s[8:11], s59 offen offset:2048 sc1
v_mfma_f32_16x16x32_bf16 v[172:175], a[228:231], a[140:143], v[172:175]
s_waitcnt lgkmcnt(4)
ds_read_b64_tr_b16 a[216:217], v2 offset:14400
ds_read_b64_tr_b16 a[218:219], v2 offset:16192
v_mfma_f32_16x16x32_bf16 v[188:191], a[232:235], a[124:127], v[188:191]
s_add_u32 m0, s54, 73728
v_add_f32 v57, v57, v61
v_add_f32 v58, v58, v62
v_mfma_f32_16x16x32_bf16 v[188:191], a[236:239], a[140:143], v[188:191]
v_add_f32 v59, v59, v63
v_accvgpr_write_b32 a184, v56
v_mfma_f32_16x16x32_bf16 v[184:187], a[232:235], a[120:123], v[184:187]
buffer_load_dwordx4 v8, s[12:15], s57 offen lds
v_mfma_f32_16x16x32_bf16 v[184:187], a[236:239], a[136:139], v[184:187]
s_waitcnt lgkmcnt(6)
ds_read_b64_tr_b16 a[220:221], v2 offset:21568
ds_read_b64_tr_b16 a[222:223], v2 offset:23360
v_mfma_f32_16x16x32_bf16 v[180:183], a[232:235], a[116:119], v[180:183]
v_accvgpr_write_b32 a185, v57
v_accvgpr_write_b32 a186, v58
v_mfma_f32_16x16x32_bf16 v[180:183], a[236:239], a[132:135], v[180:183]
L_tr5:
s_cbranch_execz L_tr9
v_accvgpr_write_b32 a187, v59
v_mfma_f32_16x16x32_bf16 v[176:179], a[232:235], a[112:115], v[176:179]
buffer_load_dwordx2 v[44:45], v50, s[36:39], s66 offen offset:768 sc1
v_mfma_f32_16x16x32_bf16 v[176:179], a[236:239], a[128:131], v[176:179]
s_waitcnt lgkmcnt(4)
ds_read_b64_tr_b16 a[224:225], v2 offset:96
ds_read_b64_tr_b16 a[226:227], v2 offset:1888
v_mfma_f32_16x16x32_bf16 v[192:195], a[208:211], a[112:115], v[192:195]
v_mfma_f32_16x16x32_bf16 v[192:195], a[212:215], a[128:131], v[192:195]
v_mfma_f32_16x16x32_bf16 v[196:199], a[208:211], a[116:119], v[196:199]
v_mfma_f32_16x16x32_bf16 v[196:199], a[212:215], a[132:135], v[196:199]
s_waitcnt lgkmcnt(6)
ds_read_b64_tr_b16 a[228:229], v2 offset:7264
ds_read_b64_tr_b16 a[230:231], v2 offset:9056
v_mfma_f32_16x16x32_bf16 v[200:203], a[208:211], a[120:123], v[200:203]
buffer_load_dwordx4 a[204:207], v1, s[8:11], s59 offen offset:3072 sc1
v_mfma_f32_16x16x32_bf16 v[200:203], a[212:215], a[136:139], v[200:203]
s_add_u32 m0, s55, 65536
v_mfma_f32_16x16x32_bf16 v[204:207], a[208:211], a[124:127], v[204:207]
v_mfma_f32_16x16x32_bf16 v[204:207], a[212:215], a[140:143], v[204:207]
s_waitcnt lgkmcnt(4)
ds_read_b64_tr_b16 a[232:233], v2 offset:14432
ds_read_b64_tr_b16 a[234:235], v2 offset:16224
v_mfma_f32_16x16x32_bf16 v[220:223], a[216:219], a[124:127], v[220:223]
buffer_load_dwordx4 v9, s[20:23], s57 offen lds
v_mfma_f32_16x16x32_bf16 v[220:223], a[220:223], a[140:143], v[220:223]
s_add_u32 m0, s54, 79872
v_mfma_f32_16x16x32_bf16 v[216:219], a[216:219], a[120:123], v[216:219]
v_mfma_f32_16x16x32_bf16 v[216:219], a[220:223], a[136:139], v[216:219]
s_waitcnt lgkmcnt(6)
ds_read_b64_tr_b16 a[236:237], v2 offset:21600
ds_read_b64_tr_b16 a[238:239], v2 offset:23392
v_mfma_f32_16x16x32_bf16 v[212:215], a[216:219], a[116:119], v[212:215]
v_mfma_f32_16x16x32_bf16 v[212:215], a[220:223], a[132:135], v[212:215]
v_mfma_f32_16x16x32_bf16 v[208:211], a[216:219], a[112:115], v[208:211]
v_mfma_f32_16x16x32_bf16 v[208:211], a[220:223], a[128:131], v[208:211]
s_waitcnt lgkmcnt(4)
ds_read_b64_tr_b16 a[208:209], v2 offset:128
ds_read_b64_tr_b16 a[210:211], v2 offset:1920
v_mfma_f32_16x16x32_bf16 v[224:227], a[224:227], a[112:115], v[224:227]
v_mfma_f32_16x16x32_bf16 v[224:227], a[228:231], a[128:131], v[224:227]
v_mfma_f32_16x16x32_bf16 v[228:231], a[224:227], a[116:119], v[228:231]
v_mfma_f32_16x16x32_bf16 v[228:231], a[228:231], a[132:135], v[228:231]
s_waitcnt lgkmcnt(6)
ds_read_b64_tr_b16 a[212:213], v2 offset:7296
ds_read_b64_tr_b16 a[214:215], v2 offset:9088
v_mfma_f32_16x16x32_bf16 v[232:235], a[224:227], a[120:123], v[232:235]
v_mfma_f32_16x16x32_bf16 v[232:235], a[228:231], a[136:139], v[232:235]
v_mfma_f32_16x16x32_bf16 v[236:239], a[224:227], a[124:127], v[236:239]
buffer_load_dwordx4 v6, s[16:19], s57 offen lds
v_mfma_f32_16x16x32_bf16 v[236:239], a[228:231], a[140:143], v[236:239]
s_waitcnt lgkmcnt(4)
ds_read_b64_tr_b16 a[216:217], v2 offset:14464
ds_read_b64_tr_b16 a[218:219], v2 offset:16256
v_mfma_f32_16x16x32_bf16 v[252:255], a[232:235], a[124:127], v[252:255]
s_mov_b32 s59, 81920
v_mfma_f32_16x16x32_bf16 v[252:255], a[236:239], a[140:143], v[252:255]
v_mfma_f32_16x16x32_bf16 v[248:251], a[232:235], a[120:123], v[248:251]
buffer_load_dwordx4 a[96:99], v1, s[8:11], s59 offen offset:0 sc1
v_mfma_f32_16x16x32_bf16 v[248:251], a[236:239], a[136:139], v[248:251]
s_waitcnt lgkmcnt(6)
ds_read_b64_tr_b16 a[220:221], v2 offset:21632
ds_read_b64_tr_b16 a[222:223], v2 offset:23424
v_mfma_f32_16x16x32_bf16 v[244:247], a[232:235], a[116:119], v[244:247]
s_add_u32 m0, s54, 83968
v_mfma_f32_16x16x32_bf16 v[244:247], a[236:239], a[132:135], v[244:247]
v_mfma_f32_16x16x32_bf16 v[240:243], a[232:235], a[112:115], v[240:243]
v_mfma_f32_16x16x32_bf16 v[240:243], a[236:239], a[128:131], v[240:243]
s_waitcnt lgkmcnt(4)
ds_read_b64_tr_b16 a[224:225], v2 offset:160
ds_read_b64_tr_b16 a[226:227], v2 offset:1952
v_mfma_f32_16x16x32_bf16 a[0:3], a[208:211], a[112:115], a[0:3]
buffer_load_dwordx4 v7, s[16:19], s57 offen lds
v_mfma_f32_16x16x32_bf16 a[0:3], a[212:215], a[128:131], a[0:3]
v_mfma_f32_16x16x32_bf16 a[4:7], a[208:211], a[116:119], a[4:7]
v_mfma_f32_16x16x32_bf16 a[4:7], a[212:215], a[132:135], a[4:7]
s_waitcnt lgkmcnt(6)
ds_read_b64_tr_b16 a[228:229], v2 offset:7328
ds_read_b64_tr_b16 a[230:231], v2 offset:9120
v_mfma_f32_16x16x32_bf16 a[8:11], a[208:211], a[120:123], a[8:11]
buffer_load_dwordx4 a[100:103], v1, s[8:11], s59 offen offset:1024 sc1
v_mfma_f32_16x16x32_bf16 a[8:11], a[212:215], a[136:139], a[8:11]
v_mfma_f32_16x16x32_bf16 a[12:15], a[208:211], a[124:127], a[12:15]
v_mfma_f32_16x16x32_bf16 a[12:15], a[212:215], a[140:143], a[12:15]
s_waitcnt lgkmcnt(4)
ds_read_b64_tr_b16 a[232:233], v2 offset:14496
ds_read_b64_tr_b16 a[234:235], v2 offset:16288
v_mfma_f32_16x16x32_bf16 a[28:31], a[216:219], a[124:127], a[28:31]
v_mfma_f32_16x16x32_bf16 a[28:31], a[220:223], a[140:143], a[28:31]
v_mfma_f32_16x16x32_bf16 a[24:27], a[216:219], a[120:123], a[24:27]
v_mfma_f32_16x16x32_bf16 a[24:27], a[220:223], a[136:139], a[24:27]
s_waitcnt lgkmcnt(6)
ds_read_b64_tr_b16 a[236:237], v2 offset:21664
ds_read_b64_tr_b16 a[238:239], v2 offset:23456
v_mfma_f32_16x16x32_bf16 a[20:23], a[216:219], a[116:119], a[20:23]
buffer_load_dword a246, v13, s[40:43], s77 offen
v_mfma_f32_16x16x32_bf16 a[20:23], a[220:223], a[132:135], a[20:23]
s_add_u32 s77, s77, s76
v_mfma_f32_16x16x32_bf16 a[16:19], a[216:219], a[112:115], a[16:19]
v_mfma_f32_16x16x32_bf16 a[16:19], a[220:223], a[128:131], a[16:19]
s_waitcnt lgkmcnt(4)
ds_read_b64_tr_b16 a[208:209], v2 offset:192
ds_read_b64_tr_b16 a[210:211], v2 offset:1984
v_mfma_f32_16x16x32_bf16 a[32:35], a[224:227], a[112:115], a[32:35]
buffer_load_dword a246, v13, s[40:43], s77 offen
v_mfma_f32_16x16x32_bf16 a[32:35], a[228:231], a[128:131], a[32:35]
s_add_u32 s77, s77, s76
v_mfma_f32_16x16x32_bf16 a[36:39], a[224:227], a[116:119], a[36:39]
v_mfma_f32_16x16x32_bf16 a[36:39], a[228:231], a[132:135], a[36:39]
s_waitcnt lgkmcnt(6)
ds_read_b64_tr_b16 a[212:213], v2 offset:7360
ds_read_b64_tr_b16 a[214:215], v2 offset:9152
v_mfma_f32_16x16x32_bf16 a[40:43], a[224:227], a[120:123], a[40:43]
v_mfma_f32_16x16x32_bf16 a[40:43], a[228:231], a[136:139], a[40:43]
v_mfma_f32_16x16x32_bf16 a[44:47], a[224:227], a[124:127], a[44:47]
v_mfma_f32_16x16x32_bf16 a[44:47], a[228:231], a[140:143], a[44:47]
s_waitcnt lgkmcnt(4)
ds_read_b64_tr_b16 a[216:217], v2 offset:14528
ds_read_b64_tr_b16 a[218:219], v2 offset:16320
v_mfma_f32_16x16x32_bf16 a[60:63], a[232:235], a[124:127], a[60:63]
v_mfma_f32_16x16x32_bf16 a[60:63], a[236:239], a[140:143], a[60:63]
v_mfma_f32_16x16x32_bf16 a[56:59], a[232:235], a[120:123], a[56:59]
v_mfma_f32_16x16x32_bf16 a[56:59], a[236:239], a[136:139], a[56:59]
s_waitcnt lgkmcnt(6)
ds_read_b64_tr_b16 a[220:221], v2 offset:21696
ds_read_b64_tr_b16 a[222:223], v2 offset:23488
v_mfma_f32_16x16x32_bf16 a[52:55], a[232:235], a[116:119], a[52:55]
v_mfma_f32_16x16x32_bf16 a[52:55], a[236:239], a[132:135], a[52:55]
v_mfma_f32_16x16x32_bf16 a[48:51], a[232:235], a[112:115], a[48:51]
v_mfma_f32_16x16x32_bf16 a[48:51], a[236:239], a[128:131], a[48:51]
s_waitcnt lgkmcnt(4)
ds_read_b128 a[224:227], v3 offset:0
v_mfma_f32_16x16x32_bf16 a[64:67], a[208:211], a[112:115], a[64:67]
buffer_load_dword a246, v14, s[44:47], s78 offen
v_mfma_f32_16x16x32_bf16 a[64:67], a[212:215], a[128:131], a[64:67]
s_add_u32 s78, s78, s80
s_add_u32 m0, s54, 88064
v_mfma_f32_16x16x32_bf16 a[68:71], a[208:211], a[116:119], a[68:71]
v_mfma_f32_16x16x32_bf16 a[68:71], a[212:215], a[132:135], a[68:71]
ds_read_b128 a[228:231], v4 offset:0
v_mfma_f32_16x16x32_bf16 a[72:75], a[208:211], a[120:123], a[72:75]
buffer_load_dwordx4 v8, s[16:19], s57 offen lds
v_mfma_f32_16x16x32_bf16 a[72:75], a[212:215], a[136:139], a[72:75]
v_mfma_f32_16x16x32_bf16 a[76:79], a[208:211], a[124:127], a[76:79]
v_mfma_f32_16x16x32_bf16 a[76:79], a[212:215], a[140:143], a[76:79]
s_waitcnt lgkmcnt(2)
ds_read_b128 a[232:235], v3 offset:4096
v_mfma_f32_16x16x32_bf16 a[92:95], a[216:219], a[124:127], a[92:95]
buffer_load_dwordx4 a[104:107], v1, s[8:11], s59 offen offset:2048 sc1
v_mfma_f32_16x16x32_bf16 a[92:95], a[220:223], a[140:143], a[92:95]
s_movk_i32 s58, 1280
s_add_u32 m0, s56, 16384
v_mfma_f32_16x16x32_bf16 a[88:91], a[216:219], a[120:123], a[88:91]
v_mfma_f32_16x16x32_bf16 a[88:91], a[220:223], a[136:139], a[88:91]
ds_read_b128 a[236:239], v4 offset:4096
v_mfma_f32_16x16x32_bf16 a[84:87], a[216:219], a[116:119], a[84:87]
v_mfma_f32_16x16x32_bf16 a[84:87], a[220:223], a[132:135], a[84:87]
v_mfma_f32_16x16x32_bf16 a[80:83], a[216:219], a[112:115], a[80:83]
v_mfma_f32_16x16x32_bf16 a[80:83], a[220:223], a[128:131], a[80:83]
s_waitcnt lgkmcnt(2)
ds_read_b128 a[208:211], v3 offset:2048
ds_read_b128 a[212:215], v4 offset:2048
v_mfma_f32_16x16x32_bf16 v[64:67], a[112:115], a[224:227], v[64:67]
v_mfma_f32_16x16x32_bf16 v[64:67], a[128:131], a[228:231], v[64:67]
v_mfma_f32_16x16x32_bf16 v[68:71], a[116:119], a[224:227], v[68:71]
v_mfma_f32_16x16x32_bf16 v[68:71], a[132:135], a[228:231], v[68:71]
s_waitcnt lgkmcnt(4)
ds_read_b128 a[216:219], v3 offset:6144
ds_read_b128 a[220:223], v4 offset:6144
v_mfma_f32_16x16x32_bf16 v[72:75], a[120:123], a[224:227], v[72:75]
v_mfma_f32_16x16x32_bf16 v[72:75], a[136:139], a[228:231], v[72:75]
v_mfma_f32_16x16x32_bf16 v[76:79], a[124:127], a[224:227], v[76:79]
v_mfma_f32_16x16x32_bf16 v[76:79], a[140:143], a[228:231], v[76:79]
s_waitcnt lgkmcnt(4)
v_mfma_f32_16x16x32_bf16 v[108:111], a[124:127], a[232:235], v[108:111]
v_mfma_f32_16x16x32_bf16 v[108:111], a[140:143], a[236:239], v[108:111]
v_mfma_f32_16x16x32_bf16 v[104:107], a[120:123], a[232:235], v[104:107]
v_mfma_f32_16x16x32_bf16 v[104:107], a[136:139], a[236:239], v[104:107]
v_mfma_f32_16x16x32_bf16 v[100:103], a[116:119], a[232:235], v[100:103]
v_mfma_f32_16x16x32_bf16 v[100:103], a[132:135], a[236:239], v[100:103]
v_mfma_f32_16x16x32_bf16 v[96:99], a[112:115], a[232:235], v[96:99]
s_waitcnt vmcnt(18) lgkmcnt(0)
s_barrier
v_mfma_f32_16x16x32_bf16 v[96:99], a[128:131], a[236:239], v[96:99]
s_waitcnt lgkmcnt(2)
ds_read_b64_tr_b16 a[224:225], v2 offset:28672
ds_read_b64_tr_b16 a[226:227], v2 offset:30464
v_mfma_f32_16x16x32_bf16 v[80:83], a[112:115], a[208:211], v[80:83]
v_mfma_f32_16x16x32_bf16 v[80:83], a[128:131], a[212:215], v[80:83]
v_mfma_f32_16x16x32_bf16 v[84:87], a[116:119], a[208:211], v[84:87]
s_waitcnt vmcnt(11)
ds_read_b64 v[52:53], v11 offset:3072
ds_read_b64 v[54:55], v11 offset:3104
v_mfma_f32_16x16x32_bf16 v[84:87], a[132:135], a[212:215], v[84:87]
s_waitcnt lgkmcnt(6)
ds_read_b64_tr_b16 a[228:229], v2 offset:35840
ds_read_b64_tr_b16 a[230:231], v2 offset:37632
v_mfma_f32_16x16x32_bf16 v[88:91], a[120:123], a[208:211], v[88:91]
v_mfma_f32_16x16x32_bf16 v[88:91], a[136:139], a[212:215], v[88:91]
v_mfma_f32_16x16x32_bf16 v[92:95], a[124:127], a[208:211], v[92:95]
v_mfma_f32_16x16x32_bf16 v[92:95], a[140:143], a[212:215], v[92:95]
s_waitcnt lgkmcnt(6)
ds_read_b64_tr_b16 a[232:233], v2 offset:43008
ds_read_b64_tr_b16 a[234:235], v2 offset:44800
v_mfma_f32_16x16x32_bf16 v[124:127], a[124:127], a[216:219], v[124:127]
v_mfma_f32_16x16x32_bf16 v[124:127], a[140:143], a[220:223], v[124:127]
v_mfma_f32_16x16x32_bf16 v[120:123], a[120:123], a[216:219], v[120:123]
v_mfma_f32_16x16x32_bf16 v[120:123], a[136:139], a[220:223], v[120:123]
s_waitcnt lgkmcnt(8)
ds_read_b64_tr_b16 a[236:237], v2 offset:50176
ds_read_b64_tr_b16 a[238:239], v2 offset:51968
v_mfma_f32_16x16x32_bf16 v[116:119], a[116:119], a[216:219], v[116:119]
buffer_load_dwordx4 v10, s[24:27], s58 offen lds
v_mfma_f32_16x16x32_bf16 v[116:119], a[132:135], a[220:223], v[116:119]
s_waitcnt lgkmcnt(6)
v_lshlrev_b32 v56, 16, v52
v_and_b32 v57, 0xffff0000, v52
v_mfma_f32_16x16x32_bf16 v[112:115], a[112:115], a[216:219], v[112:115]
v_lshlrev_b32 v58, 16, v53
v_and_b32 v59, 0xffff0000, v53
v_mfma_f32_16x16x32_bf16 v[112:115], a[128:131], a[220:223], v[112:115]
s_waitcnt vmcnt(11) lgkmcnt(4)
ds_read_b64_tr_b16 a[208:209], v2 offset:28704
ds_read_b64_tr_b16 a[210:211], v2 offset:30496
v_mfma_f32_16x16x32_bf16 v[128:131], a[224:227], a[144:147], v[128:131]
v_sub_f32 v60, v56, v44
v_sub_f32 v61, v57, v44
v_mfma_f32_16x16x32_bf16 v[128:131], a[228:231], a[192:195], v[128:131]
buffer_load_dwordx4 a[108:111], v1, s[8:11], s59 offen offset:3072 sc1
v_mfma_f32_16x16x32_bf16 v[132:135], a[224:227], a[148:151], v[132:135]
s_add_u32 m0, s56, 20480
v_sub_f32 v62, v58, v44
v_sub_f32 v63, v59, v44
v_mfma_f32_16x16x32_bf16 v[132:135], a[228:231], a[196:199], v[132:135]
s_waitcnt lgkmcnt(6)
ds_read_b64_tr_b16 a[212:213], v2 offset:35872
ds_read_b64_tr_b16 a[214:215], v2 offset:37664
v_mfma_f32_16x16x32_bf16 v[136:139], a[224:227], a[152:155], v[136:139]
v_cvt_pk_bf16_f32 v48, v60, v61
v_cvt_pk_bf16_f32 v49, v62, v63
v_mfma_f32_16x16x32_bf16 v[136:139], a[228:231], a[200:203], v[136:139]
v_lshlrev_b32 v60, 16, v48
v_and_b32 v61, 0xffff0000, v48
v_mfma_f32_16x16x32_bf16 v[140:143], a[224:227], a[156:159], v[140:143]
v_lshlrev_b32 v62, 16, v49
v_and_b32 v63, 0xffff0000, v49
v_mfma_f32_16x16x32_bf16 v[140:143], a[228:231], a[204:207], v[140:143]
s_waitcnt lgkmcnt(4)
ds_read_b64_tr_b16 a[216:217], v2 offset:43040
ds_read_b64_tr_b16 a[218:219], v2 offset:44832
v_mfma_f32_16x16x32_bf16 v[156:159], a[232:235], a[156:159], v[156:159]
v_mul_f32 v60, v60, v45
v_mul_f32 v61, v61, v45
v_mfma_f32_16x16x32_bf16 v[156:159], a[236:239], a[204:207], v[156:159]
v_mul_f32 v62, v62, v45
v_mul_f32 v63, v63, v45
v_mfma_f32_16x16x32_bf16 v[152:155], a[232:235], a[152:155], v[152:155]
v_cvt_pk_bf16_f32 v48, v60, v61
v_cvt_pk_bf16_f32 v49, v62, v63
v_mfma_f32_16x16x32_bf16 v[152:155], a[236:239], a[200:203], v[152:155]
s_waitcnt lgkmcnt(6)
ds_read_b64_tr_b16 a[220:221], v2 offset:50208
ds_read_b64_tr_b16 a[222:223], v2 offset:52000
v_mfma_f32_16x16x32_bf16 v[148:151], a[232:235], a[148:151], v[148:151]
v_lshlrev_b32 v60, 16, v48
v_and_b32 v61, 0xffff0000, v48
v_mfma_f32_16x16x32_bf16 v[148:151], a[236:239], a[196:199], v[148:151]
v_lshlrev_b32 v62, 16, v49
v_and_b32 v63, 0xffff0000, v49
v_mfma_f32_16x16x32_bf16 v[144:147], a[232:235], a[144:147], v[144:147]
v_lshlrev_b32 v46, 16, v40
v_and_b32 v47, 0xffff0000, v40
v_mfma_f32_16x16x32_bf16 v[144:147], a[236:239], a[192:195], v[144:147]
s_waitcnt lgkmcnt(4)
ds_read_b64_tr_b16 a[224:225], v2 offset:28736
ds_read_b64_tr_b16 a[226:227], v2 offset:30528
v_mfma_f32_16x16x32_bf16 v[160:163], a[208:211], a[144:147], v[160:163]
buffer_load_dwordx4 v10, s[28:31], s58 offen lds
v_mfma_f32_16x16x32_bf16 v[160:163], a[212:215], a[192:195], v[160:163]
s_mov_b32 s59, 86016
v_mul_f32 v60, v60, v46
v_mul_f32 v61, v61, v47
v_mfma_f32_16x16x32_bf16 v[164:167], a[208:211], a[148:151], v[164:167]
v_lshlrev_b32 v46, 16, v41
v_and_b32 v47, 0xffff0000, v41
v_mfma_f32_16x16x32_bf16 v[164:167], a[212:215], a[196:199], v[164:167]
s_waitcnt lgkmcnt(6)
ds_read_b64_tr_b16 a[228:229], v2 offset:35904
ds_read_b64_tr_b16 a[230:231], v2 offset:37696
v_mfma_f32_16x16x32_bf16 v[168:171], a[208:211], a[152:155], v[168:171]
buffer_load_dwordx4 a[112:115], v1, s[8:11], s59 offen offset:0 sc1
v_mfma_f32_16x16x32_bf16 v[168:171], a[212:215], a[200:203], v[168:171]
v_mul_f32 v62, v62, v46
v_mul_f32 v63, v63, v47
v_mfma_f32_16x16x32_bf16 v[172:175], a[208:211], a[156:159], v[172:175]
v_cvt_pk_bf16_f32 v48, v60, v61
v_cvt_pk_bf16_f32 v49, v62, v63
v_mfma_f32_16x16x32_bf16 v[172:175], a[212:215], a[204:207], v[172:175]
s_waitcnt lgkmcnt(4)
ds_read_b64_tr_b16 a[232:233], v2 offset:43072
ds_read_b64_tr_b16 a[234:235], v2 offset:44864
v_mfma_f32_16x16x32_bf16 v[188:191], a[216:219], a[156:159], v[188:191]
buffer_load_dwordx4 a[116:119], v1, s[8:11], s59 offen offset:1024 sc1
v_mfma_f32_16x16x32_bf16 v[188:191], a[220:223], a[204:207], v[188:191]
s_mov_b32 s57, 5046272
s_add_u32 m0, s54, 94208
v_lshlrev_b32 v60, 16, v48
v_mfma_f32_16x16x32_bf16 v[184:187], a[216:219], a[152:155], v[184:187]
v_and_b32 v61, 0xffff0000, v48
v_lshlrev_b32 v62, 16, v49
v_mfma_f32_16x16x32_bf16 v[184:187], a[220:223], a[200:203], v[184:187]
s_waitcnt lgkmcnt(6)
ds_read_b64_tr_b16 a[236:237], v2 offset:50240
ds_read_b64_tr_b16 a[238:239], v2 offset:52032
v_mfma_f32_16x16x32_bf16 v[180:183], a[216:219], a[148:151], v[180:183]
v_and_b32 v63, 0xffff0000, v49
v_add_f32 v56, v56, v60
v_mfma_f32_16x16x32_bf16 v[180:183], a[220:223], a[196:199], v[180:183]
buffer_load_dwordx4 v6, s[12:15], s57 offen lds
v_mfma_f32_16x16x32_bf16 v[176:179], a[216:219], a[144:147], v[176:179]
v_add_f32 v57, v57, v61
v_add_f32 v58, v58, v62
v_mfma_f32_16x16x32_bf16 v[176:179], a[220:223], a[192:195], v[176:179]
s_waitcnt lgkmcnt(4)
ds_read_b64_tr_b16 a[208:209], v2 offset:28768
ds_read_b64_tr_b16 a[210:211], v2 offset:30560
v_mfma_f32_16x16x32_bf16 v[192:195], a[224:227], a[144:147], v[192:195]
v_add_f32 v59, v59, v63
v_accvgpr_write_b32 a172, v56
v_mfma_f32_16x16x32_bf16 v[192:195], a[228:231], a[192:195], v[192:195]
buffer_load_dwordx4 a[120:123], v1, s[8:11], s59 offen offset:2048 sc1
v_mfma_f32_16x16x32_bf16 v[196:199], a[224:227], a[148:151], v[196:199]
v_accvgpr_write_b32 a173, v57
v_accvgpr_write_b32 a174, v58
v_mfma_f32_16x16x32_bf16 v[196:199], a[228:231], a[196:199], v[196:199]
s_waitcnt lgkmcnt(6)
ds_read_b64_tr_b16 a[212:213], v2 offset:35936
ds_read_b64_tr_b16 a[214:215], v2 offset:37728
v_mfma_f32_16x16x32_bf16 v[200:203], a[224:227], a[152:155], v[200:203]
v_accvgpr_write_b32 a175, v59
v_lshlrev_b32 v56, 16, v54
v_mfma_f32_16x16x32_bf16 v[200:203], a[228:231], a[200:203], v[200:203]
v_and_b32 v57, 0xffff0000, v54
v_lshlrev_b32 v58, 16, v55
v_mfma_f32_16x16x32_bf16 v[204:207], a[224:227], a[156:159], v[204:207]
buffer_load_dwordx4 a[124:127], v1, s[8:11], s59 offen offset:3072 sc1
v_mfma_f32_16x16x32_bf16 v[204:207], a[228:231], a[204:207], v[204:207]
s_waitcnt lgkmcnt(4)
ds_read_b64_tr_b16 a[216:217], v2 offset:43104
ds_read_b64_tr_b16 a[218:219], v2 offset:44896
v_mfma_f32_16x16x32_bf16 v[220:223], a[232:235], a[156:159], v[220:223]
s_add_u32 m0, s54, 98304
v_and_b32 v59, 0xffff0000, v55
v_sub_f32 v60, v56, v44
v_mfma_f32_16x16x32_bf16 v[220:223], a[236:239], a[204:207], v[220:223]
v_sub_f32 v61, v57, v44
v_sub_f32 v62, v58, v44
v_mfma_f32_16x16x32_bf16 v[216:219], a[232:235], a[152:155], v[216:219]
v_sub_f32 v63, v59, v44
v_cvt_pk_bf16_f32 v48, v60, v61
v_mfma_f32_16x16x32_bf16 v[216:219], a[236:239], a[200:203], v[216:219]
s_waitcnt lgkmcnt(6)
ds_read_b64_tr_b16 a[220:221], v2 offset:50272
ds_read_b64_tr_b16 a[222:223], v2 offset:52064
v_mfma_f32_16x16x32_bf16 v[212:215], a[232:235], a[148:151], v[212:215]
v_cvt_pk_bf16_f32 v49, v62, v63
v_lshlrev_b32 v60, 16, v48
v_mfma_f32_16x16x32_bf16 v[212:215], a[236:239], a[196:199], v[212:215]
v_and_b32 v61, 0xffff0000, v48
v_lshlrev_b32 v62, 16, v49
v_mfma_f32_16x16x32_bf16 v[208:211], a[232:235], a[144:147], v[208:211]
v_and_b32 v63, 0xffff0000, v49
v_mul_f32 v60, v60, v45
v_mfma_f32_16x16x32_bf16 v[208:211], a[236:239], a[192:195], v[208:211]
s_waitcnt lgkmcnt(4)
ds_read_b64_tr_b16 a[224:225], v2 offset:28800
ds_read_b64_tr_b16 a[226:227], v2 offset:30592
v_mfma_f32_16x16x32_bf16 v[224:227], a[208:211], a[144:147], v[224:227]
v_mul_f32 v61, v61, v45
v_mul_f32 v62, v62, v45
v_mfma_f32_16x16x32_bf16 v[224:227], a[212:215], a[192:195], v[224:227]
v_mul_f32 v63, v63, v45
v_cvt_pk_bf16_f32 v48, v60, v61
v_mfma_f32_16x16x32_bf16 v[228:231], a[208:211], a[148:151], v[228:231]
v_cvt_pk_bf16_f32 v49, v62, v63
v_lshlrev_b32 v60, 16, v48
v_mfma_f32_16x16x32_bf16 v[228:231], a[212:215], a[196:199], v[228:231]
s_waitcnt lgkmcnt(6)
ds_read_b64_tr_b16 a[228:229], v2 offset:35968
ds_read_b64_tr_b16 a[230:231], v2 offset:37760
v_mfma_f32_16x16x32_bf16 v[232:235], a[208:211], a[152:155], v[232:235]
buffer_load_dwordx4 v7, s[12:15], s57 offen lds
v_mfma_f32_16x16x32_bf16 v[232:235], a[212:215], a[200:203], v[232:235]
s_add_u32 m0, s54, 102400
v_and_b32 v61, 0xffff0000, v48
v_lshlrev_b32 v62, 16, v49
v_mfma_f32_16x16x32_bf16 v[236:239], a[208:211], a[156:159], v[236:239]
v_and_b32 v63, 0xffff0000, v49
v_lshlrev_b32 v46, 16, v42
v_mfma_f32_16x16x32_bf16 v[236:239], a[212:215], a[204:207], v[236:239]
s_waitcnt lgkmcnt(4)
ds_read_b64_tr_b16 a[232:233], v2 offset:43136
ds_read_b64_tr_b16 a[234:235], v2 offset:44928
v_mfma_f32_16x16x32_bf16 v[252:255], a[216:219], a[156:159], v[252:255]
buffer_load_dwordx4 v8, s[12:15], s57 offen lds
v_mfma_f32_16x16x32_bf16 v[252:255], a[220:223], a[204:207], v[252:255]
s_mov_b32 s59, 90112
v_and_b32 v47, 0xffff0000, v42
v_mul_f32 v60, v60, v46
v_mfma_f32_16x16x32_bf16 v[248:251], a[216:219], a[152:155], v[248:251]
v_mul_f32 v61, v61, v47
v_lshlrev_b32 v46, 16, v43
v_mfma_f32_16x16x32_bf16 v[248:251], a[220:223], a[200:203], v[248:251]
s_waitcnt lgkmcnt(6)
ds_read_b64_tr_b16 a[236:237], v2 offset:50304
ds_read_b64_tr_b16 a[238:239], v2 offset:52096
v_mfma_f32_16x16x32_bf16 v[244:247], a[216:219], a[148:151], v[244:247]
buffer_load_dwordx4 a[128:131], v1, s[8:11], s59 offen offset:0 sc1
v_mfma_f32_16x16x32_bf16 v[244:247], a[220:223], a[196:199], v[244:247]
s_add_u32 m0, s55, 94208
v_and_b32 v47, 0xffff0000, v43
v_mul_f32 v62, v62, v46
v_mfma_f32_16x16x32_bf16 v[240:243], a[216:219], a[144:147], v[240:243]
v_mul_f32 v63, v63, v47
v_cvt_pk_bf16_f32 v48, v60, v61
v_mfma_f32_16x16x32_bf16 v[240:243], a[220:223], a[192:195], v[240:243]
s_waitcnt lgkmcnt(4)
ds_read_b64_tr_b16 a[208:209], v2 offset:28832
ds_read_b64_tr_b16 a[210:211], v2 offset:30624
v_mfma_f32_16x16x32_bf16 a[0:3], a[224:227], a[144:147], a[0:3]
v_cvt_pk_bf16_f32 v49, v62, v63
v_lshlrev_b32 v60, 16, v48
v_mfma_f32_16x16x32_bf16 a[0:3], a[228:231], a[192:195], a[0:3]
buffer_load_dwordx4 v9, s[20:23], s57 offen lds
v_mfma_f32_16x16x32_bf16 a[4:7], a[224:227], a[148:151], a[4:7]
v_and_b32 v61, 0xffff0000, v48
v_lshlrev_b32 v62, 16, v49
v_mfma_f32_16x16x32_bf16 a[4:7], a[228:231], a[196:199], a[4:7]
s_waitcnt lgkmcnt(6)
ds_read_b64_tr_b16 a[212:213], v2 offset:36000
ds_read_b64_tr_b16 a[214:215], v2 offset:37792
v_mfma_f32_16x16x32_bf16 a[8:11], a[224:227], a[152:155], a[8:11]
v_and_b32 v63, 0xffff0000, v49
v_add_f32 v56, v56, v60
v_mfma_f32_16x16x32_bf16 a[8:11], a[228:231], a[200:203], a[8:11]
buffer_load_dwordx4 a[132:135], v1, s[8:11], s59 offen offset:1024 sc1
v_mfma_f32_16x16x32_bf16 a[12:15], a[224:227], a[156:159], a[12:15]
s_add_u32 m0, s54, 108544
v_add_f32 v57, v57, v61
v_add_f32 v58, v58, v62
v_mfma_f32_16x16x32_bf16 a[12:15], a[228:231], a[204:207], a[12:15]
s_waitcnt lgkmcnt(4)
ds_read_b64_tr_b16 a[216:217], v2 offset:43168
ds_read_b64_tr_b16 a[218:219], v2 offset:44960
v_mfma_f32_16x16x32_bf16 a[28:31], a[232:235], a[156:159], a[28:31]
v_add_f32 v59, v59, v63
v_accvgpr_write_b32 a188, v56
v_mfma_f32_16x16x32_bf16 a[28:31], a[236:239], a[204:207], a[28:31]
v_accvgpr_write_b32 a189, v57
v_accvgpr_write_b32 a190, v58
v_mfma_f32_16x16x32_bf16 a[24:27], a[232:235], a[152:155], a[24:27]
v_accvgpr_write_b32 a191, v59
v_mfma_f32_16x16x32_bf16 a[24:27], a[236:239], a[200:203], a[24:27]
s_waitcnt lgkmcnt(6)
ds_read_b64_tr_b16 a[220:221], v2 offset:50336
ds_read_b64_tr_b16 a[222:223], v2 offset:52128
v_mfma_f32_16x16x32_bf16 a[20:23], a[232:235], a[148:151], a[20:23]
v_mfma_f32_16x16x32_bf16 a[20:23], a[236:239], a[196:199], a[20:23]
v_mfma_f32_16x16x32_bf16 a[16:19], a[232:235], a[144:147], a[16:19]
v_mfma_f32_16x16x32_bf16 a[16:19], a[236:239], a[192:195], a[16:19]
s_waitcnt lgkmcnt(4)
ds_read_b64_tr_b16 a[224:225], v2 offset:28864
ds_read_b64_tr_b16 a[226:227], v2 offset:30656
v_mfma_f32_16x16x32_bf16 a[32:35], a[208:211], a[144:147], a[32:35]
v_mfma_f32_16x16x32_bf16 a[32:35], a[212:215], a[192:195], a[32:35]
v_mfma_f32_16x16x32_bf16 a[36:39], a[208:211], a[148:151], a[36:39]
v_mfma_f32_16x16x32_bf16 a[36:39], a[212:215], a[196:199], a[36:39]
s_waitcnt lgkmcnt(6)
ds_read_b64_tr_b16 a[228:229], v2 offset:36032
ds_read_b64_tr_b16 a[230:231], v2 offset:37824
v_mfma_f32_16x16x32_bf16 a[40:43], a[208:211], a[152:155], a[40:43]
v_mfma_f32_16x16x32_bf16 a[40:43], a[212:215], a[200:203], a[40:43]
v_mfma_f32_16x16x32_bf16 a[44:47], a[208:211], a[156:159], a[44:47]
v_mfma_f32_16x16x32_bf16 a[44:47], a[212:215], a[204:207], a[44:47]
s_waitcnt lgkmcnt(4)
ds_read_b64_tr_b16 a[232:233], v2 offset:43200
ds_read_b64_tr_b16 a[234:235], v2 offset:44992
v_mfma_f32_16x16x32_bf16 a[60:63], a[216:219], a[156:159], a[60:63]
buffer_load_dwordx4 v6, s[16:19], s57 offen lds
v_mfma_f32_16x16x32_bf16 a[60:63], a[220:223], a[204:207], a[60:63]
v_mfma_f32_16x16x32_bf16 a[56:59], a[216:219], a[152:155], a[56:59]
v_mfma_f32_16x16x32_bf16 a[56:59], a[220:223], a[200:203], a[56:59]
s_waitcnt lgkmcnt(6)
ds_read_b64_tr_b16 a[236:237], v2 offset:50368
ds_read_b64_tr_b16 a[238:239], v2 offset:52160
v_mfma_f32_16x16x32_bf16 a[52:55], a[216:219], a[148:151], a[52:55]
buffer_load_dwordx4 a[136:139], v1, s[8:11], s59 offen offset:2048 sc1
v_mfma_f32_16x16x32_bf16 a[52:55], a[220:223], a[196:199], a[52:55]
s_add_u32 m0, s54, 112640
v_mfma_f32_16x16x32_bf16 a[48:51], a[216:219], a[144:147], a[48:51]
v_mfma_f32_16x16x32_bf16 a[48:51], a[220:223], a[192:195], a[48:51]
s_waitcnt lgkmcnt(4)
ds_read_b128 a[208:211], v3 offset:8192
v_mfma_f32_16x16x32_bf16 a[64:67], a[224:227], a[144:147], a[64:67]
v_mfma_f32_16x16x32_bf16 a[64:67], a[228:231], a[192:195], a[64:67]
buffer_load_dwordx4 v7, s[16:19], s57 offen lds
v_mfma_f32_16x16x32_bf16 a[68:71], a[224:227], a[148:151], a[68:71]
v_mfma_f32_16x16x32_bf16 a[68:71], a[228:231], a[196:199], a[68:71]
ds_read_b128 a[212:215], v4 offset:8192
v_mfma_f32_16x16x32_bf16 a[72:75], a[224:227], a[152:155], a[72:75]
v_mfma_f32_16x16x32_bf16 a[72:75], a[228:231], a[200:203], a[72:75]
buffer_load_dwordx4 a[140:143], v1, s[8:11], s59 offen offset:3072 sc1
v_mfma_f32_16x16x32_bf16 a[76:79], a[224:227], a[156:159], a[76:79]
s_add_u32 m0, s54, 116736
v_mfma_f32_16x16x32_bf16 a[76:79], a[228:231], a[204:207], a[76:79]
s_waitcnt lgkmcnt(2)
ds_read_b128 a[216:219], v3 offset:12288
v_mfma_f32_16x16x32_bf16 a[92:95], a[232:235], a[156:159], a[92:95]
v_mfma_f32_16x16x32_bf16 a[92:95], a[236:239], a[204:207], a[92:95]
v_mfma_f32_16x16x32_bf16 a[88:91], a[232:235], a[152:155], a[88:91]
buffer_load_dwordx4 v8, s[16:19], s57 offen lds
v_mfma_f32_16x16x32_bf16 a[88:91], a[236:239], a[200:203], a[88:91]
ds_read_b128 a[220:223], v4 offset:12288
s_movk_i32 s58, 1408
v_mfma_f32_16x16x32_bf16 a[84:87], a[232:235], a[148:151], a[84:87]
s_add_u32 m0, s56, 24576
v_mfma_f32_16x16x32_bf16 a[84:87], a[236:239], a[196:199], a[84:87]
v_mfma_f32_16x16x32_bf16 a[80:83], a[232:235], a[144:147], a[80:83]
buffer_load_dwordx4 v10, s[24:27], s58 offen lds
v_mfma_f32_16x16x32_bf16 a[80:83], a[236:239], a[192:195], a[80:83]
s_waitcnt lgkmcnt(2)
ds_read_b128 a[224:227], v3 offset:10240
ds_read_b128 a[228:231], v4 offset:10240
v_mfma_f32_16x16x32_bf16 v[64:67], a[144:147], a[208:211], v[64:67]
s_add_u32 m0, s56, 28672
v_mfma_f32_16x16x32_bf16 v[64:67], a[192:195], a[212:215], v[64:67]
v_mfma_f32_16x16x32_bf16 v[68:71], a[148:151], a[208:211], v[68:71]
v_mfma_f32_16x16x32_bf16 v[68:71], a[196:199], a[212:215], v[68:71]
s_waitcnt lgkmcnt(4)
ds_read_b128 a[232:235], v3 offset:14336
ds_read_b128 a[236:239], v4 offset:14336
v_mfma_f32_16x16x32_bf16 v[72:75], a[152:155], a[208:211], v[72:75]
v_mfma_f32_16x16x32_bf16 v[72:75], a[200:203], a[212:215], v[72:75]
v_mfma_f32_16x16x32_bf16 v[76:79], a[156:159], a[208:211], v[76:79]
v_mfma_f32_16x16x32_bf16 v[76:79], a[204:207], a[212:215], v[76:79]
s_waitcnt lgkmcnt(4)
v_mfma_f32_16x16x32_bf16 v[108:111], a[156:159], a[216:219], v[108:111]
v_mfma_f32_16x16x32_bf16 v[108:111], a[204:207], a[220:223], v[108:111]
v_mfma_f32_16x16x32_bf16 v[104:107], a[152:155], a[216:219], v[104:107]
v_mfma_f32_16x16x32_bf16 v[104:107], a[200:203], a[220:223], v[104:107]
v_mfma_f32_16x16x32_bf16 v[100:103], a[148:151], a[216:219], v[100:103]
buffer_load_dwordx4 v10, s[28:31], s58 offen lds
v_mfma_f32_16x16x32_bf16 v[100:103], a[196:199], a[220:223], v[100:103]
s_mov_b32 s57, 5505024
s_add_u32 m0, s54, 0
v_mfma_f32_16x16x32_bf16 v[96:99], a[144:147], a[216:219], v[96:99]
s_waitcnt vmcnt(17) lgkmcnt(0)
s_barrier
v_mfma_f32_16x16x32_bf16 v[96:99], a[192:195], a[220:223], v[96:99]
s_waitcnt lgkmcnt(2)
ds_read_b64_tr_b16 a[208:209], v5 offset:0
ds_read_b64_tr_b16 a[210:211], v5 offset:1792
v_mfma_f32_16x16x32_bf16 v[80:83], a[144:147], a[224:227], v[80:83]
buffer_load_dwordx4 v6, s[12:15], s57 offen lds
v_mfma_f32_16x16x32_bf16 v[80:83], a[192:195], a[228:231], v[80:83]
s_add_u32 m0, s54, 4096
v_mfma_f32_16x16x32_bf16 v[84:87], a[148:151], a[224:227], v[84:87]
v_mfma_f32_16x16x32_bf16 v[84:87], a[196:199], a[228:231], v[84:87]
s_waitcnt lgkmcnt(4)
ds_read_b64_tr_b16 a[212:213], v5 offset:7168
ds_read_b64_tr_b16 a[214:215], v5 offset:8960
v_mfma_f32_16x16x32_bf16 v[88:91], a[152:155], a[224:227], v[88:91]
L_tr6:
s_cbranch_execz L_tr10
v_mfma_f32_16x16x32_bf16 v[88:91], a[200:203], a[228:231], v[88:91]
buffer_load_dwordx4 v7, s[12:15], s57 offen lds
v_mfma_f32_16x16x32_bf16 v[92:95], a[156:159], a[224:227], v[92:95]
s_add_u32 m0, s54, 8192
v_mfma_f32_16x16x32_bf16 v[92:95], a[204:207], a[228:231], v[92:95]
s_waitcnt lgkmcnt(4)
ds_read_b64_tr_b16 a[216:217], v5 offset:14336
ds_read_b64_tr_b16 a[218:219], v5 offset:16128
v_mfma_f32_16x16x32_bf16 v[124:127], a[156:159], a[232:235], v[124:127]
v_mfma_f32_16x16x32_bf16 v[124:127], a[204:207], a[236:239], v[124:127]
v_mfma_f32_16x16x32_bf16 v[120:123], a[152:155], a[232:235], v[120:123]
v_mfma_f32_16x16x32_bf16 v[120:123], a[200:203], a[236:239], v[120:123]
s_waitcnt lgkmcnt(6)
ds_read_b64_tr_b16 a[220:221], v5 offset:21504
ds_read_b64_tr_b16 a[222:223], v5 offset:23296
v_mfma_f32_16x16x32_bf16 v[116:119], a[148:151], a[232:235], v[116:119]
v_mfma_f32_16x16x32_bf16 v[116:119], a[196:199], a[236:239], v[116:119]
v_mfma_f32_16x16x32_bf16 v[112:115], a[144:147], a[232:235], v[112:115]
buffer_load_dwordx4 v8, s[12:15], s57 offen lds
v_mfma_f32_16x16x32_bf16 v[112:115], a[192:195], a[236:239], v[112:115]
s_waitcnt vmcnt(15) lgkmcnt(4)
ds_read_b64_tr_b16 a[224:225], v5 offset:32
ds_read_b64_tr_b16 a[226:227], v5 offset:1824
v_mfma_f32_16x16x32_bf16 v[128:131], a[208:211], a[96:99], v[128:131]
s_mov_b32 s59, 94208
v_mfma_f32_16x16x32_bf16 v[128:131], a[212:215], a[112:115], v[128:131]
v_mfma_f32_16x16x32_bf16 v[132:135], a[208:211], a[100:103], v[132:135]
v_mfma_f32_16x16x32_bf16 v[132:135], a[212:215], a[116:119], v[132:135]
s_waitcnt lgkmcnt(6)
ds_read_b64_tr_b16 a[228:229], v5 offset:7200
ds_read_b64_tr_b16 a[230:231], v5 offset:8992
v_mfma_f32_16x16x32_bf16 v[136:139], a[208:211], a[104:107], v[136:139]
buffer_load_dwordx4 a[144:147], v1, s[8:11], s59 offen offset:0 sc1
v_mfma_f32_16x16x32_bf16 v[136:139], a[212:215], a[120:123], v[136:139]
s_add_u32 m0, s55, 0
v_mfma_f32_16x16x32_bf16 v[140:143], a[208:211], a[108:111], v[140:143]
v_mfma_f32_16x16x32_bf16 v[140:143], a[212:215], a[124:127], v[140:143]
s_waitcnt lgkmcnt(4)
ds_read_b64_tr_b16 a[232:233], v5 offset:14368
ds_read_b64_tr_b16 a[234:235], v5 offset:16160
v_mfma_f32_16x16x32_bf16 v[156:159], a[216:219], a[108:111], v[156:159]
v_mfma_f32_16x16x32_bf16 v[156:159], a[220:223], a[124:127], v[156:159]
v_mfma_f32_16x16x32_bf16 v[152:155], a[216:219], a[104:107], v[152:155]
v_mfma_f32_16x16x32_bf16 v[152:155], a[220:223], a[120:123], v[152:155]
s_waitcnt lgkmcnt(6)
ds_read_b64_tr_b16 a[236:237], v5 offset:21536
ds_read_b64_tr_b16 a[238:239], v5 offset:23328
v_mfma_f32_16x16x32_bf16 v[148:151], a[216:219], a[100:103], v[148:151]
v_mfma_f32_16x16x32_bf16 v[148:151], a[220:223], a[116:119], v[148:151]
v_mfma_f32_16x16x32_bf16 v[144:147], a[216:219], a[96:99], v[144:147]
v_mfma_f32_16x16x32_bf16 v[144:147], a[220:223], a[112:115], v[144:147]
s_waitcnt lgkmcnt(4)
ds_read_b64_tr_b16 a[208:209], v5 offset:64
ds_read_b64_tr_b16 a[210:211], v5 offset:1856
v_mfma_f32_16x16x32_bf16 v[160:163], a[224:227], a[96:99], v[160:163]
buffer_load_dwordx4 v9, s[20:23], s57 offen lds
v_mfma_f32_16x16x32_bf16 v[160:163], a[228:231], a[112:115], v[160:163]
v_mfma_f32_16x16x32_bf16 v[164:167], a[224:227], a[100:103], v[164:167]
v_mfma_f32_16x16x32_bf16 v[164:167], a[228:231], a[116:119], v[164:167]
s_waitcnt lgkmcnt(6)
ds_read_b64_tr_b16 a[212:213], v5 offset:7232
ds_read_b64_tr_b16 a[214:215], v5 offset:9024
v_mfma_f32_16x16x32_bf16 v[168:171], a[224:227], a[104:107], v[168:171]
v_mfma_f32_16x16x32_bf16 v[168:171], a[228:231], a[120:123], v[168:171]
buffer_load_dwordx4 a[148:151], v1, s[8:11], s59 offen offset:1024 sc1
v_mfma_f32_16x16x32_bf16 v[172:175], a[224:227], a[108:111], v[172:175]
s_add_u32 m0, s54, 14336
v_mfma_f32_16x16x32_bf16 v[172:175], a[228:231], a[124:127], v[172:175]
s_waitcnt lgkmcnt(4)
ds_read_b64_tr_b16 a[216:217], v5 offset:14400
ds_read_b64_tr_b16 a[218:219], v5 offset:16192
v_mfma_f32_16x16x32_bf16 v[188:191], a[232:235], a[108:111], v[188:191]
v_mfma_f32_16x16x32_bf16 v[188:191], a[236:239], a[124:127], v[188:191]
buffer_load_dwordx4 v6, s[16:19], s57 offen lds
v_mfma_f32_16x16x32_bf16 v[184:187], a[232:235], a[104:107], v[184:187]
v_mfma_f32_16x16x32_bf16 v[184:187], a[236:239], a[120:123], v[184:187]
s_waitcnt lgkmcnt(6)
ds_read_b64_tr_b16 a[220:221], v5 offset:21568
ds_read_b64_tr_b16 a[222:223], v5 offset:23360
v_mfma_f32_16x16x32_bf16 v[180:183], a[232:235], a[100:103], v[180:183]
v_mfma_f32_16x16x32_bf16 v[180:183], a[236:239], a[116:119], v[180:183]
v_mfma_f32_16x16x32_bf16 v[176:179], a[232:235], a[96:99], v[176:179]
buffer_load_dwordx4 a[152:155], v1, s[8:11], s59 offen offset:2048 sc1
v_mfma_f32_16x16x32_bf16 v[176:179], a[236:239], a[112:115], v[176:179]
s_waitcnt lgkmcnt(4)
ds_read_b64_tr_b16 a[224:225], v5 offset:96
ds_read_b64_tr_b16 a[226:227], v5 offset:1888
v_mfma_f32_16x16x32_bf16 v[192:195], a[208:211], a[96:99], v[192:195]
v_mfma_f32_16x16x32_bf16 v[192:195], a[212:215], a[112:115], v[192:195]
v_mfma_f32_16x16x32_bf16 v[196:199], a[208:211], a[100:103], v[196:199]
buffer_load_dwordx4 a[156:159], v1, s[8:11], s59 offen offset:3072 sc1
v_mfma_f32_16x16x32_bf16 v[196:199], a[212:215], a[116:119], v[196:199]
s_waitcnt lgkmcnt(6)
ds_read_b64_tr_b16 a[228:229], v5 offset:7264
ds_read_b64_tr_b16 a[230:231], v5 offset:9056
v_mfma_f32_16x16x32_bf16 v[200:203], a[208:211], a[104:107], v[200:203]
s_add_u32 m0, s54, 18432
v_mfma_f32_16x16x32_bf16 v[200:203], a[212:215], a[120:123], v[200:203]
v_mfma_f32_16x16x32_bf16 v[204:207], a[208:211], a[108:111], v[204:207]
v_mfma_f32_16x16x32_bf16 v[204:207], a[212:215], a[124:127], v[204:207]
s_waitcnt lgkmcnt(4)
ds_read_b64_tr_b16 a[232:233], v5 offset:14432
ds_read_b64_tr_b16 a[234:235], v5 offset:16224
v_mfma_f32_16x16x32_bf16 v[220:223], a[216:219], a[108:111], v[220:223]
buffer_load_dwordx4 v7, s[16:19], s57 offen lds
v_mfma_f32_16x16x32_bf16 v[220:223], a[220:223], a[124:127], v[220:223]
s_add_u32 m0, s54, 22528
v_mfma_f32_16x16x32_bf16 v[216:219], a[216:219], a[104:107], v[216:219]
v_mfma_f32_16x16x32_bf16 v[216:219], a[220:223], a[120:123], v[216:219]
s_waitcnt lgkmcnt(6)
ds_read_b64_tr_b16 a[236:237], v5 offset:21600
ds_read_b64_tr_b16 a[238:239], v5 offset:23392
v_mfma_f32_16x16x32_bf16 v[212:215], a[216:219], a[100:103], v[212:215]
v_mfma_f32_16x16x32_bf16 v[212:215], a[220:223], a[116:119], v[212:215]
v_mfma_f32_16x16x32_bf16 v[208:211], a[216:219], a[96:99], v[208:211]
v_mfma_f32_16x16x32_bf16 v[208:211], a[220:223], a[112:115], v[208:211]
s_waitcnt lgkmcnt(4)
ds_read_b64_tr_b16 a[208:209], v5 offset:128
ds_read_b64_tr_b16 a[210:211], v5 offset:1920
v_mfma_f32_16x16x32_bf16 v[224:227], a[224:227], a[96:99], v[224:227]
v_mfma_f32_16x16x32_bf16 v[224:227], a[228:231], a[112:115], v[224:227]
v_mfma_f32_16x16x32_bf16 v[228:231], a[224:227], a[100:103], v[228:231]
v_mfma_f32_16x16x32_bf16 v[228:231], a[228:231], a[116:119], v[228:231]
s_waitcnt lgkmcnt(6)
ds_read_b64_tr_b16 a[212:213], v5 offset:7296
ds_read_b64_tr_b16 a[214:215], v5 offset:9088
v_mfma_f32_16x16x32_bf16 v[232:235], a[224:227], a[104:107], v[232:235]
buffer_load_dwordx4 v8, s[16:19], s57 offen lds
v_mfma_f32_16x16x32_bf16 v[232:235], a[228:231], a[120:123], v[232:235]
s_movk_i32 s58, 1536
s_add_u32 m0, s56, 0
v_mfma_f32_16x16x32_bf16 v[236:239], a[224:227], a[108:111], v[236:239]
v_mfma_f32_16x16x32_bf16 v[236:239], a[228:231], a[124:127], v[236:239]
s_waitcnt lgkmcnt(4)
ds_read_b64_tr_b16 a[216:217], v5 offset:14464
ds_read_b64_tr_b16 a[218:219], v5 offset:16256
v_mfma_f32_16x16x32_bf16 v[252:255], a[232:235], a[108:111], v[252:255]
v_mfma_f32_16x16x32_bf16 v[252:255], a[236:239], a[124:127], v[252:255]
buffer_load_dwordx4 v10, s[24:27], s58 offen lds
v_mfma_f32_16x16x32_bf16 v[248:251], a[232:235], a[104:107], v[248:251]
s_mov_b32 s59, 98304
v_mfma_f32_16x16x32_bf16 v[248:251], a[236:239], a[120:123], v[248:251]
s_waitcnt lgkmcnt(6)
ds_read_b64_tr_b16 a[220:221], v5 offset:21632
ds_read_b64_tr_b16 a[222:223], v5 offset:23424
v_mfma_f32_16x16x32_bf16 v[244:247], a[232:235], a[100:103], v[244:247]
v_mfma_f32_16x16x32_bf16 v[244:247], a[236:239], a[116:119], v[244:247]
buffer_load_dwordx4 a[192:195], v1, s[8:11], s59 offen offset:0 sc1
v_mfma_f32_16x16x32_bf16 v[240:243], a[232:235], a[96:99], v[240:243]
s_add_u32 m0, s56, 4096
v_mfma_f32_16x16x32_bf16 v[240:243], a[236:239], a[112:115], v[240:243]
s_waitcnt lgkmcnt(4)
ds_read_b64_tr_b16 a[224:225], v5 offset:160
ds_read_b64_tr_b16 a[226:227], v5 offset:1952
v_mfma_f32_16x16x32_bf16 a[0:3], a[208:211], a[96:99], a[0:3]
v_mfma_f32_16x16x32_bf16 a[0:3], a[212:215], a[112:115], a[0:3]
v_mfma_f32_16x16x32_bf16 a[4:7], a[208:211], a[100:103], a[4:7]
buffer_load_dwordx4 v10, s[28:31], s58 offen lds
v_mfma_f32_16x16x32_bf16 a[4:7], a[212:215], a[116:119], a[4:7]
s_waitcnt lgkmcnt(6)
ds_read_b64_tr_b16 a[228:229], v5 offset:7328
ds_read_b64_tr_b16 a[230:231], v5 offset:9120
v_mfma_f32_16x16x32_bf16 a[8:11], a[208:211], a[104:107], a[8:11]
v_mfma_f32_16x16x32_bf16 a[8:11], a[212:215], a[120:123], a[8:11]
v_mfma_f32_16x16x32_bf16 a[12:15], a[208:211], a[108:111], a[12:15]
buffer_load_dword a246, v13, s[40:43], s77 offen
v_mfma_f32_16x16x32_bf16 a[12:15], a[212:215], a[124:127], a[12:15]
s_waitcnt lgkmcnt(4)
ds_read_b64_tr_b16 a[232:233], v5 offset:14496
ds_read_b64_tr_b16 a[234:235], v5 offset:16288
v_mfma_f32_16x16x32_bf16 a[28:31], a[216:219], a[108:111], a[28:31]
s_add_u32 s77, s77, s76
v_mfma_f32_16x16x32_bf16 a[28:31], a[220:223], a[124:127], a[28:31]
v_mfma_f32_16x16x32_bf16 a[24:27], a[216:219], a[104:107], a[24:27]
v_mfma_f32_16x16x32_bf16 a[24:27], a[220:223], a[120:123], a[24:27]
s_waitcnt lgkmcnt(6)
ds_read_b64_tr_b16 a[236:237], v5 offset:21664
ds_read_b64_tr_b16 a[238:239], v5 offset:23456
v_mfma_f32_16x16x32_bf16 a[20:23], a[216:219], a[100:103], a[20:23]
buffer_load_dword a246, v13, s[40:43], s77 offen
v_mfma_f32_16x16x32_bf16 a[20:23], a[220:223], a[116:119], a[20:23]
s_add_u32 s77, s77, s76
v_mfma_f32_16x16x32_bf16 a[16:19], a[216:219], a[96:99], a[16:19]
v_mfma_f32_16x16x32_bf16 a[16:19], a[220:223], a[112:115], a[16:19]
s_waitcnt lgkmcnt(4)
ds_read_b64_tr_b16 a[208:209], v5 offset:192
ds_read_b64_tr_b16 a[210:211], v5 offset:1984
v_mfma_f32_16x16x32_bf16 a[32:35], a[224:227], a[96:99], a[32:35]
buffer_load_dword a246, v13, s[40:43], s77 offen
v_mfma_f32_16x16x32_bf16 a[32:35], a[228:231], a[112:115], a[32:35]
s_add_u32 s77, s77, s76
v_mfma_f32_16x16x32_bf16 a[36:39], a[224:227], a[100:103], a[36:39]
v_mfma_f32_16x16x32_bf16 a[36:39], a[228:231], a[116:119], a[36:39]
s_waitcnt lgkmcnt(6)
ds_read_b64_tr_b16 a[212:213], v5 offset:7360
ds_read_b64_tr_b16 a[214:215], v5 offset:9152
v_mfma_f32_16x16x32_bf16 a[40:43], a[224:227], a[104:107], a[40:43]
v_mfma_f32_16x16x32_bf16 a[40:43], a[228:231], a[120:123], a[40:43]
v_mfma_f32_16x16x32_bf16 a[44:47], a[224:227], a[108:111], a[44:47]
v_mfma_f32_16x16x32_bf16 a[44:47], a[228:231], a[124:127], a[44:47]
s_waitcnt lgkmcnt(4)
ds_read_b64_tr_b16 a[216:217], v5 offset:14528
ds_read_b64_tr_b16 a[218:219], v5 offset:16320
v_mfma_f32_16x16x32_bf16 a[60:63], a[232:235], a[108:111], a[60:63]
v_mfma_f32_16x16x32_bf16 a[60:63], a[236:239], a[124:127], a[60:63]
v_mfma_f32_16x16x32_bf16 a[56:59], a[232:235], a[104:107], a[56:59]
v_mfma_f32_16x16x32_bf16 a[56:59], a[236:239], a[120:123], a[56:59]
s_waitcnt lgkmcnt(6)
ds_read_b64_tr_b16 a[220:221], v5 offset:21696
ds_read_b64_tr_b16 a[222:223], v5 offset:23488
v_mfma_f32_16x16x32_bf16 a[52:55], a[232:235], a[100:103], a[52:55]
v_mfma_f32_16x16x32_bf16 a[52:55], a[236:239], a[116:119], a[52:55]
buffer_load_dword a246, v14, s[44:47], s78 offen
v_mfma_f32_16x16x32_bf16 a[48:51], a[232:235], a[96:99], a[48:51]
s_add_u32 s78, s78, s80
v_mfma_f32_16x16x32_bf16 a[48:51], a[236:239], a[112:115], a[48:51]
s_waitcnt lgkmcnt(4)
ds_read_b128 a[224:227], v3 offset:16384
v_mfma_f32_16x16x32_bf16 a[64:67], a[208:211], a[96:99], a[64:67]
v_mfma_f32_16x16x32_bf16 a[64:67], a[212:215], a[112:115], a[64:67]
buffer_load_dwordx4 a[196:199], v1, s[8:11], s59 offen offset:1024 sc1
v_mfma_f32_16x16x32_bf16 a[68:71], a[208:211], a[100:103], a[68:71]
v_mfma_f32_16x16x32_bf16 a[68:71], a[212:215], a[116:119], a[68:71]
ds_read_b128 a[228:231], v4 offset:16384
v_mfma_f32_16x16x32_bf16 a[72:75], a[208:211], a[104:107], a[72:75]
v_mfma_f32_16x16x32_bf16 a[72:75], a[212:215], a[120:123], a[72:75]
v_mfma_f32_16x16x32_bf16 a[76:79], a[208:211], a[108:111], a[76:79]
buffer_load_dwordx4 a[200:203], v1, s[8:11], s59 offen offset:2048 sc1
v_mfma_f32_16x16x32_bf16 a[76:79], a[212:215], a[124:127], a[76:79]
s_waitcnt lgkmcnt(2)
ds_read_b128 a[232:235], v3 offset:20480
v_mfma_f32_16x16x32_bf16 a[92:95], a[216:219], a[108:111], a[92:95]
v_mfma_f32_16x16x32_bf16 a[92:95], a[220:223], a[124:127], a[92:95]
v_mfma_f32_16x16x32_bf16 a[88:91], a[216:219], a[104:107], a[88:91]
v_mfma_f32_16x16x32_bf16 a[88:91], a[220:223], a[120:123], a[88:91]
ds_read_b128 a[236:239], v4 offset:20480
v_mfma_f32_16x16x32_bf16 a[84:87], a[216:219], a[100:103], a[84:87]
v_mfma_f32_16x16x32_bf16 a[84:87], a[220:223], a[116:119], a[84:87]
v_mfma_f32_16x16x32_bf16 a[80:83], a[216:219], a[96:99], a[80:83]
v_mfma_f32_16x16x32_bf16 a[80:83], a[220:223], a[112:115], a[80:83]
s_waitcnt lgkmcnt(2)
ds_read_b128 a[208:211], v3 offset:18432
ds_read_b128 a[212:215], v4 offset:18432
v_mfma_f32_16x16x32_bf16 v[64:67], a[96:99], a[224:227], v[64:67]
v_mfma_f32_16x16x32_bf16 v[64:67], a[112:115], a[228:231], v[64:67]
v_mfma_f32_16x16x32_bf16 v[68:71], a[100:103], a[224:227], v[68:71]
v_mfma_f32_16x16x32_bf16 v[68:71], a[116:119], a[228:231], v[68:71]
s_waitcnt lgkmcnt(4)
ds_read_b128 a[216:219], v3 offset:22528
ds_read_b128 a[220:223], v4 offset:22528
v_mfma_f32_16x16x32_bf16 v[72:75], a[104:107], a[224:227], v[72:75]
v_mfma_f32_16x16x32_bf16 v[72:75], a[120:123], a[228:231], v[72:75]
v_mfma_f32_16x16x32_bf16 v[76:79], a[108:111], a[224:227], v[76:79]
v_mfma_f32_16x16x32_bf16 v[76:79], a[124:127], a[228:231], v[76:79]
s_waitcnt lgkmcnt(4)
v_mfma_f32_16x16x32_bf16 v[108:111], a[108:111], a[232:235], v[108:111]
v_mfma_f32_16x16x32_bf16 v[108:111], a[124:127], a[236:239], v[108:111]
v_mfma_f32_16x16x32_bf16 v[104:107], a[104:107], a[232:235], v[104:107]
v_mfma_f32_16x16x32_bf16 v[104:107], a[120:123], a[236:239], v[104:107]
v_mfma_f32_16x16x32_bf16 v[100:103], a[100:103], a[232:235], v[100:103]
v_mfma_f32_16x16x32_bf16 v[100:103], a[116:119], a[236:239], v[100:103]
v_mfma_f32_16x16x32_bf16 v[96:99], a[96:99], a[232:235], v[96:99]
s_waitcnt vmcnt(20) lgkmcnt(0)
s_barrier
v_mfma_f32_16x16x32_bf16 v[96:99], a[112:115], a[236:239], v[96:99]
s_waitcnt lgkmcnt(2)
ds_read_b64_tr_b16 a[224:225], v5 offset:28672
ds_read_b64_tr_b16 a[226:227], v5 offset:30464
v_mfma_f32_16x16x32_bf16 v[80:83], a[96:99], a[208:211], v[80:83]
v_mfma_f32_16x16x32_bf16 v[80:83], a[112:115], a[212:215], v[80:83]
v_mfma_f32_16x16x32_bf16 v[84:87], a[100:103], a[208:211], v[84:87]
v_mfma_f32_16x16x32_bf16 v[84:87], a[116:119], a[212:215], v[84:87]
s_waitcnt lgkmcnt(4)
ds_read_b64_tr_b16 a[228:229], v5 offset:35840
ds_read_b64_tr_b16 a[230:231], v5 offset:37632
v_mfma_f32_16x16x32_bf16 v[88:91], a[104:107], a[208:211], v[88:91]
v_mfma_f32_16x16x32_bf16 v[88:91], a[120:123], a[212:215], v[88:91]
v_mfma_f32_16x16x32_bf16 v[92:95], a[108:111], a[208:211], v[92:95]
buffer_load_dwordx4 a[204:207], v1, s[8:11], s59 offen offset:3072 sc1
v_mfma_f32_16x16x32_bf16 v[92:95], a[124:127], a[212:215], v[92:95]
s_waitcnt lgkmcnt(4)
ds_read_b64_tr_b16 a[232:233], v5 offset:43008
ds_read_b64_tr_b16 a[234:235], v5 offset:44800
v_mfma_f32_16x16x32_bf16 v[124:127], a[108:111], a[216:219], v[124:127]
s_mov_b32 s59, 102400
v_mfma_f32_16x16x32_bf16 v[124:127], a[124:127], a[220:223], v[124:127]
v_mfma_f32_16x16x32_bf16 v[120:123], a[104:107], a[216:219], v[120:123]
v_mfma_f32_16x16x32_bf16 v[120:123], a[120:123], a[220:223], v[120:123]
s_waitcnt lgkmcnt(6)
ds_read_b64_tr_b16 a[236:237], v5 offset:50176
ds_read_b64_tr_b16 a[238:239], v5 offset:51968
v_mfma_f32_16x16x32_bf16 v[116:119], a[100:103], a[216:219], v[116:119]
v_mfma_f32_16x16x32_bf16 v[116:119], a[116:119], a[220:223], v[116:119]
v_mfma_f32_16x16x32_bf16 v[112:115], a[96:99], a[216:219], v[112:115]
v_mfma_f32_16x16x32_bf16 v[112:115], a[112:115], a[220:223], v[112:115]
s_waitcnt vmcnt(12) lgkmcnt(4)
ds_read_b64_tr_b16 a[208:209], v5 offset:28704
ds_read_b64_tr_b16 a[210:211], v5 offset:30496
v_mfma_f32_16x16x32_bf16 v[128:131], a[224:227], a[128:131], v[128:131]
buffer_load_dwordx4 a[96:99], v1, s[8:11], s59 offen offset:0 sc1
v_mfma_f32_16x16x32_bf16 v[128:131], a[228:231], a[144:147], v[128:131]
v_mfma_f32_16x16x32_bf16 v[132:135], a[224:227], a[132:135], v[132:135]
v_mfma_f32_16x16x32_bf16 v[132:135], a[228:231], a[148:151], v[132:135]
s_waitcnt lgkmcnt(6)
ds_read_b64_tr_b16 a[212:213], v5 offset:35872
ds_read_b64_tr_b16 a[214:215], v5 offset:37664
v_mfma_f32_16x16x32_bf16 v[136:139], a[224:227], a[136:139], v[136:139]
buffer_load_dwordx4 a[100:103], v1, s[8:11], s59 offen offset:1024 sc1
v_mfma_f32_16x16x32_bf16 v[136:139], a[228:231], a[152:155], v[136:139]
v_mfma_f32_16x16x32_bf16 v[140:143], a[224:227], a[140:143], v[140:143]
v_mfma_f32_16x16x32_bf16 v[140:143], a[228:231], a[156:159], v[140:143]
s_waitcnt lgkmcnt(4)
ds_read_b64_tr_b16 a[216:217], v5 offset:43040
ds_read_b64_tr_b16 a[218:219], v5 offset:44832
v_mfma_f32_16x16x32_bf16 v[156:159], a[232:235], a[140:143], v[156:159]
v_mfma_f32_16x16x32_bf16 v[156:159], a[236:239], a[156:159], v[156:159]
v_mfma_f32_16x16x32_bf16 v[152:155], a[232:235], a[136:139], v[152:155]
v_mfma_f32_16x16x32_bf16 v[152:155], a[236:239], a[152:155], v[152:155]
s_waitcnt lgkmcnt(6)
ds_read_b64_tr_b16 a[220:221], v5 offset:50208
ds_read_b64_tr_b16 a[222:223], v5 offset:52000
v_mfma_f32_16x16x32_bf16 v[148:151], a[232:235], a[132:135], v[148:151]
v_mfma_f32_16x16x32_bf16 v[148:151], a[236:239], a[148:151], v[148:151]
buffer_load_dwordx4 a[104:107], v1, s[8:11], s59 offen offset:2048 sc1
v_mfma_f32_16x16x32_bf16 v[144:147], a[232:235], a[128:131], v[144:147]
v_mfma_f32_16x16x32_bf16 v[144:147], a[236:239], a[144:147], v[144:147]
s_waitcnt lgkmcnt(4)
ds_read_b64_tr_b16 a[224:225], v5 offset:28736
ds_read_b64_tr_b16 a[226:227], v5 offset:30528
v_mfma_f32_16x16x32_bf16 v[160:163], a[208:211], a[128:131], v[160:163]
v_mfma_f32_16x16x32_bf16 v[160:163], a[212:215], a[144:147], v[160:163]
buffer_load_dwordx4 a[108:111], v1, s[8:11], s59 offen offset:3072 sc1
v_mfma_f32_16x16x32_bf16 v[164:167], a[208:211], a[132:135], v[164:167]
s_mov_b32 s57, 5963776
s_add_u32 m0, s54, 28672
v_mfma_f32_16x16x32_bf16 v[164:167], a[212:215], a[148:151], v[164:167]
s_waitcnt lgkmcnt(6)
ds_read_b64_tr_b16 a[228:229], v5 offset:35904
ds_read_b64_tr_b16 a[230:231], v5 offset:37696
v_mfma_f32_16x16x32_bf16 v[168:171], a[208:211], a[136:139], v[168:171]
v_mfma_f32_16x16x32_bf16 v[168:171], a[212:215], a[152:155], v[168:171]
v_mfma_f32_16x16x32_bf16 v[172:175], a[208:211], a[140:143], v[172:175]
v_mfma_f32_16x16x32_bf16 v[172:175], a[212:215], a[156:159], v[172:175]
s_waitcnt lgkmcnt(4)
ds_read_b64_tr_b16 a[232:233], v5 offset:43072
ds_read_b64_tr_b16 a[234:235], v5 offset:44864
v_mfma_f32_16x16x32_bf16 v[188:191], a[216:219], a[140:143], v[188:191]
v_mfma_f32_16x16x32_bf16 v[188:191], a[220:223], a[156:159], v[188:191]
v_mfma_f32_16x16x32_bf16 v[184:187], a[216:219], a[136:139], v[184:187]
buffer_load_dwordx4 v6, s[12:15], s57 offen lds
v_mfma_f32_16x16x32_bf16 v[184:187], a[220:223], a[152:155], v[184:187]
s_waitcnt lgkmcnt(6)
ds_read_b64_tr_b16 a[236:237], v5 offset:50240
ds_read_b64_tr_b16 a[238:239], v5 offset:52032
v_mfma_f32_16x16x32_bf16 v[180:183], a[216:219], a[132:135], v[180:183]
s_add_u32 m0, s54, 32768
v_mfma_f32_16x16x32_bf16 v[180:183], a[220:223], a[148:151], v[180:183]
v_mfma_f32_16x16x32_bf16 v[176:179], a[216:219], a[128:131], v[176:179]
buffer_load_dwordx4 v7, s[12:15], s57 offen lds
v_mfma_f32_16x16x32_bf16 v[176:179], a[220:223], a[144:147], v[176:179]
s_waitcnt lgkmcnt(4)
ds_read_b64_tr_b16 a[208:209], v5 offset:28768
ds_read_b64_tr_b16 a[210:211], v5 offset:30560
v_mfma_f32_16x16x32_bf16 v[192:195], a[224:227], a[128:131], v[192:195]
s_add_u32 m0, s54, 36864
v_mfma_f32_16x16x32_bf16 v[192:195], a[228:231], a[144:147], v[192:195]
v_mfma_f32_16x16x32_bf16 v[196:199], a[224:227], a[132:135], v[196:199]
v_mfma_f32_16x16x32_bf16 v[196:199], a[228:231], a[148:151], v[196:199]
s_waitcnt lgkmcnt(6)
ds_read_b64_tr_b16 a[212:213], v5 offset:35936
ds_read_b64_tr_b16 a[214:215], v5 offset:37728
v_mfma_f32_16x16x32_bf16 v[200:203], a[224:227], a[136:139], v[200:203]
buffer_load_dwordx4 v8, s[12:15], s57 offen lds
v_mfma_f32_16x16x32_bf16 v[200:203], a[228:231], a[152:155], v[200:203]
s_add_u32 m0, s55, 28672
v_mfma_f32_16x16x32_bf16 v[204:207], a[224:227], a[140:143], v[204:207]
v_mfma_f32_16x16x32_bf16 v[204:207], a[228:231], a[156:159], v[204:207]
s_waitcnt lgkmcnt(4)
ds_read_b64_tr_b16 a[216:217], v5 offset:43104
ds_read_b64_tr_b16 a[218:219], v5 offset:44896
v_mfma_f32_16x16x32_bf16 v[220:223], a[232:235], a[140:143], v[220:223]
v_mfma_f32_16x16x32_bf16 v[220:223], a[236:239], a[156:159], v[220:223]
v_mfma_f32_16x16x32_bf16 v[216:219], a[232:235], a[136:139], v[216:219]
v_mfma_f32_16x16x32_bf16 v[216:219], a[236:239], a[152:155], v[216:219]
s_waitcnt lgkmcnt(6)
ds_read_b64_tr_b16 a[220:221], v5 offset:50272
ds_read_b64_tr_b16 a[222:223], v5 offset:52064
v_mfma_f32_16x16x32_bf16 v[212:215], a[232:235], a[132:135], v[212:215]
v_mfma_f32_16x16x32_bf16 v[212:215], a[236:239], a[148:151], v[212:215]
v_mfma_f32_16x16x32_bf16 v[208:211], a[232:235], a[128:131], v[208:211]
v_mfma_f32_16x16x32_bf16 v[208:211], a[236:239], a[144:147], v[208:211]
s_waitcnt lgkmcnt(4)
ds_read_b64_tr_b16 a[224:225], v5 offset:28800
ds_read_b64_tr_b16 a[226:227], v5 offset:30592
v_mfma_f32_16x16x32_bf16 v[224:227], a[208:211], a[128:131], v[224:227]
v_mfma_f32_16x16x32_bf16 v[224:227], a[212:215], a[144:147], v[224:227]
buffer_load_dwordx4 v9, s[20:23], s57 offen lds
v_mfma_f32_16x16x32_bf16 v[228:231], a[208:211], a[132:135], v[228:231]
s_mov_b32 s59, 106496
v_mfma_f32_16x16x32_bf16 v[228:231], a[212:215], a[148:151], v[228:231]
s_waitcnt lgkmcnt(6)
ds_read_b64_tr_b16 a[228:229], v5 offset:35968
ds_read_b64_tr_b16 a[230:231], v5 offset:37760
v_mfma_f32_16x16x32_bf16 v[232:235], a[208:211], a[136:139], v[232:235]
v_mfma_f32_16x16x32_bf16 v[232:235], a[212:215], a[152:155], v[232:235]
v_mfma_f32_16x16x32_bf16 v[236:239], a[208:211], a[140:143], v[236:239]
v_mfma_f32_16x16x32_bf16 v[236:239], a[212:215], a[156:159], v[236:239]
s_waitcnt lgkmcnt(4)
ds_read_b64_tr_b16 a[232:233], v5 offset:43136
ds_read_b64_tr_b16 a[234:235], v5 offset:44928
v_mfma_f32_16x16x32_bf16 v[252:255], a[216:219], a[140:143], v[252:255]
v_mfma_f32_16x16x32_bf16 v[252:255], a[220:223], a[156:159], v[252:255]
v_mfma_f32_16x16x32_bf16 v[248:251], a[216:219], a[136:139], v[248:251]
buffer_load_dwordx4 v[48:51], v1, s[8:11], s59 offen offset:0 sc1
v_mfma_f32_16x16x32_bf16 v[248:251], a[220:223], a[152:155], v[248:251]
s_waitcnt lgkmcnt(6)
ds_read_b64_tr_b16 a[236:237], v5 offset:50304
ds_read_b64_tr_b16 a[238:239], v5 offset:52096
v_mfma_f32_16x16x32_bf16 v[244:247], a[216:219], a[132:135], v[244:247]
s_add_u32 m0, s54, 43008
v_mfma_f32_16x16x32_bf16 v[244:247], a[220:223], a[148:151], v[244:247]
v_mfma_f32_16x16x32_bf16 v[240:243], a[216:219], a[128:131], v[240:243]
buffer_load_dwordx4 v6, s[16:19], s57 offen lds
v_mfma_f32_16x16x32_bf16 v[240:243], a[220:223], a[144:147], v[240:243]
s_waitcnt lgkmcnt(4)
ds_read_b64_tr_b16 a[208:209], v5 offset:28832
ds_read_b64_tr_b16 a[210:211], v5 offset:30624
v_mfma_f32_16x16x32_bf16 a[0:3], a[224:227], a[128:131], a[0:3]
v_mfma_f32_16x16x32_bf16 a[0:3], a[228:231], a[144:147], a[0:3]
v_mfma_f32_16x16x32_bf16 a[4:7], a[224:227], a[132:135], a[4:7]
v_mfma_f32_16x16x32_bf16 a[4:7], a[228:231], a[148:151], a[4:7]
s_waitcnt lgkmcnt(6)
ds_read_b64_tr_b16 a[212:213], v5 offset:36000
ds_read_b64_tr_b16 a[214:215], v5 offset:37792
v_mfma_f32_16x16x32_bf16 a[8:11], a[224:227], a[136:139], a[8:11]
buffer_load_dwordx4 v[52:55], v1, s[8:11], s59 offen offset:1024 sc1
v_mfma_f32_16x16x32_bf16 a[8:11], a[228:231], a[152:155], a[8:11]
s_add_u32 m0, s54, 47104
v_mfma_f32_16x16x32_bf16 a[12:15], a[224:227], a[140:143], a[12:15]
v_mfma_f32_16x16x32_bf16 a[12:15], a[228:231], a[156:159], a[12:15]
s_waitcnt lgkmcnt(4)
ds_read_b64_tr_b16 a[216:217], v5 offset:43168
ds_read_b64_tr_b16 a[218:219], v5 offset:44960
v_mfma_f32_16x16x32_bf16 a[28:31], a[232:235], a[140:143], a[28:31]
buffer_load_dwordx4 v7, s[16:19], s57 offen lds
v_mfma_f32_16x16x32_bf16 a[28:31], a[236:239], a[156:159], a[28:31]
v_mfma_f32_16x16x32_bf16 a[24:27], a[232:235], a[136:139], a[24:27]
v_mfma_f32_16x16x32_bf16 a[24:27], a[236:239], a[152:155], a[24:27]
s_waitcnt lgkmcnt(6)
ds_read_b64_tr_b16 a[220:221], v5 offset:50336
ds_read_b64_tr_b16 a[222:223], v5 offset:52128
v_mfma_f32_16x16x32_bf16 a[20:23], a[232:235], a[132:135], a[20:23]
buffer_load_dwordx4 v[56:59], v1, s[8:11], s59 offen offset:2048 sc1
v_mfma_f32_16x16x32_bf16 a[20:23], a[236:239], a[148:151], a[20:23]
s_add_u32 m0, s54, 51200
v_mfma_f32_16x16x32_bf16 a[16:19], a[232:235], a[128:131], a[16:19]
v_mfma_f32_16x16x32_bf16 a[16:19], a[236:239], a[144:147], a[16:19]
s_waitcnt lgkmcnt(4)
ds_read_b64_tr_b16 a[224:225], v5 offset:28864
ds_read_b64_tr_b16 a[226:227], v5 offset:30656
v_mfma_f32_16x16x32_bf16 a[32:35], a[208:211], a[128:131], a[32:35]
v_mfma_f32_16x16x32_bf16 a[32:35], a[212:215], a[144:147], a[32:35]
v_mfma_f32_16x16x32_bf16 a[36:39], a[208:211], a[132:135], a[36:39]
v_mfma_f32_16x16x32_bf16 a[36:39], a[212:215], a[148:151], a[36:39]
s_waitcnt lgkmcnt(6)
ds_read_b64_tr_b16 a[228:229], v5 offset:36032
ds_read_b64_tr_b16 a[230:231], v5 offset:37824
v_mfma_f32_16x16x32_bf16 a[40:43], a[208:211], a[136:139], a[40:43]
v_mfma_f32_16x16x32_bf16 a[40:43], a[212:215], a[152:155], a[40:43]
buffer_load_dwordx4 v8, s[16:19], s57 offen lds
v_mfma_f32_16x16x32_bf16 a[44:47], a[208:211], a[140:143], a[44:47]
v_mfma_f32_16x16x32_bf16 a[44:47], a[212:215], a[156:159], a[44:47]
s_waitcnt lgkmcnt(4)
ds_read_b64_tr_b16 a[232:233], v5 offset:43200
ds_read_b64_tr_b16 a[234:235], v5 offset:44992
v_mfma_f32_16x16x32_bf16 a[60:63], a[216:219], a[140:143], a[60:63]
v_mfma_f32_16x16x32_bf16 a[60:63], a[220:223], a[156:159], a[60:63]
v_mfma_f32_16x16x32_bf16 a[56:59], a[216:219], a[136:139], a[56:59]
v_mfma_f32_16x16x32_bf16 a[56:59], a[220:223], a[152:155], a[56:59]
s_waitcnt lgkmcnt(6)
ds_read_b64_tr_b16 a[236:237], v5 offset:50368
ds_read_b64_tr_b16 a[238:239], v5 offset:52160
v_mfma_f32_16x16x32_bf16 a[52:55], a[216:219], a[132:135], a[52:55]
v_mfma_f32_16x16x32_bf16 a[52:55], a[220:223], a[148:151], a[52:55]
v_mfma_f32_16x16x32_bf16 a[48:51], a[216:219], a[128:131], a[48:51]
buffer_load_dwordx4 v[60:63], v1, s[8:11], s59 offen offset:3072 sc1
v_mfma_f32_16x16x32_bf16 a[48:51], a[220:223], a[144:147], a[48:51]
s_waitcnt lgkmcnt(4)
ds_read_b128 a[208:211], v3 offset:24576
s_movk_i32 s58, 1664
v_mfma_f32_16x16x32_bf16 a[64:67], a[224:227], a[128:131], a[64:67]
s_add_u32 m0, s56, 8192
v_mfma_f32_16x16x32_bf16 a[64:67], a[228:231], a[144:147], a[64:67]
v_mfma_f32_16x16x32_bf16 a[68:71], a[224:227], a[132:135], a[68:71]
buffer_load_dwordx4 v10, s[24:27], s58 offen lds
v_mfma_f32_16x16x32_bf16 a[68:71], a[228:231], a[148:151], a[68:71]
ds_read_b128 a[212:215], v4 offset:24576
s_mov_b32 s59, 110592
v_mfma_f32_16x16x32_bf16 a[72:75], a[224:227], a[136:139], a[72:75]
v_mfma_f32_16x16x32_bf16 a[72:75], a[228:231], a[152:155], a[72:75]
v_mfma_f32_16x16x32_bf16 a[76:79], a[224:227], a[140:143], a[76:79]
v_mfma_f32_16x16x32_bf16 a[76:79], a[228:231], a[156:159], a[76:79]
s_waitcnt lgkmcnt(2)
ds_read_b128 a[216:219], v3 offset:28672
v_mfma_f32_16x16x32_bf16 a[92:95], a[232:235], a[140:143], a[92:95]
buffer_load_dwordx4 a[112:115], v1, s[8:11], s59 offen offset:0 sc1
v_mfma_f32_16x16x32_bf16 a[92:95], a[236:239], a[156:159], a[92:95]
s_add_u32 m0, s56, 12288
v_mfma_f32_16x16x32_bf16 a[88:91], a[232:235], a[136:139], a[88:91]
v_mfma_f32_16x16x32_bf16 a[88:91], a[236:239], a[152:155], a[88:91]
ds_read_b128 a[220:223], v4 offset:28672
v_mfma_f32_16x16x32_bf16 a[84:87], a[232:235], a[132:135], a[84:87]
buffer_load_dwordx4 v10, s[28:31], s58 offen lds
v_mfma_f32_16x16x32_bf16 a[84:87], a[236:239], a[148:151], a[84:87]
v_mfma_f32_16x16x32_bf16 a[80:83], a[232:235], a[128:131], a[80:83]
v_mfma_f32_16x16x32_bf16 a[80:83], a[236:239], a[144:147], a[80:83]
s_waitcnt lgkmcnt(2)
ds_read_b128 a[224:227], v3 offset:26624
ds_read_b128 a[228:231], v4 offset:26624
v_mfma_f32_16x16x32_bf16 v[64:67], a[128:131], a[208:211], v[64:67]
buffer_load_dwordx4 a[116:119], v1, s[8:11], s59 offen offset:1024 sc1
v_mfma_f32_16x16x32_bf16 v[64:67], a[144:147], a[212:215], v[64:67]
s_mov_b32 s57, 6422528
s_add_u32 m0, s54, 65536
v_mfma_f32_16x16x32_bf16 v[68:71], a[132:135], a[208:211], v[68:71]
v_mfma_f32_16x16x32_bf16 v[68:71], a[148:151], a[212:215], v[68:71]
s_waitcnt lgkmcnt(4)
ds_read_b128 a[232:235], v3 offset:30720
ds_read_b128 a[236:239], v4 offset:30720
v_mfma_f32_16x16x32_bf16 v[72:75], a[136:139], a[208:211], v[72:75]
v_mfma_f32_16x16x32_bf16 v[72:75], a[152:155], a[212:215], v[72:75]
v_mfma_f32_16x16x32_bf16 v[76:79], a[140:143], a[208:211], v[76:79]
v_mfma_f32_16x16x32_bf16 v[76:79], a[156:159], a[212:215], v[76:79]
s_waitcnt lgkmcnt(4)
v_mfma_f32_16x16x32_bf16 v[108:111], a[140:143], a[216:219], v[108:111]
v_mfma_f32_16x16x32_bf16 v[108:111], a[156:159], a[220:223], v[108:111]
buffer_load_dwordx4 v6, s[12:15], s57 offen lds
v_mfma_f32_16x16x32_bf16 v[104:107], a[136:139], a[216:219], v[104:107]
v_mfma_f32_16x16x32_bf16 v[104:107], a[152:155], a[220:223], v[104:107]
v_mfma_f32_16x16x32_bf16 v[100:103], a[132:135], a[216:219], v[100:103]
v_mfma_f32_16x16x32_bf16 v[100:103], a[148:151], a[220:223], v[100:103]
v_mfma_f32_16x16x32_bf16 v[96:99], a[128:131], a[216:219], v[96:99]
s_waitcnt vmcnt(27) lgkmcnt(0)
s_barrier
v_mfma_f32_16x16x32_bf16 v[96:99], a[144:147], a[220:223], v[96:99]
s_waitcnt lgkmcnt(2)
ds_read_b64_tr_b16 a[208:209], v2 offset:0
ds_read_b64_tr_b16 a[210:211], v2 offset:1792
v_mfma_f32_16x16x32_bf16 v[80:83], a[128:131], a[224:227], v[80:83]
buffer_load_dwordx4 a[120:123], v1, s[8:11], s59 offen offset:2048 sc1
v_mfma_f32_16x16x32_bf16 v[80:83], a[144:147], a[228:231], v[80:83]
L_tr7:
s_cbranch_execz L_tr11
s_add_u32 m0, s54, 69632
v_mfma_f32_16x16x32_bf16 v[84:87], a[132:135], a[224:227], v[84:87]
v_mfma_f32_16x16x32_bf16 v[84:87], a[148:151], a[228:231], v[84:87]
s_waitcnt lgkmcnt(4)
ds_read_b64_tr_b16 a[212:213], v2 offset:7168
ds_read_b64_tr_b16 a[214:215], v2 offset:8960
v_mfma_f32_16x16x32_bf16 v[88:91], a[136:139], a[224:227], v[88:91]
v_mfma_f32_16x16x32_bf16 v[88:91], a[152:155], a[228:231], v[88:91]
v_mfma_f32_16x16x32_bf16 v[92:95], a[140:143], a[224:227], v[92:95]
buffer_load_dwordx4 v7, s[12:15], s57 offen lds
v_mfma_f32_16x16x32_bf16 v[92:95], a[156:159], a[228:231], v[92:95]
s_waitcnt lgkmcnt(4)
ds_read_b64_tr_b16 a[216:217], v2 offset:14336
ds_read_b64_tr_b16 a[218:219], v2 offset:16128
v_mfma_f32_16x16x32_bf16 v[124:127], a[140:143], a[232:235], v[124:127]
v_mfma_f32_16x16x32_bf16 v[124:127], a[156:159], a[236:239], v[124:127]
v_mfma_f32_16x16x32_bf16 v[120:123], a[136:139], a[232:235], v[120:123]
v_mfma_f32_16x16x32_bf16 v[120:123], a[152:155], a[236:239], v[120:123]
s_waitcnt lgkmcnt(6)
ds_read_b64_tr_b16 a[220:221], v2 offset:21504
ds_read_b64_tr_b16 a[222:223], v2 offset:23296
v_mfma_f32_16x16x32_bf16 v[116:119], a[132:135], a[232:235], v[116:119]
buffer_load_dwordx4 a[124:127], v1, s[8:11], s59 offen offset:3072 sc1
v_mfma_f32_16x16x32_bf16 v[116:119], a[148:151], a[236:239], v[116:119]
s_add_u32 m0, s54, 73728
v_mfma_f32_16x16x32_bf16 v[112:115], a[128:131], a[232:235], v[112:115]
v_mfma_f32_16x16x32_bf16 v[112:115], a[144:147], a[236:239], v[112:115]
s_waitcnt vmcnt(19) lgkmcnt(4)
ds_read_b64_tr_b16 a[224:225], v2 offset:32
ds_read_b64_tr_b16 a[226:227], v2 offset:1824
v_mfma_f32_16x16x32_bf16 v[128:131], a[208:211], a[192:195], v[128:131]
buffer_load_dwordx4 v8, s[12:15], s57 offen lds
v_mfma_f32_16x16x32_bf16 v[128:131], a[212:215], a[96:99], v[128:131]
s_add_u32 m0, s55, 65536
v_mfma_f32_16x16x32_bf16 v[132:135], a[208:211], a[196:199], v[132:135]
v_mfma_f32_16x16x32_bf16 v[132:135], a[212:215], a[100:103], v[132:135]
s_waitcnt lgkmcnt(6)
ds_read_b64_tr_b16 a[228:229], v2 offset:7200
ds_read_b64_tr_b16 a[230:231], v2 offset:8992
v_mfma_f32_16x16x32_bf16 v[136:139], a[208:211], a[200:203], v[136:139]
v_mfma_f32_16x16x32_bf16 v[136:139], a[212:215], a[104:107], v[136:139]
v_mfma_f32_16x16x32_bf16 v[140:143], a[208:211], a[204:207], v[140:143]
v_mfma_f32_16x16x32_bf16 v[140:143], a[212:215], a[108:111], v[140:143]
s_waitcnt lgkmcnt(4)
ds_read_b64_tr_b16 a[232:233], v2 offset:14368
ds_read_b64_tr_b16 a[234:235], v2 offset:16160
v_mfma_f32_16x16x32_bf16 v[156:159], a[216:219], a[204:207], v[156:159]
v_mfma_f32_16x16x32_bf16 v[156:159], a[220:223], a[108:111], v[156:159]
v_mfma_f32_16x16x32_bf16 v[152:155], a[216:219], a[200:203], v[152:155]
v_mfma_f32_16x16x32_bf16 v[152:155], a[220:223], a[104:107], v[152:155]
s_waitcnt lgkmcnt(6)
ds_read_b64_tr_b16 a[236:237], v2 offset:21536
ds_read_b64_tr_b16 a[238:239], v2 offset:23328
v_mfma_f32_16x16x32_bf16 v[148:151], a[216:219], a[196:199], v[148:151]
v_mfma_f32_16x16x32_bf16 v[148:151], a[220:223], a[100:103], v[148:151]
v_mfma_f32_16x16x32_bf16 v[144:147], a[216:219], a[192:195], v[144:147]
buffer_load_dwordx4 v9, s[20:23], s57 offen lds
v_mfma_f32_16x16x32_bf16 v[144:147], a[220:223], a[96:99], v[144:147]
s_waitcnt lgkmcnt(4)
ds_read_b64_tr_b16 a[208:209], v2 offset:64
ds_read_b64_tr_b16 a[210:211], v2 offset:1856
v_mfma_f32_16x16x32_bf16 v[160:163], a[224:227], a[192:195], v[160:163]
s_add_u32 m0, s54, 79872
v_mfma_f32_16x16x32_bf16 v[160:163], a[228:231], a[96:99], v[160:163]
v_mfma_f32_16x16x32_bf16 v[164:167], a[224:227], a[196:199], v[164:167]
buffer_load_dwordx4 v6, s[16:19], s57 offen lds
v_mfma_f32_16x16x32_bf16 v[164:167], a[228:231], a[100:103], v[164:167]
s_waitcnt lgkmcnt(6)
ds_read_b64_tr_b16 a[212:213], v2 offset:7232
ds_read_b64_tr_b16 a[214:215], v2 offset:9024
v_mfma_f32_16x16x32_bf16 v[168:171], a[224:227], a[200:203], v[168:171]
s_add_u32 m0, s54, 83968
v_mfma_f32_16x16x32_bf16 v[168:171], a[228:231], a[104:107], v[168:171]
v_mfma_f32_16x16x32_bf16 v[172:175], a[224:227], a[204:207], v[172:175]
v_mfma_f32_16x16x32_bf16 v[172:175], a[228:231], a[108:111], v[172:175]
s_waitcnt lgkmcnt(4)
ds_read_b64_tr_b16 a[216:217], v2 offset:14400
ds_read_b64_tr_b16 a[218:219], v2 offset:16192
v_mfma_f32_16x16x32_bf16 v[188:191], a[232:235], a[204:207], v[188:191]
v_mfma_f32_16x16x32_bf16 v[188:191], a[236:239], a[108:111], v[188:191]
v_mfma_f32_16x16x32_bf16 v[184:187], a[232:235], a[200:203], v[184:187]
v_mfma_f32_16x16x32_bf16 v[184:187], a[236:239], a[104:107], v[184:187]
s_waitcnt lgkmcnt(6)
ds_read_b64_tr_b16 a[220:221], v2 offset:21568
ds_read_b64_tr_b16 a[222:223], v2 offset:23360
v_mfma_f32_16x16x32_bf16 v[180:183], a[232:235], a[196:199], v[180:183]
buffer_load_dwordx4 v7, s[16:19], s57 offen lds
v_mfma_f32_16x16x32_bf16 v[180:183], a[236:239], a[100:103], v[180:183]
s_add_u32 m0, s54, 88064
v_mfma_f32_16x16x32_bf16 v[176:179], a[232:235], a[192:195], v[176:179]
v_mfma_f32_16x16x32_bf16 v[176:179], a[236:239], a[96:99], v[176:179]
s_waitcnt lgkmcnt(4)
ds_read_b64_tr_b16 a[224:225], v2 offset:96
ds_read_b64_tr_b16 a[226:227], v2 offset:1888
v_mfma_f32_16x16x32_bf16 v[192:195], a[208:211], a[192:195], v[192:195]
v_mfma_f32_16x16x32_bf16 v[192:195], a[212:215], a[96:99], v[192:195]
v_mfma_f32_16x16x32_bf16 v[196:199], a[208:211], a[196:199], v[196:199]
v_mfma_f32_16x16x32_bf16 v[196:199], a[212:215], a[100:103], v[196:199]
s_waitcnt lgkmcnt(6)
ds_read_b64_tr_b16 a[228:229], v2 offset:7264
ds_read_b64_tr_b16 a[230:231], v2 offset:9056
v_mfma_f32_16x16x32_bf16 v[200:203], a[208:211], a[200:203], v[200:203]
buffer_load_dwordx4 v8, s[16:19], s57 offen lds
v_mfma_f32_16x16x32_bf16 v[200:203], a[212:215], a[104:107], v[200:203]
s_movk_i32 s58, 1792
s_add_u32 m0, s56, 16384
v_mfma_f32_16x16x32_bf16 v[204:207], a[208:211], a[204:207], v[204:207]
v_mfma_f32_16x16x32_bf16 v[204:207], a[212:215], a[108:111], v[204:207]
s_waitcnt lgkmcnt(4)
ds_read_b64_tr_b16 a[232:233], v2 offset:14432
ds_read_b64_tr_b16 a[234:235], v2 offset:16224
v_mfma_f32_16x16x32_bf16 v[220:223], a[216:219], a[204:207], v[220:223]
buffer_load_dwordx4 v10, s[24:27], s58 offen lds
v_mfma_f32_16x16x32_bf16 v[220:223], a[220:223], a[108:111], v[220:223]
s_add_u32 m0, s56, 20480
v_mfma_f32_16x16x32_bf16 v[216:219], a[216:219], a[200:203], v[216:219]
v_mfma_f32_16x16x32_bf16 v[216:219], a[220:223], a[104:107], v[216:219]
s_waitcnt lgkmcnt(6)
ds_read_b64_tr_b16 a[236:237], v2 offset:21600
ds_read_b64_tr_b16 a[238:239], v2 offset:23392
v_mfma_f32_16x16x32_bf16 v[212:215], a[216:219], a[196:199], v[212:215]
v_mfma_f32_16x16x32_bf16 v[212:215], a[220:223], a[100:103], v[212:215]
v_mfma_f32_16x16x32_bf16 v[208:211], a[216:219], a[192:195], v[208:211]
v_mfma_f32_16x16x32_bf16 v[208:211], a[220:223], a[96:99], v[208:211]
s_waitcnt lgkmcnt(4)
ds_read_b64_tr_b16 a[208:209], v2 offset:128
ds_read_b64_tr_b16 a[210:211], v2 offset:1920
v_mfma_f32_16x16x32_bf16 v[224:227], a[224:227], a[192:195], v[224:227]
v_mfma_f32_16x16x32_bf16 v[224:227], a[228:231], a[96:99], v[224:227]
v_mfma_f32_16x16x32_bf16 v[228:231], a[224:227], a[196:199], v[228:231]
buffer_load_dwordx4 v10, s[28:31], s58 offen lds
v_mfma_f32_16x16x32_bf16 v[228:231], a[228:231], a[100:103], v[228:231]
s_waitcnt lgkmcnt(6)
ds_read_b64_tr_b16 a[212:213], v2 offset:7296
ds_read_b64_tr_b16 a[214:215], v2 offset:9088
v_mfma_f32_16x16x32_bf16 v[232:235], a[224:227], a[200:203], v[232:235]
s_mov_b32 s57, 6881280
s_add_u32 m0, s54, 94208
v_mfma_f32_16x16x32_bf16 v[232:235], a[228:231], a[104:107], v[232:235]
v_mfma_f32_16x16x32_bf16 v[236:239], a[224:227], a[204:207], v[236:239]
v_mfma_f32_16x16x32_bf16 v[236:239], a[228:231], a[108:111], v[236:239]
s_waitcnt lgkmcnt(4)
ds_read_b64_tr_b16 a[216:217], v2 offset:14464
ds_read_b64_tr_b16 a[218:219], v2 offset:16256
v_mfma_f32_16x16x32_bf16 v[252:255], a[232:235], a[204:207], v[252:255]
buffer_load_dwordx4 v6, s[12:15], s57 offen lds
v_mfma_f32_16x16x32_bf16 v[252:255], a[236:239], a[108:111], v[252:255]
s_mov_b32 s59, 114688
v_mfma_f32_16x16x32_bf16 v[248:251], a[232:235], a[200:203], v[248:251]
v_mfma_f32_16x16x32_bf16 v[248:251], a[236:239], a[104:107], v[248:251]
s_waitcnt lgkmcnt(6)
ds_read_b64_tr_b16 a[220:221], v2 offset:21632
ds_read_b64_tr_b16 a[222:223], v2 offset:23424
v_mfma_f32_16x16x32_bf16 v[244:247], a[232:235], a[196:199], v[244:247]
buffer_load_dwordx4 a[128:131], v1, s[8:11], s59 offen offset:0 sc1
v_mfma_f32_16x16x32_bf16 v[244:247], a[236:239], a[100:103], v[244:247]
s_add_u32 m0, s54, 98304
v_mfma_f32_16x16x32_bf16 v[240:243], a[232:235], a[192:195], v[240:243]
v_mfma_f32_16x16x32_bf16 v[240:243], a[236:239], a[96:99], v[240:243]
s_waitcnt lgkmcnt(4)
ds_read_b64_tr_b16 a[224:225], v2 offset:160
ds_read_b64_tr_b16 a[226:227], v2 offset:1952
v_mfma_f32_16x16x32_bf16 a[0:3], a[208:211], a[192:195], a[0:3]
buffer_load_dwordx4 v7, s[12:15], s57 offen lds
v_mfma_f32_16x16x32_bf16 a[0:3], a[212:215], a[96:99], a[0:3]
v_mfma_f32_16x16x32_bf16 a[4:7], a[208:211], a[196:199], a[4:7]
v_mfma_f32_16x16x32_bf16 a[4:7], a[212:215], a[100:103], a[4:7]
s_waitcnt lgkmcnt(6)
ds_read_b64_tr_b16 a[228:229], v2 offset:7328
ds_read_b64_tr_b16 a[230:231], v2 offset:9120
v_mfma_f32_16x16x32_bf16 a[8:11], a[208:211], a[200:203], a[8:11]
v_mfma_f32_16x16x32_bf16 a[8:11], a[212:215], a[104:107], a[8:11]
v_mfma_f32_16x16x32_bf16 a[12:15], a[208:211], a[204:207], a[12:15]
v_mfma_f32_16x16x32_bf16 a[12:15], a[212:215], a[108:111], a[12:15]
s_waitcnt lgkmcnt(4)
ds_read_b64_tr_b16 a[232:233], v2 offset:14496
ds_read_b64_tr_b16 a[234:235], v2 offset:16288
v_mfma_f32_16x16x32_bf16 a[28:31], a[216:219], a[204:207], a[28:31]
buffer_load_dwordx4 a[132:135], v1, s[8:11], s59 offen offset:1024 sc1
v_mfma_f32_16x16x32_bf16 a[28:31], a[220:223], a[108:111], a[28:31]
s_add_u32 m0, s54, 102400
v_mfma_f32_16x16x32_bf16 a[24:27], a[216:219], a[200:203], a[24:27]
v_mfma_f32_16x16x32_bf16 a[24:27], a[220:223], a[104:107], a[24:27]
s_waitcnt lgkmcnt(6)
ds_read_b64_tr_b16 a[236:237], v2 offset:21664
ds_read_b64_tr_b16 a[238:239], v2 offset:23456
v_mfma_f32_16x16x32_bf16 a[20:23], a[216:219], a[196:199], a[20:23]
buffer_load_dwordx4 v8, s[12:15], s57 offen lds
v_mfma_f32_16x16x32_bf16 a[20:23], a[220:223], a[100:103], a[20:23]
v_mfma_f32_16x16x32_bf16 a[16:19], a[216:219], a[192:195], a[16:19]
v_mfma_f32_16x16x32_bf16 a[16:19], a[220:223], a[96:99], a[16:19]
s_waitcnt lgkmcnt(4)
ds_read_b64_tr_b16 a[208:209], v2 offset:192
ds_read_b64_tr_b16 a[210:211], v2 offset:1984
v_mfma_f32_16x16x32_bf16 a[32:35], a[224:227], a[192:195], a[32:35]
v_mfma_f32_16x16x32_bf16 a[32:35], a[228:231], a[96:99], a[32:35]
v_mfma_f32_16x16x32_bf16 a[36:39], a[224:227], a[196:199], a[36:39]
v_mfma_f32_16x16x32_bf16 a[36:39], a[228:231], a[100:103], a[36:39]
s_waitcnt lgkmcnt(6)
ds_read_b64_tr_b16 a[212:213], v2 offset:7360
ds_read_b64_tr_b16 a[214:215], v2 offset:9152
v_mfma_f32_16x16x32_bf16 a[40:43], a[224:227], a[200:203], a[40:43]
v_mfma_f32_16x16x32_bf16 a[40:43], a[228:231], a[104:107], a[40:43]
v_mfma_f32_16x16x32_bf16 a[44:47], a[224:227], a[204:207], a[44:47]
buffer_load_dwordx4 a[136:139], v1, s[8:11], s59 offen offset:2048 sc1
v_mfma_f32_16x16x32_bf16 a[44:47], a[228:231], a[108:111], a[44:47]
s_waitcnt lgkmcnt(4)
ds_read_b64_tr_b16 a[216:217], v2 offset:14528
ds_read_b64_tr_b16 a[218:219], v2 offset:16320
v_mfma_f32_16x16x32_bf16 a[60:63], a[232:235], a[204:207], a[60:63]
s_add_u32 m0, s55, 94208
v_mfma_f32_16x16x32_bf16 a[60:63], a[236:239], a[108:111], a[60:63]
v_mfma_f32_16x16x32_bf16 a[56:59], a[232:235], a[200:203], a[56:59]
v_mfma_f32_16x16x32_bf16 a[56:59], a[236:239], a[104:107], a[56:59]
s_waitcnt lgkmcnt(6)
ds_read_b64_tr_b16 a[220:221], v2 offset:21696
ds_read_b64_tr_b16 a[222:223], v2 offset:23488
v_mfma_f32_16x16x32_bf16 a[52:55], a[232:235], a[196:199], a[52:55]
buffer_load_dwordx4 v9, s[20:23], s57 offen lds
v_mfma_f32_16x16x32_bf16 a[52:55], a[236:239], a[100:103], a[52:55]
v_mfma_f32_16x16x32_bf16 a[48:51], a[232:235], a[192:195], a[48:51]
v_mfma_f32_16x16x32_bf16 a[48:51], a[236:239], a[96:99], a[48:51]
s_waitcnt lgkmcnt(4)
ds_read_b128 a[224:227], v3 offset:0
v_mfma_f32_16x16x32_bf16 a[64:67], a[208:211], a[192:195], a[64:67]
buffer_load_dwordx4 a[140:143], v1, s[8:11], s59 offen offset:3072 sc1
v_mfma_f32_16x16x32_bf16 a[64:67], a[212:215], a[96:99], a[64:67]
s_add_u32 m0, s54, 108544
v_mfma_f32_16x16x32_bf16 a[68:71], a[208:211], a[196:199], a[68:71]
v_mfma_f32_16x16x32_bf16 a[68:71], a[212:215], a[100:103], a[68:71]
ds_read_b128 a[228:231], v4 offset:0
v_mfma_f32_16x16x32_bf16 a[72:75], a[208:211], a[200:203], a[72:75]
buffer_load_dwordx4 v6, s[16:19], s57 offen lds
v_mfma_f32_16x16x32_bf16 a[72:75], a[212:215], a[104:107], a[72:75]
s_mov_b32 s59, 118784
v_mfma_f32_16x16x32_bf16 a[76:79], a[208:211], a[204:207], a[76:79]
v_mfma_f32_16x16x32_bf16 a[76:79], a[212:215], a[108:111], a[76:79]
s_waitcnt lgkmcnt(2)
ds_read_b128 a[232:235], v3 offset:4096
v_mfma_f32_16x16x32_bf16 a[92:95], a[216:219], a[204:207], a[92:95]
v_mfma_f32_16x16x32_bf16 a[92:95], a[220:223], a[108:111], a[92:95]
v_mfma_f32_16x16x32_bf16 a[88:91], a[216:219], a[200:203], a[88:91]
v_mfma_f32_16x16x32_bf16 a[88:91], a[220:223], a[104:107], a[88:91]
ds_read_b128 a[236:239], v4 offset:4096
v_mfma_f32_16x16x32_bf16 a[84:87], a[216:219], a[196:199], a[84:87]
buffer_load_dwordx4 a[144:147], v1, s[8:11], s59 offen offset:0 sc1
v_mfma_f32_16x16x32_bf16 a[84:87], a[220:223], a[100:103], a[84:87]
s_add_u32 m0, s54, 112640
v_mfma_f32_16x16x32_bf16 a[80:83], a[216:219], a[192:195], a[80:83]
v_mfma_f32_16x16x32_bf16 a[80:83], a[220:223], a[96:99], a[80:83]
s_waitcnt lgkmcnt(2)
ds_read_b128 a[208:211], v3 offset:2048
ds_read_b128 a[212:215], v4 offset:2048
v_mfma_f32_16x16x32_bf16 v[64:67], a[192:195], a[224:227], v[64:67]
buffer_load_dwordx4 v7, s[16:19], s57 offen lds
v_mfma_f32_16x16x32_bf16 v[64:67], a[96:99], a[228:231], v[64:67]
v_mfma_f32_16x16x32_bf16 v[68:71], a[196:199], a[224:227], v[68:71]
v_mfma_f32_16x16x32_bf16 v[68:71], a[100:103], a[228:231], v[68:71]
s_waitcnt lgkmcnt(4)
ds_read_b128 a[216:219], v3 offset:6144
ds_read_b128 a[220:223], v4 offset:6144
v_mfma_f32_16x16x32_bf16 v[72:75], a[200:203], a[224:227], v[72:75]
v_mfma_f32_16x16x32_bf16 v[72:75], a[104:107], a[228:231], v[72:75]
v_mfma_f32_16x16x32_bf16 v[76:79], a[204:207], a[224:227], v[76:79]
v_mfma_f32_16x16x32_bf16 v[76:79], a[108:111], a[228:231], v[76:79]
s_waitcnt lgkmcnt(4)
v_mfma_f32_16x16x32_bf16 v[108:111], a[204:207], a[232:235], v[108:111]
v_mfma_f32_16x16x32_bf16 v[108:111], a[108:111], a[236:239], v[108:111]
v_mfma_f32_16x16x32_bf16 v[104:107], a[200:203], a[232:235], v[104:107]
buffer_load_dwordx4 a[148:151], v1, s[8:11], s59 offen offset:1024 sc1
v_mfma_f32_16x16x32_bf16 v[104:107], a[104:107], a[236:239], v[104:107]
s_add_u32 m0, s54, 116736
v_mfma_f32_16x16x32_bf16 v[100:103], a[196:199], a[232:235], v[100:103]
v_mfma_f32_16x16x32_bf16 v[100:103], a[100:103], a[236:239], v[100:103]
v_mfma_f32_16x16x32_bf16 v[96:99], a[192:195], a[232:235], v[96:99]
s_waitcnt vmcnt(24) lgkmcnt(0)
s_barrier
v_mfma_f32_16x16x32_bf16 v[96:99], a[96:99], a[236:239], v[96:99]
s_waitcnt lgkmcnt(2)
ds_read_b64_tr_b16 a[224:225], v2 offset:28672
ds_read_b64_tr_b16 a[226:227], v2 offset:30464
v_mfma_f32_16x16x32_bf16 v[80:83], a[192:195], a[208:211], v[80:83]
buffer_load_dwordx4 v8, s[16:19], s57 offen lds
v_mfma_f32_16x16x32_bf16 v[80:83], a[96:99], a[212:215], v[80:83]
v_mfma_f32_16x16x32_bf16 v[84:87], a[196:199], a[208:211], v[84:87]
v_mfma_f32_16x16x32_bf16 v[84:87], a[100:103], a[212:215], v[84:87]
s_waitcnt lgkmcnt(4)
ds_read_b64_tr_b16 a[228:229], v2 offset:35840
ds_read_b64_tr_b16 a[230:231], v2 offset:37632
v_mfma_f32_16x16x32_bf16 v[88:91], a[200:203], a[208:211], v[88:91]
buffer_load_dwordx4 a[152:155], v1, s[8:11], s59 offen offset:2048 sc1
v_mfma_f32_16x16x32_bf16 v[88:91], a[104:107], a[212:215], v[88:91]
s_movk_i32 s58, 1920
s_add_u32 m0, s56, 24576
v_mfma_f32_16x16x32_bf16 v[92:95], a[204:207], a[208:211], v[92:95]
v_mfma_f32_16x16x32_bf16 v[92:95], a[108:111], a[212:215], v[92:95]
s_waitcnt lgkmcnt(4)
ds_read_b64_tr_b16 a[232:233], v2 offset:43008
ds_read_b64_tr_b16 a[234:235], v2 offset:44800
v_mfma_f32_16x16x32_bf16 v[124:127], a[204:207], a[216:219], v[124:127]
buffer_load_dwordx4 v10, s[24:27], s58 offen lds
v_mfma_f32_16x16x32_bf16 v[124:127], a[108:111], a[220:223], v[124:127]
v_mfma_f32_16x16x32_bf16 v[120:123], a[200:203], a[216:219], v[120:123]
v_mfma_f32_16x16x32_bf16 v[120:123], a[104:107], a[220:223], v[120:123]
s_waitcnt lgkmcnt(6)
ds_read_b64_tr_b16 a[236:237], v2 offset:50176
ds_read_b64_tr_b16 a[238:239], v2 offset:51968
v_mfma_f32_16x16x32_bf16 v[116:119], a[196:199], a[216:219], v[116:119]
v_mfma_f32_16x16x32_bf16 v[116:119], a[100:103], a[220:223], v[116:119]
v_mfma_f32_16x16x32_bf16 v[112:115], a[192:195], a[216:219], v[112:115]
v_mfma_f32_16x16x32_bf16 v[112:115], a[96:99], a[220:223], v[112:115]
s_waitcnt vmcnt(22) lgkmcnt(4)
ds_read_b64_tr_b16 a[208:209], v2 offset:28704
ds_read_b64_tr_b16 a[210:211], v2 offset:30496
v_mfma_f32_16x16x32_bf16 v[128:131], a[224:227], v[48:51], v[128:131]
buffer_load_dwordx4 a[156:159], v1, s[8:11], s59 offen offset:3072 sc1
v_mfma_f32_16x16x32_bf16 v[128:131], a[228:231], a[112:115], v[128:131]
s_add_u32 m0, s56, 28672
v_mfma_f32_16x16x32_bf16 v[132:135], a[224:227], v[52:55], v[132:135]
v_mfma_f32_16x16x32_bf16 v[132:135], a[228:231], a[116:119], v[132:135]
s_waitcnt lgkmcnt(6)
ds_read_b64_tr_b16 a[212:213], v2 offset:35872
ds_read_b64_tr_b16 a[214:215], v2 offset:37664
v_mfma_f32_16x16x32_bf16 v[136:139], a[224:227], v[56:59], v[136:139]
buffer_load_dwordx4 v10, s[28:31], s58 offen lds
v_mfma_f32_16x16x32_bf16 v[136:139], a[228:231], a[120:123], v[136:139]
s_mov_b32 s59, 122880
v_mfma_f32_16x16x32_bf16 v[140:143], a[224:227], v[60:63], v[140:143]
v_mfma_f32_16x16x32_bf16 v[140:143], a[228:231], a[124:127], v[140:143]
s_waitcnt lgkmcnt(4)
ds_read_b64_tr_b16 a[216:217], v2 offset:43040
ds_read_b64_tr_b16 a[218:219], v2 offset:44832
v_mfma_f32_16x16x32_bf16 v[156:159], a[232:235], v[60:63], v[156:159]
buffer_load_dwordx4 a[192:195], v1, s[8:11], s59 offen offset:0 sc1
v_mfma_f32_16x16x32_bf16 v[156:159], a[236:239], a[124:127], v[156:159]
v_mfma_f32_16x16x32_bf16 v[152:155], a[232:235], v[56:59], v[152:155]
v_mfma_f32_16x16x32_bf16 v[152:155], a[236:239], a[120:123], v[152:155]
s_waitcnt lgkmcnt(6)
ds_read_b64_tr_b16 a[220:221], v2 offset:50208
ds_read_b64_tr_b16 a[222:223], v2 offset:52000
v_mfma_f32_16x16x32_bf16 v[148:151], a[232:235], v[52:55], v[148:151]
v_mfma_f32_16x16x32_bf16 v[148:151], a[236:239], a[116:119], v[148:151]
v_mfma_f32_16x16x32_bf16 v[144:147], a[232:235], v[48:51], v[144:147]
v_mfma_f32_16x16x32_bf16 v[144:147], a[236:239], a[112:115], v[144:147]
s_waitcnt lgkmcnt(4)
ds_read_b64_tr_b16 a[224:225], v2 offset:28736
ds_read_b64_tr_b16 a[226:227], v2 offset:30528
v_mfma_f32_16x16x32_bf16 v[160:163], a[208:211], v[48:51], v[160:163]
buffer_load_dwordx4 a[196:199], v1, s[8:11], s59 offen offset:1024 sc1
v_mfma_f32_16x16x32_bf16 v[160:163], a[212:215], a[112:115], v[160:163]
v_mfma_f32_16x16x32_bf16 v[164:167], a[208:211], v[52:55], v[164:167]
v_mfma_f32_16x16x32_bf16 v[164:167], a[212:215], a[116:119], v[164:167]
s_waitcnt lgkmcnt(6)
ds_read_b64_tr_b16 a[228:229], v2 offset:35904
ds_read_b64_tr_b16 a[230:231], v2 offset:37696
v_mfma_f32_16x16x32_bf16 v[168:171], a[208:211], v[56:59], v[168:171]
buffer_load_dwordx4 a[200:203], v1, s[8:11], s59 offen offset:2048 sc1
v_mfma_f32_16x16x32_bf16 v[168:171], a[212:215], a[120:123], v[168:171]
v_mfma_f32_16x16x32_bf16 v[172:175], a[208:211], v[60:63], v[172:175]
v_mfma_f32_16x16x32_bf16 v[172:175], a[212:215], a[124:127], v[172:175]
s_waitcnt lgkmcnt(4)
ds_read_b64_tr_b16 a[232:233], v2 offset:43072
ds_read_b64_tr_b16 a[234:235], v2 offset:44864
v_mfma_f32_16x16x32_bf16 v[188:191], a[216:219], v[60:63], v[188:191]
buffer_load_dwordx4 a[204:207], v1, s[8:11], s59 offen offset:3072 sc1
v_mfma_f32_16x16x32_bf16 v[188:191], a[220:223], a[124:127], v[188:191]
s_mov_b32 s59, 126976
v_mfma_f32_16x16x32_bf16 v[184:187], a[216:219], v[56:59], v[184:187]
v_mfma_f32_16x16x32_bf16 v[184:187], a[220:223], a[120:123], v[184:187]
s_waitcnt lgkmcnt(6)
ds_read_b64_tr_b16 a[236:237], v2 offset:50240
ds_read_b64_tr_b16 a[238:239], v2 offset:52032
v_mfma_f32_16x16x32_bf16 v[180:183], a[216:219], v[52:55], v[180:183]
buffer_load_dwordx4 a[96:99], v1, s[8:11], s59 offen offset:0 sc1
v_mfma_f32_16x16x32_bf16 v[180:183], a[220:223], a[116:119], v[180:183]
v_mfma_f32_16x16x32_bf16 v[176:179], a[216:219], v[48:51], v[176:179]
v_mfma_f32_16x16x32_bf16 v[176:179], a[220:223], a[112:115], v[176:179]
s_waitcnt lgkmcnt(4)
ds_read_b64_tr_b16 a[208:209], v2 offset:28768
ds_read_b64_tr_b16 a[210:211], v2 offset:30560
v_mfma_f32_16x16x32_bf16 v[192:195], a[224:227], v[48:51], v[192:195]
v_mfma_f32_16x16x32_bf16 v[192:195], a[228:231], a[112:115], v[192:195]
buffer_load_dwordx4 a[100:103], v1, s[8:11], s59 offen offset:1024 sc1
v_mfma_f32_16x16x32_bf16 v[196:199], a[224:227], v[52:55], v[196:199]
v_mfma_f32_16x16x32_bf16 v[196:199], a[228:231], a[116:119], v[196:199]
s_waitcnt lgkmcnt(6)
ds_read_b64_tr_b16 a[212:213], v2 offset:35936
ds_read_b64_tr_b16 a[214:215], v2 offset:37728
v_mfma_f32_16x16x32_bf16 v[200:203], a[224:227], v[56:59], v[200:203]
v_mfma_f32_16x16x32_bf16 v[200:203], a[228:231], a[120:123], v[200:203]
buffer_load_dwordx4 a[104:107], v1, s[8:11], s59 offen offset:2048 sc1
v_mfma_f32_16x16x32_bf16 v[204:207], a[224:227], v[60:63], v[204:207]
v_mfma_f32_16x16x32_bf16 v[204:207], a[228:231], a[124:127], v[204:207]
s_waitcnt lgkmcnt(4)
ds_read_b64_tr_b16 a[216:217], v2 offset:43104
ds_read_b64_tr_b16 a[218:219], v2 offset:44896
v_mfma_f32_16x16x32_bf16 v[220:223], a[232:235], v[60:63], v[220:223]
v_mfma_f32_16x16x32_bf16 v[220:223], a[236:239], a[124:127], v[220:223]
v_mfma_f32_16x16x32_bf16 v[216:219], a[232:235], v[56:59], v[216:219]
buffer_load_dwordx4 a[108:111], v1, s[8:11], s59 offen offset:3072 sc1
v_mfma_f32_16x16x32_bf16 v[216:219], a[236:239], a[120:123], v[216:219]
s_waitcnt lgkmcnt(6)
ds_read_b64_tr_b16 a[220:221], v2 offset:50272
ds_read_b64_tr_b16 a[222:223], v2 offset:52064
v_mfma_f32_16x16x32_bf16 v[212:215], a[232:235], v[52:55], v[212:215]
v_accvgpr_read_b32 v14, a240
v_lshlrev_b32 v10, 3, v0
v_mfma_f32_16x16x32_bf16 v[212:215], a[236:239], a[116:119], v[212:215]
v_add_u32 v11, 32768, v14
v_and_b32 v43, 31, v0
v_mfma_f32_16x16x32_bf16 v[208:211], a[232:235], v[48:51], v[208:211]
v_lshlrev_b32 v43, 7, v43
s_lshl_b32 s71, s60, 2
v_mfma_f32_16x16x32_bf16 v[208:211], a[236:239], a[112:115], v[208:211]
s_waitcnt lgkmcnt(4)
ds_read_b64_tr_b16 a[224:225], v2 offset:28800
ds_read_b64_tr_b16 a[226:227], v2 offset:30592
v_mfma_f32_16x16x32_bf16 v[224:227], a[208:211], v[48:51], v[224:227]
s_add_u32 s71, s71, 0x60000
s_mul_i32 s65, s63, 176
s_mul_i32 s66, s52, 44
v_mfma_f32_16x16x32_bf16 v[224:227], a[212:215], a[112:115], v[224:227]
s_add_u32 s65, s65, s66
s_lshl_b32 s65, s65, 12
s_add_u32 s65, s65, 0x400000
v_mfma_f32_16x16x32_bf16 v[228:231], a[208:211], v[52:55], v[228:231]
s_add_u32 s32, s6, s65
s_addc_u32 s33, s7, 0
s_and_b32 s33, s33, 0xffff
v_mfma_f32_16x16x32_bf16 v[228:231], a[212:215], a[116:119], v[228:231]
s_waitcnt lgkmcnt(6)
ds_read_b64_tr_b16 a[228:229], v2 offset:35968
ds_read_b64_tr_b16 a[230:231], v2 offset:37760
v_mfma_f32_16x16x32_bf16 v[232:235], a[208:211], v[56:59], v[232:235]
s_mov_b32 s34, 0x2c000
s_mov_b32 s35, 0x20000
s_mov_b32 s12, s84
v_mfma_f32_16x16x32_bf16 v[232:235], a[212:215], a[120:123], v[232:235]
s_and_b32 s13, s85, 0xffff
s_mov_b32 s14, 7340032
s_mov_b32 s15, 0x20000
v_mfma_f32_16x16x32_bf16 v[236:239], a[208:211], v[60:63], v[236:239]
s_mov_b32 s16, s88
s_and_b32 s17, s89, 0xffff
s_mov_b32 s18, 2097152
v_mfma_f32_16x16x32_bf16 v[236:239], a[212:215], a[124:127], v[236:239]
s_waitcnt lgkmcnt(4)
ds_read_b64_tr_b16 a[232:233], v2 offset:43136
ds_read_b64_tr_b16 a[234:235], v2 offset:44928
v_mfma_f32_16x16x32_bf16 v[252:255], a[216:219], v[60:63], v[252:255]
s_mov_b32 s19, 0x20000
s_mov_b32 s20, s90
s_and_b32 s21, s91, 0xffff
v_mfma_f32_16x16x32_bf16 v[252:255], a[220:223], a[124:127], v[252:255]
s_mov_b32 s22, 2097152
s_mov_b32 s23, 0x20000
s_lshl_b32 s54, s62, 10
v_mfma_f32_16x16x32_bf16 v[248:251], a[216:219], v[56:59], v[248:251]
v_mov_b32 v46, 0xc0135761
v_mov_b32 v47, 0xbdd2d3e8
v_mfma_f32_16x16x32_bf16 v[248:251], a[220:223], a[120:123], v[248:251]
s_waitcnt lgkmcnt(6)
ds_read_b64_tr_b16 a[236:237], v2 offset:50304
ds_read_b64_tr_b16 a[238:239], v2 offset:52096
v_mfma_f32_16x16x32_bf16 v[244:247], a[216:219], v[52:55], v[244:247]
s_and_b32 s67, s61, 3
s_lshl_b32 s67, s67, 1
s_mov_b32 s65, s53
v_mfma_f32_16x16x32_bf16 v[244:247], a[220:223], a[116:119], v[244:247]
s_mul_i32 s65, s65, 7
s_add_u32 s65, s65, 1
s_lshr_b32 s65, s65, 1
v_mfma_f32_16x16x32_bf16 v[240:243], a[216:219], v[48:51], v[240:243]
s_lshl_b32 s96, s65, 12
s_cmp_le_u32 s53, 0
s_cselect_b32 s65, 1, 0
v_mfma_f32_16x16x32_bf16 v[240:243], a[220:223], a[112:115], v[240:243]
s_waitcnt lgkmcnt(4)
ds_read_b64_tr_b16 a[208:209], v2 offset:28832
ds_read_b64_tr_b16 a[210:211], v2 offset:30624
v_mfma_f32_16x16x32_bf16 a[0:3], a[224:227], v[48:51], a[0:3]
s_mul_i32 s65, s65, 7
s_add_u32 s65, s65, 1
s_lshr_b32 s65, s65, 1
v_mfma_f32_16x16x32_bf16 a[0:3], a[228:231], a[112:115], a[0:3]
s_lshl_b32 s97, s65, 12
s_cmp_le_u32 s53, 1
s_cselect_b32 s65, 2, 1
v_mfma_f32_16x16x32_bf16 a[4:7], a[224:227], v[52:55], a[4:7]
s_mul_i32 s65, s65, 7
s_add_u32 s65, s65, 1
s_lshr_b32 s65, s65, 1
v_mfma_f32_16x16x32_bf16 a[4:7], a[228:231], a[116:119], a[4:7]
s_waitcnt lgkmcnt(6)
ds_read_b64_tr_b16 a[212:213], v2 offset:36000
ds_read_b64_tr_b16 a[214:215], v2 offset:37792
v_mfma_f32_16x16x32_bf16 a[8:11], a[224:227], v[56:59], a[8:11]
s_lshl_b32 s98, s65, 12
s_cmp_le_u32 s53, 2
s_cselect_b32 s65, 3, 2
v_mfma_f32_16x16x32_bf16 a[8:11], a[228:231], a[120:123], a[8:11]
s_mul_i32 s65, s65, 7
s_add_u32 s65, s65, 1
s_lshr_b32 s65, s65, 1
v_mfma_f32_16x16x32_bf16 a[12:15], a[224:227], v[60:63], a[12:15]
s_lshl_b32 s99, s65, 12
s_cmp_le_u32 s53, 3
s_cselect_b32 s65, 4, 3
v_mfma_f32_16x16x32_bf16 a[12:15], a[228:231], a[124:127], a[12:15]
s_waitcnt lgkmcnt(4)
ds_read_b64_tr_b16 a[216:217], v2 offset:43168
ds_read_b64_tr_b16 a[218:219], v2 offset:44960
v_mfma_f32_16x16x32_bf16 a[28:31], a[232:235], v[60:63], a[28:31]
s_mul_i32 s65, s65, 7
s_add_u32 s65, s65, 1
s_lshr_b32 s65, s65, 1
v_mfma_f32_16x16x32_bf16 a[28:31], a[236:239], a[124:127], a[28:31]
s_lshl_b32 s48, s65, 12
s_cmp_le_u32 s53, 4
s_cselect_b32 s65, 5, 4
v_mfma_f32_16x16x32_bf16 a[24:27], a[232:235], v[56:59], a[24:27]
s_mul_i32 s65, s65, 7
s_add_u32 s65, s65, 1
s_lshr_b32 s65, s65, 1
v_mfma_f32_16x16x32_bf16 a[24:27], a[236:239], a[120:123], a[24:27]
s_waitcnt lgkmcnt(6)
ds_read_b64_tr_b16 a[220:221], v2 offset:50336
ds_read_b64_tr_b16 a[222:223], v2 offset:52128
v_mfma_f32_16x16x32_bf16 a[20:23], a[232:235], v[52:55], a[20:23]
s_lshl_b32 s49, s65, 12
s_cmp_le_u32 s53, 5
s_cselect_b32 s65, 6, 5
v_mfma_f32_16x16x32_bf16 a[20:23], a[236:239], a[116:119], a[20:23]
s_mul_i32 s65, s65, 7
s_add_u32 s65, s65, 1
s_lshr_b32 s65, s65, 1
v_mfma_f32_16x16x32_bf16 a[16:19], a[232:235], v[48:51], a[16:19]
s_lshl_b32 s50, s65, 12
s_cmp_le_u32 s53, 6
s_cselect_b32 s65, 7, 6
v_mfma_f32_16x16x32_bf16 a[16:19], a[236:239], a[112:115], a[16:19]
s_waitcnt lgkmcnt(4)
ds_read_b64_tr_b16 a[224:225], v2 offset:28864
ds_read_b64_tr_b16 a[226:227], v2 offset:30656
v_mfma_f32_16x16x32_bf16 a[32:35], a[208:211], v[48:51], a[32:35]
s_mul_i32 s65, s65, 7
s_add_u32 s65, s65, 1
s_lshr_b32 s65, s65, 1
v_mfma_f32_16x16x32_bf16 a[32:35], a[212:215], a[112:115], a[32:35]
s_lshl_b32 s51, s65, 12
s_lshr_b32 s67, s53, 1
s_movk_i32 s76, 12288
v_mfma_f32_16x16x32_bf16 a[36:39], a[208:211], v[52:55], a[36:39]
s_lshl_b32 s24, s67, 13
s_mov_b32 s77, 40960
v_mfma_f32_16x16x32_bf16 a[36:39], a[212:215], a[116:119], a[36:39]
s_waitcnt lgkmcnt(6)
ds_read_b64_tr_b16 a[228:229], v2 offset:36032
ds_read_b64_tr_b16 a[230:231], v2 offset:37824
v_mfma_f32_16x16x32_bf16 a[40:43], a[208:211], v[56:59], a[40:43]
s_cmp_le_u32 s67, 0
s_cselect_b32 s65, 1, 0
s_lshl_b32 s25, s65, 13
v_mfma_f32_16x16x32_bf16 a[40:43], a[212:215], a[120:123], a[40:43]
s_mov_b32 s78, 69632
s_cmp_le_u32 s67, 1
s_cselect_b32 s65, 2, 1
v_mfma_f32_16x16x32_bf16 a[44:47], a[208:211], v[60:63], a[44:47]
s_lshl_b32 s26, s65, 13
s_mov_b32 s80, 98304
v_mfma_f32_16x16x32_bf16 a[44:47], a[212:215], a[124:127], a[44:47]
s_waitcnt lgkmcnt(4)
ds_read_b64_tr_b16 a[232:233], v2 offset:43200
ds_read_b64_tr_b16 a[234:235], v2 offset:44992
v_mfma_f32_16x16x32_bf16 a[60:63], a[216:219], v[60:63], a[60:63]
s_cmp_le_u32 s67, 2
s_cselect_b32 s65, 3, 2
s_lshl_b32 s27, s65, 13
v_mfma_f32_16x16x32_bf16 a[60:63], a[220:223], a[124:127], a[60:63]
s_lshl_b32 s44, s53, 12
s_and_b32 s69, s53, 1
s_lshl_b32 s45, s69, 12
v_mfma_f32_16x16x32_bf16 a[56:59], a[216:219], v[56:59], a[56:59]
s_mul_i32 s67, s67, 28672
s_lshl_b32 s69, s69, 9
L_tr8:
s_cbranch_execz L_trret
s_add_u32 s67, s67, s69
v_mfma_f32_16x16x32_bf16 a[56:59], a[220:223], a[120:123], a[56:59]
s_waitcnt lgkmcnt(6)
ds_read_b64_tr_b16 a[236:237], v2 offset:50368
ds_read_b64_tr_b16 a[238:239], v2 offset:52160
v_mfma_f32_16x16x32_bf16 a[52:55], a[216:219], v[52:55], a[52:55]
s_add_u32 s67, s67, 12288
s_add_u32 s72, s44, 114688
s_add_u32 s73, s44, 147456
v_mfma_f32_16x16x32_bf16 a[52:55], a[220:223], a[116:119], a[52:55]
s_mov_b32 s66, s96
s_lshl_b32 s68, s63, 2
s_add_u32 s68, s68, s52
v_mfma_f32_16x16x32_bf16 a[48:51], a[216:219], v[48:51], a[48:51]
s_lshl_b32 s68, s68, 7
s_add_u32 s68, s68, 0x70000
s_lshl_b32 s81, s53, 2
v_mfma_f32_16x16x32_bf16 a[48:51], a[220:223], a[112:115], a[48:51]
s_waitcnt lgkmcnt(4)
ds_read_b128 a[208:211], v3 offset:8192
s_add_u32 s81, s81, s68
v_mfma_f32_16x16x32_bf16 a[64:67], a[224:227], v[48:51], a[64:67]
v_and_b32 v12, 7, v0
v_lshlrev_b32 v12, 2, v12
v_mfma_f32_16x16x32_bf16 a[64:67], a[228:231], a[112:115], a[64:67]
s_sub_u32 s64, 31, s63
s_lshl_b32 s64, s64, 13
s_lshl_b32 s65, s60, 8
v_mfma_f32_16x16x32_bf16 a[68:71], a[224:227], v[52:55], a[68:71]
s_add_u32 s64, s64, s65
s_mul_i32 s46, s62, 8192
s_add_u32 s46, s46, 131072
v_mfma_f32_16x16x32_bf16 a[68:71], a[228:231], a[116:119], a[68:71]
ds_read_b128 a[212:215], v4 offset:8192
s_getpc_b64 s[82:83]
L_pc2:
v_mfma_f32_16x16x32_bf16 a[72:75], a[224:227], v[56:59], a[72:75]
v_lshrrev_b32 v40, 3, v0
v_lshlrev_b32 v40, 12, v40
v_mfma_f32_16x16x32_bf16 a[72:75], a[228:231], a[120:123], a[72:75]
v_and_b32 v41, 7, v0
v_lshl_add_u32 v40, v41, 7, v40
v_mfma_f32_16x16x32_bf16 a[76:79], a[224:227], v[60:63], a[76:79]
v_add_u32 v40, L_main-L_pc2+49152, v40
v_min_u32 v40, L_codeend-L_pc2-4, v40
v_mfma_f32_16x16x32_bf16 a[76:79], a[228:231], a[124:127], a[76:79]
s_waitcnt lgkmcnt(2)
ds_read_b128 a[216:219], v3 offset:12288
v_mov_b32 v41, 0
v_mfma_f32_16x16x32_bf16 a[92:95], a[232:235], v[60:63], a[92:95]
v_lshl_add_u64 v[40:41], v[40:41], 0, s[82:83]
v_mfma_f32_16x16x32_bf16 a[92:95], a[236:239], a[124:127], a[92:95]
global_load_dword a246, v[40:41], off
v_mfma_f32_16x16x32_bf16 a[88:91], a[232:235], v[56:59], a[88:91]
v_mfma_f32_16x16x32_bf16 a[88:91], a[236:239], a[120:123], a[88:91]
ds_read_b128 a[220:223], v4 offset:12288
v_mfma_f32_16x16x32_bf16 a[84:87], a[232:235], v[52:55], a[84:87]
v_mfma_f32_16x16x32_bf16 a[84:87], a[236:239], a[116:119], a[84:87]
buffer_load_dword v44, v43, s[36:39], s71 offen sc0 sc1
v_mfma_f32_16x16x32_bf16 a[80:83], a[232:235], v[48:51], a[80:83]
v_mfma_f32_16x16x32_bf16 a[80:83], a[236:239], a[112:115], a[80:83]
s_waitcnt lgkmcnt(2)
ds_read_b128 a[224:227], v3 offset:10240
ds_read_b128 a[228:231], v4 offset:10240
v_mfma_f32_16x16x32_bf16 v[64:67], v[48:51], a[208:211], v[64:67]
v_mfma_f32_16x16x32_bf16 v[64:67], a[112:115], a[212:215], v[64:67]
v_mfma_f32_16x16x32_bf16 v[68:71], v[52:55], a[208:211], v[68:71]
v_mfma_f32_16x16x32_bf16 v[68:71], a[116:119], a[212:215], v[68:71]
s_waitcnt lgkmcnt(4)
ds_read_b128 a[232:235], v3 offset:14336
ds_read_b128 a[236:239], v4 offset:14336
v_mfma_f32_16x16x32_bf16 v[72:75], v[56:59], a[208:211], v[72:75]
v_mfma_f32_16x16x32_bf16 v[72:75], a[120:123], a[212:215], v[72:75]
v_mfma_f32_16x16x32_bf16 v[76:79], v[60:63], a[208:211], v[76:79]
v_mfma_f32_16x16x32_bf16 v[76:79], a[124:127], a[212:215], v[76:79]
s_waitcnt lgkmcnt(4)
v_mfma_f32_16x16x32_bf16 v[108:111], v[60:63], a[216:219], v[108:111]
v_mfma_f32_16x16x32_bf16 v[108:111], a[124:127], a[220:223], v[108:111]
v_mfma_f32_16x16x32_bf16 v[104:107], v[56:59], a[216:219], v[104:107]
v_mfma_f32_16x16x32_bf16 v[104:107], a[120:123], a[220:223], v[104:107]
v_mfma_f32_16x16x32_bf16 v[100:103], v[52:55], a[216:219], v[100:103]
v_mfma_f32_16x16x32_bf16 v[100:103], a[116:119], a[220:223], v[100:103]
v_mfma_f32_16x16x32_bf16 v[96:99], v[48:51], a[216:219], v[96:99]
s_waitcnt vmcnt(27) lgkmcnt(0)
s_barrier
v_mfma_f32_16x16x32_bf16 v[96:99], a[112:115], a[220:223], v[96:99]
s_waitcnt lgkmcnt(2)
ds_read_b64_tr_b16 a[208:209], v5 offset:0
ds_read_b64_tr_b16 a[210:211], v5 offset:1792
v_mfma_f32_16x16x32_bf16 v[80:83], v[48:51], a[224:227], v[80:83]
s_add_u32 s55, s96, 8192
s_lshl_b32 s55, s55, 4
s_add_u32 m0, s54, 0
v_mfma_f32_16x16x32_bf16 v[80:83], a[112:115], a[228:231], v[80:83]
buffer_load_dwordx4 v14, s[12:15], s55 offen lds
v_mfma_f32_16x16x32_bf16 v[84:87], v[52:55], a[224:227], v[84:87]
s_add_u32 m0, s54, 4096
v_mfma_f32_16x16x32_bf16 v[84:87], a[116:119], a[228:231], v[84:87]
s_waitcnt lgkmcnt(4)
ds_read_b64_tr_b16 a[212:213], v5 offset:7168
ds_read_b64_tr_b16 a[214:215], v5 offset:8960
v_mfma_f32_16x16x32_bf16 v[88:91], v[56:59], a[224:227], v[88:91]
v_mfma_f32_16x16x32_bf16 v[88:91], a[120:123], a[228:231], v[88:91]
v_mfma_f32_16x16x32_bf16 v[92:95], v[60:63], a[224:227], v[92:95]
buffer_load_dwordx4 v11, s[12:15], s55 offen lds
v_mfma_f32_16x16x32_bf16 v[92:95], a[124:127], a[228:231], v[92:95]
s_waitcnt lgkmcnt(4)
ds_read_b64_tr_b16 a[216:217], v5 offset:14336
ds_read_b64_tr_b16 a[218:219], v5 offset:16128
v_mfma_f32_16x16x32_bf16 v[124:127], v[60:63], a[232:235], v[124:127]
s_lshl_b32 s55, s96, 4
s_add_u32 m0, s54, 8192
v_mfma_f32_16x16x32_bf16 v[124:127], a[124:127], a[236:239], v[124:127]
v_mfma_f32_16x16x32_bf16 v[120:123], v[56:59], a[232:235], v[120:123]
v_mfma_f32_16x16x32_bf16 v[120:123], a[120:123], a[236:239], v[120:123]
s_waitcnt lgkmcnt(6)
ds_read_b64_tr_b16 a[220:221], v5 offset:21504
ds_read_b64_tr_b16 a[222:223], v5 offset:23296
v_mfma_f32_16x16x32_bf16 v[116:119], v[52:55], a[232:235], v[116:119]
buffer_load_dwordx4 v14, s[12:15], s55 offen lds
v_mfma_f32_16x16x32_bf16 v[116:119], a[116:119], a[236:239], v[116:119]
s_add_u32 m0, s54, 12288
v_mfma_f32_16x16x32_bf16 v[112:115], v[48:51], a[232:235], v[112:115]
v_mfma_f32_16x16x32_bf16 v[112:115], a[112:115], a[236:239], v[112:115]
s_waitcnt vmcnt(14) lgkmcnt(4)
ds_read_b64_tr_b16 a[224:225], v5 offset:32
ds_read_b64_tr_b16 a[226:227], v5 offset:1824
v_mfma_f32_16x16x32_bf16 v[128:131], a[208:211], a[128:131], v[128:131]
v_mfma_f32_16x16x32_bf16 v[128:131], a[212:215], a[144:147], v[128:131]
buffer_load_dwordx4 v11, s[12:15], s55 offen lds
v_mfma_f32_16x16x32_bf16 v[132:135], a[208:211], a[132:135], v[132:135]
s_add_u32 s55, s96, 4096
s_lshl_b32 s55, s55, 4
s_add_u32 m0, s54, 16384
v_mfma_f32_16x16x32_bf16 v[132:135], a[212:215], a[148:151], v[132:135]
s_waitcnt lgkmcnt(6)
ds_read_b64_tr_b16 a[228:229], v5 offset:7200
ds_read_b64_tr_b16 a[230:231], v5 offset:8992
v_mfma_f32_16x16x32_bf16 v[136:139], a[208:211], a[136:139], v[136:139]
v_mfma_f32_16x16x32_bf16 v[136:139], a[212:215], a[152:155], v[136:139]
v_mfma_f32_16x16x32_bf16 v[140:143], a[208:211], a[140:143], v[140:143]
buffer_load_dwordx4 v14, s[12:15], s55 offen lds
v_mfma_f32_16x16x32_bf16 v[140:143], a[212:215], a[156:159], v[140:143]
s_waitcnt lgkmcnt(4)
ds_read_b64_tr_b16 a[232:233], v5 offset:14368
ds_read_b64_tr_b16 a[234:235], v5 offset:16160
v_mfma_f32_16x16x32_bf16 v[156:159], a[216:219], a[140:143], v[156:159]
s_add_u32 m0, s54, 20480
v_mfma_f32_16x16x32_bf16 v[156:159], a[220:223], a[156:159], v[156:159]
v_mfma_f32_16x16x32_bf16 v[152:155], a[216:219], a[136:139], v[152:155]
v_mfma_f32_16x16x32_bf16 v[152:155], a[220:223], a[152:155], v[152:155]
s_waitcnt lgkmcnt(6)
ds_read_b64_tr_b16 a[236:237], v5 offset:21536
ds_read_b64_tr_b16 a[238:239], v5 offset:23328
v_mfma_f32_16x16x32_bf16 v[148:151], a[216:219], a[132:135], v[148:151]
buffer_load_dwordx4 v11, s[12:15], s55 offen lds
v_mfma_f32_16x16x32_bf16 v[148:151], a[220:223], a[148:151], v[148:151]
s_lshl_b32 s55, s97, 4
s_add_u32 m0, s54, 24576
v_mfma_f32_16x16x32_bf16 v[144:147], a[216:219], a[128:131], v[144:147]
s_waitcnt vmcnt(16)
s_barrier
v_mfma_f32_16x16x32_bf16 v[144:147], a[220:223], a[144:147], v[144:147]
s_waitcnt lgkmcnt(4)
ds_read_b64_tr_b16 a[208:209], v5 offset:28672
ds_read_b64_tr_b16 a[210:211], v5 offset:30464
v_mfma_f32_16x16x32_bf16 v[160:163], a[224:227], a[128:131], v[160:163]
v_mfma_f32_16x16x32_bf16 v[160:163], a[228:231], a[144:147], v[160:163]
buffer_load_dwordx4 v14, s[12:15], s55 offen lds
v_mfma_f32_16x16x32_bf16 v[164:167], a[224:227], a[132:135], v[164:167]
s_add_u32 m0, s54, 28672
v_mfma_f32_16x16x32_bf16 v[164:167], a[228:231], a[148:151], v[164:167]
s_waitcnt lgkmcnt(6)
ds_read_b64_tr_b16 a[212:213], v5 offset:35840
ds_read_b64_tr_b16 a[214:215], v5 offset:37632
v_mfma_f32_16x16x32_bf16 v[168:171], a[224:227], a[136:139], v[168:171]
v_mfma_f32_16x16x32_bf16 v[168:171], a[228:231], a[152:155], v[168:171]
v_mfma_f32_16x16x32_bf16 v[172:175], a[224:227], a[140:143], v[172:175]
buffer_load_dwordx4 v11, s[12:15], s55 offen lds
v_mfma_f32_16x16x32_bf16 v[172:175], a[228:231], a[156:159], v[172:175]
s_waitcnt lgkmcnt(4)
ds_read_b64_tr_b16 a[216:217], v5 offset:43008
ds_read_b64_tr_b16 a[218:219], v5 offset:44800
v_mfma_f32_16x16x32_bf16 v[188:191], a[232:235], a[140:143], v[188:191]
s_lshl_b32 s55, s98, 4
s_add_u32 m0, s54, 32768
v_mfma_f32_16x16x32_bf16 v[188:191], a[236:239], a[156:159], v[188:191]
v_mfma_f32_16x16x32_bf16 v[184:187], a[232:235], a[136:139], v[184:187]
v_mfma_f32_16x16x32_bf16 v[184:187], a[236:239], a[152:155], v[184:187]
s_waitcnt lgkmcnt(6)
ds_read_b64_tr_b16 a[220:221], v5 offset:50176
ds_read_b64_tr_b16 a[222:223], v5 offset:51968
v_mfma_f32_16x16x32_bf16 v[180:183], a[232:235], a[132:135], v[180:183]
buffer_load_dwordx4 v14, s[12:15], s55 offen lds
v_mfma_f32_16x16x32_bf16 v[180:183], a[236:239], a[148:151], v[180:183]
s_add_u32 m0, s54, 36864
v_mfma_f32_16x16x32_bf16 v[176:179], a[232:235], a[128:131], v[176:179]
v_mfma_f32_16x16x32_bf16 v[176:179], a[236:239], a[144:147], v[176:179]
s_waitcnt vmcnt(11) lgkmcnt(4)
ds_read_b64_tr_b16 a[224:225], v5 offset:28704
ds_read_b64_tr_b16 a[226:227], v5 offset:30496
v_mfma_f32_16x16x32_bf16 v[128:131], a[208:211], a[192:195], v[128:131]
v_mfma_f32_16x16x32_bf16 v[128:131], a[212:215], a[96:99], v[128:131]
buffer_load_dwordx4 v11, s[12:15], s55 offen lds
v_mfma_f32_16x16x32_bf16 v[132:135], a[208:211], a[196:199], v[132:135]
s_add_u32 s55, s97, 4096
s_lshl_b32 s55, s55, 4
s_add_u32 m0, s54, 40960
v_mfma_f32_16x16x32_bf16 v[132:135], a[212:215], a[100:103], v[132:135]
s_waitcnt lgkmcnt(6)
ds_read_b64_tr_b16 a[228:229], v5 offset:35872
ds_read_b64_tr_b16 a[230:231], v5 offset:37664
v_mfma_f32_16x16x32_bf16 v[136:139], a[208:211], a[200:203], v[136:139]
v_mfma_f32_16x16x32_bf16 v[136:139], a[212:215], a[104:107], v[136:139]
v_mfma_f32_16x16x32_bf16 v[140:143], a[208:211], a[204:207], v[140:143]
buffer_load_dwordx4 v14, s[12:15], s55 offen lds
v_mfma_f32_16x16x32_bf16 v[140:143], a[212:215], a[108:111], v[140:143]
s_waitcnt lgkmcnt(4)
ds_read_b64_tr_b16 a[232:233], v5 offset:43040
ds_read_b64_tr_b16 a[234:235], v5 offset:44832
v_mfma_f32_16x16x32_bf16 v[156:159], a[216:219], a[204:207], v[156:159]
s_add_u32 m0, s54, 45056
v_mfma_f32_16x16x32_bf16 v[156:159], a[220:223], a[108:111], v[156:159]
v_mfma_f32_16x16x32_bf16 v[152:155], a[216:219], a[200:203], v[152:155]
v_mfma_f32_16x16x32_bf16 v[152:155], a[220:223], a[104:107], v[152:155]
s_waitcnt lgkmcnt(6)
ds_read_b64_tr_b16 a[236:237], v5 offset:50208
ds_read_b64_tr_b16 a[238:239], v5 offset:52000
v_mfma_f32_16x16x32_bf16 v[148:151], a[216:219], a[196:199], v[148:151]
buffer_load_dwordx4 v11, s[12:15], s55 offen lds
v_mfma_f32_16x16x32_bf16 v[148:151], a[220:223], a[100:103], v[148:151]
s_add_u32 s55, s98, 4096
s_lshl_b32 s55, s55, 4
s_add_u32 m0, s54, 49152
v_mfma_f32_16x16x32_bf16 v[144:147], a[216:219], a[192:195], v[144:147]
v_mfma_f32_16x16x32_bf16 v[144:147], a[220:223], a[96:99], v[144:147]
s_waitcnt lgkmcnt(4)
ds_read_b64_tr_b16 a[208:209], v5 offset:64
ds_read_b64_tr_b16 a[210:211], v5 offset:1856
v_mfma_f32_16x16x32_bf16 v[160:163], a[224:227], a[192:195], v[160:163]
v_mfma_f32_16x16x32_bf16 v[160:163], a[228:231], a[96:99], v[160:163]
buffer_load_dwordx4 v14, s[12:15], s55 offen lds
v_mfma_f32_16x16x32_bf16 v[164:167], a[224:227], a[196:199], v[164:167]
s_add_u32 m0, s54, 53248
v_mfma_f32_16x16x32_bf16 v[164:167], a[228:231], a[100:103], v[164:167]
s_waitcnt lgkmcnt(6)
ds_read_b64_tr_b16 a[212:213], v5 offset:7232
ds_read_b64_tr_b16 a[214:215], v5 offset:9024
v_mfma_f32_16x16x32_bf16 v[168:171], a[224:227], a[200:203], v[168:171]
v_mfma_f32_16x16x32_bf16 v[168:171], a[228:231], a[104:107], v[168:171]
v_mfma_f32_16x16x32_bf16 v[172:175], a[224:227], a[204:207], v[172:175]
buffer_load_dwordx4 v11, s[12:15], s55 offen lds
v_mfma_f32_16x16x32_bf16 v[172:175], a[228:231], a[108:111], v[172:175]
s_waitcnt lgkmcnt(4)
ds_read_b64_tr_b16 a[216:217], v5 offset:14400
ds_read_b64_tr_b16 a[218:219], v5 offset:16192
v_mfma_f32_16x16x32_bf16 v[188:191], a[232:235], a[204:207], v[188:191]
s_lshl_b32 s55, s99, 4
s_add_u32 m0, s54, 57344
v_mfma_f32_16x16x32_bf16 v[188:191], a[236:239], a[108:111], v[188:191]
v_mfma_f32_16x16x32_bf16 v[184:187], a[232:235], a[200:203], v[184:187]
v_mfma_f32_16x16x32_bf16 v[184:187], a[236:239], a[104:107], v[184:187]
s_waitcnt lgkmcnt(6)
ds_read_b64_tr_b16 a[220:221], v5 offset:21568
ds_read_b64_tr_b16 a[222:223], v5 offset:23360
v_mfma_f32_16x16x32_bf16 v[180:183], a[232:235], a[196:199], v[180:183]
buffer_load_dwordx4 v14, s[12:15], s55 offen lds
v_mfma_f32_16x16x32_bf16 v[180:183], a[236:239], a[100:103], v[180:183]
s_add_u32 m0, s54, 61440
v_mfma_f32_16x16x32_bf16 v[176:179], a[232:235], a[192:195], v[176:179]
v_mfma_f32_16x16x32_bf16 v[176:179], a[236:239], a[96:99], v[176:179]
s_waitcnt lgkmcnt(4)
ds_read_b64_tr_b16 a[224:225], v5 offset:96
ds_read_b64_tr_b16 a[226:227], v5 offset:1888
v_mfma_f32_16x16x32_bf16 v[192:195], a[208:211], a[128:131], v[192:195]
v_mfma_f32_16x16x32_bf16 v[192:195], a[212:215], a[144:147], v[192:195]
buffer_load_dwordx4 v11, s[12:15], s55 offen lds
v_mfma_f32_16x16x32_bf16 v[196:199], a[208:211], a[132:135], v[196:199]
v_mul_f32 v48, v128, v128
v_mul_f32 v49, v129, v129
v_mfma_f32_16x16x32_bf16 v[196:199], a[212:215], a[148:151], v[196:199]
s_waitcnt lgkmcnt(6)
ds_read_b64_tr_b16 a[228:229], v5 offset:7264
ds_read_b64_tr_b16 a[230:231], v5 offset:9056
v_mfma_f32_16x16x32_bf16 v[200:203], a[208:211], a[136:139], v[200:203]
v_mul_f32 v50, v130, v130
v_mul_f32 v51, v131, v131
v_mfma_f32_16x16x32_bf16 v[200:203], a[212:215], a[152:155], v[200:203]
v_mul_f32 v52, v160, v160
v_mul_f32 v53, v161, v161
v_mfma_f32_16x16x32_bf16 v[204:207], a[208:211], a[140:143], v[204:207]
v_mul_f32 v54, v162, v162
v_mul_f32 v55, v163, v163
v_mfma_f32_16x16x32_bf16 v[204:207], a[212:215], a[156:159], v[204:207]
s_waitcnt lgkmcnt(4)
ds_read_b64_tr_b16 a[232:233], v5 offset:14432
ds_read_b64_tr_b16 a[234:235], v5 offset:16224
v_mfma_f32_16x16x32_bf16 v[220:223], a[216:219], a[140:143], v[220:223]
v_fma_f32 v48, v48, v47, v46
v_fma_f32 v49, v49, v47, v46
v_mfma_f32_16x16x32_bf16 v[220:223], a[220:223], a[156:159], v[220:223]
v_fma_f32 v50, v50, v47, v46
v_fma_f32 v51, v51, v47, v46
v_mfma_f32_16x16x32_bf16 v[216:219], a[216:219], a[136:139], v[216:219]
v_fma_f32 v52, v52, v47, v46
v_fma_f32 v53, v53, v47, v46
v_mfma_f32_16x16x32_bf16 v[216:219], a[220:223], a[152:155], v[216:219]
s_waitcnt lgkmcnt(6)
ds_read_b64_tr_b16 a[236:237], v5 offset:21600
ds_read_b64_tr_b16 a[238:239], v5 offset:23392
v_mfma_f32_16x16x32_bf16 v[212:215], a[216:219], a[132:135], v[212:215]
v_fma_f32 v54, v54, v47, v46
v_fma_f32 v55, v55, v47, v46
v_mfma_f32_16x16x32_bf16 v[212:215], a[220:223], a[148:151], v[212:215]
v_mul_f32 v48, v48, v128
v_mul_f32 v49, v49, v129
v_mfma_f32_16x16x32_bf16 v[208:211], a[216:219], a[128:131], v[208:211]
v_mul_f32 v50, v50, v130
v_mul_f32 v51, v51, v131
v_mfma_f32_16x16x32_bf16 v[208:211], a[220:223], a[144:147], v[208:211]
s_waitcnt lgkmcnt(4)
ds_read_b64_tr_b16 a[208:209], v5 offset:128
ds_read_b64_tr_b16 a[210:211], v5 offset:1920
v_mfma_f32_16x16x32_bf16 v[224:227], a[224:227], a[128:131], v[224:227]
v_mul_f32 v52, v52, v160
v_mul_f32 v53, v53, v161
v_mfma_f32_16x16x32_bf16 v[224:227], a[228:231], a[144:147], v[224:227]
v_mul_f32 v54, v54, v162
v_mul_f32 v55, v55, v163
v_mfma_f32_16x16x32_bf16 v[228:231], a[224:227], a[132:135], v[228:231]
v_exp_f32 v48, v48
v_mfma_f32_16x16x32_bf16 v[228:231], a[228:231], a[148:151], v[228:231]
s_waitcnt lgkmcnt(6)
ds_read_b64_tr_b16 a[212:213], v5 offset:7296
ds_read_b64_tr_b16 a[214:215], v5 offset:9088
v_mfma_f32_16x16x32_bf16 v[232:235], a[224:227], a[136:139], v[232:235]
v_exp_f32 v49, v49
v_mfma_f32_16x16x32_bf16 v[232:235], a[228:231], a[152:155], v[232:235]
v_exp_f32 v50, v50
v_mfma_f32_16x16x32_bf16 v[236:239], a[224:227], a[140:143], v[236:239]
v_exp_f32 v51, v51
v_mfma_f32_16x16x32_bf16 v[236:239], a[228:231], a[156:159], v[236:239]
s_waitcnt lgkmcnt(4)
ds_read_b64_tr_b16 a[216:217], v5 offset:14464
ds_read_b64_tr_b16 a[218:219], v5 offset:16256
v_mfma_f32_16x16x32_bf16 v[252:255], a[232:235], a[140:143], v[252:255]
v_exp_f32 v52, v52
v_mfma_f32_16x16x32_bf16 v[252:255], a[236:239], a[156:159], v[252:255]
v_exp_f32 v53, v53
v_mfma_f32_16x16x32_bf16 v[248:251], a[232:235], a[136:139], v[248:251]
v_exp_f32 v54, v54
v_mfma_f32_16x16x32_bf16 v[248:251], a[236:239], a[152:155], v[248:251]
s_waitcnt lgkmcnt(6)
ds_read_b64_tr_b16 a[220:221], v5 offset:21632
ds_read_b64_tr_b16 a[222:223], v5 offset:23424
v_mfma_f32_16x16x32_bf16 v[244:247], a[232:235], a[132:135], v[244:247]
v_exp_f32 v55, v55
v_mfma_f32_16x16x32_bf16 v[244:247], a[236:239], a[148:151], v[244:247]
v_mul_f32 v144, v128, v144
v_mul_f32 v145, v129, v145
v_mfma_f32_16x16x32_bf16 v[240:243], a[232:235], a[128:131], v[240:243]
v_mul_f32 v146, v130, v146
v_mul_f32 v147, v131, v147
v_mfma_f32_16x16x32_bf16 v[240:243], a[236:239], a[144:147], v[240:243]
s_waitcnt lgkmcnt(4)
ds_read_b64_tr_b16 a[224:225], v5 offset:160
ds_read_b64_tr_b16 a[226:227], v5 offset:1952
v_mfma_f32_16x16x32_bf16 a[0:3], a[208:211], a[128:131], a[0:3]
v_mul_f32 v176, v160, v176
v_mul_f32 v177, v161, v177
v_mfma_f32_16x16x32_bf16 a[0:3], a[212:215], a[144:147], a[0:3]
v_mul_f32 v178, v162, v178
v_mul_f32 v179, v163, v179
v_mfma_f32_16x16x32_bf16 a[4:7], a[208:211], a[132:135], a[4:7]
v_add_f32 v48, 1.0, v48
v_add_f32 v49, 1.0, v49
v_mfma_f32_16x16x32_bf16 a[4:7], a[212:215], a[148:151], a[4:7]
s_waitcnt lgkmcnt(6)
ds_read_b64_tr_b16 a[228:229], v5 offset:7328
ds_read_b64_tr_b16 a[230:231], v5 offset:9120
v_mfma_f32_16x16x32_bf16 a[8:11], a[208:211], a[136:139], a[8:11]
v_add_f32 v50, 1.0, v50
v_add_f32 v51, 1.0, v51
v_mfma_f32_16x16x32_bf16 a[8:11], a[212:215], a[152:155], a[8:11]
v_add_f32 v52, 1.0, v52
v_add_f32 v53, 1.0, v53
v_mfma_f32_16x16x32_bf16 a[12:15], a[208:211], a[140:143], a[12:15]
v_add_f32 v54, 1.0, v54
v_add_f32 v55, 1.0, v55
v_mfma_f32_16x16x32_bf16 a[12:15], a[212:215], a[156:159], a[12:15]
s_waitcnt lgkmcnt(4)
ds_read_b64_tr_b16 a[232:233], v5 offset:14496
ds_read_b64_tr_b16 a[234:235], v5 offset:16288
v_mfma_f32_16x16x32_bf16 a[28:31], a[216:219], a[140:143], a[28:31]
v_rcp_f32 v48, v48
v_mfma_f32_16x16x32_bf16 a[28:31], a[220:223], a[156:159], a[28:31]
v_rcp_f32 v49, v49
v_mfma_f32_16x16x32_bf16 a[24:27], a[216:219], a[136:139], a[24:27]
v_rcp_f32 v50, v50
v_mfma_f32_16x16x32_bf16 a[24:27], a[220:223], a[152:155], a[24:27]
s_waitcnt lgkmcnt(6)
ds_read_b64_tr_b16 a[236:237], v5 offset:21664
ds_read_b64_tr_b16 a[238:239], v5 offset:23456
v_mfma_f32_16x16x32_bf16 a[20:23], a[216:219], a[132:135], a[20:23]
v_rcp_f32 v51, v51
v_mfma_f32_16x16x32_bf16 a[20:23], a[220:223], a[148:151], a[20:23]
v_rcp_f32 v52, v52
v_mfma_f32_16x16x32_bf16 a[16:19], a[216:219], a[128:131], a[16:19]
v_rcp_f32 v53, v53
v_mfma_f32_16x16x32_bf16 a[16:19], a[220:223], a[144:147], a[16:19]
s_waitcnt lgkmcnt(4)
ds_read_b64_tr_b16 a[208:209], v5 offset:192
ds_read_b64_tr_b16 a[210:211], v5 offset:1984
v_mfma_f32_16x16x32_bf16 a[32:35], a[224:227], a[128:131], a[32:35]
v_rcp_f32 v54, v54
v_mfma_f32_16x16x32_bf16 a[32:35], a[228:231], a[144:147], a[32:35]
v_rcp_f32 v55, v55
v_mfma_f32_16x16x32_bf16 a[36:39], a[224:227], a[132:135], a[36:39]
v_mul_f32 v144, v144, v48
v_mul_f32 v145, v145, v49
v_mfma_f32_16x16x32_bf16 a[36:39], a[228:231], a[148:151], a[36:39]
s_waitcnt lgkmcnt(6)
ds_read_b64_tr_b16 a[212:213], v5 offset:7360
ds_read_b64_tr_b16 a[214:215], v5 offset:9152
v_mfma_f32_16x16x32_bf16 a[40:43], a[224:227], a[136:139], a[40:43]
v_mul_f32 v146, v146, v50
v_mul_f32 v147, v147, v51
v_mfma_f32_16x16x32_bf16 a[40:43], a[228:231], a[152:155], a[40:43]
v_mul_f32 v176, v176, v52
v_mul_f32 v177, v177, v53
v_mfma_f32_16x16x32_bf16 a[44:47], a[224:227], a[140:143], a[44:47]
v_mul_f32 v178, v178, v54
v_mul_f32 v179, v179, v55
v_mfma_f32_16x16x32_bf16 a[44:47], a[228:231], a[156:159], a[44:47]
s_waitcnt lgkmcnt(4)
ds_read_b64_tr_b16 a[216:217], v5 offset:14528
ds_read_b64_tr_b16 a[218:219], v5 offset:16320
v_mfma_f32_16x16x32_bf16 a[60:63], a[232:235], a[140:143], a[60:63]
v_cvt_pk_bf16_f32 v56, v144, v145
v_cvt_pk_bf16_f32 v57, v146, v147
v_mfma_f32_16x16x32_bf16 a[60:63], a[236:239], a[156:159], a[60:63]
v_cvt_pk_bf16_f32 v58, v176, v177
v_cvt_pk_bf16_f32 v59, v178, v179
v_mfma_f32_16x16x32_bf16 a[56:59], a[232:235], a[136:139], a[56:59]
buffer_store_dwordx4 v[56:59], v1, s[32:35], s66 offen offset:0 sc0 sc1
v_mfma_f32_16x16x32_bf16 a[56:59], a[236:239], a[152:155], a[56:59]
s_waitcnt lgkmcnt(6)
ds_read_b64_tr_b16 a[220:221], v5 offset:21696
ds_read_b64_tr_b16 a[222:223], v5 offset:23488
v_mfma_f32_16x16x32_bf16 a[52:55], a[232:235], a[132:135], a[52:55]
v_accvgpr_write_b32 a112, v56
v_accvgpr_write_b32 a113, v57
v_mfma_f32_16x16x32_bf16 a[52:55], a[236:239], a[148:151], a[52:55]
v_accvgpr_write_b32 a114, v58
v_accvgpr_write_b32 a115, v59
v_mfma_f32_16x16x32_bf16 a[48:51], a[232:235], a[128:131], a[48:51]
v_mul_f32 v48, v132, v132
v_mul_f32 v49, v133, v133
v_mfma_f32_16x16x32_bf16 a[48:51], a[236:239], a[144:147], a[48:51]
s_waitcnt lgkmcnt(4)
ds_read_b128 a[224:227], v3 offset:16384
v_mul_f32 v50, v134, v134
v_mfma_f32_16x16x32_bf16 a[64:67], a[208:211], a[128:131], a[64:67]
v_mul_f32 v51, v135, v135
v_mul_f32 v52, v164, v164
v_mfma_f32_16x16x32_bf16 a[64:67], a[212:215], a[144:147], a[64:67]
v_mul_f32 v53, v165, v165
v_mul_f32 v54, v166, v166
v_mfma_f32_16x16x32_bf16 a[68:71], a[208:211], a[132:135], a[68:71]
v_mul_f32 v55, v167, v167
v_fma_f32 v48, v48, v47, v46
v_mfma_f32_16x16x32_bf16 a[68:71], a[212:215], a[148:151], a[68:71]
ds_read_b128 a[228:231], v4 offset:16384
v_fma_f32 v49, v49, v47, v46
v_mfma_f32_16x16x32_bf16 a[72:75], a[208:211], a[136:139], a[72:75]
v_fma_f32 v50, v50, v47, v46
v_fma_f32 v51, v51, v47, v46
v_mfma_f32_16x16x32_bf16 a[72:75], a[212:215], a[152:155], a[72:75]
v_fma_f32 v52, v52, v47, v46
v_fma_f32 v53, v53, v47, v46
v_mfma_f32_16x16x32_bf16 a[76:79], a[208:211], a[140:143], a[76:79]
v_fma_f32 v54, v54, v47, v46
v_fma_f32 v55, v55, v47, v46
v_mfma_f32_16x16x32_bf16 a[76:79], a[212:215], a[156:159], a[76:79]
s_waitcnt lgkmcnt(2)
ds_read_b128 a[232:235], v3 offset:20480
v_mul_f32 v48, v48, v132
v_mfma_f32_16x16x32_bf16 a[92:95], a[216:219], a[140:143], a[92:95]
v_mul_f32 v49, v49, v133
v_mul_f32 v50, v50, v134
v_mfma_f32_16x16x32_bf16 a[92:95], a[220:223], a[156:159], a[92:95]
v_mul_f32 v51, v51, v135
v_mul_f32 v52, v52, v164
v_mfma_f32_16x16x32_bf16 a[88:91], a[216:219], a[136:139], a[88:91]
v_mul_f32 v53, v53, v165
v_mul_f32 v54, v54, v166
v_mfma_f32_16x16x32_bf16 a[88:91], a[220:223], a[152:155], a[88:91]
ds_read_b128 a[236:239], v4 offset:20480
v_mul_f32 v55, v55, v167
v_mfma_f32_16x16x32_bf16 a[84:87], a[216:219], a[132:135], a[84:87]
v_exp_f32 v48, v48
v_mfma_f32_16x16x32_bf16 a[84:87], a[220:223], a[148:151], a[84:87]
v_exp_f32 v49, v49
v_mfma_f32_16x16x32_bf16 a[80:83], a[216:219], a[128:131], a[80:83]
v_exp_f32 v50, v50
v_mfma_f32_16x16x32_bf16 a[80:83], a[220:223], a[144:147], a[80:83]
s_waitcnt lgkmcnt(2)
ds_read_b128 a[208:211], v3 offset:18432
v_mfma_f32_16x16x32_bf16 v[64:67], a[128:131], a[224:227], v[64:67]
v_exp_f32 v51, v51
v_mfma_f32_16x16x32_bf16 v[64:67], a[144:147], a[228:231], v[64:67]
v_exp_f32 v52, v52
v_mfma_f32_16x16x32_bf16 v[68:71], a[132:135], a[224:227], v[68:71]
v_exp_f32 v53, v53
v_mfma_f32_16x16x32_bf16 v[68:71], a[148:151], a[228:231], v[68:71]
ds_read_b128 a[212:215], v4 offset:18432
v_mfma_f32_16x16x32_bf16 v[72:75], a[136:139], a[224:227], v[72:75]
v_exp_f32 v54, v54
v_mfma_f32_16x16x32_bf16 v[72:75], a[152:155], a[228:231], v[72:75]
v_exp_f32 v55, v55
v_mfma_f32_16x16x32_bf16 v[76:79], a[140:143], a[224:227], v[76:79]
v_mul_f32 v148, v132, v148
v_mul_f32 v149, v133, v149
v_mfma_f32_16x16x32_bf16 v[76:79], a[156:159], a[228:231], v[76:79]
s_waitcnt lgkmcnt(2)
ds_read_b128 a[216:219], v3 offset:22528
v_mul_f32 v150, v134, v150
v_mfma_f32_16x16x32_bf16 v[108:111], a[140:143], a[232:235], v[108:111]
v_mul_f32 v151, v135, v151
v_mul_f32 v180, v164, v180
v_mfma_f32_16x16x32_bf16 v[108:111], a[156:159], a[236:239], v[108:111]
v_mul_f32 v181, v165, v181
v_mul_f32 v182, v166, v182
v_mfma_f32_16x16x32_bf16 v[104:107], a[136:139], a[232:235], v[104:107]
v_mul_f32 v183, v167, v183
v_add_f32 v48, 1.0, v48
v_mfma_f32_16x16x32_bf16 v[104:107], a[152:155], a[236:239], v[104:107]
ds_read_b128 a[220:223], v4 offset:22528
v_add_f32 v49, 1.0, v49
v_mfma_f32_16x16x32_bf16 v[100:103], a[132:135], a[232:235], v[100:103]
v_add_f32 v50, 1.0, v50
v_add_f32 v51, 1.0, v51
v_mfma_f32_16x16x32_bf16 v[100:103], a[148:151], a[236:239], v[100:103]
v_add_f32 v52, 1.0, v52
v_add_f32 v53, 1.0, v53
v_mfma_f32_16x16x32_bf16 v[96:99], a[128:131], a[232:235], v[96:99]
v_add_f32 v54, 1.0, v54
v_add_f32 v55, 1.0, v55
v_mfma_f32_16x16x32_bf16 v[96:99], a[144:147], a[236:239], v[96:99]
s_waitcnt lgkmcnt(2)
ds_read_b64_tr_b16 a[224:225], v5 offset:28736
ds_read_b64_tr_b16 a[226:227], v5 offset:30528
v_mfma_f32_16x16x32_bf16 v[80:83], a[128:131], a[208:211], v[80:83]
v_rcp_f32 v48, v48
v_mfma_f32_16x16x32_bf16 v[80:83], a[144:147], a[212:215], v[80:83]
v_rcp_f32 v49, v49
v_mfma_f32_16x16x32_bf16 v[84:87], a[132:135], a[208:211], v[84:87]
v_rcp_f32 v50, v50
v_mfma_f32_16x16x32_bf16 v[84:87], a[148:151], a[212:215], v[84:87]
s_waitcnt lgkmcnt(4)
ds_read_b64_tr_b16 a[228:229], v5 offset:35904
ds_read_b64_tr_b16 a[230:231], v5 offset:37696
v_mfma_f32_16x16x32_bf16 v[88:91], a[136:139], a[208:211], v[88:91]
v_rcp_f32 v51, v51
v_mfma_f32_16x16x32_bf16 v[88:91], a[152:155], a[212:215], v[88:91]
v_rcp_f32 v52, v52
v_mfma_f32_16x16x32_bf16 v[92:95], a[140:143], a[208:211], v[92:95]
v_rcp_f32 v53, v53
v_mfma_f32_16x16x32_bf16 v[92:95], a[156:159], a[212:215], v[92:95]
s_waitcnt lgkmcnt(4)
ds_read_b64_tr_b16 a[232:233], v5 offset:43072
ds_read_b64_tr_b16 a[234:235], v5 offset:44864
v_mfma_f32_16x16x32_bf16 v[124:127], a[140:143], a[216:219], v[124:127]
v_rcp_f32 v54, v54
v_mfma_f32_16x16x32_bf16 v[124:127], a[156:159], a[220:223], v[124:127]
v_rcp_f32 v55, v55
v_mfma_f32_16x16x32_bf16 v[120:123], a[136:139], a[216:219], v[120:123]
v_mul_f32 v148, v148, v48
v_mul_f32 v149, v149, v49
v_mfma_f32_16x16x32_bf16 v[120:123], a[152:155], a[220:223], v[120:123]
s_waitcnt lgkmcnt(6)
ds_read_b64_tr_b16 a[236:237], v5 offset:50240
ds_read_b64_tr_b16 a[238:239], v5 offset:52032
v_mfma_f32_16x16x32_bf16 v[116:119], a[132:135], a[216:219], v[116:119]
v_mul_f32 v150, v150, v50
v_mul_f32 v151, v151, v51
v_mfma_f32_16x16x32_bf16 v[116:119], a[148:151], a[220:223], v[116:119]
v_mul_f32 v180, v180, v52
v_mul_f32 v181, v181, v53
v_mfma_f32_16x16x32_bf16 v[112:115], a[128:131], a[216:219], v[112:115]
v_mul_f32 v182, v182, v54
v_mul_f32 v183, v183, v55
v_mfma_f32_16x16x32_bf16 v[112:115], a[144:147], a[220:223], v[112:115]
s_waitcnt lgkmcnt(4)
ds_read_b64_tr_b16 a[208:209], v5 offset:28768
ds_read_b64_tr_b16 a[210:211], v5 offset:30560
v_mfma_f32_16x16x32_bf16 v[192:195], a[224:227], a[192:195], v[192:195]
v_cvt_pk_bf16_f32 v60, v148, v149
v_cvt_pk_bf16_f32 v61, v150, v151
v_mfma_f32_16x16x32_bf16 v[192:195], a[228:231], a[96:99], v[192:195]
v_cvt_pk_bf16_f32 v62, v180, v181
v_cvt_pk_bf16_f32 v63, v182, v183
v_mfma_f32_16x16x32_bf16 v[196:199], a[224:227], a[196:199], v[196:199]
buffer_store_dwordx4 v[60:63], v1, s[32:35], s66 offen offset:1024 sc0 sc1
v_mfma_f32_16x16x32_bf16 v[196:199], a[228:231], a[100:103], v[196:199]
s_waitcnt lgkmcnt(6)
ds_read_b64_tr_b16 a[212:213], v5 offset:35936
ds_read_b64_tr_b16 a[214:215], v5 offset:37728
v_mfma_f32_16x16x32_bf16 v[200:203], a[224:227], a[200:203], v[200:203]
L_tr9:
s_cbranch_execz L_trret
v_accvgpr_write_b32 a116, v60
v_accvgpr_write_b32 a117, v61
v_mfma_f32_16x16x32_bf16 v[200:203], a[228:231], a[104:107], v[200:203]
v_accvgpr_write_b32 a118, v62
v_accvgpr_write_b32 a119, v63
v_mfma_f32_16x16x32_bf16 v[204:207], a[224:227], a[204:207], v[204:207]
v_mul_f32 v48, v136, v136
v_mul_f32 v49, v137, v137
v_mfma_f32_16x16x32_bf16 v[204:207], a[228:231], a[108:111], v[204:207]
s_waitcnt lgkmcnt(4)
ds_read_b64_tr_b16 a[216:217], v5 offset:43104
ds_read_b64_tr_b16 a[218:219], v5 offset:44896
v_mfma_f32_16x16x32_bf16 v[220:223], a[232:235], a[204:207], v[220:223]
v_mul_f32 v50, v138, v138
v_mul_f32 v51, v139, v139
v_mfma_f32_16x16x32_bf16 v[220:223], a[236:239], a[108:111], v[220:223]
v_mul_f32 v52, v168, v168
v_mul_f32 v53, v169, v169
v_mfma_f32_16x16x32_bf16 v[216:219], a[232:235], a[200:203], v[216:219]
v_mul_f32 v54, v170, v170
v_mul_f32 v55, v171, v171
v_mfma_f32_16x16x32_bf16 v[216:219], a[236:239], a[104:107], v[216:219]
s_waitcnt lgkmcnt(6)
ds_read_b64_tr_b16 a[220:221], v5 offset:50272
ds_read_b64_tr_b16 a[222:223], v5 offset:52064
v_mfma_f32_16x16x32_bf16 v[212:215], a[232:235], a[196:199], v[212:215]
v_fma_f32 v48, v48, v47, v46
v_fma_f32 v49, v49, v47, v46
v_mfma_f32_16x16x32_bf16 v[212:215], a[236:239], a[100:103], v[212:215]
v_fma_f32 v50, v50, v47, v46
v_fma_f32 v51, v51, v47, v46
v_mfma_f32_16x16x32_bf16 v[208:211], a[232:235], a[192:195], v[208:211]
v_fma_f32 v52, v52, v47, v46
v_fma_f32 v53, v53, v47, v46
v_mfma_f32_16x16x32_bf16 v[208:211], a[236:239], a[96:99], v[208:211]
s_waitcnt lgkmcnt(4)
ds_read_b64_tr_b16 a[224:225], v5 offset:28800
ds_read_b64_tr_b16 a[226:227], v5 offset:30592
v_mfma_f32_16x16x32_bf16 v[224:227], a[208:211], a[192:195], v[224:227]
v_fma_f32 v54, v54, v47, v46
v_fma_f32 v55, v55, v47, v46
v_mfma_f32_16x16x32_bf16 v[224:227], a[212:215], a[96:99], v[224:227]
v_mul_f32 v48, v48, v136
v_mul_f32 v49, v49, v137
v_mfma_f32_16x16x32_bf16 v[228:231], a[208:211], a[196:199], v[228:231]
v_mul_f32 v50, v50, v138
v_mul_f32 v51, v51, v139
v_mfma_f32_16x16x32_bf16 v[228:231], a[212:215], a[100:103], v[228:231]
s_waitcnt lgkmcnt(6)
ds_read_b64_tr_b16 a[228:229], v5 offset:35968
ds_read_b64_tr_b16 a[230:231], v5 offset:37760
v_mfma_f32_16x16x32_bf16 v[232:235], a[208:211], a[200:203], v[232:235]
v_mul_f32 v52, v52, v168
v_mul_f32 v53, v53, v169
v_mfma_f32_16x16x32_bf16 v[232:235], a[212:215], a[104:107], v[232:235]
v_mul_f32 v54, v54, v170
v_mul_f32 v55, v55, v171
v_mfma_f32_16x16x32_bf16 v[236:239], a[208:211], a[204:207], v[236:239]
v_exp_f32 v48, v48
v_mfma_f32_16x16x32_bf16 v[236:239], a[212:215], a[108:111], v[236:239]
s_waitcnt lgkmcnt(4)
ds_read_b64_tr_b16 a[232:233], v5 offset:43136
ds_read_b64_tr_b16 a[234:235], v5 offset:44928
v_mfma_f32_16x16x32_bf16 v[252:255], a[216:219], a[204:207], v[252:255]
v_exp_f32 v49, v49
v_mfma_f32_16x16x32_bf16 v[252:255], a[220:223], a[108:111], v[252:255]
v_exp_f32 v50, v50
v_mfma_f32_16x16x32_bf16 v[248:251], a[216:219], a[200:203], v[248:251]
v_exp_f32 v51, v51
v_mfma_f32_16x16x32_bf16 v[248:251], a[220:223], a[104:107], v[248:251]
s_waitcnt lgkmcnt(6)
ds_read_b64_tr_b16 a[236:237], v5 offset:50304
ds_read_b64_tr_b16 a[238:239], v5 offset:52096
v_mfma_f32_16x16x32_bf16 v[244:247], a[216:219], a[196:199], v[244:247]
v_exp_f32 v52, v52
v_mfma_f32_16x16x32_bf16 v[244:247], a[220:223], a[100:103], v[244:247]
v_exp_f32 v53, v53
v_mfma_f32_16x16x32_bf16 v[240:243], a[216:219], a[192:195], v[240:243]
v_exp_f32 v54, v54
v_mfma_f32_16x16x32_bf16 v[240:243], a[220:223], a[96:99], v[240:243]
s_waitcnt lgkmcnt(4)
ds_read_b64_tr_b16 a[208:209], v5 offset:28832
ds_read_b64_tr_b16 a[210:211], v5 offset:30624
v_mfma_f32_16x16x32_bf16 a[0:3], a[224:227], a[192:195], a[0:3]
v_exp_f32 v55, v55
v_mfma_f32_16x16x32_bf16 a[0:3], a[228:231], a[96:99], a[0:3]
v_mul_f32 v152, v136, v152
v_mul_f32 v153, v137, v153
v_mfma_f32_16x16x32_bf16 a[4:7], a[224:227], a[196:199], a[4:7]
v_mul_f32 v154, v138, v154
v_mul_f32 v155, v139, v155
v_mfma_f32_16x16x32_bf16 a[4:7], a[228:231], a[100:103], a[4:7]
s_waitcnt lgkmcnt(6)
ds_read_b64_tr_b16 a[212:213], v5 offset:36000
ds_read_b64_tr_b16 a[214:215], v5 offset:37792
v_mfma_f32_16x16x32_bf16 a[8:11], a[224:227], a[200:203], a[8:11]
v_mul_f32 v184, v168, v184
v_mul_f32 v185, v169, v185
v_mfma_f32_16x16x32_bf16 a[8:11], a[228:231], a[104:107], a[8:11]
v_mul_f32 v186, v170, v186
v_mul_f32 v187, v171, v187
v_mfma_f32_16x16x32_bf16 a[12:15], a[224:227], a[204:207], a[12:15]
v_add_f32 v48, 1.0, v48
v_add_f32 v49, 1.0, v49
v_mfma_f32_16x16x32_bf16 a[12:15], a[228:231], a[108:111], a[12:15]
s_waitcnt lgkmcnt(4)
ds_read_b64_tr_b16 a[216:217], v5 offset:43168
ds_read_b64_tr_b16 a[218:219], v5 offset:44960
v_mfma_f32_16x16x32_bf16 a[28:31], a[232:235], a[204:207], a[28:31]
v_add_f32 v50, 1.0, v50
v_add_f32 v51, 1.0, v51
v_mfma_f32_16x16x32_bf16 a[28:31], a[236:239], a[108:111], a[28:31]
v_add_f32 v52, 1.0, v52
v_add_f32 v53, 1.0, v53
v_mfma_f32_16x16x32_bf16 a[24:27], a[232:235], a[200:203], a[24:27]
v_add_f32 v54, 1.0, v54
v_add_f32 v55, 1.0, v55
v_mfma_f32_16x16x32_bf16 a[24:27], a[236:239], a[104:107], a[24:27]
s_waitcnt lgkmcnt(6)
ds_read_b64_tr_b16 a[220:221], v5 offset:50336
ds_read_b64_tr_b16 a[222:223], v5 offset:52128
v_mfma_f32_16x16x32_bf16 a[20:23], a[232:235], a[196:199], a[20:23]
v_rcp_f32 v48, v48
v_mfma_f32_16x16x32_bf16 a[20:23], a[236:239], a[100:103], a[20:23]
v_rcp_f32 v49, v49
v_mfma_f32_16x16x32_bf16 a[16:19], a[232:235], a[192:195], a[16:19]
v_rcp_f32 v50, v50
v_mfma_f32_16x16x32_bf16 a[16:19], a[236:239], a[96:99], a[16:19]
s_waitcnt lgkmcnt(4)
ds_read_b64_tr_b16 a[224:225], v5 offset:28864
ds_read_b64_tr_b16 a[226:227], v5 offset:30656
v_mfma_f32_16x16x32_bf16 a[32:35], a[208:211], a[192:195], a[32:35]
v_rcp_f32 v51, v51
v_mfma_f32_16x16x32_bf16 a[32:35], a[212:215], a[96:99], a[32:35]
v_rcp_f32 v52, v52
v_mfma_f32_16x16x32_bf16 a[36:39], a[208:211], a[196:199], a[36:39]
v_rcp_f32 v53, v53
v_mfma_f32_16x16x32_bf16 a[36:39], a[212:215], a[100:103], a[36:39]
s_waitcnt lgkmcnt(6)
ds_read_b64_tr_b16 a[228:229], v5 offset:36032
ds_read_b64_tr_b16 a[230:231], v5 offset:37824
v_mfma_f32_16x16x32_bf16 a[40:43], a[208:211], a[200:203], a[40:43]
v_rcp_f32 v54, v54
v_mfma_f32_16x16x32_bf16 a[40:43], a[212:215], a[104:107], a[40:43]
v_rcp_f32 v55, v55
v_mfma_f32_16x16x32_bf16 a[44:47], a[208:211], a[204:207], a[44:47]
v_mul_f32 v152, v152, v48
v_mul_f32 v153, v153, v49
v_mfma_f32_16x16x32_bf16 a[44:47], a[212:215], a[108:111], a[44:47]
s_waitcnt lgkmcnt(4)
ds_read_b64_tr_b16 a[232:233], v5 offset:43200
ds_read_b64_tr_b16 a[234:235], v5 offset:44992
v_mfma_f32_16x16x32_bf16 a[60:63], a[216:219], a[204:207], a[60:63]
v_mul_f32 v154, v154, v50
v_mul_f32 v155, v155, v51
v_mfma_f32_16x16x32_bf16 a[60:63], a[220:223], a[108:111], a[60:63]
v_mul_f32 v184, v184, v52
v_mul_f32 v185, v185, v53
v_mfma_f32_16x16x32_bf16 a[56:59], a[216:219], a[200:203], a[56:59]
v_mul_f32 v186, v186, v54
v_mul_f32 v187, v187, v55
v_mfma_f32_16x16x32_bf16 a[56:59], a[220:223], a[104:107], a[56:59]
s_waitcnt lgkmcnt(6)
ds_read_b64_tr_b16 a[236:237], v5 offset:50368
ds_read_b64_tr_b16 a[238:239], v5 offset:52160
v_mfma_f32_16x16x32_bf16 a[52:55], a[216:219], a[196:199], a[52:55]
v_cvt_pk_bf16_f32 v56, v152, v153
v_cvt_pk_bf16_f32 v57, v154, v155
v_mfma_f32_16x16x32_bf16 a[52:55], a[220:223], a[100:103], a[52:55]
v_cvt_pk_bf16_f32 v58, v184, v185
v_cvt_pk_bf16_f32 v59, v186, v187
v_mfma_f32_16x16x32_bf16 a[48:51], a[216:219], a[192:195], a[48:51]
buffer_store_dwordx4 v[56:59], v1, s[32:35], s66 offen offset:2048 sc0 sc1
v_mfma_f32_16x16x32_bf16 a[48:51], a[220:223], a[96:99], a[48:51]
s_waitcnt lgkmcnt(4)
ds_read_b128 a[208:211], v3 offset:24576
v_accvgpr_write_b32 a120, v56
v_mfma_f32_16x16x32_bf16 a[64:67], a[224:227], a[192:195], a[64:67]
v_accvgpr_write_b32 a121, v57
v_accvgpr_write_b32 a122, v58
v_mfma_f32_16x16x32_bf16 a[64:67], a[228:231], a[96:99], a[64:67]
v_accvgpr_write_b32 a123, v59
v_mul_f32 v48, v140, v140
v_mfma_f32_16x16x32_bf16 a[68:71], a[224:227], a[196:199], a[68:71]
v_mul_f32 v49, v141, v141
v_mul_f32 v50, v142, v142
v_mfma_f32_16x16x32_bf16 a[68:71], a[228:231], a[100:103], a[68:71]
ds_read_b128 a[212:215], v4 offset:24576
v_mul_f32 v51, v143, v143
v_mfma_f32_16x16x32_bf16 a[72:75], a[224:227], a[200:203], a[72:75]
v_mul_f32 v52, v172, v172
v_mul_f32 v53, v173, v173
v_mfma_f32_16x16x32_bf16 a[72:75], a[228:231], a[104:107], a[72:75]
v_mul_f32 v54, v174, v174
v_mul_f32 v55, v175, v175
v_mfma_f32_16x16x32_bf16 a[76:79], a[224:227], a[204:207], a[76:79]
v_fma_f32 v48, v48, v47, v46
v_fma_f32 v49, v49, v47, v46
v_mfma_f32_16x16x32_bf16 a[76:79], a[228:231], a[108:111], a[76:79]
s_waitcnt lgkmcnt(2)
ds_read_b128 a[216:219], v3 offset:28672
v_fma_f32 v50, v50, v47, v46
v_mfma_f32_16x16x32_bf16 a[92:95], a[232:235], a[204:207], a[92:95]
v_fma_f32 v51, v51, v47, v46
v_fma_f32 v52, v52, v47, v46
v_mfma_f32_16x16x32_bf16 a[92:95], a[236:239], a[108:111], a[92:95]
v_fma_f32 v53, v53, v47, v46
v_fma_f32 v54, v54, v47, v46
v_mfma_f32_16x16x32_bf16 a[88:91], a[232:235], a[200:203], a[88:91]
v_fma_f32 v55, v55, v47, v46
v_mul_f32 v48, v48, v140
v_mfma_f32_16x16x32_bf16 a[88:91], a[236:239], a[104:107], a[88:91]
ds_read_b128 a[220:223], v4 offset:28672
v_mul_f32 v49, v49, v141
v_mfma_f32_16x16x32_bf16 a[84:87], a[232:235], a[196:199], a[84:87]
v_mul_f32 v50, v50, v142
v_mul_f32 v51, v51, v143
v_mfma_f32_16x16x32_bf16 a[84:87], a[236:239], a[100:103], a[84:87]
v_mul_f32 v52, v52, v172
v_mul_f32 v53, v53, v173
v_mfma_f32_16x16x32_bf16 a[80:83], a[232:235], a[192:195], a[80:83]
v_mul_f32 v54, v54, v174
v_mul_f32 v55, v55, v175
v_mfma_f32_16x16x32_bf16 a[80:83], a[236:239], a[96:99], a[80:83]
s_waitcnt lgkmcnt(2)
ds_read_b128 a[224:227], v3 offset:26624
v_mfma_f32_16x16x32_bf16 v[64:67], a[192:195], a[208:211], v[64:67]
v_exp_f32 v48, v48
v_mfma_f32_16x16x32_bf16 v[64:67], a[96:99], a[212:215], v[64:67]
v_exp_f32 v49, v49
v_mfma_f32_16x16x32_bf16 v[68:71], a[196:199], a[208:211], v[68:71]
v_exp_f32 v50, v50
v_mfma_f32_16x16x32_bf16 v[68:71], a[100:103], a[212:215], v[68:71]
ds_read_b128 a[228:231], v4 offset:26624
v_mfma_f32_16x16x32_bf16 v[72:75], a[200:203], a[208:211], v[72:75]
v_exp_f32 v51, v51
v_mfma_f32_16x16x32_bf16 v[72:75], a[104:107], a[212:215], v[72:75]
v_exp_f32 v52, v52
v_mfma_f32_16x16x32_bf16 v[76:79], a[204:207], a[208:211], v[76:79]
v_exp_f32 v53, v53
v_mfma_f32_16x16x32_bf16 v[76:79], a[108:111], a[212:215], v[76:79]
s_waitcnt lgkmcnt(2)
ds_read_b128 a[232:235], v3 offset:30720
v_mfma_f32_16x16x32_bf16 v[108:111], a[204:207], a[216:219], v[108:111]
v_exp_f32 v54, v54
v_mfma_f32_16x16x32_bf16 v[108:111], a[108:111], a[220:223], v[108:111]
v_exp_f32 v55, v55
v_mfma_f32_16x16x32_bf16 v[104:107], a[200:203], a[216:219], v[104:107]
v_mul_f32 v156, v140, v156
v_mul_f32 v157, v141, v157
v_mfma_f32_16x16x32_bf16 v[104:107], a[104:107], a[220:223], v[104:107]
ds_read_b128 a[236:239], v4 offset:30720
v_mul_f32 v158, v142, v158
v_mfma_f32_16x16x32_bf16 v[100:103], a[196:199], a[216:219], v[100:103]
v_mul_f32 v159, v143, v159
v_mul_f32 v188, v172, v188
v_mfma_f32_16x16x32_bf16 v[100:103], a[100:103], a[220:223], v[100:103]
v_mul_f32 v189, v173, v189
v_mul_f32 v190, v174, v190
v_mfma_f32_16x16x32_bf16 v[96:99], a[192:195], a[216:219], v[96:99]
v_mul_f32 v191, v175, v191
v_add_f32 v48, 1.0, v48
v_mfma_f32_16x16x32_bf16 v[96:99], a[96:99], a[220:223], v[96:99]
s_waitcnt lgkmcnt(2)
v_add_f32 v49, 1.0, v49
v_add_f32 v50, 1.0, v50
v_mfma_f32_16x16x32_bf16 v[80:83], a[192:195], a[224:227], v[80:83]
v_add_f32 v51, 1.0, v51
v_add_f32 v52, 1.0, v52
v_mfma_f32_16x16x32_bf16 v[80:83], a[96:99], a[228:231], v[80:83]
v_add_f32 v53, 1.0, v53
v_add_f32 v54, 1.0, v54
v_mfma_f32_16x16x32_bf16 v[84:87], a[196:199], a[224:227], v[84:87]
v_add_f32 v55, 1.0, v55
v_mfma_f32_16x16x32_bf16 v[84:87], a[100:103], a[228:231], v[84:87]
v_rcp_f32 v48, v48
v_mfma_f32_16x16x32_bf16 v[88:91], a[200:203], a[224:227], v[88:91]
v_rcp_f32 v49, v49
v_mfma_f32_16x16x32_bf16 v[88:91], a[104:107], a[228:231], v[88:91]
v_rcp_f32 v50, v50
v_mfma_f32_16x16x32_bf16 v[92:95], a[204:207], a[224:227], v[92:95]
v_rcp_f32 v51, v51
v_mfma_f32_16x16x32_bf16 v[92:95], a[108:111], a[228:231], v[92:95]
s_waitcnt lgkmcnt(0)
v_rcp_f32 v52, v52
v_mfma_f32_16x16x32_bf16 v[124:127], a[204:207], a[232:235], v[124:127]
v_rcp_f32 v53, v53
v_mfma_f32_16x16x32_bf16 v[124:127], a[108:111], a[236:239], v[124:127]
v_rcp_f32 v54, v54
v_mfma_f32_16x16x32_bf16 v[120:123], a[200:203], a[232:235], v[120:123]
v_rcp_f32 v55, v55
v_mfma_f32_16x16x32_bf16 v[120:123], a[104:107], a[236:239], v[120:123]
v_mul_f32 v156, v156, v48
v_mul_f32 v157, v157, v49
v_mfma_f32_16x16x32_bf16 v[116:119], a[196:199], a[232:235], v[116:119]
v_mul_f32 v158, v158, v50
v_mul_f32 v159, v159, v51
v_mfma_f32_16x16x32_bf16 v[116:119], a[100:103], a[236:239], v[116:119]
v_mul_f32 v188, v188, v52
v_mul_f32 v189, v189, v53
v_mfma_f32_16x16x32_bf16 v[112:115], a[192:195], a[232:235], v[112:115]
v_mul_f32 v190, v190, v54
v_mul_f32 v191, v191, v55
v_mfma_f32_16x16x32_bf16 v[112:115], a[96:99], a[236:239], v[112:115]
v_cvt_pk_bf16_f32 v60, v156, v157
v_cvt_pk_bf16_f32 v61, v158, v159
L_epi:
s_barrier
v_cvt_pk_bf16_f32 v62, v188, v189
v_cvt_pk_bf16_f32 v63, v190, v191
buffer_store_dwordx4 v[60:63], v1, s[32:35], s66 offen offset:3072 sc0 sc1
v_accvgpr_write_b32 a124, v60
v_accvgpr_write_b32 a125, v61
v_accvgpr_write_b32 a126, v62
v_accvgpr_write_b32 a127, v63
v_mov_b32 v4, s3
s_add_u32 s55, s99, 4096
s_lshl_b32 s55, s55, 4
s_add_u32 m0, s54, 65536
s_nop 0
buffer_load_dwordx4 v14, s[12:15], s55 offen lds
s_add_u32 m0, s54, 69632
s_nop 0
buffer_load_dwordx4 v11, s[12:15], s55 offen lds
s_lshl_b32 s55, s48, 4
s_add_u32 m0, s54, 73728
s_nop 0
buffer_load_dwordx4 v14, s[12:15], s55 offen lds
s_add_u32 m0, s54, 77824
s_nop 0
buffer_load_dwordx4 v11, s[12:15], s55 offen lds
s_add_u32 s66, s66, 4096
v_pk_mul_f32 v[48:49], v[192:193], v[192:193]
v_pk_mul_f32 v[50:51], v[194:195], v[194:195]
v_pk_mul_f32 v[52:53], v[224:225], v[224:225]
v_pk_mul_f32 v[54:55], v[226:227], v[226:227]
v_pk_fma_f32 v[48:49], v[48:49], v[46:47], v[46:47] op_sel:[0,1,0] op_sel_hi:[1,1,0]
v_pk_fma_f32 v[50:51], v[50:51], v[46:47], v[46:47] op_sel:[0,1,0] op_sel_hi:[1,1,0]
v_pk_fma_f32 v[52:53], v[52:53], v[46:47], v[46:47] op_sel:[0,1,0] op_sel_hi:[1,1,0]
v_pk_fma_f32 v[54:55], v[54:55], v[46:47], v[46:47] op_sel:[0,1,0] op_sel_hi:[1,1,0]
v_pk_mul_f32 v[48:49], v[48:49], v[192:193]
v_pk_mul_f32 v[50:51], v[50:51], v[194:195]
v_pk_mul_f32 v[52:53], v[52:53], v[224:225]
v_pk_mul_f32 v[54:55], v[54:55], v[226:227]
v_exp_f32 v48, v48
v_exp_f32 v49, v49
v_pk_mul_f32 v[208:209], v[192:193], v[208:209]
v_exp_f32 v50, v50
v_exp_f32 v51, v51
v_pk_mul_f32 v[210:211], v[194:195], v[210:211]
v_exp_f32 v52, v52
v_exp_f32 v53, v53
v_pk_mul_f32 v[240:241], v[224:225], v[240:241]
v_exp_f32 v54, v54
v_exp_f32 v55, v55
v_pk_mul_f32 v[242:243], v[226:227], v[242:243]
v_pk_add_f32 v[48:49], v[48:49], 1.0 op_sel_hi:[1,0]
v_pk_add_f32 v[50:51], v[50:51], 1.0 op_sel_hi:[1,0]
v_pk_add_f32 v[52:53], v[52:53], 1.0 op_sel_hi:[1,0]
v_pk_add_f32 v[54:55], v[54:55], 1.0 op_sel_hi:[1,0]
v_rcp_f32 v48, v48
v_rcp_f32 v49, v49
v_rcp_f32 v50, v50
v_rcp_f32 v51, v51
v_rcp_f32 v52, v52
v_rcp_f32 v53, v53
v_rcp_f32 v54, v54
v_rcp_f32 v55, v55
v_pk_mul_f32 v[208:209], v[208:209], v[48:49]
v_pk_mul_f32 v[210:211], v[210:211], v[50:51]
v_pk_mul_f32 v[240:241], v[240:241], v[52:53]
v_pk_mul_f32 v[242:243], v[242:243], v[54:55]
v_cvt_pk_bf16_f32 v56, v208, v209
v_cvt_pk_bf16_f32 v57, v210, v211
v_cvt_pk_bf16_f32 v58, v240, v241
v_cvt_pk_bf16_f32 v59, v242, v243
buffer_store_dwordx4 v[56:59], v1, s[32:35], s66 offen offset:0 sc0 sc1
v_accvgpr_write_b32 a96, v56
v_accvgpr_write_b32 a97, v57
v_accvgpr_write_b32 a98, v58
v_accvgpr_write_b32 a99, v59
s_add_u32 s55, s48, 4096
s_lshl_b32 s55, s55, 4
s_add_u32 m0, s54, 81920
s_nop 0
buffer_load_dwordx4 v14, s[12:15], s55 offen lds
v_pk_mul_f32 v[48:49], v[196:197], v[196:197]
v_pk_mul_f32 v[50:51], v[198:199], v[198:199]
v_pk_mul_f32 v[52:53], v[228:229], v[228:229]
v_pk_mul_f32 v[54:55], v[230:231], v[230:231]
v_pk_fma_f32 v[48:49], v[48:49], v[46:47], v[46:47] op_sel:[0,1,0] op_sel_hi:[1,1,0]
v_pk_fma_f32 v[50:51], v[50:51], v[46:47], v[46:47] op_sel:[0,1,0] op_sel_hi:[1,1,0]
v_pk_fma_f32 v[52:53], v[52:53], v[46:47], v[46:47] op_sel:[0,1,0] op_sel_hi:[1,1,0]
v_pk_fma_f32 v[54:55], v[54:55], v[46:47], v[46:47] op_sel:[0,1,0] op_sel_hi:[1,1,0]
v_pk_mul_f32 v[48:49], v[48:49], v[196:197]
v_pk_mul_f32 v[50:51], v[50:51], v[198:199]
v_pk_mul_f32 v[52:53], v[52:53], v[228:229]
v_pk_mul_f32 v[54:55], v[54:55], v[230:231]
v_exp_f32 v48, v48
v_exp_f32 v49, v49
v_pk_mul_f32 v[212:213], v[196:197], v[212:213]
v_exp_f32 v50, v50
v_exp_f32 v51, v51
v_pk_mul_f32 v[214:215], v[198:199], v[214:215]
v_exp_f32 v52, v52
v_exp_f32 v53, v53
v_pk_mul_f32 v[244:245], v[228:229], v[244:245]
v_exp_f32 v54, v54
v_exp_f32 v55, v55
v_pk_mul_f32 v[246:247], v[230:231], v[246:247]
v_pk_add_f32 v[48:49], v[48:49], 1.0 op_sel_hi:[1,0]
v_pk_add_f32 v[50:51], v[50:51], 1.0 op_sel_hi:[1,0]
v_pk_add_f32 v[52:53], v[52:53], 1.0 op_sel_hi:[1,0]
v_pk_add_f32 v[54:55], v[54:55], 1.0 op_sel_hi:[1,0]
v_rcp_f32 v48, v48
v_rcp_f32 v49, v49
v_rcp_f32 v50, v50
v_rcp_f32 v51, v51
v_rcp_f32 v52, v52
v_rcp_f32 v53, v53
v_rcp_f32 v54, v54
v_rcp_f32 v55, v55
v_pk_mul_f32 v[212:213], v[212:213], v[48:49]
v_pk_mul_f32 v[214:215], v[214:215], v[50:51]
v_pk_mul_f32 v[244:245], v[244:245], v[52:53]
v_pk_mul_f32 v[246:247], v[246:247], v[54:55]
v_cvt_pk_bf16_f32 v60, v212, v213
v_cvt_pk_bf16_f32 v61, v214, v215
v_cvt_pk_bf16_f32 v62, v244, v245
v_cvt_pk_bf16_f32 v63, v246, v247
buffer_store_dwordx4 v[60:63], v1, s[32:35], s66 offen offset:1024 sc0 sc1
v_accvgpr_write_b32 a100, v60
v_accvgpr_write_b32 a101, v61
v_accvgpr_write_b32 a102, v62
v_accvgpr_write_b32 a103, v63
s_add_u32 m0, s54, 86016
s_nop 0
buffer_load_dwordx4 v11, s[12:15], s55 offen lds
s_waitcnt vmcnt(8)
s_mov_b64 exec, 1
buffer_store_dword v4, v1, s[36:39], s81 offen offset:96 sc0 sc1
s_mov_b64 exec, -1
v_pk_mul_f32 v[48:49], v[200:201], v[200:201]
v_pk_mul_f32 v[50:51], v[202:203], v[202:203]
v_pk_mul_f32 v[52:53], v[232:233], v[232:233]
v_pk_mul_f32 v[54:55], v[234:235], v[234:235]
v_pk_fma_f32 v[48:49], v[48:49], v[46:47], v[46:47] op_sel:[0,1,0] op_sel_hi:[1,1,0]
v_pk_fma_f32 v[50:51], v[50:51], v[46:47], v[46:47] op_sel:[0,1,0] op_sel_hi:[1,1,0]
v_pk_fma_f32 v[52:53], v[52:53], v[46:47], v[46:47] op_sel:[0,1,0] op_sel_hi:[1,1,0]
v_pk_fma_f32 v[54:55], v[54:55], v[46:47], v[46:47] op_sel:[0,1,0] op_sel_hi:[1,1,0]
v_pk_mul_f32 v[48:49], v[48:49], v[200:201]
v_pk_mul_f32 v[50:51], v[50:51], v[202:203]
v_pk_mul_f32 v[52:53], v[52:53], v[232:233]
v_pk_mul_f32 v[54:55], v[54:55], v[234:235]
v_exp_f32 v48, v48
v_exp_f32 v49, v49
v_pk_mul_f32 v[216:217], v[200:201], v[216:217]
v_exp_f32 v50, v50
v_exp_f32 v51, v51
v_pk_mul_f32 v[218:219], v[202:203], v[218:219]
v_exp_f32 v52, v52
v_exp_f32 v53, v53
v_pk_mul_f32 v[248:249], v[232:233], v[248:249]
v_exp_f32 v54, v54
v_exp_f32 v55, v55
v_pk_mul_f32 v[250:251], v[234:235], v[250:251]
v_pk_add_f32 v[48:49], v[48:49], 1.0 op_sel_hi:[1,0]
v_pk_add_f32 v[50:51], v[50:51], 1.0 op_sel_hi:[1,0]
v_pk_add_f32 v[52:53], v[52:53], 1.0 op_sel_hi:[1,0]
v_pk_add_f32 v[54:55], v[54:55], 1.0 op_sel_hi:[1,0]
v_rcp_f32 v48, v48
v_rcp_f32 v49, v49
v_rcp_f32 v50, v50
v_rcp_f32 v51, v51
v_rcp_f32 v52, v52
v_rcp_f32 v53, v53
v_rcp_f32 v54, v54
v_rcp_f32 v55, v55
v_pk_mul_f32 v[216:217], v[216:217], v[48:49]
v_pk_mul_f32 v[218:219], v[218:219], v[50:51]
v_pk_mul_f32 v[248:249], v[248:249], v[52:53]
v_pk_mul_f32 v[250:251], v[250:251], v[54:55]
v_cvt_pk_bf16_f32 v56, v216, v217
v_cvt_pk_bf16_f32 v57, v218, v219
v_cvt_pk_bf16_f32 v58, v248, v249
v_cvt_pk_bf16_f32 v59, v250, v251
buffer_store_dwordx4 v[56:59], v1, s[32:35], s66 offen offset:2048 sc0 sc1
v_accvgpr_write_b32 a104, v56
v_accvgpr_write_b32 a105, v57
v_accvgpr_write_b32 a106, v58
v_accvgpr_write_b32 a107, v59
s_lshl_b32 s55, s49, 4
s_add_u32 m0, s54, 90112
s_nop 0
buffer_load_dwordx4 v14, s[12:15], s55 offen lds
v_pk_mul_f32 v[48:49], v[204:205], v[204:205]
v_pk_mul_f32 v[50:51], v[206:207], v[206:207]
v_pk_mul_f32 v[52:53], v[236:237], v[236:237]
v_pk_mul_f32 v[54:55], v[238:239], v[238:239]
v_pk_fma_f32 v[48:49], v[48:49], v[46:47], v[46:47] op_sel:[0,1,0] op_sel_hi:[1,1,0]
v_pk_fma_f32 v[50:51], v[50:51], v[46:47], v[46:47] op_sel:[0,1,0] op_sel_hi:[1,1,0]
v_pk_fma_f32 v[52:53], v[52:53], v[46:47], v[46:47] op_sel:[0,1,0] op_sel_hi:[1,1,0]
v_pk_fma_f32 v[54:55], v[54:55], v[46:47], v[46:47] op_sel:[0,1,0] op_sel_hi:[1,1,0]
v_pk_mul_f32 v[48:49], v[48:49], v[204:205]
v_pk_mul_f32 v[50:51], v[50:51], v[206:207]
v_pk_mul_f32 v[52:53], v[52:53], v[236:237]
v_pk_mul_f32 v[54:55], v[54:55], v[238:239]
v_exp_f32 v48, v48
v_exp_f32 v49, v49
v_pk_mul_f32 v[220:221], v[204:205], v[220:221]
v_exp_f32 v50, v50
v_exp_f32 v51, v51
v_pk_mul_f32 v[222:223], v[206:207], v[222:223]
v_exp_f32 v52, v52
v_exp_f32 v53, v53
v_pk_mul_f32 v[252:253], v[236:237], v[252:253]
v_exp_f32 v54, v54
v_exp_f32 v55, v55
v_pk_mul_f32 v[254:255], v[238:239], v[254:255]
v_pk_add_f32 v[48:49], v[48:49], 1.0 op_sel_hi:[1,0]
v_pk_add_f32 v[50:51], v[50:51], 1.0 op_sel_hi:[1,0]
v_pk_add_f32 v[52:53], v[52:53], 1.0 op_sel_hi:[1,0]
v_pk_add_f32 v[54:55], v[54:55], 1.0 op_sel_hi:[1,0]
v_rcp_f32 v48, v48
v_rcp_f32 v49, v49
v_rcp_f32 v50, v50
v_rcp_f32 v51, v51
v_rcp_f32 v52, v52
v_rcp_f32 v53, v53
v_rcp_f32 v54, v54
v_rcp_f32 v55, v55
v_pk_mul_f32 v[220:221], v[220:221], v[48:49]
v_pk_mul_f32 v[222:223], v[222:223], v[50:51]
v_pk_mul_f32 v[252:253], v[252:253], v[52:53]
v_pk_mul_f32 v[254:255], v[254:255], v[54:55]
v_cvt_pk_bf16_f32 v60, v220, v221
v_cvt_pk_bf16_f32 v61, v222, v223
v_cvt_pk_bf16_f32 v62, v252, v253
v_cvt_pk_bf16_f32 v63, v254, v255
buffer_store_dwordx4 v[60:63], v1, s[32:35], s66 offen offset:3072 sc0 sc1
v_accvgpr_write_b32 a108, v60
v_accvgpr_write_b32 a109, v61
v_accvgpr_write_b32 a110, v62
v_accvgpr_write_b32 a111, v63
s_add_u32 m0, s54, 94208
s_nop 0
buffer_load_dwordx4 v11, s[12:15], s55 offen lds
s_add_u32 s66, s66, 4096
v_pk_mul_f32 v[128:129], v[22:23], v[96:97] op_sel:[0,0] op_sel_hi:[0,1] neg_lo:[1,0] neg_hi:[1,0]
v_pk_mul_f32 v[96:97], v[20:21], v[96:97] op_sel:[0,0] op_sel_hi:[0,1] neg_lo:[1,0] neg_hi:[1,0]
v_pk_mul_f32 v[130:131], v[22:23], v[112:113] op_sel:[1,0] op_sel_hi:[1,1] neg_lo:[1,0] neg_hi:[1,0]
v_pk_mul_f32 v[112:113], v[20:21], v[112:113] op_sel:[1,0] op_sel_hi:[1,1] neg_lo:[1,0] neg_hi:[1,0]
v_pk_fma_f32 v[96:97], v[22:23], v[64:65], v[96:97] op_sel:[0,0,0] op_sel_hi:[0,1,1] neg_lo:[1,0,0] neg_hi:[1,0,0]
v_pk_fma_f32 v[64:65], v[20:21], v[64:65], v[128:129] op_sel:[0,0,0] op_sel_hi:[0,1,1]
v_pk_fma_f32 v[112:113], v[22:23], v[80:81], v[112:113] op_sel:[1,0,0] op_sel_hi:[1,1,1] neg_lo:[1,0,0] neg_hi:[1,0,0]
v_pk_fma_f32 v[80:81], v[20:21], v[80:81], v[130:131] op_sel:[1,0,0] op_sel_hi:[1,1,1]
v_pk_mul_f32 v[128:129], v[22:23], v[98:99] op_sel:[0,0] op_sel_hi:[0,1] neg_lo:[1,0] neg_hi:[1,0]
v_pk_mul_f32 v[98:99], v[20:21], v[98:99] op_sel:[0,0] op_sel_hi:[0,1] neg_lo:[1,0] neg_hi:[1,0]
v_pk_mul_f32 v[130:131], v[22:23], v[114:115] op_sel:[1,0] op_sel_hi:[1,1] neg_lo:[1,0] neg_hi:[1,0]
v_pk_mul_f32 v[114:115], v[20:21], v[114:115] op_sel:[1,0] op_sel_hi:[1,1] neg_lo:[1,0] neg_hi:[1,0]
v_pk_fma_f32 v[98:99], v[22:23], v[66:67], v[98:99] op_sel:[0,0,0] op_sel_hi:[0,1,1] neg_lo:[1,0,0] neg_hi:[1,0,0]
v_pk_fma_f32 v[66:67], v[20:21], v[66:67], v[128:129] op_sel:[0,0,0] op_sel_hi:[0,1,1]
v_pk_fma_f32 v[114:115], v[22:23], v[82:83], v[114:115] op_sel:[1,0,0] op_sel_hi:[1,1,1] neg_lo:[1,0,0] neg_hi:[1,0,0]
v_pk_fma_f32 v[82:83], v[20:21], v[82:83], v[130:131] op_sel:[1,0,0] op_sel_hi:[1,1,1]
v_pk_mul_f32 v[128:129], v[22:23], v[100:101] op_sel:[0,0] op_sel_hi:[0,1] neg_lo:[1,0] neg_hi:[1,0]
v_pk_mul_f32 v[100:101], v[20:21], v[100:101] op_sel:[0,0] op_sel_hi:[0,1] neg_lo:[1,0] neg_hi:[1,0]
v_pk_mul_f32 v[130:131], v[22:23], v[116:117] op_sel:[1,0] op_sel_hi:[1,1] neg_lo:[1,0] neg_hi:[1,0]
v_pk_mul_f32 v[116:117], v[20:21], v[116:117] op_sel:[1,0] op_sel_hi:[1,1] neg_lo:[1,0] neg_hi:[1,0]
v_pk_fma_f32 v[100:101], v[22:23], v[68:69], v[100:101] op_sel:[0,0,0] op_sel_hi:[0,1,1] neg_lo:[1,0,0] neg_hi:[1,0,0]
v_pk_fma_f32 v[68:69], v[20:21], v[68:69], v[128:129] op_sel:[0,0,0] op_sel_hi:[0,1,1]
v_pk_fma_f32 v[116:117], v[22:23], v[84:85], v[116:117] op_sel:[1,0,0] op_sel_hi:[1,1,1] neg_lo:[1,0,0] neg_hi:[1,0,0]
v_pk_fma_f32 v[84:85], v[20:21], v[84:85], v[130:131] op_sel:[1,0,0] op_sel_hi:[1,1,1]
v_pk_mul_f32 v[128:129], v[22:23], v[102:103] op_sel:[0,0] op_sel_hi:[0,1] neg_lo:[1,0] neg_hi:[1,0]
v_pk_mul_f32 v[102:103], v[20:21], v[102:103] op_sel:[0,0] op_sel_hi:[0,1] neg_lo:[1,0] neg_hi:[1,0]
v_pk_mul_f32 v[130:131], v[22:23], v[118:119] op_sel:[1,0] op_sel_hi:[1,1] neg_lo:[1,0] neg_hi:[1,0]
v_pk_mul_f32 v[118:119], v[20:21], v[118:119] op_sel:[1,0] op_sel_hi:[1,1] neg_lo:[1,0] neg_hi:[1,0]
v_pk_fma_f32 v[102:103], v[22:23], v[70:71], v[102:103] op_sel:[0,0,0] op_sel_hi:[0,1,1] neg_lo:[1,0,0] neg_hi:[1,0,0]
v_pk_fma_f32 v[70:71], v[20:21], v[70:71], v[128:129] op_sel:[0,0,0] op_sel_hi:[0,1,1]
v_pk_fma_f32 v[118:119], v[22:23], v[86:87], v[118:119] op_sel:[1,0,0] op_sel_hi:[1,1,1] neg_lo:[1,0,0] neg_hi:[1,0,0]
v_pk_fma_f32 v[86:87], v[20:21], v[86:87], v[130:131] op_sel:[1,0,0] op_sel_hi:[1,1,1]
v_pk_mul_f32 v[128:129], v[22:23], v[104:105] op_sel:[0,0] op_sel_hi:[0,1] neg_lo:[1,0] neg_hi:[1,0]
v_pk_mul_f32 v[104:105], v[20:21], v[104:105] op_sel:[0,0] op_sel_hi:[0,1] neg_lo:[1,0] neg_hi:[1,0]
v_pk_mul_f32 v[130:131], v[22:23], v[120:121] op_sel:[1,0] op_sel_hi:[1,1] neg_lo:[1,0] neg_hi:[1,0]
v_pk_mul_f32 v[120:121], v[20:21], v[120:121] op_sel:[1,0] op_sel_hi:[1,1] neg_lo:[1,0] neg_hi:[1,0]
v_pk_fma_f32 v[104:105], v[22:23], v[72:73], v[104:105] op_sel:[0,0,0] op_sel_hi:[0,1,1] neg_lo:[1,0,0] neg_hi:[1,0,0]
v_pk_fma_f32 v[72:73], v[20:21], v[72:73], v[128:129] op_sel:[0,0,0] op_sel_hi:[0,1,1]
v_pk_fma_f32 v[120:121], v[22:23], v[88:89], v[120:121] op_sel:[1,0,0] op_sel_hi:[1,1,1] neg_lo:[1,0,0] neg_hi:[1,0,0]
v_pk_fma_f32 v[88:89], v[20:21], v[88:89], v[130:131] op_sel:[1,0,0] op_sel_hi:[1,1,1]
v_pk_mul_f32 v[128:129], v[22:23], v[106:107] op_sel:[0,0] op_sel_hi:[0,1] neg_lo:[1,0] neg_hi:[1,0]
v_pk_mul_f32 v[106:107], v[20:21], v[106:107] op_sel:[0,0] op_sel_hi:[0,1] neg_lo:[1,0] neg_hi:[1,0]
v_pk_mul_f32 v[130:131], v[22:23], v[122:123] op_sel:[1,0] op_sel_hi:[1,1] neg_lo:[1,0] neg_hi:[1,0]
v_pk_mul_f32 v[122:123], v[20:21], v[122:123] op_sel:[1,0] op_sel_hi:[1,1] neg_lo:[1,0] neg_hi:[1,0]
v_pk_fma_f32 v[106:107], v[22:23], v[74:75], v[106:107] op_sel:[0,0,0] op_sel_hi:[0,1,1] neg_lo:[1,0,0] neg_hi:[1,0,0]
v_pk_fma_f32 v[74:75], v[20:21], v[74:75], v[128:129] op_sel:[0,0,0] op_sel_hi:[0,1,1]
v_pk_fma_f32 v[122:123], v[22:23], v[90:91], v[122:123] op_sel:[1,0,0] op_sel_hi:[1,1,1] neg_lo:[1,0,0] neg_hi:[1,0,0]
v_pk_fma_f32 v[90:91], v[20:21], v[90:91], v[130:131] op_sel:[1,0,0] op_sel_hi:[1,1,1]
v_pk_mul_f32 v[128:129], v[22:23], v[108:109] op_sel:[0,0] op_sel_hi:[0,1] neg_lo:[1,0] neg_hi:[1,0]
v_pk_mul_f32 v[108:109], v[20:21], v[108:109] op_sel:[0,0] op_sel_hi:[0,1] neg_lo:[1,0] neg_hi:[1,0]
v_pk_mul_f32 v[130:131], v[22:23], v[124:125] op_sel:[1,0] op_sel_hi:[1,1] neg_lo:[1,0] neg_hi:[1,0]
v_pk_mul_f32 v[124:125], v[20:21], v[124:125] op_sel:[1,0] op_sel_hi:[1,1] neg_lo:[1,0] neg_hi:[1,0]
v_pk_fma_f32 v[108:109], v[22:23], v[76:77], v[108:109] op_sel:[0,0,0] op_sel_hi:[0,1,1] neg_lo:[1,0,0] neg_hi:[1,0,0]
v_pk_fma_f32 v[76:77], v[20:21], v[76:77], v[128:129] op_sel:[0,0,0] op_sel_hi:[0,1,1]
v_pk_fma_f32 v[124:125], v[22:23], v[92:93], v[124:125] op_sel:[1,0,0] op_sel_hi:[1,1,1] neg_lo:[1,0,0] neg_hi:[1,0,0]
v_pk_fma_f32 v[92:93], v[20:21], v[92:93], v[130:131] op_sel:[1,0,0] op_sel_hi:[1,1,1]
v_pk_mul_f32 v[128:129], v[22:23], v[110:111] op_sel:[0,0] op_sel_hi:[0,1] neg_lo:[1,0] neg_hi:[1,0]
v_pk_mul_f32 v[110:111], v[20:21], v[110:111] op_sel:[0,0] op_sel_hi:[0,1] neg_lo:[1,0] neg_hi:[1,0]
v_pk_mul_f32 v[130:131], v[22:23], v[126:127] op_sel:[1,0] op_sel_hi:[1,1] neg_lo:[1,0] neg_hi:[1,0]
v_pk_mul_f32 v[126:127], v[20:21], v[126:127] op_sel:[1,0] op_sel_hi:[1,1] neg_lo:[1,0] neg_hi:[1,0]
v_pk_fma_f32 v[110:111], v[22:23], v[78:79], v[110:111] op_sel:[0,0,0] op_sel_hi:[0,1,1] neg_lo:[1,0,0] neg_hi:[1,0,0]
v_pk_fma_f32 v[78:79], v[20:21], v[78:79], v[128:129] op_sel:[0,0,0] op_sel_hi:[0,1,1]
v_pk_fma_f32 v[126:127], v[22:23], v[94:95], v[126:127] op_sel:[1,0,0] op_sel_hi:[1,1,1] neg_lo:[1,0,0] neg_hi:[1,0,0]
v_pk_fma_f32 v[94:95], v[20:21], v[94:95], v[130:131] op_sel:[1,0,0] op_sel_hi:[1,1,1]
v_pk_fma_f32 v[134:135], v[16:17], v[64:65], v[66:67] op_sel:[0,0,0] op_sel_hi:[0,1,1]
L_tr10:
s_cbranch_execz L_trret
v_pk_fma_f32 v[140:141], v[16:17], v[80:81], v[82:83] op_sel:[1,0,0] op_sel_hi:[1,1,1]
v_pk_fma_f32 v[134:135], v[18:19], v[96:97], v[134:135] op_sel:[0,0,0] op_sel_hi:[0,1,1] neg_lo:[1,0,0] neg_hi:[1,0,0]
v_pk_fma_f32 v[140:141], v[18:19], v[112:113], v[140:141] op_sel:[1,0,0] op_sel_hi:[1,1,1] neg_lo:[1,0,0] neg_hi:[1,0,0]
v_pk_fma_f32 v[136:137], v[16:17], v[96:97], v[98:99] op_sel:[0,0,0] op_sel_hi:[0,1,1]
v_pk_fma_f32 v[142:143], v[16:17], v[112:113], v[114:115] op_sel:[1,0,0] op_sel_hi:[1,1,1]
v_pk_fma_f32 v[136:137], v[18:19], v[64:65], v[136:137] op_sel:[0,0,0] op_sel_hi:[0,1,1]
v_pk_fma_f32 v[142:143], v[18:19], v[80:81], v[142:143] op_sel:[1,0,0] op_sel_hi:[1,1,1]
s_add_u32 s55, s49, 4096
s_lshl_b32 s55, s55, 4
s_add_u32 m0, s54, 98304
s_nop 0
buffer_load_dwordx4 v14, s[12:15], s55 offen lds
v_pk_fma_f32 v[132:133], v[16:17], v[134:135], v[68:69] op_sel:[0,0,0] op_sel_hi:[0,1,1]
v_pk_fma_f32 v[138:139], v[16:17], v[140:141], v[84:85] op_sel:[1,0,0] op_sel_hi:[1,1,1]
v_pk_fma_f32 v[132:133], v[18:19], v[136:137], v[132:133] op_sel:[0,0,0] op_sel_hi:[0,1,1] neg_lo:[1,0,0] neg_hi:[1,0,0]
v_pk_fma_f32 v[138:139], v[18:19], v[142:143], v[138:139] op_sel:[1,0,0] op_sel_hi:[1,1,1] neg_lo:[1,0,0] neg_hi:[1,0,0]
v_pk_fma_f32 v[136:137], v[16:17], v[136:137], v[100:101] op_sel:[0,0,0] op_sel_hi:[0,1,1]
v_pk_fma_f32 v[142:143], v[16:17], v[142:143], v[116:117] op_sel:[1,0,0] op_sel_hi:[1,1,1]
v_pk_fma_f32 v[136:137], v[18:19], v[134:135], v[136:137] op_sel:[0,0,0] op_sel_hi:[0,1,1]
v_pk_fma_f32 v[142:143], v[18:19], v[140:141], v[142:143] op_sel:[1,0,0] op_sel_hi:[1,1,1]
v_pk_fma_f32 v[134:135], v[16:17], v[132:133], v[70:71] op_sel:[0,0,0] op_sel_hi:[0,1,1]
v_pk_fma_f32 v[140:141], v[16:17], v[138:139], v[86:87] op_sel:[1,0,0] op_sel_hi:[1,1,1]
v_pk_fma_f32 v[134:135], v[18:19], v[136:137], v[134:135] op_sel:[0,0,0] op_sel_hi:[0,1,1] neg_lo:[1,0,0] neg_hi:[1,0,0]
v_pk_fma_f32 v[140:141], v[18:19], v[142:143], v[140:141] op_sel:[1,0,0] op_sel_hi:[1,1,1] neg_lo:[1,0,0] neg_hi:[1,0,0]
v_pk_fma_f32 v[136:137], v[16:17], v[136:137], v[102:103] op_sel:[0,0,0] op_sel_hi:[0,1,1]
v_pk_fma_f32 v[142:143], v[16:17], v[142:143], v[118:119] op_sel:[1,0,0] op_sel_hi:[1,1,1]
v_pk_fma_f32 v[136:137], v[18:19], v[132:133], v[136:137] op_sel:[0,0,0] op_sel_hi:[0,1,1]
v_pk_fma_f32 v[142:143], v[18:19], v[138:139], v[142:143] op_sel:[1,0,0] op_sel_hi:[1,1,1]
s_add_u32 m0, s54, 102400
s_nop 0
buffer_load_dwordx4 v11, s[12:15], s55 offen lds
v_pk_fma_f32 v[132:133], v[16:17], v[134:135], v[72:73] op_sel:[0,0,0] op_sel_hi:[0,1,1]
v_pk_fma_f32 v[138:139], v[16:17], v[140:141], v[88:89] op_sel:[1,0,0] op_sel_hi:[1,1,1]
v_pk_fma_f32 v[132:133], v[18:19], v[136:137], v[132:133] op_sel:[0,0,0] op_sel_hi:[0,1,1] neg_lo:[1,0,0] neg_hi:[1,0,0]
v_pk_fma_f32 v[138:139], v[18:19], v[142:143], v[138:139] op_sel:[1,0,0] op_sel_hi:[1,1,1] neg_lo:[1,0,0] neg_hi:[1,0,0]
v_pk_fma_f32 v[136:137], v[16:17], v[136:137], v[104:105] op_sel:[0,0,0] op_sel_hi:[0,1,1]
v_pk_fma_f32 v[142:143], v[16:17], v[142:143], v[120:121] op_sel:[1,0,0] op_sel_hi:[1,1,1]
v_pk_fma_f32 v[136:137], v[18:19], v[134:135], v[136:137] op_sel:[0,0,0] op_sel_hi:[0,1,1]
v_pk_fma_f32 v[142:143], v[18:19], v[140:141], v[142:143] op_sel:[1,0,0] op_sel_hi:[1,1,1]
v_pk_fma_f32 v[134:135], v[16:17], v[132:133], v[74:75] op_sel:[0,0,0] op_sel_hi:[0,1,1]
v_pk_fma_f32 v[140:141], v[16:17], v[138:139], v[90:91] op_sel:[1,0,0] op_sel_hi:[1,1,1]
v_pk_fma_f32 v[134:135], v[18:19], v[136:137], v[134:135] op_sel:[0,0,0] op_sel_hi:[0,1,1] neg_lo:[1,0,0] neg_hi:[1,0,0]
v_pk_fma_f32 v[140:141], v[18:19], v[142:143], v[140:141] op_sel:[1,0,0] op_sel_hi:[1,1,1] neg_lo:[1,0,0] neg_hi:[1,0,0]
v_pk_fma_f32 v[136:137], v[16:17], v[136:137], v[106:107] op_sel:[0,0,0] op_sel_hi:[0,1,1]
v_pk_fma_f32 v[142:143], v[16:17], v[142:143], v[122:123] op_sel:[1,0,0] op_sel_hi:[1,1,1]
v_pk_fma_f32 v[136:137], v[18:19], v[132:133], v[136:137] op_sel:[0,0,0] op_sel_hi:[0,1,1]
v_pk_fma_f32 v[142:143], v[18:19], v[138:139], v[142:143] op_sel:[1,0,0] op_sel_hi:[1,1,1]
s_lshl_b32 s55, s50, 4
s_add_u32 m0, s54, 106496
s_nop 0
buffer_load_dwordx4 v14, s[12:15], s55 offen lds
v_pk_fma_f32 v[132:133], v[16:17], v[134:135], v[76:77] op_sel:[0,0,0] op_sel_hi:[0,1,1]
v_pk_fma_f32 v[138:139], v[16:17], v[140:141], v[92:93] op_sel:[1,0,0] op_sel_hi:[1,1,1]
v_pk_fma_f32 v[132:133], v[18:19], v[136:137], v[132:133] op_sel:[0,0,0] op_sel_hi:[0,1,1] neg_lo:[1,0,0] neg_hi:[1,0,0]
v_pk_fma_f32 v[138:139], v[18:19], v[142:143], v[138:139] op_sel:[1,0,0] op_sel_hi:[1,1,1] neg_lo:[1,0,0] neg_hi:[1,0,0]
v_pk_fma_f32 v[136:137], v[16:17], v[136:137], v[108:109] op_sel:[0,0,0] op_sel_hi:[0,1,1]
v_pk_fma_f32 v[142:143], v[16:17], v[142:143], v[124:125] op_sel:[1,0,0] op_sel_hi:[1,1,1]
v_pk_fma_f32 v[136:137], v[18:19], v[134:135], v[136:137] op_sel:[0,0,0] op_sel_hi:[0,1,1]
v_pk_fma_f32 v[142:143], v[18:19], v[140:141], v[142:143] op_sel:[1,0,0] op_sel_hi:[1,1,1]
v_pk_fma_f32 v[134:135], v[16:17], v[132:133], v[78:79] op_sel:[0,0,0] op_sel_hi:[0,1,1]
v_pk_fma_f32 v[140:141], v[16:17], v[138:139], v[94:95] op_sel:[1,0,0] op_sel_hi:[1,1,1]
v_pk_fma_f32 v[134:135], v[18:19], v[136:137], v[134:135] op_sel:[0,0,0] op_sel_hi:[0,1,1] neg_lo:[1,0,0] neg_hi:[1,0,0]
v_pk_fma_f32 v[140:141], v[18:19], v[142:143], v[140:141] op_sel:[1,0,0] op_sel_hi:[1,1,1] neg_lo:[1,0,0] neg_hi:[1,0,0]
v_pk_fma_f32 v[136:137], v[16:17], v[136:137], v[110:111] op_sel:[0,0,0] op_sel_hi:[0,1,1]
v_pk_fma_f32 v[142:143], v[16:17], v[142:143], v[126:127] op_sel:[1,0,0] op_sel_hi:[1,1,1]
v_pk_fma_f32 v[136:137], v[18:19], v[132:133], v[136:137] op_sel:[0,0,0] op_sel_hi:[0,1,1]
v_pk_fma_f32 v[142:143], v[18:19], v[138:139], v[142:143] op_sel:[1,0,0] op_sel_hi:[1,1,1]
s_add_u32 m0, s54, 110592
s_nop 0
buffer_load_dwordx4 v11, s[12:15], s55 offen lds
v_mov_b32 v20, v134
v_mov_b32 v22, v136
v_mov_b32 v144, v135
v_mov_b32 v146, v137
v_mov_b32 v21, v140
v_mov_b32 v23, v142
v_mov_b32 v145, v141
v_mov_b32 v147, v143
v_pk_fma_f32 v[144:145], v[24:25], v[20:21], v[144:145]
v_pk_fma_f32 v[146:147], v[24:25], v[22:23], v[146:147]
v_pk_fma_f32 v[144:145], v[26:27], v[22:23], v[144:145] neg_lo:[1,0,0] neg_hi:[1,0,0]
v_pk_fma_f32 v[146:147], v[26:27], v[20:21], v[146:147]
v_add_u32 v2, s46, v1
v_and_b32 v3, 0xf0, v1
v_add_u32 v3, s46, v3
ds_write_b128 v2, v[144:147]
ds_read_b128 v[148:151], v3 offset:0
ds_read_b128 v[152:155], v3 offset:256
ds_read_b128 v[156:159], v3 offset:512
ds_read_b128 v[160:163], v3 offset:768
v_accvgpr_read_b32 v192, a0
v_accvgpr_read_b32 v193, a1
v_accvgpr_read_b32 v194, a2
v_accvgpr_read_b32 v195, a3
v_accvgpr_read_b32 v196, a4
v_accvgpr_read_b32 v197, a5
v_accvgpr_read_b32 v198, a6
v_accvgpr_read_b32 v199, a7
v_accvgpr_read_b32 v200, a8
v_accvgpr_read_b32 v201, a9
v_accvgpr_read_b32 v202, a10
v_accvgpr_read_b32 v203, a11
v_accvgpr_read_b32 v204, a12
v_accvgpr_read_b32 v205, a13
v_accvgpr_read_b32 v206, a14
v_accvgpr_read_b32 v207, a15
s_add_u32 s55, s50, 4096
s_lshl_b32 s55, s55, 4
s_add_u32 m0, s54, 114688
s_nop 0
buffer_load_dwordx4 v14, s[12:15], s55 offen lds
v_accvgpr_read_b32 v208, a16
v_accvgpr_read_b32 v209, a17
v_accvgpr_read_b32 v210, a18
v_accvgpr_read_b32 v211, a19
v_accvgpr_read_b32 v212, a20
v_accvgpr_read_b32 v213, a21
v_accvgpr_read_b32 v214, a22
v_accvgpr_read_b32 v215, a23
v_accvgpr_read_b32 v216, a24
v_accvgpr_read_b32 v217, a25
v_accvgpr_read_b32 v218, a26
v_accvgpr_read_b32 v219, a27
v_accvgpr_read_b32 v220, a28
v_accvgpr_read_b32 v221, a29
v_accvgpr_read_b32 v222, a30
v_accvgpr_read_b32 v223, a31
s_add_u32 m0, s54, 118784
s_nop 0
buffer_load_dwordx4 v11, s[12:15], s55 offen lds
s_waitcnt vmcnt(7)
s_mov_b64 exec, 1
buffer_store_dword v4, v1, s[36:39], s81 offen offset:0 sc0 sc1
s_mov_b64 exec, -1
s_waitcnt lgkmcnt(2)
v_pk_fma_f32 v[152:153], v[28:29], v[148:149], v[152:153]
v_pk_fma_f32 v[154:155], v[28:29], v[150:151], v[154:155]
v_pk_fma_f32 v[152:153], v[30:31], v[150:151], v[152:153] neg_lo:[1,0,0] neg_hi:[1,0,0]
v_pk_fma_f32 v[154:155], v[30:31], v[148:149], v[154:155]
s_waitcnt lgkmcnt(1)
v_pk_fma_f32 v[156:157], v[28:29], v[152:153], v[156:157]
v_pk_fma_f32 v[158:159], v[28:29], v[154:155], v[158:159]
v_pk_fma_f32 v[156:157], v[30:31], v[154:155], v[156:157] neg_lo:[1,0,0] neg_hi:[1,0,0]
v_pk_fma_f32 v[158:159], v[30:31], v[152:153], v[158:159]
s_waitcnt lgkmcnt(0)
v_pk_fma_f32 v[160:161], v[28:29], v[156:157], v[160:161]
v_pk_fma_f32 v[162:163], v[28:29], v[158:159], v[162:163]
v_pk_fma_f32 v[160:161], v[30:31], v[158:159], v[160:161] neg_lo:[1,0,0] neg_hi:[1,0,0]
v_pk_fma_f32 v[162:163], v[30:31], v[156:157], v[162:163]
v_min_u32 v160, -2, v160
v_min_u32 v161, -2, v161
v_min_u32 v162, -2, v162
v_min_u32 v163, -2, v163
s_mov_b64 exec, 0xffff
buffer_store_dwordx4 v[160:163], v1, s[36:39], s64 offen sc0 sc1
s_mov_b64 exec, -1
P1b_chk:
v_cmp_ne_u32 vcc, s3, v44
s_nop 0
s_and_b64 vcc, vcc, exec
s_cbranch_scc1 P1b_retry
P1b_ok:
v_accvgpr_read_b32 v224, a32
v_accvgpr_read_b32 v225, a33
v_accvgpr_read_b32 v226, a34
v_accvgpr_read_b32 v227, a35
v_accvgpr_read_b32 v228, a36
v_accvgpr_read_b32 v229, a37
v_accvgpr_read_b32 v230, a38
v_accvgpr_read_b32 v231, a39
v_accvgpr_read_b32 v232, a40
v_accvgpr_read_b32 v233, a41
v_accvgpr_read_b32 v234, a42
v_accvgpr_read_b32 v235, a43
v_accvgpr_read_b32 v236, a44
v_accvgpr_read_b32 v237, a45
v_accvgpr_read_b32 v238, a46
v_accvgpr_read_b32 v239, a47
s_lshl_b32 s55, s51, 4
s_add_u32 m0, s54, 122880
s_nop 0
buffer_load_dwordx4 v14, s[12:15], s55 offen lds
v_accvgpr_read_b32 v240, a48
v_accvgpr_read_b32 v241, a49
v_accvgpr_read_b32 v242, a50
v_accvgpr_read_b32 v243, a51
v_accvgpr_read_b32 v244, a52
v_accvgpr_read_b32 v245, a53
v_accvgpr_read_b32 v246, a54
v_accvgpr_read_b32 v247, a55
v_accvgpr_read_b32 v248, a56
v_accvgpr_read_b32 v249, a57
v_accvgpr_read_b32 v250, a58
v_accvgpr_read_b32 v251, a59
v_accvgpr_read_b32 v252, a60
v_accvgpr_read_b32 v253, a61
v_accvgpr_read_b32 v254, a62
v_accvgpr_read_b32 v255, a63
s_add_u32 m0, s54, 126976
s_nop 0
buffer_load_dwordx4 v11, s[12:15], s55 offen lds
v_accvgpr_read_b32 v128, a160
v_accvgpr_read_b32 v129, a161
v_accvgpr_read_b32 v130, a162
v_accvgpr_read_b32 v131, a163
v_accvgpr_read_b32 v132, a164
v_accvgpr_read_b32 v133, a165
v_accvgpr_read_b32 v134, a166
v_accvgpr_read_b32 v135, a167
v_accvgpr_read_b32 v136, a168
v_accvgpr_read_b32 v137, a169
v_accvgpr_read_b32 v138, a170
v_accvgpr_read_b32 v139, a171
v_accvgpr_read_b32 v140, a172
v_accvgpr_read_b32 v141, a173
v_accvgpr_read_b32 v142, a174
v_accvgpr_read_b32 v143, a175
v_accvgpr_read_b32 v144, a176
v_accvgpr_read_b32 v145, a177
v_accvgpr_read_b32 v146, a178
v_accvgpr_read_b32 v147, a179
v_accvgpr_read_b32 v148, a180
v_accvgpr_read_b32 v149, a181
v_accvgpr_read_b32 v150, a182
v_accvgpr_read_b32 v151, a183
v_accvgpr_read_b32 v152, a184
v_accvgpr_read_b32 v153, a185
v_accvgpr_read_b32 v154, a186
v_accvgpr_read_b32 v155, a187
v_accvgpr_read_b32 v156, a188
v_accvgpr_read_b32 v157, a189
v_accvgpr_read_b32 v158, a190
v_accvgpr_read_b32 v159, a191
s_mov_b64 exec, 0
s_cmp_eq_u32 s62, 1
s_cbranch_scc1 L_tr13
s_cmp_eq_u32 s62, 2
s_cbranch_scc1 L_tr14
s_cmp_eq_u32 s62, 3
s_cbranch_scc1 L_tr15
s_branch L_tr12
L_trret2:
s_mov_b64 exec, -1
v_pk_mul_f32 v[168:169], v[192:193], v[192:193]
v_pk_mul_f32 v[170:171], v[194:195], v[194:195]
v_pk_mul_f32 v[172:173], v[224:225], v[224:225]
v_pk_mul_f32 v[174:175], v[226:227], v[226:227]
v_pk_fma_f32 v[168:169], v[168:169], v[46:47], v[46:47] op_sel:[0,1,0] op_sel_hi:[1,1,0]
v_pk_fma_f32 v[170:171], v[170:171], v[46:47], v[46:47] op_sel:[0,1,0] op_sel_hi:[1,1,0]
v_pk_fma_f32 v[172:173], v[172:173], v[46:47], v[46:47] op_sel:[0,1,0] op_sel_hi:[1,1,0]
v_pk_fma_f32 v[174:175], v[174:175], v[46:47], v[46:47] op_sel:[0,1,0] op_sel_hi:[1,1,0]
v_pk_mul_f32 v[168:169], v[168:169], v[192:193]
v_pk_mul_f32 v[170:171], v[170:171], v[194:195]
v_pk_mul_f32 v[172:173], v[172:173], v[224:225]
v_pk_mul_f32 v[174:175], v[174:175], v[226:227]
v_exp_f32 v168, v168
v_exp_f32 v169, v169
v_pk_mul_f32 v[208:209], v[192:193], v[208:209]
v_exp_f32 v170, v170
v_exp_f32 v171, v171
v_pk_mul_f32 v[210:211], v[194:195], v[210:211]
v_exp_f32 v172, v172
v_exp_f32 v173, v173
v_pk_mul_f32 v[240:241], v[224:225], v[240:241]
v_exp_f32 v174, v174
v_exp_f32 v175, v175
v_pk_mul_f32 v[242:243], v[226:227], v[242:243]
v_pk_add_f32 v[168:169], v[168:169], 1.0 op_sel_hi:[1,0]
v_pk_add_f32 v[170:171], v[170:171], 1.0 op_sel_hi:[1,0]
v_pk_add_f32 v[172:173], v[172:173], 1.0 op_sel_hi:[1,0]
v_pk_add_f32 v[174:175], v[174:175], 1.0 op_sel_hi:[1,0]
v_rcp_f32 v168, v168
v_rcp_f32 v169, v169
v_rcp_f32 v170, v170
v_rcp_f32 v171, v171
v_rcp_f32 v172, v172
v_rcp_f32 v173, v173
v_rcp_f32 v174, v174
v_rcp_f32 v175, v175
v_pk_mul_f32 v[208:209], v[208:209], v[168:169]
v_pk_mul_f32 v[210:211], v[210:211], v[170:171]
v_pk_mul_f32 v[240:241], v[240:241], v[172:173]
v_pk_mul_f32 v[242:243], v[242:243], v[174:175]
v_cvt_pk_bf16_f32 v48, v208, v209
v_cvt_pk_bf16_f32 v49, v210, v211
v_cvt_pk_bf16_f32 v50, v240, v241
v_cvt_pk_bf16_f32 v51, v242, v243
buffer_store_dwordx4 v[48:51], v1, s[32:35], s66 offen offset:0 sc0 sc1
v_pk_mul_f32 v[168:169], v[196:197], v[196:197]
v_pk_mul_f32 v[170:171], v[198:199], v[198:199]
v_pk_mul_f32 v[172:173], v[228:229], v[228:229]
v_pk_mul_f32 v[174:175], v[230:231], v[230:231]
v_pk_fma_f32 v[168:169], v[168:169], v[46:47], v[46:47] op_sel:[0,1,0] op_sel_hi:[1,1,0]
v_pk_fma_f32 v[170:171], v[170:171], v[46:47], v[46:47] op_sel:[0,1,0] op_sel_hi:[1,1,0]
v_pk_fma_f32 v[172:173], v[172:173], v[46:47], v[46:47] op_sel:[0,1,0] op_sel_hi:[1,1,0]
v_pk_fma_f32 v[174:175], v[174:175], v[46:47], v[46:47] op_sel:[0,1,0] op_sel_hi:[1,1,0]
v_pk_mul_f32 v[168:169], v[168:169], v[196:197]
v_pk_mul_f32 v[170:171], v[170:171], v[198:199]
v_pk_mul_f32 v[172:173], v[172:173], v[228:229]
v_pk_mul_f32 v[174:175], v[174:175], v[230:231]
v_exp_f32 v168, v168
v_exp_f32 v169, v169
v_pk_mul_f32 v[212:213], v[196:197], v[212:213]
v_exp_f32 v170, v170
v_exp_f32 v171, v171
v_pk_mul_f32 v[214:215], v[198:199], v[214:215]
v_exp_f32 v172, v172
v_exp_f32 v173, v173
v_pk_mul_f32 v[244:245], v[228:229], v[244:245]
v_exp_f32 v174, v174
v_exp_f32 v175, v175
v_pk_mul_f32 v[246:247], v[230:231], v[246:247]
v_pk_add_f32 v[168:169], v[168:169], 1.0 op_sel_hi:[1,0]
v_pk_add_f32 v[170:171], v[170:171], 1.0 op_sel_hi:[1,0]
v_pk_add_f32 v[172:173], v[172:173], 1.0 op_sel_hi:[1,0]
v_pk_add_f32 v[174:175], v[174:175], 1.0 op_sel_hi:[1,0]
v_rcp_f32 v168, v168
v_rcp_f32 v169, v169
v_rcp_f32 v170, v170
v_rcp_f32 v171, v171
v_rcp_f32 v172, v172
v_rcp_f32 v173, v173
v_rcp_f32 v174, v174
v_rcp_f32 v175, v175
v_pk_mul_f32 v[212:213], v[212:213], v[168:169]
v_pk_mul_f32 v[214:215], v[214:215], v[170:171]
v_pk_mul_f32 v[244:245], v[244:245], v[172:173]
v_pk_mul_f32 v[246:247], v[246:247], v[174:175]
v_cvt_pk_bf16_f32 v52, v212, v213
v_cvt_pk_bf16_f32 v53, v214, v215
v_cvt_pk_bf16_f32 v54, v244, v245
v_cvt_pk_bf16_f32 v55, v246, v247
buffer_store_dwordx4 v[52:55], v1, s[32:35], s66 offen offset:1024 sc0 sc1
v_pk_mul_f32 v[168:169], v[200:201], v[200:201]
v_pk_mul_f32 v[170:171], v[202:203], v[202:203]
v_pk_mul_f32 v[172:173], v[232:233], v[232:233]
v_pk_mul_f32 v[174:175], v[234:235], v[234:235]
v_pk_fma_f32 v[168:169], v[168:169], v[46:47], v[46:47] op_sel:[0,1,0] op_sel_hi:[1,1,0]
v_pk_fma_f32 v[170:171], v[170:171], v[46:47], v[46:47] op_sel:[0,1,0] op_sel_hi:[1,1,0]
v_pk_fma_f32 v[172:173], v[172:173], v[46:47], v[46:47] op_sel:[0,1,0] op_sel_hi:[1,1,0]
v_pk_fma_f32 v[174:175], v[174:175], v[46:47], v[46:47] op_sel:[0,1,0] op_sel_hi:[1,1,0]
v_pk_mul_f32 v[168:169], v[168:169], v[200:201]
v_pk_mul_f32 v[170:171], v[170:171], v[202:203]
v_pk_mul_f32 v[172:173], v[172:173], v[232:233]
v_pk_mul_f32 v[174:175], v[174:175], v[234:235]
v_exp_f32 v168, v168
v_exp_f32 v169, v169
v_pk_mul_f32 v[216:217], v[200:201], v[216:217]
v_exp_f32 v170, v170
v_exp_f32 v171, v171
v_pk_mul_f32 v[218:219], v[202:203], v[218:219]
v_exp_f32 v172, v172
v_exp_f32 v173, v173
v_pk_mul_f32 v[248:249], v[232:233], v[248:249]
v_exp_f32 v174, v174
v_exp_f32 v175, v175
v_pk_mul_f32 v[250:251], v[234:235], v[250:251]
v_pk_add_f32 v[168:169], v[168:169], 1.0 op_sel_hi:[1,0]
v_pk_add_f32 v[170:171], v[170:171], 1.0 op_sel_hi:[1,0]
v_pk_add_f32 v[172:173], v[172:173], 1.0 op_sel_hi:[1,0]
v_pk_add_f32 v[174:175], v[174:175], 1.0 op_sel_hi:[1,0]
v_rcp_f32 v168, v168
v_rcp_f32 v169, v169
v_rcp_f32 v170, v170
v_rcp_f32 v171, v171
v_rcp_f32 v172, v172
v_rcp_f32 v173, v173
v_rcp_f32 v174, v174
v_rcp_f32 v175, v175
v_pk_mul_f32 v[216:217], v[216:217], v[168:169]
v_pk_mul_f32 v[218:219], v[218:219], v[170:171]
v_pk_mul_f32 v[248:249], v[248:249], v[172:173]
v_pk_mul_f32 v[250:251], v[250:251], v[174:175]
v_cvt_pk_bf16_f32 v56, v216, v217
v_cvt_pk_bf16_f32 v57, v218, v219
v_cvt_pk_bf16_f32 v58, v248, v249
v_cvt_pk_bf16_f32 v59, v250, v251
buffer_store_dwordx4 v[56:59], v1, s[32:35], s66 offen offset:2048 sc0 sc1
v_pk_mul_f32 v[168:169], v[204:205], v[204:205]
v_pk_mul_f32 v[170:171], v[206:207], v[206:207]
v_pk_mul_f32 v[172:173], v[236:237], v[236:237]
v_pk_mul_f32 v[174:175], v[238:239], v[238:239]
v_pk_fma_f32 v[168:169], v[168:169], v[46:47], v[46:47] op_sel:[0,1,0] op_sel_hi:[1,1,0]
v_pk_fma_f32 v[170:171], v[170:171], v[46:47], v[46:47] op_sel:[0,1,0] op_sel_hi:[1,1,0]
v_pk_fma_f32 v[172:173], v[172:173], v[46:47], v[46:47] op_sel:[0,1,0] op_sel_hi:[1,1,0]
v_pk_fma_f32 v[174:175], v[174:175], v[46:47], v[46:47] op_sel:[0,1,0] op_sel_hi:[1,1,0]
v_pk_mul_f32 v[168:169], v[168:169], v[204:205]
v_pk_mul_f32 v[170:171], v[170:171], v[206:207]
v_pk_mul_f32 v[172:173], v[172:173], v[236:237]
v_pk_mul_f32 v[174:175], v[174:175], v[238:239]
v_exp_f32 v168, v168
v_exp_f32 v169, v169
v_pk_mul_f32 v[220:221], v[204:205], v[220:221]
v_exp_f32 v170, v170
v_exp_f32 v171, v171
v_pk_mul_f32 v[222:223], v[206:207], v[222:223]
v_exp_f32 v172, v172
v_exp_f32 v173, v173
v_pk_mul_f32 v[252:253], v[236:237], v[252:253]
v_exp_f32 v174, v174
v_exp_f32 v175, v175
v_pk_mul_f32 v[254:255], v[238:239], v[254:255]
v_pk_add_f32 v[168:169], v[168:169], 1.0 op_sel_hi:[1,0]
v_pk_add_f32 v[170:171], v[170:171], 1.0 op_sel_hi:[1,0]
v_pk_add_f32 v[172:173], v[172:173], 1.0 op_sel_hi:[1,0]
v_pk_add_f32 v[174:175], v[174:175], 1.0 op_sel_hi:[1,0]
v_rcp_f32 v168, v168
v_rcp_f32 v169, v169
v_rcp_f32 v170, v170
v_rcp_f32 v171, v171
v_rcp_f32 v172, v172
v_rcp_f32 v173, v173
v_rcp_f32 v174, v174
v_rcp_f32 v175, v175
v_pk_mul_f32 v[220:221], v[220:221], v[168:169]
v_pk_mul_f32 v[222:223], v[222:223], v[170:171]
v_pk_mul_f32 v[252:253], v[252:253], v[172:173]
v_pk_mul_f32 v[254:255], v[254:255], v[174:175]
v_cvt_pk_bf16_f32 v60, v220, v221
v_cvt_pk_bf16_f32 v61, v222, v223
v_cvt_pk_bf16_f32 v62, v252, v253
v_cvt_pk_bf16_f32 v63, v254, v255
buffer_store_dwordx4 v[60:63], v1, s[32:35], s66 offen offset:3072 sc0 sc1
buffer_load_dword v13, v12, s[36:39], s68 offen offset:96 sc0 sc1
s_add_u32 s66, s66, 4096
v_accvgpr_read_b32 v192, a64
v_accvgpr_read_b32 v193, a65
v_accvgpr_read_b32 v194, a66
v_accvgpr_read_b32 v195, a67
v_accvgpr_read_b32 v196, a68
v_accvgpr_read_b32 v197, a69
v_accvgpr_read_b32 v198, a70
v_accvgpr_read_b32 v199, a71
v_accvgpr_read_b32 v200, a72
v_accvgpr_read_b32 v201, a73
v_accvgpr_read_b32 v202, a74
v_accvgpr_read_b32 v203, a75
v_accvgpr_read_b32 v204, a76
v_accvgpr_read_b32 v205, a77
v_accvgpr_read_b32 v206, a78
v_accvgpr_read_b32 v207, a79
v_accvgpr_read_b32 v208, a80
v_accvgpr_read_b32 v209, a81
v_accvgpr_read_b32 v210, a82
v_accvgpr_read_b32 v211, a83
v_accvgpr_read_b32 v212, a84
v_accvgpr_read_b32 v213, a85
v_accvgpr_read_b32 v214, a86
v_accvgpr_read_b32 v215, a87
v_accvgpr_read_b32 v216, a88
v_accvgpr_read_b32 v217, a89
v_accvgpr_read_b32 v218, a90
v_accvgpr_read_b32 v219, a91
v_accvgpr_read_b32 v220, a92
v_accvgpr_read_b32 v221, a93
v_accvgpr_read_b32 v222, a94
v_accvgpr_read_b32 v223, a95
v_pk_mul_f32 v[168:169], v[192:193], v[192:193]
v_pk_mul_f32 v[170:171], v[194:195], v[194:195]
v_pk_mul_f32 v[172:173], v[196:197], v[196:197]
v_pk_mul_f32 v[174:175], v[198:199], v[198:199]
v_pk_fma_f32 v[168:169], v[168:169], v[46:47], v[46:47] op_sel:[0,1,0] op_sel_hi:[1,1,0]
v_pk_fma_f32 v[170:171], v[170:171], v[46:47], v[46:47] op_sel:[0,1,0] op_sel_hi:[1,1,0]
v_pk_fma_f32 v[172:173], v[172:173], v[46:47], v[46:47] op_sel:[0,1,0] op_sel_hi:[1,1,0]
v_pk_fma_f32 v[174:175], v[174:175], v[46:47], v[46:47] op_sel:[0,1,0] op_sel_hi:[1,1,0]
v_pk_mul_f32 v[168:169], v[168:169], v[192:193]
v_pk_mul_f32 v[170:171], v[170:171], v[194:195]
v_pk_mul_f32 v[172:173], v[172:173], v[196:197]
v_pk_mul_f32 v[174:175], v[174:175], v[198:199]
v_exp_f32 v168, v168
v_exp_f32 v169, v169
v_pk_mul_f32 v[208:209], v[192:193], v[208:209]
v_exp_f32 v170, v170
v_exp_f32 v171, v171
v_pk_mul_f32 v[210:211], v[194:195], v[210:211]
v_exp_f32 v172, v172
v_exp_f32 v173, v173
v_pk_mul_f32 v[212:213], v[196:197], v[212:213]
v_exp_f32 v174, v174
v_exp_f32 v175, v175
v_pk_mul_f32 v[214:215], v[198:199], v[214:215]
v_pk_add_f32 v[168:169], v[168:169], 1.0 op_sel_hi:[1,0]
v_pk_add_f32 v[170:171], v[170:171], 1.0 op_sel_hi:[1,0]
v_pk_add_f32 v[172:173], v[172:173], 1.0 op_sel_hi:[1,0]
v_pk_add_f32 v[174:175], v[174:175], 1.0 op_sel_hi:[1,0]
v_rcp_f32 v168, v168
v_rcp_f32 v169, v169
v_rcp_f32 v170, v170
v_rcp_f32 v171, v171
v_rcp_f32 v172, v172
v_rcp_f32 v173, v173
v_rcp_f32 v174, v174
v_rcp_f32 v175, v175
v_pk_mul_f32 v[208:209], v[208:209], v[168:169]
v_pk_mul_f32 v[210:211], v[210:211], v[170:171]
v_pk_mul_f32 v[212:213], v[212:213], v[172:173]
v_pk_mul_f32 v[214:215], v[214:215], v[174:175]
v_cvt_pk_bf16_f32 v240, v208, v209
v_cvt_pk_bf16_f32 v241, v210, v211
v_cvt_pk_bf16_f32 v242, v212, v213
v_cvt_pk_bf16_f32 v243, v214, v215
v_accvgpr_read_b32 v40, a242
v_xor_b32 v41, 32, v40
v_xor_b32 v42, 64, v40
v_xor_b32 v43, 96, v40
v_xor_b32 v44, 128, v40
v_xor_b32 v45, 160, v40
buffer_store_dwordx2 v[240:241], v10, s[32:35], s67 offen offset:0 sc0 sc1
buffer_store_dwordx2 v[242:243], v10, s[32:35], s67 offen offset:1024 sc0 sc1
s_barrier
ds_read_b64_tr_b16 a[0:1], v40 offset:0
ds_read_b64_tr_b16 a[2:3], v40 offset:4096
ds_read_b64_tr_b16 a[4:5], v40 offset:8192
ds_read_b64_tr_b16 a[6:7], v40 offset:12288
ds_read_b64_tr_b16 a[8:9], v41 offset:0
ds_read_b64_tr_b16 a[10:11], v41 offset:4096
ds_read_b64_tr_b16 a[12:13], v41 offset:8192
ds_read_b64_tr_b16 a[14:15], v41 offset:12288
ds_read_b64_tr_b16 a[16:17], v42 offset:0
ds_read_b64_tr_b16 a[18:19], v42 offset:4096
v_pk_mul_f32 v[168:169], v[200:201], v[200:201]
v_pk_mul_f32 v[170:171], v[202:203], v[202:203]
v_pk_mul_f32 v[172:173], v[204:205], v[204:205]
v_pk_mul_f32 v[174:175], v[206:207], v[206:207]
v_pk_fma_f32 v[168:169], v[168:169], v[46:47], v[46:47] op_sel:[0,1,0] op_sel_hi:[1,1,0]
v_pk_fma_f32 v[170:171], v[170:171], v[46:47], v[46:47] op_sel:[0,1,0] op_sel_hi:[1,1,0]
v_pk_fma_f32 v[172:173], v[172:173], v[46:47], v[46:47] op_sel:[0,1,0] op_sel_hi:[1,1,0]
v_pk_fma_f32 v[174:175], v[174:175], v[46:47], v[46:47] op_sel:[0,1,0] op_sel_hi:[1,1,0]
v_pk_mul_f32 v[168:169], v[168:169], v[200:201]
v_pk_mul_f32 v[170:171], v[170:171], v[202:203]
v_pk_mul_f32 v[172:173], v[172:173], v[204:205]
v_pk_mul_f32 v[174:175], v[174:175], v[206:207]
v_exp_f32 v168, v168
v_exp_f32 v169, v169
v_pk_mul_f32 v[216:217], v[200:201], v[216:217]
v_exp_f32 v170, v170
v_exp_f32 v171, v171
v_pk_mul_f32 v[218:219], v[202:203], v[218:219]
v_exp_f32 v172, v172
v_exp_f32 v173, v173
v_pk_mul_f32 v[220:221], v[204:205], v[220:221]
v_exp_f32 v174, v174
v_exp_f32 v175, v175
v_pk_mul_f32 v[222:223], v[206:207], v[222:223]
v_pk_add_f32 v[168:169], v[168:169], 1.0 op_sel_hi:[1,0]
v_pk_add_f32 v[170:171], v[170:171], 1.0 op_sel_hi:[1,0]
v_pk_add_f32 v[172:173], v[172:173], 1.0 op_sel_hi:[1,0]
v_pk_add_f32 v[174:175], v[174:175], 1.0 op_sel_hi:[1,0]
v_rcp_f32 v168, v168
v_rcp_f32 v169, v169
v_rcp_f32 v170, v170
v_rcp_f32 v171, v171
v_rcp_f32 v172, v172
v_rcp_f32 v173, v173
v_rcp_f32 v174, v174
v_rcp_f32 v175, v175
v_pk_mul_f32 v[216:217], v[216:217], v[168:169]
v_pk_mul_f32 v[218:219], v[218:219], v[170:171]
v_pk_mul_f32 v[220:221], v[220:221], v[172:173]
v_pk_mul_f32 v[222:223], v[222:223], v[174:175]
v_cvt_pk_bf16_f32 v244, v216, v217
v_cvt_pk_bf16_f32 v245, v218, v219
v_cvt_pk_bf16_f32 v246, v220, v221
v_cvt_pk_bf16_f32 v247, v222, v223
buffer_store_dwordx2 v[244:245], v10, s[32:35], s67 offen offset:2048 sc0 sc1
buffer_store_dwordx2 v[246:247], v10, s[32:35], s67 offen offset:3072 sc0 sc1
v_xor_b32 v46, 192, v40
v_xor_b32 v47, 224, v40
s_waitcnt lgkmcnt(6)
v_mfma_f32_16x16x32_bf16 v[128:131], a[0:3], v[48:51], v[128:131]
s_add_u32 s55, s51, 4096
s_lshl_b32 s55, s55, 4
s_add_u32 m0, s54, 0
v_mfma_f32_16x16x32_bf16 v[128:131], a[4:7], a[112:115], v[128:131]
s_waitcnt vmcnt(4)
v_accvgpr_read_b32 v5, a245
v_accvgpr_read_b32 v6, a243
v_mfma_f32_16x16x32_bf16 v[132:135], a[0:3], v[52:55], v[132:135]
P3a0_chk:
v_cmp_ne_u32 vcc, s3, v13
s_nop 0
s_and_b64 vcc, vcc, exec
s_cbranch_scc1 P3a0_retry
P3a0_ok:
v_mfma_f32_16x16x32_bf16 v[132:135], a[4:7], a[116:119], v[132:135]
s_waitcnt lgkmcnt(6)
ds_read_b64_tr_b16 a[20:21], v42 offset:8192
ds_read_b64_tr_b16 a[22:23], v42 offset:12288
v_mfma_f32_16x16x32_bf16 v[136:139], a[0:3], v[56:59], v[136:139]
buffer_load_dword v13, v12, s[36:39], s68 offen offset:0 sc0 sc1
v_mfma_f32_16x16x32_bf16 v[136:139], a[4:7], a[120:123], v[136:139]
s_add_u32 s56, s97, 0
v_accvgpr_read_b32 v7, a244
s_mov_b32 s40, s36
v_mfma_f32_16x16x32_bf16 v[140:143], a[0:3], v[60:63], v[140:143]
s_mov_b32 s41, s37
s_mov_b32 s42, 0x40000
s_mov_b32 s43, 0x20000
v_mfma_f32_16x16x32_bf16 v[140:143], a[4:7], a[124:127], v[140:143]
s_waitcnt lgkmcnt(4)
ds_read_b64_tr_b16 a[24:25], v43 offset:0
ds_read_b64_tr_b16 a[26:27], v43 offset:4096
L_tr11:
s_cbranch_execz L_trret
v_mfma_f32_16x16x32_bf16 v[156:159], a[8:11], v[60:63], v[156:159]
v_lshrrev_b32 v8, 4, v0
v_cmp_eq_u32 s[64:65], 1, v8
v_mfma_f32_16x16x32_bf16 v[156:159], a[12:15], a[124:127], v[156:159]
v_cmp_eq_u32 s[66:67], 2, v8
v_cmp_eq_u32 s[74:75], 3, v8
v_mfma_f32_16x16x32_bf16 v[152:155], a[8:11], v[56:59], v[152:155]
v_mfma_f32_16x16x32_bf16 v[152:155], a[12:15], a[120:123], v[152:155]
s_waitcnt lgkmcnt(6)
ds_read_b64_tr_b16 a[28:29], v43 offset:8192
ds_read_b64_tr_b16 a[30:31], v43 offset:12288
v_mfma_f32_16x16x32_bf16 v[148:151], a[8:11], v[52:55], v[148:151]
buffer_load_dwordx4 a[128:131], v1, s[32:35], s56 offen offset:0 sc1
v_mfma_f32_16x16x32_bf16 v[148:151], a[12:15], a[116:119], v[148:151]
v_mfma_f32_16x16x32_bf16 v[144:147], a[8:11], v[48:51], v[144:147]
v_mfma_f32_16x16x32_bf16 v[144:147], a[12:15], a[112:115], v[144:147]
s_waitcnt lgkmcnt(4)
ds_read_b64_tr_b16 a[0:1], v44 offset:0
ds_read_b64_tr_b16 a[2:3], v44 offset:4096
v_mfma_f32_16x16x32_bf16 v[160:163], a[16:19], v[48:51], 0
buffer_load_dwordx4 a[132:135], v1, s[32:35], s56 offen offset:1024 sc1
v_mfma_f32_16x16x32_bf16 v[160:163], a[20:23], a[112:115], v[160:163]
v_mfma_f32_16x16x32_bf16 v[164:167], a[16:19], v[52:55], 0
v_mfma_f32_16x16x32_bf16 v[164:167], a[20:23], a[116:119], v[164:167]
s_waitcnt lgkmcnt(6)
ds_read_b64_tr_b16 a[4:5], v44 offset:8192
ds_read_b64_tr_b16 a[6:7], v44 offset:12288
v_mfma_f32_16x16x32_bf16 v[168:171], a[16:19], v[56:59], 0
buffer_load_dwordx4 a[136:139], v1, s[32:35], s56 offen offset:2048 sc1
v_mfma_f32_16x16x32_bf16 v[168:171], a[20:23], a[120:123], v[168:171]
v_mfma_f32_16x16x32_bf16 v[172:175], a[16:19], v[60:63], 0
v_mfma_f32_16x16x32_bf16 v[172:175], a[20:23], a[124:127], v[172:175]
s_waitcnt lgkmcnt(4)
ds_read_b64_tr_b16 a[8:9], v45 offset:0
ds_read_b64_tr_b16 a[10:11], v45 offset:4096
v_mfma_f32_16x16x32_bf16 v[188:191], a[24:27], v[60:63], 0
buffer_load_dwordx4 a[140:143], v1, s[32:35], s56 offen offset:3072 sc1
v_mfma_f32_16x16x32_bf16 v[188:191], a[28:31], a[124:127], v[188:191]
s_add_u32 s56, s98, 0
v_mfma_f32_16x16x32_bf16 v[184:187], a[24:27], v[56:59], 0
v_mfma_f32_16x16x32_bf16 v[184:187], a[28:31], a[120:123], v[184:187]
s_waitcnt lgkmcnt(6)
ds_read_b64_tr_b16 a[12:13], v45 offset:8192
ds_read_b64_tr_b16 a[14:15], v45 offset:12288
v_mfma_f32_16x16x32_bf16 v[180:183], a[24:27], v[52:55], 0
v_mfma_f32_16x16x32_bf16 v[180:183], a[28:31], a[116:119], v[180:183]
buffer_load_dwordx4 a[144:147], v1, s[32:35], s56 offen offset:0 sc1
v_mfma_f32_16x16x32_bf16 v[176:179], a[24:27], v[48:51], 0
v_mfma_f32_16x16x32_bf16 v[176:179], a[28:31], a[112:115], v[176:179]
s_waitcnt lgkmcnt(4)
ds_read_b64_tr_b16 a[16:17], v46 offset:0
ds_read_b64_tr_b16 a[18:19], v46 offset:4096
v_mfma_f32_16x16x32_bf16 v[192:195], a[0:3], v[48:51], 0
s_mov_b32 s57, 57344
v_mfma_f32_16x16x32_bf16 v[192:195], a[4:7], a[112:115], v[192:195]
buffer_load_dwordx4 a[60:63], v5, s[40:43], s57 offen sc0 sc1
v_mfma_f32_16x16x32_bf16 v[196:199], a[0:3], v[52:55], 0
v_mfma_f32_16x16x32_bf16 v[196:199], a[4:7], a[116:119], v[196:199]
s_waitcnt lgkmcnt(6)
ds_read_b64_tr_b16 a[20:21], v46 offset:8192
ds_read_b64_tr_b16 a[22:23], v46 offset:12288
v_mfma_f32_16x16x32_bf16 v[200:203], a[0:3], v[56:59], 0
v_mfma_f32_16x16x32_bf16 v[200:203], a[4:7], a[120:123], v[200:203]
buffer_load_dwordx4 a[148:151], v1, s[32:35], s56 offen offset:1024 sc1
v_mfma_f32_16x16x32_bf16 v[204:207], a[0:3], v[60:63], 0
v_mfma_f32_16x16x32_bf16 v[204:207], a[4:7], a[124:127], v[204:207]
s_waitcnt lgkmcnt(4)
ds_read_b64_tr_b16 a[24:25], v47 offset:0
ds_read_b64_tr_b16 a[26:27], v47 offset:4096
v_mfma_f32_16x16x32_bf16 v[220:223], a[8:11], v[60:63], 0
v_mfma_f32_16x16x32_bf16 v[220:223], a[12:15], a[124:127], v[220:223]
s_mov_b32 s57, 49152
v_mfma_f32_16x16x32_bf16 v[216:219], a[8:11], v[56:59], 0
buffer_load_dwordx4 a[56:59], v5, s[40:43], s57 offen sc0 sc1
v_mfma_f32_16x16x32_bf16 v[216:219], a[12:15], a[120:123], v[216:219]
s_waitcnt lgkmcnt(6)
ds_read_b64_tr_b16 a[28:29], v47 offset:8192
ds_read_b64_tr_b16 a[30:31], v47 offset:12288
v_mfma_f32_16x16x32_bf16 v[212:215], a[8:11], v[52:55], 0
v_mfma_f32_16x16x32_bf16 v[212:215], a[12:15], a[116:119], v[212:215]
v_mfma_f32_16x16x32_bf16 v[208:211], a[8:11], v[48:51], 0
buffer_load_dwordx4 a[152:155], v1, s[32:35], s56 offen offset:2048 sc1
v_mfma_f32_16x16x32_bf16 v[208:211], a[12:15], a[112:115], v[208:211]
s_waitcnt lgkmcnt(4)
ds_read_b64_tr_b16 a[0:1], v40 offset:16384
ds_read_b64_tr_b16 a[2:3], v40 offset:20480
v_mfma_f32_16x16x32_bf16 v[224:227], a[16:19], v[48:51], 0
v_mfma_f32_16x16x32_bf16 v[224:227], a[20:23], a[112:115], v[224:227]
v_mfma_f32_16x16x32_bf16 v[228:231], a[16:19], v[52:55], 0
s_mov_b32 s57, 40960
v_mfma_f32_16x16x32_bf16 v[228:231], a[20:23], a[116:119], v[228:231]
s_waitcnt lgkmcnt(6)
ds_read_b64_tr_b16 a[4:5], v41 offset:16384
ds_read_b64_tr_b16 a[6:7], v41 offset:20480
v_mfma_f32_16x16x32_bf16 v[232:235], a[16:19], v[56:59], 0
buffer_load_dwordx4 a[52:55], v5, s[40:43], s57 offen sc0 sc1
v_mfma_f32_16x16x32_bf16 v[232:235], a[20:23], a[120:123], v[232:235]
v_mfma_f32_16x16x32_bf16 v[236:239], a[16:19], v[60:63], 0
v_mfma_f32_16x16x32_bf16 v[236:239], a[20:23], a[124:127], v[236:239]
s_waitcnt lgkmcnt(4)
ds_read_b64_tr_b16 a[8:9], v42 offset:16384
ds_read_b64_tr_b16 a[10:11], v42 offset:20480
v_mfma_f32_16x16x32_bf16 v[252:255], a[24:27], v[60:63], 0
buffer_load_dwordx4 a[156:159], v1, s[32:35], s56 offen offset:3072 sc1
v_mfma_f32_16x16x32_bf16 v[252:255], a[28:31], a[124:127], v[252:255]
s_waitcnt vmcnt(11)
v_mfma_f32_16x16x32_bf16 v[248:251], a[24:27], v[56:59], 0
P3a_chk:
v_cmp_ne_u32 vcc, s3, v13
s_nop 0
s_and_b64 vcc, vcc, exec
s_cbranch_scc1 P3a_retry
P3a_ok:
v_mfma_f32_16x16x32_bf16 v[248:251], a[28:31], a[120:123], v[248:251]
s_waitcnt lgkmcnt(6)
ds_read_b64_tr_b16 a[12:13], v43 offset:16384
ds_read_b64_tr_b16 a[14:15], v43 offset:20480
v_mfma_f32_16x16x32_bf16 v[244:247], a[24:27], v[52:55], 0
s_add_u32 s56, s97, 4096
s_mov_b32 s57, 32768
v_mfma_f32_16x16x32_bf16 v[244:247], a[28:31], a[116:119], v[244:247]
buffer_load_dwordx4 a[48:51], v5, s[40:43], s57 offen sc0 sc1
v_mfma_f32_16x16x32_bf16 v[240:243], a[24:27], v[48:51], 0
v_mfma_f32_16x16x32_bf16 v[240:243], a[28:31], a[112:115], v[240:243]
s_waitcnt lgkmcnt(6)
ds_read_b64_tr_b16 a[16:17], v44 offset:16384
ds_read_b64_tr_b16 a[18:19], v44 offset:20480
v_mfma_f32_16x16x32_bf16 v[128:131], a[0:3], a[96:99], v[128:131]
v_mfma_f32_16x16x32_bf16 v[132:135], a[0:3], a[100:103], v[132:135]
s_waitcnt lgkmcnt(15)
ds_read_b64_tr_b16 a[20:21], v45 offset:16384
ds_read_b64_tr_b16 a[22:23], v45 offset:20480
v_mfma_f32_16x16x32_bf16 v[136:139], a[0:3], a[104:107], v[136:139]
buffer_load_dwordx4 a[192:195], v1, s[32:35], s56 offen offset:0 sc1
v_mfma_f32_16x16x32_bf16 v[140:143], a[0:3], a[108:111], v[140:143]
s_waitcnt lgkmcnt(8)
ds_read_b64_tr_b16 a[24:25], v46 offset:16384
ds_read_b64_tr_b16 a[26:27], v46 offset:20480
v_mfma_f32_16x16x32_bf16 v[156:159], a[4:7], a[108:111], v[156:159]
v_mfma_f32_16x16x32_bf16 v[152:155], a[4:7], a[104:107], v[152:155]
s_movk_i32 s57, 24576
v_mfma_f32_16x16x32_bf16 v[148:151], a[4:7], a[100:103], v[148:151]
buffer_load_dwordx4 a[44:47], v5, s[40:43], s57 offen sc0 sc1
v_mfma_f32_16x16x32_bf16 v[144:147], a[4:7], a[96:99], v[144:147]
s_waitcnt lgkmcnt(8)
ds_read_b64_tr_b16 a[28:29], v47 offset:16384
ds_read_b64_tr_b16 a[30:31], v47 offset:20480
v_mfma_f32_16x16x32_bf16 v[160:163], a[8:11], a[96:99], v[160:163]
v_mfma_f32_16x16x32_bf16 v[164:167], a[8:11], a[100:103], v[164:167]
v_mfma_f32_16x16x32_bf16 v[168:171], a[8:11], a[104:107], v[168:171]
buffer_load_dwordx4 a[196:199], v1, s[32:35], s56 offen offset:1024 sc1
v_mfma_f32_16x16x32_bf16 v[172:175], a[8:11], a[108:111], v[172:175]
s_waitcnt lgkmcnt(8)
ds_read_b64_tr_b16 a[0:1], v40 offset:24576
ds_read_b64_tr_b16 a[2:3], v40 offset:28672
v_mfma_f32_16x16x32_bf16 v[188:191], a[12:15], a[108:111], v[188:191]
v_mfma_f32_16x16x32_bf16 v[184:187], a[12:15], a[104:107], v[184:187]
v_mfma_f32_16x16x32_bf16 v[180:183], a[12:15], a[100:103], v[180:183]
buffer_load_dwordx4 a[200:203], v1, s[32:35], s56 offen offset:2048 sc1
v_mfma_f32_16x16x32_bf16 v[176:179], a[12:15], a[96:99], v[176:179]
s_waitcnt lgkmcnt(8)
ds_read_b64_tr_b16 a[4:5], v41 offset:24576
ds_read_b64_tr_b16 a[6:7], v41 offset:28672
v_mfma_f32_16x16x32_bf16 v[192:195], a[16:19], a[96:99], v[192:195]
s_movk_i32 s57, 16384
v_mfma_f32_16x16x32_bf16 v[196:199], a[16:19], a[100:103], v[196:199]
v_mfma_f32_16x16x32_bf16 v[200:203], a[16:19], a[104:107], v[200:203]
buffer_load_dwordx4 a[40:43], v5, s[40:43], s57 offen sc0 sc1
v_mfma_f32_16x16x32_bf16 v[204:207], a[16:19], a[108:111], v[204:207]
s_waitcnt lgkmcnt(8)
ds_read_b64_tr_b16 a[8:9], v42 offset:24576
ds_read_b64_tr_b16 a[10:11], v42 offset:28672
v_mfma_f32_16x16x32_bf16 v[220:223], a[20:23], a[108:111], v[220:223]
v_mfma_f32_16x16x32_bf16 v[216:219], a[20:23], a[104:107], v[216:219]
s_waitcnt lgkmcnt(15)
ds_read_b64_tr_b16 a[12:13], v43 offset:24576
ds_read_b64_tr_b16 a[14:15], v43 offset:28672
v_mfma_f32_16x16x32_bf16 v[212:215], a[20:23], a[100:103], v[212:215]
buffer_load_dwordx4 a[204:207], v1, s[32:35], s56 offen offset:3072 sc1
v_mfma_f32_16x16x32_bf16 v[208:211], a[20:23], a[96:99], v[208:211]
s_waitcnt lgkmcnt(10)
ds_read_b64_tr_b16 a[16:17], v44 offset:24576
ds_read_b64_tr_b16 a[18:19], v44 offset:28672
v_mfma_f32_16x16x32_bf16 v[224:227], a[24:27], a[96:99], v[224:227]
s_add_u32 s56, s98, 4096
v_mfma_f32_16x16x32_bf16 v[228:231], a[24:27], a[100:103], v[228:231]
v_mfma_f32_16x16x32_bf16 v[232:235], a[24:27], a[104:107], v[232:235]
buffer_load_dwordx4 a[208:211], v1, s[32:35], s56 offen offset:0 sc1
v_mfma_f32_16x16x32_bf16 v[236:239], a[24:27], a[108:111], v[236:239]
s_waitcnt lgkmcnt(10)
ds_read_b64_tr_b16 a[20:21], v45 offset:24576
ds_read_b64_tr_b16 a[22:23], v45 offset:28672
v_mfma_f32_16x16x32_bf16 v[252:255], a[28:31], a[108:111], v[252:255]
s_movk_i32 s57, 8192
v_mfma_f32_16x16x32_bf16 v[248:251], a[28:31], a[104:107], v[248:251]
v_mfma_f32_16x16x32_bf16 v[244:247], a[28:31], a[100:103], v[244:247]
buffer_load_dwordx4 a[36:39], v5, s[40:43], s57 offen sc0 sc1
v_mfma_f32_16x16x32_bf16 v[240:243], a[28:31], a[96:99], v[240:243]
s_waitcnt vmcnt(16) lgkmcnt(10)
ds_read_b64_tr_b16 a[24:25], v46 offset:24576
ds_read_b64_tr_b16 a[26:27], v46 offset:28672
v_mfma_f32_16x16x32_bf16 v[128:131], a[0:3], a[128:131], v[128:131]
v_mfma_f32_16x16x32_bf16 v[132:135], a[0:3], a[132:135], v[132:135]
v_mfma_f32_16x16x32_bf16 v[136:139], a[0:3], a[136:139], v[136:139]
v_mfma_f32_16x16x32_bf16 v[140:143], a[0:3], a[140:143], v[140:143]
s_waitcnt lgkmcnt(10)
ds_read_b64_tr_b16 a[28:29], v47 offset:24576
ds_read_b64_tr_b16 a[30:31], v47 offset:28672
v_mfma_f32_16x16x32_bf16 v[156:159], a[4:7], a[140:143], v[156:159]
buffer_load_dwordx4 a[212:215], v1, s[32:35], s56 offen offset:1024 sc1
v_mfma_f32_16x16x32_bf16 v[152:155], a[4:7], a[136:139], v[152:155]
v_mfma_f32_16x16x32_bf16 v[148:151], a[4:7], a[132:135], v[148:151]
s_mov_b32 s57, 0
v_mfma_f32_16x16x32_bf16 v[144:147], a[4:7], a[128:131], v[144:147]
s_waitcnt lgkmcnt(10)
v_mfma_f32_16x16x32_bf16 v[160:163], a[8:11], a[128:131], v[160:163]
buffer_load_dwordx4 a[32:35], v5, s[40:43], s57 offen sc0 sc1
v_mfma_f32_16x16x32_bf16 v[164:167], a[8:11], a[132:135], v[164:167]
s_mov_b32 s8, s86
s_and_b32 s9, s87, 0xffff
s_mov_b32 s10, 8388608
v_mfma_f32_16x16x32_bf16 v[168:171], a[8:11], a[136:139], v[168:171]
s_mov_b32 s11, 0x20000
v_mfma_f32_16x16x32_bf16 v[172:175], a[8:11], a[140:143], v[172:175]
s_waitcnt lgkmcnt(8)
v_mfma_f32_16x16x32_bf16 v[188:191], a[12:15], a[140:143], v[188:191]
s_mov_b64 exec, 1
buffer_store_dword v4, v1, s[36:39], s81 offen offset:32 sc0 sc1
s_mov_b64 exec, -1
v_mfma_f32_16x16x32_bf16 v[184:187], a[12:15], a[136:139], v[184:187]
v_mfma_f32_16x16x32_bf16 v[180:183], a[12:15], a[132:135], v[180:183]
s_waitcnt lgkmcnt(0)
s_barrier
v_mfma_f32_16x16x32_bf16 v[176:179], a[12:15], a[128:131], v[176:179]
s_waitcnt lgkmcnt(6)
ds_read_b64_tr_b16 a[0:1], v40 offset:32768
ds_read_b64_tr_b16 a[2:3], v40 offset:36864
v_mfma_f32_16x16x32_bf16 v[192:195], a[16:19], a[128:131], v[192:195]
buffer_load_dwordx4 a[216:219], v1, s[32:35], s56 offen offset:2048 sc1
v_mfma_f32_16x16x32_bf16 v[196:199], a[16:19], a[132:135], v[196:199]
v_mfma_f32_16x16x32_bf16 v[200:203], a[16:19], a[136:139], v[200:203]
v_mfma_f32_16x16x32_bf16 v[204:207], a[16:19], a[140:143], v[204:207]
s_waitcnt lgkmcnt(6)
ds_read_b64_tr_b16 a[4:5], v40 offset:40960
ds_read_b64_tr_b16 a[6:7], v40 offset:45056
v_mfma_f32_16x16x32_bf16 v[220:223], a[20:23], a[140:143], v[220:223]
buffer_load_dwordx4 a[220:223], v1, s[32:35], s56 offen offset:3072 sc1
v_mfma_f32_16x16x32_bf16 v[216:219], a[20:23], a[136:139], v[216:219]
s_add_u32 s56, s99, 0
v_mfma_f32_16x16x32_bf16 v[212:215], a[20:23], a[132:135], v[212:215]
v_mfma_f32_16x16x32_bf16 v[208:211], a[20:23], a[128:131], v[208:211]
s_waitcnt lgkmcnt(6)
ds_read_b64_tr_b16 a[8:9], v41 offset:32768
ds_read_b64_tr_b16 a[10:11], v41 offset:36864
v_mfma_f32_16x16x32_bf16 v[224:227], a[24:27], a[128:131], v[224:227]
buffer_load_dwordx4 a[224:227], v1, s[32:35], s56 offen offset:0 sc1
v_mfma_f32_16x16x32_bf16 v[228:231], a[24:27], a[132:135], v[228:231]
v_mfma_f32_16x16x32_bf16 v[232:235], a[24:27], a[136:139], v[232:235]
v_mfma_f32_16x16x32_bf16 v[236:239], a[24:27], a[140:143], v[236:239]
s_waitcnt lgkmcnt(6)
ds_read_b64_tr_b16 a[12:13], v41 offset:40960
ds_read_b64_tr_b16 a[14:15], v41 offset:45056
v_mfma_f32_16x16x32_bf16 v[252:255], a[28:31], a[140:143], v[252:255]
buffer_load_dwordx4 a[228:231], v1, s[32:35], s56 offen offset:1024 sc1
v_mfma_f32_16x16x32_bf16 v[248:251], a[28:31], a[136:139], v[248:251]
s_waitcnt vmcnt(21)
v_accvgpr_read_b32 v52, a60
v_accvgpr_read_b32 v53, a61
v_mfma_f32_16x16x32_bf16 v[244:247], a[28:31], a[132:135], v[244:247]
v_accvgpr_read_b32 v54, a62
v_accvgpr_read_b32 v55, a63
v_mfma_f32_16x16x32_bf16 v[240:243], a[28:31], a[128:131], v[240:243]
s_waitcnt vmcnt(9) lgkmcnt(4)
ds_read_b64_tr_b16 a[16:17], v42 offset:32768
ds_read_b64_tr_b16 a[18:19], v42 offset:36864
v_mfma_f32_16x16x32_bf16 v[128:131], a[0:3], a[144:147], v[128:131]
buffer_load_dwordx4 a[232:235], v1, s[32:35], s56 offen offset:2048 sc1
v_mfma_f32_16x16x32_bf16 v[128:131], a[4:7], a[192:195], v[128:131]
v_accvgpr_read_b32 v48, a56
v_accvgpr_read_b32 v49, a57
v_mfma_f32_16x16x32_bf16 v[132:135], a[0:3], a[148:151], v[132:135]
v_accvgpr_read_b32 v50, a58
v_accvgpr_read_b32 v51, a59
v_mfma_f32_16x16x32_bf16 v[132:135], a[4:7], a[196:199], v[132:135]
s_waitcnt lgkmcnt(6)
ds_read_b64_tr_b16 a[20:21], v42 offset:40960
ds_read_b64_tr_b16 a[22:23], v42 offset:45056
v_mfma_f32_16x16x32_bf16 v[136:139], a[0:3], a[152:155], v[136:139]
buffer_load_dwordx4 a[236:239], v1, s[32:35], s56 offen offset:3072 sc1
v_mfma_f32_16x16x32_bf16 v[136:139], a[4:7], a[200:203], v[136:139]
s_add_u32 s56, s99, 4096
v_fmac_f32 v48, v32, v52
v_fmac_f32 v50, v32, v54
v_mfma_f32_16x16x32_bf16 v[140:143], a[0:3], a[156:159], v[140:143]
v_fmac_f32 v49, v33, v53
v_fmac_f32 v51, v33, v55
v_mfma_f32_16x16x32_bf16 v[140:143], a[4:7], a[204:207], v[140:143]
s_waitcnt lgkmcnt(4)
ds_read_b64_tr_b16 a[24:25], v43 offset:32768
ds_read_b64_tr_b16 a[26:27], v43 offset:36864
v_mfma_f32_16x16x32_bf16 v[156:159], a[8:11], a[156:159], v[156:159]
buffer_load_dwordx4 a[160:163], v1, s[32:35], s56 offen offset:0 sc1
v_mfma_f32_16x16x32_bf16 v[156:159], a[12:15], a[204:207], v[156:159]
v_fma_f32 v48, -v34, v54, v48
v_fmac_f32 v50, v34, v52
v_mfma_f32_16x16x32_bf16 v[152:155], a[8:11], a[152:155], v[152:155]
v_fma_f32 v49, -v35, v55, v49
v_fmac_f32 v51, v35, v53
v_mfma_f32_16x16x32_bf16 v[152:155], a[12:15], a[200:203], v[152:155]
s_waitcnt lgkmcnt(6)
ds_read_b64_tr_b16 a[28:29], v43 offset:40960
ds_read_b64_tr_b16 a[30:31], v43 offset:45056
v_mfma_f32_16x16x32_bf16 v[148:151], a[8:11], a[148:151], v[148:151]
buffer_load_dwordx4 a[164:167], v1, s[32:35], s56 offen offset:1024 sc1
v_mfma_f32_16x16x32_bf16 v[148:151], a[12:15], a[196:199], v[148:151]
v_accvgpr_read_b32 v52, a52
v_accvgpr_read_b32 v53, a53
v_mfma_f32_16x16x32_bf16 v[144:147], a[8:11], a[144:147], v[144:147]
v_accvgpr_read_b32 v54, a54
v_accvgpr_read_b32 v55, a55
v_mfma_f32_16x16x32_bf16 v[144:147], a[12:15], a[192:195], v[144:147]
s_waitcnt lgkmcnt(4)
ds_read_b64_tr_b16 a[0:1], v44 offset:32768
ds_read_b64_tr_b16 a[2:3], v44 offset:36864
v_mfma_f32_16x16x32_bf16 v[160:163], a[16:19], a[144:147], v[160:163]
buffer_load_dwordx4 a[168:171], v1, s[32:35], s56 offen offset:2048 sc1
v_mfma_f32_16x16x32_bf16 v[160:163], a[20:23], a[192:195], v[160:163]
v_fmac_f32 v52, v32, v48
v_fmac_f32 v54, v32, v50
v_mfma_f32_16x16x32_bf16 v[164:167], a[16:19], a[148:151], v[164:167]
v_fmac_f32 v53, v33, v49
v_fmac_f32 v55, v33, v51
v_mfma_f32_16x16x32_bf16 v[164:167], a[20:23], a[196:199], v[164:167]
s_waitcnt lgkmcnt(6)
ds_read_b64_tr_b16 a[4:5], v44 offset:40960
ds_read_b64_tr_b16 a[6:7], v44 offset:45056
v_mfma_f32_16x16x32_bf16 v[168:171], a[16:19], a[152:155], v[168:171]
buffer_load_dwordx4 a[172:175], v1, s[32:35], s56 offen offset:3072 sc1
v_mfma_f32_16x16x32_bf16 v[168:171], a[20:23], a[200:203], v[168:171]
s_add_u32 s56, s48, 0
v_fma_f32 v52, -v34, v50, v52
v_fmac_f32 v54, v34, v48
v_mfma_f32_16x16x32_bf16 v[172:175], a[16:19], a[156:159], v[172:175]
v_fma_f32 v53, -v35, v51, v53
v_fmac_f32 v55, v35, v49
v_mfma_f32_16x16x32_bf16 v[172:175], a[20:23], a[204:207], v[172:175]
s_waitcnt lgkmcnt(4)
ds_read_b64_tr_b16 a[8:9], v45 offset:32768
ds_read_b64_tr_b16 a[10:11], v45 offset:36864
v_mfma_f32_16x16x32_bf16 v[188:191], a[24:27], a[156:159], v[188:191]
buffer_load_dwordx4 a[176:179], v1, s[32:35], s56 offen offset:0 sc1
v_mfma_f32_16x16x32_bf16 v[188:191], a[28:31], a[204:207], v[188:191]
v_accvgpr_read_b32 v48, a48
v_accvgpr_read_b32 v49, a49
v_mfma_f32_16x16x32_bf16 v[184:187], a[24:27], a[152:155], v[184:187]
v_accvgpr_read_b32 v50, a50
v_accvgpr_read_b32 v51, a51
v_mfma_f32_16x16x32_bf16 v[184:187], a[28:31], a[200:203], v[184:187]
s_waitcnt lgkmcnt(6)
ds_read_b64_tr_b16 a[12:13], v45 offset:40960
ds_read_b64_tr_b16 a[14:15], v45 offset:45056
v_mfma_f32_16x16x32_bf16 v[180:183], a[24:27], a[148:151], v[180:183]
v_fmac_f32 v48, v32, v52
v_fmac_f32 v50, v32, v54
v_mfma_f32_16x16x32_bf16 v[180:183], a[28:31], a[196:199], v[180:183]
buffer_load_dwordx4 a[180:183], v1, s[32:35], s56 offen offset:1024 sc1
v_mfma_f32_16x16x32_bf16 v[176:179], a[24:27], a[144:147], v[176:179]
v_fmac_f32 v49, v33, v53
v_fmac_f32 v51, v33, v55
v_mfma_f32_16x16x32_bf16 v[176:179], a[28:31], a[192:195], v[176:179]
s_waitcnt lgkmcnt(4)
ds_read_b64_tr_b16 a[16:17], v46 offset:32768
ds_read_b64_tr_b16 a[18:19], v46 offset:36864
v_mfma_f32_16x16x32_bf16 v[192:195], a[0:3], a[144:147], v[192:195]
v_fma_f32 v48, -v34, v54, v48
v_fmac_f32 v50, v34, v52
v_mfma_f32_16x16x32_bf16 v[192:195], a[4:7], a[192:195], v[192:195]
buffer_load_dwordx4 a[184:187], v1, s[32:35], s56 offen offset:2048 sc1
v_mfma_f32_16x16x32_bf16 v[196:199], a[0:3], a[148:151], v[196:199]
v_fma_f32 v49, -v35, v55, v49
v_fmac_f32 v51, v35, v53
v_mfma_f32_16x16x32_bf16 v[196:199], a[4:7], a[196:199], v[196:199]
s_waitcnt lgkmcnt(6)
ds_read_b64_tr_b16 a[20:21], v46 offset:40960
ds_read_b64_tr_b16 a[22:23], v46 offset:45056
v_mfma_f32_16x16x32_bf16 v[200:203], a[0:3], a[152:155], v[200:203]
v_accvgpr_read_b32 v52, a44
v_accvgpr_read_b32 v53, a45
v_mfma_f32_16x16x32_bf16 v[200:203], a[4:7], a[200:203], v[200:203]
v_accvgpr_read_b32 v54, a46
v_accvgpr_read_b32 v55, a47
v_mfma_f32_16x16x32_bf16 v[204:207], a[0:3], a[156:159], v[204:207]
buffer_load_dwordx4 a[188:191], v1, s[32:35], s56 offen offset:3072 sc1
v_mfma_f32_16x16x32_bf16 v[204:207], a[4:7], a[204:207], v[204:207]
s_waitcnt lgkmcnt(4)
ds_read_b64_tr_b16 a[24:25], v47 offset:32768
ds_read_b64_tr_b16 a[26:27], v47 offset:36864
v_mfma_f32_16x16x32_bf16 v[220:223], a[8:11], a[156:159], v[220:223]
s_add_u32 s56, s48, 4096
v_fmac_f32 v52, v32, v48
v_fmac_f32 v54, v32, v50
v_mfma_f32_16x16x32_bf16 v[220:223], a[12:15], a[204:207], v[220:223]
v_fmac_f32 v53, v33, v49
v_fmac_f32 v55, v33, v51
v_mfma_f32_16x16x32_bf16 v[216:219], a[8:11], a[152:155], v[216:219]
buffer_load_dwordx4 a[64:67], v1, s[32:35], s56 offen offset:0 sc1
v_mfma_f32_16x16x32_bf16 v[216:219], a[12:15], a[200:203], v[216:219]
s_waitcnt lgkmcnt(6)
ds_read_b64_tr_b16 a[28:29], v47 offset:40960
ds_read_b64_tr_b16 a[30:31], v47 offset:45056
v_mfma_f32_16x16x32_bf16 v[212:215], a[8:11], a[148:151], v[212:215]
v_fma_f32 v52, -v34, v50, v52
v_fmac_f32 v54, v34, v48
v_mfma_f32_16x16x32_bf16 v[212:215], a[12:15], a[196:199], v[212:215]
v_fma_f32 v53, -v35, v51, v53
v_fmac_f32 v55, v35, v49
v_mfma_f32_16x16x32_bf16 v[208:211], a[8:11], a[144:147], v[208:211]
buffer_load_dwordx4 a[68:71], v1, s[32:35], s56 offen offset:1024 sc1
v_mfma_f32_16x16x32_bf16 v[208:211], a[12:15], a[192:195], v[208:211]
s_waitcnt lgkmcnt(4)
ds_read_b64_tr_b16 a[0:1], v40 offset:49152
ds_read_b64_tr_b16 a[2:3], v40 offset:53248
v_mfma_f32_16x16x32_bf16 v[224:227], a[16:19], a[144:147], v[224:227]
v_accvgpr_read_b32 v48, a40
v_accvgpr_read_b32 v49, a41
v_mfma_f32_16x16x32_bf16 v[224:227], a[20:23], a[192:195], v[224:227]
v_accvgpr_read_b32 v50, a42
v_accvgpr_read_b32 v51, a43
v_mfma_f32_16x16x32_bf16 v[228:231], a[16:19], a[148:151], v[228:231]
v_fmac_f32 v48, v32, v52
v_fmac_f32 v50, v32, v54
v_mfma_f32_16x16x32_bf16 v[228:231], a[20:23], a[196:199], v[228:231]
s_waitcnt lgkmcnt(6)
ds_read_b64_tr_b16 a[4:5], v40 offset:57344
ds_read_b64_tr_b16 a[6:7], v40 offset:61440
v_mfma_f32_16x16x32_bf16 v[232:235], a[16:19], a[152:155], v[232:235]
buffer_load_dwordx4 a[72:75], v1, s[32:35], s56 offen offset:2048 sc1
v_mfma_f32_16x16x32_bf16 v[232:235], a[20:23], a[200:203], v[232:235]
v_fmac_f32 v49, v33, v53
v_fmac_f32 v51, v33, v55
v_mfma_f32_16x16x32_bf16 v[236:239], a[16:19], a[156:159], v[236:239]
v_fma_f32 v48, -v34, v54, v48
v_fmac_f32 v50, v34, v52
v_mfma_f32_16x16x32_bf16 v[236:239], a[20:23], a[204:207], v[236:239]
s_waitcnt lgkmcnt(4)
ds_read_b64_tr_b16 a[8:9], v41 offset:49152
ds_read_b64_tr_b16 a[10:11], v41 offset:53248
v_mfma_f32_16x16x32_bf16 v[252:255], a[24:27], a[156:159], v[252:255]
buffer_load_dwordx4 a[76:79], v1, s[32:35], s56 offen offset:3072 sc1
v_mfma_f32_16x16x32_bf16 v[252:255], a[28:31], a[204:207], v[252:255]
s_add_u32 s56, s49, 0
v_fma_f32 v49, -v35, v55, v49
v_fmac_f32 v51, v35, v53
v_mfma_f32_16x16x32_bf16 v[248:251], a[24:27], a[152:155], v[248:251]
s_waitcnt vmcnt(21)
v_accvgpr_read_b32 v52, a36
v_accvgpr_read_b32 v53, a37
v_mfma_f32_16x16x32_bf16 v[248:251], a[28:31], a[200:203], v[248:251]
s_waitcnt lgkmcnt(6)
ds_read_b64_tr_b16 a[12:13], v41 offset:57344
ds_read_b64_tr_b16 a[14:15], v41 offset:61440
v_mfma_f32_16x16x32_bf16 v[244:247], a[24:27], a[148:151], v[244:247]
buffer_load_dwordx4 a[80:83], v1, s[32:35], s56 offen offset:0 sc1
v_mfma_f32_16x16x32_bf16 v[244:247], a[28:31], a[196:199], v[244:247]
v_accvgpr_read_b32 v54, a38
v_accvgpr_read_b32 v55, a39
v_mfma_f32_16x16x32_bf16 v[240:243], a[24:27], a[144:147], v[240:243]
v_fmac_f32 v52, v32, v48
v_fmac_f32 v54, v32, v50
v_mfma_f32_16x16x32_bf16 v[240:243], a[28:31], a[192:195], v[240:243]
s_waitcnt vmcnt(13) lgkmcnt(4)
ds_read_b64_tr_b16 a[16:17], v42 offset:49152
ds_read_b64_tr_b16 a[18:19], v42 offset:53248
v_mfma_f32_16x16x32_bf16 v[128:131], a[0:3], a[208:211], v[128:131]
buffer_load_dwordx4 a[84:87], v1, s[32:35], s56 offen offset:1024 sc1
v_mfma_f32_16x16x32_bf16 v[128:131], a[4:7], a[224:227], v[128:131]
s_waitcnt lgkmcnt(15)
ds_read_b64_tr_b16 a[20:21], v42 offset:57344
ds_read_b64_tr_b16 a[22:23], v42 offset:61440
v_mfma_f32_16x16x32_bf16 v[132:135], a[0:3], a[212:215], v[132:135]
v_fmac_f32 v53, v33, v49
v_fmac_f32 v55, v33, v51
v_mfma_f32_16x16x32_bf16 v[132:135], a[4:7], a[228:231], v[132:135]
s_waitcnt lgkmcnt(8)
ds_read_b64_tr_b16 a[24:25], v43 offset:49152
ds_read_b64_tr_b16 a[26:27], v43 offset:53248
v_mfma_f32_16x16x32_bf16 v[136:139], a[0:3], a[216:219], v[136:139]
buffer_load_dwordx4 a[88:91], v1, s[32:35], s56 offen offset:2048 sc1
v_mfma_f32_16x16x32_bf16 v[136:139], a[4:7], a[232:235], v[136:139]
v_fma_f32 v52, -v34, v50, v52
v_fmac_f32 v54, v34, v48
v_mfma_f32_16x16x32_bf16 v[140:143], a[0:3], a[220:223], v[140:143]
v_fma_f32 v53, -v35, v51, v53
v_fmac_f32 v55, v35, v49
v_mfma_f32_16x16x32_bf16 v[140:143], a[4:7], a[236:239], v[140:143]
s_waitcnt lgkmcnt(6)
ds_read_b64_tr_b16 a[28:29], v43 offset:57344
ds_read_b64_tr_b16 a[30:31], v43 offset:61440
v_mfma_f32_16x16x32_bf16 v[156:159], a[8:11], a[220:223], v[156:159]
v_accvgpr_read_b32 v48, a32
v_accvgpr_read_b32 v49, a33
v_mfma_f32_16x16x32_bf16 v[156:159], a[12:15], a[236:239], v[156:159]
buffer_load_dwordx4 a[92:95], v1, s[32:35], s56 offen offset:3072 sc1
v_mfma_f32_16x16x32_bf16 v[152:155], a[8:11], a[216:219], v[152:155]
s_add_u32 s56, s49, 4096
v_accvgpr_read_b32 v50, a34
v_accvgpr_read_b32 v51, a35
v_mfma_f32_16x16x32_bf16 v[152:155], a[12:15], a[232:235], v[152:155]
s_waitcnt lgkmcnt(8)
ds_read_b64_tr_b16 a[0:1], v44 offset:49152
ds_read_b64_tr_b16 a[2:3], v44 offset:53248
v_mfma_f32_16x16x32_bf16 v[148:151], a[8:11], a[212:215], v[148:151]
v_fmac_f32 v48, v32, v52
v_fmac_f32 v50, v32, v54
v_mfma_f32_16x16x32_bf16 v[148:151], a[12:15], a[228:231], v[148:151]
buffer_load_dwordx4 a[112:115], v1, s[32:35], s56 offen offset:0 sc1
v_mfma_f32_16x16x32_bf16 v[144:147], a[8:11], a[208:211], v[144:147]
v_fmac_f32 v49, v33, v53
v_fmac_f32 v51, v33, v55
v_mfma_f32_16x16x32_bf16 v[144:147], a[12:15], a[224:227], v[144:147]
s_waitcnt lgkmcnt(6)
ds_read_b64_tr_b16 a[4:5], v44 offset:57344
ds_read_b64_tr_b16 a[6:7], v44 offset:61440
v_mfma_f32_16x16x32_bf16 v[160:163], a[16:19], a[208:211], v[160:163]
v_fma_f32 v48, -v34, v54, v48
v_fmac_f32 v50, v34, v52
v_mfma_f32_16x16x32_bf16 v[160:163], a[20:23], a[224:227], v[160:163]
buffer_load_dwordx4 a[116:119], v1, s[32:35], s56 offen offset:1024 sc1
v_mfma_f32_16x16x32_bf16 v[164:167], a[16:19], a[212:215], v[164:167]
v_fma_f32 v49, -v35, v55, v49
v_fmac_f32 v51, v35, v53
v_mfma_f32_16x16x32_bf16 v[164:167], a[20:23], a[228:231], v[164:167]
s_waitcnt lgkmcnt(8)
ds_read_b64_tr_b16 a[8:9], v45 offset:49152
ds_read_b64_tr_b16 a[10:11], v45 offset:53248
v_mfma_f32_16x16x32_bf16 v[168:171], a[16:19], a[216:219], v[168:171]
v_cmp_u_f32 s[70:71], v48, v49
v_mfma_f32_16x16x32_bf16 v[168:171], a[20:23], a[232:235], v[168:171]
s_waitcnt lgkmcnt(15)
ds_read_b64_tr_b16 a[12:13], v45 offset:57344
ds_read_b64_tr_b16 a[14:15], v45 offset:61440
v_mfma_f32_16x16x32_bf16 v[172:175], a[16:19], a[220:223], v[172:175]
buffer_load_dwordx4 a[120:123], v1, s[32:35], s56 offen offset:2048 sc1
v_mfma_f32_16x16x32_bf16 v[172:175], a[20:23], a[236:239], v[172:175]
s_waitcnt lgkmcnt(8)
ds_read_b64_tr_b16 a[16:17], v46 offset:49152
ds_read_b64_tr_b16 a[18:19], v46 offset:53248
v_mfma_f32_16x16x32_bf16 v[188:191], a[24:27], a[220:223], v[188:191]
v_cmp_u_f32 vcc, v50, v51
s_nop 0
s_or_b64 vcc, vcc, s[70:71]
s_cbranch_scc1 PAG_retry
PAG_ok:
v_mfma_f32_16x16x32_bf16 v[188:191], a[28:31], a[236:239], v[188:191]
ds_write_b128 v2, v[48:51] offset:1024
v_mfma_f32_16x16x32_bf16 v[184:187], a[24:27], a[216:219], v[184:187]
buffer_load_dwordx4 a[124:127], v1, s[32:35], s56 offen offset:3072 sc1
v_mfma_f32_16x16x32_bf16 v[184:187], a[28:31], a[232:235], v[184:187]
s_waitcnt lgkmcnt(11)
ds_read_b64_tr_b16 a[20:21], v46 offset:57344
ds_read_b64_tr_b16 a[22:23], v46 offset:61440
v_mfma_f32_16x16x32_bf16 v[180:183], a[24:27], a[212:215], v[180:183]
s_add_u32 s56, s50, 0
ds_read_b128 v[52:55], v3 offset:1792
ds_read_b128 v[56:59], v3 offset:1536
v_mfma_f32_16x16x32_bf16 v[180:183], a[28:31], a[228:231], v[180:183]
ds_read_b128 v[60:63], v3 offset:1280
v_mfma_f32_16x16x32_bf16 v[176:179], a[24:27], a[208:211], v[176:179]
buffer_load_dwordx4 a[96:99], v1, s[32:35], s56 offen offset:0 sc1
v_mfma_f32_16x16x32_bf16 v[176:179], a[28:31], a[224:227], v[176:179]
s_waitcnt lgkmcnt(12)
ds_read_b64_tr_b16 a[24:25], v47 offset:49152
ds_read_b64_tr_b16 a[26:27], v47 offset:53248
v_mfma_f32_16x16x32_bf16 v[192:195], a[0:3], a[208:211], v[192:195]
L_tr12:
s_cbranch_execz L_tr16
ds_read_b128 v[48:51], v3 offset:1024
v_mfma_f32_16x16x32_bf16 v[192:195], a[4:7], a[224:227], v[192:195]
v_mfma_f32_16x16x32_bf16 v[196:199], a[0:3], a[212:215], v[196:199]
v_mfma_f32_16x16x32_bf16 v[196:199], a[4:7], a[228:231], v[196:199]
s_waitcnt lgkmcnt(15)
ds_read_b64_tr_b16 a[28:29], v47 offset:57344
ds_read_b64_tr_b16 a[30:31], v47 offset:61440
v_mfma_f32_16x16x32_bf16 v[200:203], a[0:3], a[216:219], v[200:203]
buffer_load_dwordx4 a[100:103], v1, s[32:35], s56 offen offset:1024 sc1
v_mfma_f32_16x16x32_bf16 v[200:203], a[4:7], a[232:235], v[200:203]
v_mfma_f32_16x16x32_bf16 v[204:207], a[0:3], a[220:223], v[204:207]
v_mfma_f32_16x16x32_bf16 v[204:207], a[4:7], a[236:239], v[204:207]
s_waitcnt lgkmcnt(13)
v_mfma_f32_16x16x32_bf16 v[220:223], a[8:11], a[220:223], v[220:223]
buffer_load_dwordx4 a[104:107], v1, s[32:35], s56 offen offset:2048 sc1
v_mfma_f32_16x16x32_bf16 v[220:223], a[12:15], a[236:239], v[220:223]
v_xor_b32 v46, 0x10000, v46
v_xor_b32 v47, 0x10000, v47
v_mfma_f32_16x16x32_bf16 v[216:219], a[8:11], a[216:219], v[216:219]
v_xor_b32 v44, 0x10000, v44
v_xor_b32 v45, 0x10000, v45
v_mfma_f32_16x16x32_bf16 v[216:219], a[12:15], a[232:235], v[216:219]
s_waitcnt lgkmcnt(6)
v_fmac_f32 v56, v36, v52
v_fmac_f32 v58, v36, v54
v_mfma_f32_16x16x32_bf16 v[212:215], a[8:11], a[212:215], v[212:215]
v_xor_b32 v42, 0x10000, v42
v_xor_b32 v43, 0x10000, v43
v_mfma_f32_16x16x32_bf16 v[212:215], a[12:15], a[228:231], v[212:215]
v_xor_b32 v40, 0x10000, v40
v_xor_b32 v41, 0x10000, v41
v_mfma_f32_16x16x32_bf16 v[208:211], a[8:11], a[208:211], v[208:211]
s_waitcnt lgkmcnt(0)
s_barrier
v_fmac_f32 v57, v37, v53
v_mfma_f32_16x16x32_bf16 v[208:211], a[12:15], a[224:227], v[208:211]
s_waitcnt lgkmcnt(8)
ds_read_b64_tr_b16 a[0:1], v40 offset:0
ds_read_b64_tr_b16 a[2:3], v40 offset:4096
v_mfma_f32_16x16x32_bf16 v[224:227], a[16:19], a[208:211], v[224:227]
buffer_load_dwordx4 a[108:111], v1, s[32:35], s56 offen offset:3072 sc1
v_mfma_f32_16x16x32_bf16 v[224:227], a[20:23], a[224:227], v[224:227]
s_add_u32 s56, s50, 4096
v_fmac_f32 v59, v37, v55
v_fma_f32 v56, -v38, v54, v56
v_mfma_f32_16x16x32_bf16 v[228:231], a[16:19], a[212:215], v[228:231]
v_fmac_f32 v58, v38, v52
v_fma_f32 v57, -v39, v55, v57
v_mfma_f32_16x16x32_bf16 v[228:231], a[20:23], a[228:231], v[228:231]
s_waitcnt lgkmcnt(10)
ds_read_b64_tr_b16 a[4:5], v40 offset:8192
ds_read_b64_tr_b16 a[6:7], v40 offset:12288
v_mfma_f32_16x16x32_bf16 v[232:235], a[16:19], a[216:219], v[232:235]
buffer_load_dwordx4 a[128:131], v1, s[32:35], s56 offen offset:0 sc1
v_mfma_f32_16x16x32_bf16 v[232:235], a[20:23], a[232:235], v[232:235]
v_fmac_f32 v59, v39, v53
v_mfma_f32_16x16x32_bf16 v[236:239], a[16:19], a[220:223], v[236:239]
ds_read_b128 v[52:55], v3
v_mfma_f32_16x16x32_bf16 v[236:239], a[20:23], a[236:239], v[236:239]
s_waitcnt lgkmcnt(5)
ds_read_b64_tr_b16 a[8:9], v41 offset:0
ds_read_b64_tr_b16 a[10:11], v41 offset:4096
v_mfma_f32_16x16x32_bf16 v[252:255], a[24:27], a[220:223], v[252:255]
buffer_load_dwordx4 a[132:135], v1, s[32:35], s56 offen offset:1024 sc1
v_mfma_f32_16x16x32_bf16 v[252:255], a[28:31], a[236:239], v[252:255]
v_fmac_f32 v60, v36, v56
v_fmac_f32 v62, v36, v58
v_mfma_f32_16x16x32_bf16 v[248:251], a[24:27], a[216:219], v[248:251]
v_fmac_f32 v61, v37, v57
v_fmac_f32 v63, v37, v59
v_mfma_f32_16x16x32_bf16 v[248:251], a[28:31], a[232:235], v[248:251]
s_waitcnt lgkmcnt(7)
ds_read_b64_tr_b16 a[12:13], v41 offset:8192
ds_read_b64_tr_b16 a[14:15], v41 offset:12288
v_mfma_f32_16x16x32_bf16 v[244:247], a[24:27], a[212:215], v[244:247]
buffer_load_dwordx4 a[136:139], v1, s[32:35], s56 offen offset:2048 sc1
v_mfma_f32_16x16x32_bf16 v[244:247], a[28:31], a[228:231], v[244:247]
v_fma_f32 v60, -v38, v58, v60
v_fmac_f32 v62, v38, v56
v_mfma_f32_16x16x32_bf16 v[240:243], a[24:27], a[208:211], v[240:243]
v_fma_f32 v61, -v39, v59, v61
v_fmac_f32 v63, v39, v57
v_mfma_f32_16x16x32_bf16 v[240:243], a[28:31], a[224:227], v[240:243]
s_waitcnt vmcnt(19) lgkmcnt(5)
ds_read_b64_tr_b16 a[16:17], v42 offset:0
ds_read_b64_tr_b16 a[18:19], v42 offset:4096
v_mfma_f32_16x16x32_bf16 v[128:131], a[0:3], a[160:163], v[128:131]
buffer_load_dwordx4 a[140:143], v1, s[32:35], s56 offen offset:3072 sc1
v_mfma_f32_16x16x32_bf16 v[128:131], a[4:7], a[176:179], v[128:131]
ds_read_b128 v[56:59], v3 offset:256
v_mfma_f32_16x16x32_bf16 v[132:135], a[0:3], a[164:167], v[132:135]
buffer_load_dword v13, v12, s[36:39], s68 offen offset:32 sc0 sc1
v_mfma_f32_16x16x32_bf16 v[132:135], a[4:7], a[180:183], v[132:135]
s_waitcnt lgkmcnt(8)
ds_read_b64_tr_b16 a[20:21], v42 offset:8192
ds_read_b64_tr_b16 a[22:23], v42 offset:12288
v_mfma_f32_16x16x32_bf16 v[136:139], a[0:3], a[168:171], v[136:139]
s_add_u32 s56, s51, 0
v_fmac_f32 v48, v36, v60
v_fmac_f32 v50, v36, v62
v_mfma_f32_16x16x32_bf16 v[136:139], a[4:7], a[184:187], v[136:139]
v_fmac_f32 v49, v37, v61
v_fmac_f32 v51, v37, v63
v_mfma_f32_16x16x32_bf16 v[140:143], a[0:3], a[172:175], v[140:143]
buffer_load_dwordx4 a[144:147], v1, s[32:35], s56 offen offset:0 sc1
v_mfma_f32_16x16x32_bf16 v[140:143], a[4:7], a[188:191], v[140:143]
s_waitcnt lgkmcnt(5)
ds_read_b64_tr_b16 a[24:25], v43 offset:0
ds_read_b64_tr_b16 a[26:27], v43 offset:4096
v_mfma_f32_16x16x32_bf16 v[156:159], a[8:11], a[172:175], v[156:159]
v_fma_f32 v48, -v38, v62, v48
v_fmac_f32 v50, v38, v60
v_mfma_f32_16x16x32_bf16 v[156:159], a[12:15], a[188:191], v[156:159]
v_fma_f32 v49, -v39, v63, v49
v_fmac_f32 v51, v39, v61
v_mfma_f32_16x16x32_bf16 v[152:155], a[8:11], a[168:171], v[152:155]
buffer_load_dwordx4 a[148:151], v1, s[32:35], s56 offen offset:1024 sc1
v_mfma_f32_16x16x32_bf16 v[152:155], a[12:15], a[184:187], v[152:155]
s_waitcnt lgkmcnt(7)
ds_read_b64_tr_b16 a[28:29], v43 offset:8192
ds_read_b64_tr_b16 a[30:31], v43 offset:12288
v_mfma_f32_16x16x32_bf16 v[148:151], a[8:11], a[164:167], v[148:151]
ds_read_b128 v[60:63], v3 offset:512
v_mfma_f32_16x16x32_bf16 v[148:151], a[12:15], a[180:183], v[148:151]
v_fmac_f32 v52, v28, v48
v_fmac_f32 v54, v28, v50
v_mfma_f32_16x16x32_bf16 v[144:147], a[8:11], a[160:163], v[144:147]
buffer_load_dwordx4 a[152:155], v1, s[32:35], s56 offen offset:2048 sc1
v_mfma_f32_16x16x32_bf16 v[144:147], a[12:15], a[176:179], v[144:147]
s_waitcnt lgkmcnt(5)
ds_read_b64_tr_b16 a[0:1], v44 offset:0
ds_read_b64_tr_b16 a[2:3], v44 offset:4096
v_mfma_f32_16x16x32_bf16 v[160:163], a[16:19], a[160:163], v[160:163]
v_fmac_f32 v53, v29, v49
v_fmac_f32 v55, v29, v51
v_mfma_f32_16x16x32_bf16 v[160:163], a[20:23], a[176:179], v[160:163]
v_fma_f32 v52, -v30, v50, v52
v_fmac_f32 v54, v30, v48
v_mfma_f32_16x16x32_bf16 v[164:167], a[16:19], a[164:167], v[164:167]
buffer_load_dwordx4 a[156:159], v1, s[32:35], s56 offen offset:3072 sc1
v_mfma_f32_16x16x32_bf16 v[164:167], a[20:23], a[180:183], v[164:167]
s_waitcnt lgkmcnt(7)
ds_read_b64_tr_b16 a[4:5], v44 offset:8192
ds_read_b64_tr_b16 a[6:7], v44 offset:12288
v_mfma_f32_16x16x32_bf16 v[168:171], a[16:19], a[168:171], v[168:171]
s_add_u32 s56, s51, 4096
v_fma_f32 v53, -v31, v51, v53
v_fmac_f32 v55, v31, v49
v_mfma_f32_16x16x32_bf16 v[168:171], a[20:23], a[184:187], v[168:171]
v_fmac_f32 v56, v28, v52
v_fmac_f32 v58, v28, v54
v_mfma_f32_16x16x32_bf16 v[172:175], a[16:19], a[172:175], v[172:175]
buffer_load_dwordx4 v14, s[12:15], s55 offen lds
v_mfma_f32_16x16x32_bf16 v[172:175], a[20:23], a[188:191], v[172:175]
s_waitcnt lgkmcnt(5)
ds_read_b64_tr_b16 a[8:9], v45 offset:0
ds_read_b64_tr_b16 a[10:11], v45 offset:4096
v_mfma_f32_16x16x32_bf16 v[188:191], a[24:27], a[172:175], v[188:191]
s_add_u32 m0, s54, 4096
v_fmac_f32 v57, v29, v53
v_fmac_f32 v59, v29, v55
v_mfma_f32_16x16x32_bf16 v[188:191], a[28:31], a[188:191], v[188:191]
v_fma_f32 v56, -v30, v54, v56
v_fmac_f32 v58, v30, v52
v_mfma_f32_16x16x32_bf16 v[184:187], a[24:27], a[168:171], v[184:187]
buffer_load_dwordx4 v11, s[12:15], s55 offen lds
v_mfma_f32_16x16x32_bf16 v[184:187], a[28:31], a[184:187], v[184:187]
s_waitcnt lgkmcnt(7)
ds_read_b64_tr_b16 a[12:13], v45 offset:8192
ds_read_b64_tr_b16 a[14:15], v45 offset:12288
v_mfma_f32_16x16x32_bf16 v[180:183], a[24:27], a[164:167], v[180:183]
s_add_u32 s55, s97, 8192
s_lshl_b32 s55, s55, 4
s_add_u32 m0, s54, 8192
v_mfma_f32_16x16x32_bf16 v[180:183], a[28:31], a[180:183], v[180:183]
v_fma_f32 v57, -v31, v55, v57
v_fmac_f32 v59, v31, v53
v_mfma_f32_16x16x32_bf16 v[176:179], a[24:27], a[160:163], v[176:179]
buffer_load_dwordx4 v14, s[12:15], s55 offen lds
v_mfma_f32_16x16x32_bf16 v[176:179], a[28:31], a[176:179], v[176:179]
s_waitcnt lgkmcnt(4)
ds_read_b64_tr_b16 a[16:17], v46 offset:0
ds_read_b64_tr_b16 a[18:19], v46 offset:4096
v_mfma_f32_16x16x32_bf16 v[192:195], a[0:3], a[160:163], v[192:195]
s_add_u32 m0, s54, 12288
v_fmac_f32 v60, v28, v56
v_mfma_f32_16x16x32_bf16 v[192:195], a[4:7], a[176:179], v[192:195]
v_fmac_f32 v62, v28, v58
v_fmac_f32 v61, v29, v57
v_mfma_f32_16x16x32_bf16 v[196:199], a[0:3], a[164:167], v[196:199]
buffer_load_dwordx4 v11, s[12:15], s55 offen lds
v_mfma_f32_16x16x32_bf16 v[196:199], a[4:7], a[180:183], v[196:199]
s_waitcnt lgkmcnt(6)
ds_read_b64_tr_b16 a[20:21], v46 offset:8192
ds_read_b64_tr_b16 a[22:23], v46 offset:12288
v_mfma_f32_16x16x32_bf16 v[200:203], a[0:3], a[168:171], v[200:203]
s_lshl_b32 s55, s76, 4
s_add_u32 m0, s54, 16384
v_fmac_f32 v63, v29, v59
v_mfma_f32_16x16x32_bf16 v[200:203], a[4:7], a[184:187], v[200:203]
v_fma_f32 v60, -v30, v58, v60
v_fmac_f32 v62, v30, v56
v_mfma_f32_16x16x32_bf16 v[204:207], a[0:3], a[172:175], v[204:207]
buffer_load_dwordx4 v14, s[12:15], s55 offen lds
v_mfma_f32_16x16x32_bf16 v[204:207], a[4:7], a[188:191], v[204:207]
s_waitcnt lgkmcnt(4)
ds_read_b64_tr_b16 a[24:25], v47 offset:0
ds_read_b64_tr_b16 a[26:27], v47 offset:4096
v_mfma_f32_16x16x32_bf16 v[220:223], a[8:11], a[172:175], v[220:223]
s_add_u32 m0, s54, 20480
v_fma_f32 v61, -v31, v59, v61
v_fmac_f32 v63, v31, v57
v_mfma_f32_16x16x32_bf16 v[220:223], a[12:15], a[188:191], v[220:223]
v_cndmask_b32 v48, v48, v52, s[64:65]
v_cndmask_b32 v49, v49, v53, s[64:65]
v_mfma_f32_16x16x32_bf16 v[216:219], a[8:11], a[168:171], v[216:219]
buffer_load_dwordx4 v11, s[12:15], s55 offen lds
v_mfma_f32_16x16x32_bf16 v[216:219], a[12:15], a[184:187], v[216:219]
s_waitcnt lgkmcnt(6)
ds_read_b64_tr_b16 a[28:29], v47 offset:8192
ds_read_b64_tr_b16 a[30:31], v47 offset:12288
v_mfma_f32_16x16x32_bf16 v[212:215], a[8:11], a[164:167], v[212:215]
s_add_u32 s55, s98, 8192
s_lshl_b32 s55, s55, 4
s_add_u32 m0, s54, 24576
v_mfma_f32_16x16x32_bf16 v[212:215], a[12:15], a[180:183], v[212:215]
v_cndmask_b32 v50, v50, v54, s[64:65]
v_cndmask_b32 v51, v51, v55, s[64:65]
v_mfma_f32_16x16x32_bf16 v[208:211], a[8:11], a[160:163], v[208:211]
v_cndmask_b32 v48, v48, v56, s[66:67]
v_cndmask_b32 v49, v49, v57, s[66:67]
v_mfma_f32_16x16x32_bf16 v[208:211], a[12:15], a[176:179], v[208:211]
s_waitcnt lgkmcnt(4)
ds_read_b64_tr_b16 a[0:1], v40 offset:16384
ds_read_b64_tr_b16 a[2:3], v40 offset:20480
v_mfma_f32_16x16x32_bf16 v[224:227], a[16:19], a[160:163], v[224:227]
buffer_load_dwordx4 v14, s[12:15], s55 offen lds
v_mfma_f32_16x16x32_bf16 v[224:227], a[20:23], a[176:179], v[224:227]
s_add_u32 m0, s54, 28672
v_cndmask_b32 v50, v50, v58, s[66:67]
v_cndmask_b32 v51, v51, v59, s[66:67]
v_mfma_f32_16x16x32_bf16 v[228:231], a[16:19], a[164:167], v[228:231]
v_cndmask_b32 v48, v48, v60, s[74:75]
v_cndmask_b32 v49, v49, v61, s[74:75]
v_mfma_f32_16x16x32_bf16 v[228:231], a[20:23], a[180:183], v[228:231]
s_waitcnt lgkmcnt(6)
ds_read_b64_tr_b16 a[4:5], v40 offset:24576
ds_read_b64_tr_b16 a[6:7], v40 offset:28672
v_mfma_f32_16x16x32_bf16 v[232:235], a[16:19], a[168:171], v[232:235]
buffer_load_dwordx4 v11, s[12:15], s55 offen lds
v_mfma_f32_16x16x32_bf16 v[232:235], a[20:23], a[184:187], v[232:235]
s_add_u32 s55, s99, 8192
s_lshl_b32 s55, s55, 4
s_add_u32 m0, s54, 32768
v_mfma_f32_16x16x32_bf16 v[236:239], a[16:19], a[172:175], v[236:239]
v_cndmask_b32 v50, v50, v62, s[74:75]
v_cndmask_b32 v51, v51, v63, s[74:75]
v_mfma_f32_16x16x32_bf16 v[236:239], a[20:23], a[188:191], v[236:239]
s_waitcnt lgkmcnt(4)
ds_read_b64_tr_b16 a[8:9], v41 offset:16384
ds_read_b64_tr_b16 a[10:11], v41 offset:20480
v_mfma_f32_16x16x32_bf16 v[252:255], a[24:27], a[172:175], v[252:255]
buffer_load_dwordx4 a[192:195], v1, s[32:35], s56 offen offset:0 sc1
v_mfma_f32_16x16x32_bf16 v[252:255], a[28:31], a[188:191], v[252:255]
v_fmac_f32 v20, v24, v48
v_fmac_f32 v22, v24, v50
v_mfma_f32_16x16x32_bf16 v[248:251], a[24:27], a[168:171], v[248:251]
v_fmac_f32 v21, v25, v49
v_fmac_f32 v23, v25, v51
v_mfma_f32_16x16x32_bf16 v[248:251], a[28:31], a[184:187], v[248:251]
s_waitcnt lgkmcnt(6)
ds_read_b64_tr_b16 a[12:13], v41 offset:24576
ds_read_b64_tr_b16 a[14:15], v41 offset:28672
v_mfma_f32_16x16x32_bf16 v[244:247], a[24:27], a[164:167], v[244:247]
buffer_load_dwordx4 a[196:199], v1, s[32:35], s56 offen offset:1024 sc1
v_mfma_f32_16x16x32_bf16 v[244:247], a[28:31], a[180:183], v[244:247]
v_fma_f32 v20, -v26, v50, v20
v_fmac_f32 v22, v26, v48
v_mfma_f32_16x16x32_bf16 v[240:243], a[24:27], a[160:163], v[240:243]
v_fma_f32 v21, -v27, v51, v21
v_fmac_f32 v23, v27, v49
v_mfma_f32_16x16x32_bf16 v[240:243], a[28:31], a[176:179], v[240:243]
s_waitcnt vmcnt(27) lgkmcnt(4)
ds_read_b64_tr_b16 a[16:17], v42 offset:16384
ds_read_b64_tr_b16 a[18:19], v42 offset:20480
v_mfma_f32_16x16x32_bf16 v[128:131], a[0:3], a[64:67], v[128:131]
buffer_load_dwordx4 a[200:203], v1, s[32:35], s56 offen offset:2048 sc1
v_mfma_f32_16x16x32_bf16 v[128:131], a[4:7], a[80:83], v[128:131]
s_waitcnt lgkmcnt(15)
ds_read_b64_tr_b16 a[20:21], v42 offset:24576
ds_read_b64_tr_b16 a[22:23], v42 offset:28672
v_mfma_f32_16x16x32_bf16 v[132:135], a[0:3], a[68:71], v[132:135]
v_xor_b32 v52, 16, v7
v_fmac_f32 v64, v16, v48
v_mfma_f32_16x16x32_bf16 v[132:135], a[4:7], a[84:87], v[132:135]
s_waitcnt lgkmcnt(8)
ds_read_b64_tr_b16 a[24:25], v43 offset:16384
ds_read_b64_tr_b16 a[26:27], v43 offset:20480
v_mfma_f32_16x16x32_bf16 v[136:139], a[0:3], a[72:75], v[136:139]
buffer_load_dwordx4 a[204:207], v1, s[32:35], s56 offen offset:3072 sc1
v_mfma_f32_16x16x32_bf16 v[136:139], a[4:7], a[88:91], v[136:139]
s_waitcnt vmcnt(16)
v_fmac_f32 v65, v16, v20
v_fmac_f32 v80, v17, v49
v_mfma_f32_16x16x32_bf16 v[140:143], a[0:3], a[76:79], v[140:143]
P3b_chk:
v_cmp_ne_u32 vcc, s3, v13
s_nop 0
s_and_b64 vcc, vcc, exec
s_cbranch_scc1 P3b_retry
P3b_ok:
v_mfma_f32_16x16x32_bf16 v[140:143], a[4:7], a[92:95], v[140:143]
s_waitcnt lgkmcnt(6)
ds_read_b64_tr_b16 a[28:29], v43 offset:24576
ds_read_b64_tr_b16 a[30:31], v43 offset:28672
v_mfma_f32_16x16x32_bf16 v[156:159], a[8:11], a[76:79], v[156:159]
s_add_u32 s56, s97, 8192
v_fmac_f32 v81, v17, v21
v_fmac_f32 v96, v16, v50
v_mfma_f32_16x16x32_bf16 v[156:159], a[12:15], a[92:95], v[156:159]
buffer_load_dwordx4 a[208:211], v1, s[32:35], s56 offen offset:0 sc1
v_mfma_f32_16x16x32_bf16 v[152:155], a[8:11], a[72:75], v[152:155]
v_fmac_f32 v97, v16, v22
v_fmac_f32 v112, v17, v51
v_mfma_f32_16x16x32_bf16 v[152:155], a[12:15], a[88:91], v[152:155]
s_waitcnt lgkmcnt(8)
ds_read_b64_tr_b16 a[0:1], v44 offset:16384
ds_read_b64_tr_b16 a[2:3], v44 offset:20480
v_mfma_f32_16x16x32_bf16 v[148:151], a[8:11], a[68:71], v[148:151]
v_fmac_f32 v113, v17, v23
v_fma_f32 v64, -v18, v50, v64
v_mfma_f32_16x16x32_bf16 v[148:151], a[12:15], a[84:87], v[148:151]
buffer_load_dwordx4 a[212:215], v1, s[32:35], s56 offen offset:1024 sc1
v_mfma_f32_16x16x32_bf16 v[144:147], a[8:11], a[64:67], v[144:147]
v_fma_f32 v65, -v18, v22, v65
v_fma_f32 v80, -v19, v51, v80
v_mfma_f32_16x16x32_bf16 v[144:147], a[12:15], a[80:83], v[144:147]
s_waitcnt lgkmcnt(6)
ds_read_b64_tr_b16 a[4:5], v44 offset:24576
ds_read_b64_tr_b16 a[6:7], v44 offset:28672
v_mfma_f32_16x16x32_bf16 v[160:163], a[16:19], a[64:67], v[160:163]
v_fma_f32 v81, -v19, v23, v81
v_fmac_f32 v96, v18, v48
v_mfma_f32_16x16x32_bf16 v[160:163], a[20:23], a[80:83], v[160:163]
v_fmac_f32 v97, v18, v20
v_fmac_f32 v112, v19, v49
v_mfma_f32_16x16x32_bf16 v[164:167], a[16:19], a[68:71], v[164:167]
buffer_load_dwordx4 a[216:219], v1, s[32:35], s56 offen offset:2048 sc1
v_mfma_f32_16x16x32_bf16 v[164:167], a[20:23], a[84:87], v[164:167]
s_waitcnt lgkmcnt(8)
ds_read_b64_tr_b16 a[8:9], v45 offset:16384
ds_read_b64_tr_b16 a[10:11], v45 offset:20480
v_mfma_f32_16x16x32_bf16 v[168:171], a[16:19], a[72:75], v[168:171]
v_fmac_f32 v113, v19, v21
v_fmac_f32 v66, v16, v64
v_mfma_f32_16x16x32_bf16 v[168:171], a[20:23], a[88:91], v[168:171]
s_waitcnt lgkmcnt(15)
ds_read_b64_tr_b16 a[12:13], v45 offset:24576
ds_read_b64_tr_b16 a[14:15], v45 offset:28672
v_mfma_f32_16x16x32_bf16 v[172:175], a[16:19], a[76:79], v[172:175]
buffer_load_dwordx4 a[220:223], v1, s[32:35], s56 offen offset:3072 sc1
v_mfma_f32_16x16x32_bf16 v[172:175], a[20:23], a[92:95], v[172:175]
s_waitcnt lgkmcnt(8)
ds_read_b64_tr_b16 a[16:17], v46 offset:16384
ds_read_b64_tr_b16 a[18:19], v46 offset:20480
v_mfma_f32_16x16x32_bf16 v[188:191], a[24:27], a[76:79], v[188:191]
s_mov_b32 s56, s76
v_fmac_f32 v67, v16, v65
v_fmac_f32 v82, v17, v80
v_mfma_f32_16x16x32_bf16 v[188:191], a[28:31], a[92:95], v[188:191]
v_fmac_f32 v83, v17, v81
v_fmac_f32 v98, v16, v96
v_mfma_f32_16x16x32_bf16 v[184:187], a[24:27], a[72:75], v[184:187]
buffer_load_dwordx2 a[224:225], v10, s[32:35], s56 offen offset:0 sc1
v_mfma_f32_16x16x32_bf16 v[184:187], a[28:31], a[88:91], v[184:187]
s_waitcnt lgkmcnt(10)
ds_read_b64_tr_b16 a[20:21], v46 offset:24576
ds_read_b64_tr_b16 a[22:23], v46 offset:28672
v_mfma_f32_16x16x32_bf16 v[180:183], a[24:27], a[68:71], v[180:183]
buffer_load_dwordx2 a[226:227], v10, s[32:35], s56 offen offset:512 sc1
v_mfma_f32_16x16x32_bf16 v[180:183], a[28:31], a[84:87], v[180:183]
v_fmac_f32 v99, v16, v97
v_fmac_f32 v114, v17, v112
v_mfma_f32_16x16x32_bf16 v[176:179], a[24:27], a[64:67], v[176:179]
v_fmac_f32 v115, v17, v113
v_fma_f32 v66, -v18, v96, v66
v_mfma_f32_16x16x32_bf16 v[176:179], a[28:31], a[80:83], v[176:179]
s_waitcnt lgkmcnt(8)
ds_read_b64_tr_b16 a[24:25], v47 offset:16384
ds_read_b64_tr_b16 a[26:27], v47 offset:20480
v_mfma_f32_16x16x32_bf16 v[192:195], a[0:3], a[64:67], v[192:195]
buffer_load_dwordx2 a[228:229], v10, s[32:35], s56 offen offset:1024 sc1
v_mfma_f32_16x16x32_bf16 v[192:195], a[4:7], a[80:83], v[192:195]
v_fma_f32 v67, -v18, v97, v67
v_fma_f32 v82, -v19, v112, v82
v_mfma_f32_16x16x32_bf16 v[196:199], a[0:3], a[68:71], v[196:199]
buffer_load_dwordx2 a[230:231], v10, s[32:35], s56 offen offset:1536 sc1
v_mfma_f32_16x16x32_bf16 v[196:199], a[4:7], a[84:87], v[196:199]
s_waitcnt lgkmcnt(10)
ds_read_b64_tr_b16 a[28:29], v47 offset:24576
ds_read_b64_tr_b16 a[30:31], v47 offset:28672
v_mfma_f32_16x16x32_bf16 v[200:203], a[0:3], a[72:75], v[200:203]
buffer_load_dwordx2 a[232:233], v10, s[32:35], s56 offen offset:2048 sc1
v_mfma_f32_16x16x32_bf16 v[200:203], a[4:7], a[88:91], v[200:203]
v_fma_f32 v83, -v19, v113, v83
v_fmac_f32 v98, v18, v64
v_mfma_f32_16x16x32_bf16 v[204:207], a[0:3], a[76:79], v[204:207]
buffer_load_dwordx2 a[234:235], v10, s[32:35], s56 offen offset:2560 sc1
v_mfma_f32_16x16x32_bf16 v[204:207], a[4:7], a[92:95], v[204:207]
s_waitcnt lgkmcnt(8)
v_fmac_f32 v99, v18, v65
v_fmac_f32 v114, v19, v80
v_mfma_f32_16x16x32_bf16 v[220:223], a[8:11], a[76:79], v[220:223]
buffer_load_dwordx2 a[236:237], v10, s[32:35], s56 offen offset:3072 sc1
v_mfma_f32_16x16x32_bf16 v[220:223], a[12:15], a[92:95], v[220:223]
v_fmac_f32 v115, v19, v81
v_cvt_pk_bf16_f32 v56, v64, v65
v_mfma_f32_16x16x32_bf16 v[216:219], a[8:11], a[72:75], v[216:219]
buffer_load_dwordx2 a[238:239], v10, s[32:35], s56 offen offset:3584 sc1
v_mfma_f32_16x16x32_bf16 v[216:219], a[12:15], a[88:91], v[216:219]
s_add_u32 s56, s98, 8192
v_cvt_pk_bf16_f32 v57, v66, v67
v_mfma_f32_16x16x32_bf16 v[212:215], a[8:11], a[68:71], v[212:215]
ds_write_b64 v6, v[56:57] offset:0
v_mfma_f32_16x16x32_bf16 v[212:215], a[12:15], a[84:87], v[212:215]
v_cvt_pk_bf16_f32 v58, v80, v81
v_cvt_pk_bf16_f32 v59, v82, v83
v_mfma_f32_16x16x32_bf16 v[208:211], a[8:11], a[64:67], v[208:211]
s_waitcnt lgkmcnt(0)
s_barrier
v_mfma_f32_16x16x32_bf16 v[208:211], a[12:15], a[80:83], v[208:211]
s_waitcnt lgkmcnt(5)
ds_read_b64_tr_b16 a[0:1], v40 offset:32768
ds_read_b64_tr_b16 a[2:3], v40 offset:36864
v_mfma_f32_16x16x32_bf16 v[224:227], a[16:19], a[64:67], v[224:227]
buffer_load_dwordx4 a[160:163], v1, s[32:35], s56 offen offset:0 sc1
v_mfma_f32_16x16x32_bf16 v[224:227], a[20:23], a[80:83], v[224:227]
ds_write_b64 v6, v[58:59] offset:512
v_mfma_f32_16x16x32_bf16 v[228:231], a[16:19], a[68:71], v[228:231]
s_waitcnt lgkmcnt(15)
ds_read_b64_tr_b16 a[32:33], v7 offset:0
ds_read_b64_tr_b16 a[34:35], v52 offset:256
v_mfma_f32_16x16x32_bf16 v[228:231], a[20:23], a[84:87], v[228:231]
s_waitcnt lgkmcnt(10)
ds_read_b64_tr_b16 a[4:5], v40 offset:40960
ds_read_b64_tr_b16 a[6:7], v40 offset:45056
v_mfma_f32_16x16x32_bf16 v[232:235], a[16:19], a[72:75], v[232:235]
buffer_load_dwordx4 a[164:167], v1, s[32:35], s56 offen offset:1024 sc1
v_mfma_f32_16x16x32_bf16 v[232:235], a[20:23], a[88:91], v[232:235]
v_cvt_pk_bf16_f32 v60, v96, v97
v_cvt_pk_bf16_f32 v61, v98, v99
v_mfma_f32_16x16x32_bf16 v[236:239], a[16:19], a[76:79], v[236:239]
ds_write_b64 v6, v[60:61] offset:1024
v_mfma_f32_16x16x32_bf16 v[236:239], a[20:23], a[92:95], v[236:239]
s_waitcnt lgkmcnt(9)
ds_read_b64_tr_b16 a[8:9], v41 offset:32768
ds_read_b64_tr_b16 a[10:11], v41 offset:36864
v_mfma_f32_16x16x32_bf16 v[252:255], a[24:27], a[76:79], v[252:255]
buffer_load_dwordx4 a[168:171], v1, s[32:35], s56 offen offset:2048 sc1
v_mfma_f32_16x16x32_bf16 v[252:255], a[28:31], a[92:95], v[252:255]
v_cvt_pk_bf16_f32 v62, v112, v113
v_cvt_pk_bf16_f32 v63, v114, v115
v_mfma_f32_16x16x32_bf16 v[248:251], a[24:27], a[72:75], v[248:251]
ds_write_b64 v6, v[62:63] offset:1536
v_mfma_f32_16x16x32_bf16 v[248:251], a[28:31], a[88:91], v[248:251]
s_waitcnt lgkmcnt(12)
ds_read_b64_tr_b16 a[12:13], v41 offset:40960
ds_read_b64_tr_b16 a[14:15], v41 offset:45056
v_mfma_f32_16x16x32_bf16 v[244:247], a[24:27], a[68:71], v[244:247]
buffer_load_dwordx4 a[172:175], v1, s[32:35], s56 offen offset:3072 sc1
v_mfma_f32_16x16x32_bf16 v[244:247], a[28:31], a[84:87], v[244:247]
s_add_u32 s56, s99, 8192
s_waitcnt lgkmcnt(8)
v_mfma_f32_16x16x32_bf16 v[240:243], a[24:27], a[64:67], v[240:243]
s_waitcnt lgkmcnt(15)
ds_read_b64_tr_b16 a[48:49], v7 offset:1024
ds_read_b64_tr_b16 a[50:51], v52 offset:1280
v_mfma_f32_16x16x32_bf16 v[240:243], a[28:31], a[80:83], v[240:243]
s_waitcnt vmcnt(37) lgkmcnt(8)
ds_read_b64_tr_b16 a[16:17], v42 offset:32768
ds_read_b64_tr_b16 a[18:19], v42 offset:36864
v_mfma_f32_16x16x32_bf16 v[128:131], a[0:3], a[112:115], v[128:131]
buffer_store_dwordx4 a[32:35], v1, s[32:35], s72 offen offset:0 sc0 sc1
v_mfma_f32_16x16x32_bf16 v[128:131], a[4:7], a[96:99], v[128:131]
v_fmac_f32 v68, v16, v66
v_fmac_f32 v69, v16, v67
v_mfma_f32_16x16x32_bf16 v[132:135], a[0:3], a[116:119], v[132:135]
v_fmac_f32 v84, v17, v82
v_fmac_f32 v85, v17, v83
v_mfma_f32_16x16x32_bf16 v[132:135], a[4:7], a[100:103], v[132:135]
s_waitcnt lgkmcnt(10)
ds_read_b64_tr_b16 a[20:21], v42 offset:40960
ds_read_b64_tr_b16 a[22:23], v42 offset:45056
v_mfma_f32_16x16x32_bf16 v[136:139], a[0:3], a[120:123], v[136:139]
v_fmac_f32 v100, v16, v98
v_fmac_f32 v101, v16, v99
v_mfma_f32_16x16x32_bf16 v[136:139], a[4:7], a[104:107], v[136:139]
v_fmac_f32 v116, v17, v114
v_fmac_f32 v117, v17, v115
v_mfma_f32_16x16x32_bf16 v[140:143], a[0:3], a[124:127], v[140:143]
v_fma_f32 v68, -v18, v98, v68
v_fma_f32 v69, -v18, v99, v69
v_mfma_f32_16x16x32_bf16 v[140:143], a[4:7], a[108:111], v[140:143]
s_waitcnt lgkmcnt(6)
ds_read_b64_tr_b16 a[24:25], v43 offset:32768
ds_read_b64_tr_b16 a[26:27], v43 offset:36864
v_mfma_f32_16x16x32_bf16 v[156:159], a[8:11], a[124:127], v[156:159]
v_fma_f32 v84, -v19, v114, v84
v_fma_f32 v85, -v19, v115, v85
v_mfma_f32_16x16x32_bf16 v[156:159], a[12:15], a[108:111], v[156:159]
v_fmac_f32 v100, v18, v66
v_fmac_f32 v101, v18, v67
v_mfma_f32_16x16x32_bf16 v[152:155], a[8:11], a[120:123], v[152:155]
buffer_load_dwordx4 v14, s[12:15], s55 offen lds
v_mfma_f32_16x16x32_bf16 v[152:155], a[12:15], a[104:107], v[152:155]
s_waitcnt lgkmcnt(8)
ds_read_b64_tr_b16 a[28:29], v43 offset:40960
ds_read_b64_tr_b16 a[30:31], v43 offset:45056
v_mfma_f32_16x16x32_bf16 v[148:151], a[8:11], a[116:119], v[148:151]
s_add_u32 m0, s54, 36864
v_fmac_f32 v116, v19, v82
v_fmac_f32 v117, v19, v83
v_mfma_f32_16x16x32_bf16 v[148:151], a[12:15], a[100:103], v[148:151]
v_fmac_f32 v70, v16, v68
v_fmac_f32 v71, v16, v69
v_mfma_f32_16x16x32_bf16 v[144:147], a[8:11], a[112:115], v[144:147]
v_fmac_f32 v86, v17, v84
v_fmac_f32 v87, v17, v85
v_mfma_f32_16x16x32_bf16 v[144:147], a[12:15], a[96:99], v[144:147]
s_waitcnt lgkmcnt(4)
ds_read_b64_tr_b16 a[0:1], v44 offset:32768
ds_read_b64_tr_b16 a[2:3], v44 offset:36864
v_mfma_f32_16x16x32_bf16 v[160:163], a[16:19], a[112:115], v[160:163]
buffer_load_dwordx4 v11, s[12:15], s55 offen lds
v_mfma_f32_16x16x32_bf16 v[160:163], a[20:23], a[96:99], v[160:163]
s_lshl_b32 s55, s77, 4
s_add_u32 m0, s54, 40960
v_fmac_f32 v102, v16, v100
v_mfma_f32_16x16x32_bf16 v[164:167], a[16:19], a[116:119], v[164:167]
v_fmac_f32 v103, v16, v101
v_fmac_f32 v118, v17, v116
v_mfma_f32_16x16x32_bf16 v[164:167], a[20:23], a[100:103], v[164:167]
s_waitcnt lgkmcnt(6)
ds_read_b64_tr_b16 a[4:5], v44 offset:40960
ds_read_b64_tr_b16 a[6:7], v44 offset:45056
v_mfma_f32_16x16x32_bf16 v[168:171], a[16:19], a[120:123], v[168:171]
buffer_load_dwordx4 v14, s[12:15], s55 offen lds
v_mfma_f32_16x16x32_bf16 v[168:171], a[20:23], a[104:107], v[168:171]
s_add_u32 m0, s54, 45056
v_fmac_f32 v119, v17, v117
v_fma_f32 v70, -v18, v100, v70
v_mfma_f32_16x16x32_bf16 v[172:175], a[16:19], a[124:127], v[172:175]
v_fma_f32 v71, -v18, v101, v71
v_fma_f32 v86, -v19, v116, v86
v_mfma_f32_16x16x32_bf16 v[172:175], a[20:23], a[108:111], v[172:175]
s_waitcnt lgkmcnt(4)
ds_read_b64_tr_b16 a[8:9], v45 offset:32768
ds_read_b64_tr_b16 a[10:11], v45 offset:36864
v_mfma_f32_16x16x32_bf16 v[188:191], a[24:27], a[124:127], v[188:191]
buffer_load_dwordx4 v11, s[12:15], s55 offen lds
v_mfma_f32_16x16x32_bf16 v[188:191], a[28:31], a[108:111], v[188:191]
s_add_u32 s55, s48, 8192
s_lshl_b32 s55, s55, 4
s_add_u32 m0, s54, 49152
v_mfma_f32_16x16x32_bf16 v[184:187], a[24:27], a[120:123], v[184:187]
v_fma_f32 v87, -v19, v117, v87
v_fmac_f32 v102, v18, v68
v_mfma_f32_16x16x32_bf16 v[184:187], a[28:31], a[104:107], v[184:187]
s_waitcnt lgkmcnt(6)
ds_read_b64_tr_b16 a[12:13], v45 offset:40960
ds_read_b64_tr_b16 a[14:15], v45 offset:45056
v_mfma_f32_16x16x32_bf16 v[180:183], a[24:27], a[116:119], v[180:183]
buffer_store_dwordx4 a[48:51], v1, s[32:35], s73 offen offset:0 sc0 sc1
v_mfma_f32_16x16x32_bf16 v[180:183], a[28:31], a[100:103], v[180:183]
v_fmac_f32 v103, v18, v69
v_fmac_f32 v118, v19, v84
v_mfma_f32_16x16x32_bf16 v[176:179], a[24:27], a[112:115], v[176:179]
v_fmac_f32 v119, v19, v85
v_cvt_pk_bf16_f32 v56, v68, v69
v_mfma_f32_16x16x32_bf16 v[176:179], a[28:31], a[96:99], v[176:179]
s_waitcnt lgkmcnt(4)
ds_read_b64_tr_b16 a[16:17], v46 offset:32768
ds_read_b64_tr_b16 a[18:19], v46 offset:36864
v_mfma_f32_16x16x32_bf16 v[192:195], a[0:3], a[112:115], v[192:195]
v_cvt_pk_bf16_f32 v57, v70, v71
v_mfma_f32_16x16x32_bf16 v[192:195], a[4:7], a[96:99], v[192:195]
ds_write_b64 v6, v[56:57] offset:2048
v_mfma_f32_16x16x32_bf16 v[196:199], a[0:3], a[116:119], v[196:199]
v_cvt_pk_bf16_f32 v58, v84, v85
v_cvt_pk_bf16_f32 v59, v86, v87
v_mfma_f32_16x16x32_bf16 v[196:199], a[4:7], a[100:103], v[196:199]
s_waitcnt lgkmcnt(7)
ds_read_b64_tr_b16 a[20:21], v46 offset:40960
ds_read_b64_tr_b16 a[22:23], v46 offset:45056
v_mfma_f32_16x16x32_bf16 v[200:203], a[0:3], a[120:123], v[200:203]
ds_write_b64 v6, v[58:59] offset:2560
v_mfma_f32_16x16x32_bf16 v[200:203], a[4:7], a[104:107], v[200:203]
s_waitcnt lgkmcnt(15)
L_tr13:
s_cbranch_execz L_trret2
ds_read_b64_tr_b16 a[36:37], v7 offset:2048
ds_read_b64_tr_b16 a[38:39], v52 offset:2304
v_mfma_f32_16x16x32_bf16 v[204:207], a[0:3], a[124:127], v[204:207]
v_cvt_pk_bf16_f32 v60, v100, v101
v_cvt_pk_bf16_f32 v61, v102, v103
v_mfma_f32_16x16x32_bf16 v[204:207], a[4:7], a[108:111], v[204:207]
s_waitcnt lgkmcnt(8)
ds_read_b64_tr_b16 a[24:25], v47 offset:32768
ds_read_b64_tr_b16 a[26:27], v47 offset:36864
v_mfma_f32_16x16x32_bf16 v[220:223], a[8:11], a[124:127], v[220:223]
ds_write_b64 v6, v[60:61] offset:3072
v_mfma_f32_16x16x32_bf16 v[220:223], a[12:15], a[108:111], v[220:223]
buffer_load_dwordx4 v14, s[12:15], s55 offen lds
v_mfma_f32_16x16x32_bf16 v[216:219], a[8:11], a[120:123], v[216:219]
s_add_u32 m0, s54, 53248
v_cvt_pk_bf16_f32 v62, v116, v117
v_cvt_pk_bf16_f32 v63, v118, v119
v_mfma_f32_16x16x32_bf16 v[216:219], a[12:15], a[104:107], v[216:219]
s_waitcnt lgkmcnt(11)
ds_read_b64_tr_b16 a[28:29], v47 offset:40960
ds_read_b64_tr_b16 a[30:31], v47 offset:45056
v_mfma_f32_16x16x32_bf16 v[212:215], a[8:11], a[116:119], v[212:215]
ds_write_b64 v6, v[62:63] offset:3584
v_mfma_f32_16x16x32_bf16 v[212:215], a[12:15], a[100:103], v[212:215]
buffer_load_dwordx4 v11, s[12:15], s55 offen lds
v_mfma_f32_16x16x32_bf16 v[208:211], a[8:11], a[112:115], v[208:211]
s_add_u32 s55, s49, 8192
s_lshl_b32 s55, s55, 4
s_add_u32 m0, s54, 57344
v_mfma_f32_16x16x32_bf16 v[208:211], a[12:15], a[96:99], v[208:211]
s_waitcnt lgkmcnt(9)
ds_read_b64_tr_b16 a[0:1], v40 offset:49152
ds_read_b64_tr_b16 a[2:3], v40 offset:53248
v_mfma_f32_16x16x32_bf16 v[224:227], a[16:19], a[112:115], v[224:227]
s_waitcnt lgkmcnt(15)
ds_read_b64_tr_b16 a[52:53], v7 offset:3072
ds_read_b64_tr_b16 a[54:55], v52 offset:3328
v_mfma_f32_16x16x32_bf16 v[224:227], a[20:23], a[96:99], v[224:227]
v_fmac_f32 v72, v16, v70
v_fmac_f32 v73, v16, v71
v_mfma_f32_16x16x32_bf16 v[228:231], a[16:19], a[116:119], v[228:231]
buffer_load_dwordx4 v14, s[12:15], s55 offen lds
v_mfma_f32_16x16x32_bf16 v[228:231], a[20:23], a[100:103], v[228:231]
s_waitcnt lgkmcnt(13)
ds_read_b64_tr_b16 a[4:5], v40 offset:57344
ds_read_b64_tr_b16 a[6:7], v40 offset:61440
v_mfma_f32_16x16x32_bf16 v[232:235], a[16:19], a[120:123], v[232:235]
s_add_u32 m0, s54, 61440
s_waitcnt lgkmcnt(12)
v_fmac_f32 v88, v17, v86
v_mfma_f32_16x16x32_bf16 v[232:235], a[20:23], a[104:107], v[232:235]
v_fmac_f32 v89, v17, v87
v_fmac_f32 v104, v16, v102
v_mfma_f32_16x16x32_bf16 v[236:239], a[16:19], a[124:127], v[236:239]
buffer_store_dwordx4 a[36:39], v1, s[32:35], s72 offen offset:1024 sc0 sc1
v_mfma_f32_16x16x32_bf16 v[236:239], a[20:23], a[108:111], v[236:239]
s_waitcnt lgkmcnt(7)
ds_read_b64_tr_b16 a[8:9], v41 offset:49152
ds_read_b64_tr_b16 a[10:11], v41 offset:53248
v_mfma_f32_16x16x32_bf16 v[252:255], a[24:27], a[124:127], v[252:255]
v_fmac_f32 v105, v16, v103
v_fmac_f32 v120, v17, v118
v_mfma_f32_16x16x32_bf16 v[252:255], a[28:31], a[108:111], v[252:255]
v_fmac_f32 v121, v17, v119
v_fma_f32 v72, -v18, v102, v72
v_mfma_f32_16x16x32_bf16 v[248:251], a[24:27], a[120:123], v[248:251]
v_fma_f32 v73, -v18, v103, v73
v_fma_f32 v88, -v19, v118, v88
v_mfma_f32_16x16x32_bf16 v[248:251], a[28:31], a[104:107], v[248:251]
s_waitcnt lgkmcnt(9)
ds_read_b64_tr_b16 a[12:13], v41 offset:57344
ds_read_b64_tr_b16 a[14:15], v41 offset:61440
v_mfma_f32_16x16x32_bf16 v[244:247], a[24:27], a[116:119], v[244:247]
v_fma_f32 v89, -v19, v119, v89
v_fmac_f32 v104, v18, v70
v_mfma_f32_16x16x32_bf16 v[244:247], a[28:31], a[100:103], v[244:247]
v_fmac_f32 v105, v18, v71
v_fmac_f32 v120, v19, v86
v_mfma_f32_16x16x32_bf16 v[240:243], a[24:27], a[112:115], v[240:243]
v_fmac_f32 v121, v19, v87
v_fmac_f32 v74, v16, v72
v_mfma_f32_16x16x32_bf16 v[240:243], a[28:31], a[96:99], v[240:243]
s_waitcnt vmcnt(38) lgkmcnt(4)
ds_read_b64_tr_b16 a[16:17], v42 offset:49152
ds_read_b64_tr_b16 a[18:19], v42 offset:53248
v_mfma_f32_16x16x32_bf16 v[128:131], a[0:3], a[128:131], v[128:131]
v_fmac_f32 v75, v16, v73
v_fmac_f32 v90, v17, v88
v_mfma_f32_16x16x32_bf16 v[128:131], a[4:7], a[144:147], v[128:131]
s_waitcnt lgkmcnt(15)
ds_read_b64_tr_b16 a[20:21], v42 offset:57344
ds_read_b64_tr_b16 a[22:23], v42 offset:61440
v_mfma_f32_16x16x32_bf16 v[132:135], a[0:3], a[132:135], v[132:135]
v_fmac_f32 v91, v17, v89
v_fmac_f32 v106, v16, v104
v_mfma_f32_16x16x32_bf16 v[132:135], a[4:7], a[148:151], v[132:135]
s_waitcnt lgkmcnt(8)
ds_read_b64_tr_b16 a[24:25], v43 offset:49152
ds_read_b64_tr_b16 a[26:27], v43 offset:53248
v_mfma_f32_16x16x32_bf16 v[136:139], a[0:3], a[136:139], v[136:139]
buffer_load_dwordx4 v11, s[12:15], s55 offen lds
v_mfma_f32_16x16x32_bf16 v[136:139], a[4:7], a[152:155], v[136:139]
s_lshl_b32 s55, s78, 4
s_add_u32 m0, s54, 65536
v_fmac_f32 v107, v16, v105
v_mfma_f32_16x16x32_bf16 v[140:143], a[0:3], a[140:143], v[140:143]
v_fmac_f32 v122, v17, v120
v_fmac_f32 v123, v17, v121
v_mfma_f32_16x16x32_bf16 v[140:143], a[4:7], a[156:159], v[140:143]
s_waitcnt lgkmcnt(6)
ds_read_b64_tr_b16 a[28:29], v43 offset:57344
ds_read_b64_tr_b16 a[30:31], v43 offset:61440
v_mfma_f32_16x16x32_bf16 v[156:159], a[8:11], a[140:143], v[156:159]
buffer_load_dwordx4 a[176:179], v1, s[32:35], s56 offen offset:0 sc1
v_mfma_f32_16x16x32_bf16 v[156:159], a[12:15], a[156:159], v[156:159]
v_fma_f32 v74, -v18, v104, v74
v_fma_f32 v75, -v18, v105, v75
v_mfma_f32_16x16x32_bf16 v[152:155], a[8:11], a[136:139], v[152:155]
v_fma_f32 v90, -v19, v120, v90
v_fma_f32 v91, -v19, v121, v91
v_mfma_f32_16x16x32_bf16 v[152:155], a[12:15], a[152:155], v[152:155]
s_waitcnt lgkmcnt(8)
ds_read_b64_tr_b16 a[0:1], v44 offset:49152
ds_read_b64_tr_b16 a[2:3], v44 offset:53248
v_mfma_f32_16x16x32_bf16 v[148:151], a[8:11], a[132:135], v[148:151]
buffer_load_dwordx4 a[180:183], v1, s[32:35], s56 offen offset:1024 sc1
v_mfma_f32_16x16x32_bf16 v[148:151], a[12:15], a[148:151], v[148:151]
v_fmac_f32 v106, v18, v72
v_fmac_f32 v107, v18, v73
v_mfma_f32_16x16x32_bf16 v[144:147], a[8:11], a[128:131], v[144:147]
v_fmac_f32 v122, v19, v88
v_fmac_f32 v123, v19, v89
v_mfma_f32_16x16x32_bf16 v[144:147], a[12:15], a[144:147], v[144:147]
s_waitcnt lgkmcnt(6)
ds_read_b64_tr_b16 a[4:5], v44 offset:57344
ds_read_b64_tr_b16 a[6:7], v44 offset:61440
v_mfma_f32_16x16x32_bf16 v[160:163], a[16:19], a[128:131], v[160:163]
buffer_store_dwordx4 a[52:55], v1, s[32:35], s73 offen offset:1024 sc0 sc1
v_mfma_f32_16x16x32_bf16 v[160:163], a[20:23], a[144:147], v[160:163]
v_cvt_pk_bf16_f32 v56, v72, v73
v_cvt_pk_bf16_f32 v57, v74, v75
v_mfma_f32_16x16x32_bf16 v[164:167], a[16:19], a[132:135], v[164:167]
ds_write_b64 v6, v[56:57] offset:0
v_mfma_f32_16x16x32_bf16 v[164:167], a[20:23], a[148:151], v[164:167]
s_waitcnt lgkmcnt(9)
ds_read_b64_tr_b16 a[8:9], v45 offset:49152
ds_read_b64_tr_b16 a[10:11], v45 offset:53248
v_mfma_f32_16x16x32_bf16 v[168:171], a[16:19], a[136:139], v[168:171]
v_cvt_pk_bf16_f32 v58, v88, v89
v_cvt_pk_bf16_f32 v59, v90, v91
v_mfma_f32_16x16x32_bf16 v[168:171], a[20:23], a[152:155], v[168:171]
s_waitcnt lgkmcnt(15)
ds_read_b64_tr_b16 a[12:13], v45 offset:57344
ds_read_b64_tr_b16 a[14:15], v45 offset:61440
v_mfma_f32_16x16x32_bf16 v[172:175], a[16:19], a[140:143], v[172:175]
ds_write_b64 v6, v[58:59] offset:512
v_mfma_f32_16x16x32_bf16 v[172:175], a[20:23], a[156:159], v[172:175]
s_waitcnt lgkmcnt(10)
ds_read_b64_tr_b16 a[16:17], v46 offset:49152
ds_read_b64_tr_b16 a[18:19], v46 offset:53248
v_mfma_f32_16x16x32_bf16 v[188:191], a[24:27], a[140:143], v[188:191]
s_waitcnt lgkmcnt(15)
ds_read_b64_tr_b16 a[40:41], v7 offset:0
ds_read_b64_tr_b16 a[42:43], v52 offset:256
v_mfma_f32_16x16x32_bf16 v[188:191], a[28:31], a[156:159], v[188:191]
v_cvt_pk_bf16_f32 v60, v104, v105
v_cvt_pk_bf16_f32 v61, v106, v107
v_mfma_f32_16x16x32_bf16 v[184:187], a[24:27], a[136:139], v[184:187]
ds_write_b64 v6, v[60:61] offset:1024
v_mfma_f32_16x16x32_bf16 v[184:187], a[28:31], a[152:155], v[184:187]
s_waitcnt lgkmcnt(15)
ds_read_b64_tr_b16 a[20:21], v46 offset:57344
ds_read_b64_tr_b16 a[22:23], v46 offset:61440
v_mfma_f32_16x16x32_bf16 v[180:183], a[24:27], a[132:135], v[180:183]
v_cvt_pk_bf16_f32 v62, v120, v121
v_cvt_pk_bf16_f32 v63, v122, v123
v_mfma_f32_16x16x32_bf16 v[180:183], a[28:31], a[148:151], v[180:183]
ds_write_b64 v6, v[62:63] offset:1536
v_mfma_f32_16x16x32_bf16 v[176:179], a[24:27], a[128:131], v[176:179]
buffer_load_dwordx4 a[184:187], v1, s[32:35], s56 offen offset:2048 sc1
v_mfma_f32_16x16x32_bf16 v[176:179], a[28:31], a[144:147], v[176:179]
s_waitcnt lgkmcnt(14)
ds_read_b64_tr_b16 a[24:25], v47 offset:49152
ds_read_b64_tr_b16 a[26:27], v47 offset:53248
v_mfma_f32_16x16x32_bf16 v[192:195], a[0:3], a[128:131], v[192:195]
s_waitcnt lgkmcnt(15)
ds_read_b64_tr_b16 a[56:57], v7 offset:1024
ds_read_b64_tr_b16 a[58:59], v52 offset:1280
v_mfma_f32_16x16x32_bf16 v[192:195], a[4:7], a[144:147], v[192:195]
v_fmac_f32 v76, v16, v74
v_fmac_f32 v77, v16, v75
v_mfma_f32_16x16x32_bf16 v[196:199], a[0:3], a[132:135], v[196:199]
buffer_load_dwordx4 a[188:191], v1, s[32:35], s56 offen offset:3072 sc1
v_mfma_f32_16x16x32_bf16 v[196:199], a[4:7], a[148:151], v[196:199]
s_waitcnt lgkmcnt(15)
ds_read_b64_tr_b16 a[28:29], v47 offset:57344
ds_read_b64_tr_b16 a[30:31], v47 offset:61440
v_mfma_f32_16x16x32_bf16 v[200:203], a[0:3], a[136:139], v[200:203]
s_mov_b32 s56, s77
v_fmac_f32 v92, v17, v90
v_fmac_f32 v93, v17, v91
v_mfma_f32_16x16x32_bf16 v[200:203], a[4:7], a[152:155], v[200:203]
v_fmac_f32 v108, v16, v106
v_fmac_f32 v109, v16, v107
v_mfma_f32_16x16x32_bf16 v[204:207], a[0:3], a[140:143], v[204:207]
buffer_load_dwordx2 a[64:65], v10, s[32:35], s56 offen offset:0 sc1
v_mfma_f32_16x16x32_bf16 v[204:207], a[4:7], a[156:159], v[204:207]
s_waitcnt lgkmcnt(15)
v_fmac_f32 v124, v17, v122
v_fmac_f32 v125, v17, v123
v_mfma_f32_16x16x32_bf16 v[220:223], a[8:11], a[140:143], v[220:223]
buffer_load_dwordx2 a[66:67], v10, s[32:35], s56 offen offset:512 sc1
v_mfma_f32_16x16x32_bf16 v[220:223], a[12:15], a[156:159], v[220:223]
v_xor_b32 v46, 0x10000, v46
v_xor_b32 v47, 0x10000, v47
v_mfma_f32_16x16x32_bf16 v[216:219], a[8:11], a[136:139], v[216:219]
v_xor_b32 v44, 0x10000, v44
v_xor_b32 v45, 0x10000, v45
v_mfma_f32_16x16x32_bf16 v[216:219], a[12:15], a[152:155], v[216:219]
buffer_load_dwordx2 a[68:69], v10, s[32:35], s56 offen offset:1024 sc1
v_mfma_f32_16x16x32_bf16 v[212:215], a[8:11], a[132:135], v[212:215]
v_xor_b32 v42, 0x10000, v42
v_xor_b32 v43, 0x10000, v43
v_mfma_f32_16x16x32_bf16 v[212:215], a[12:15], a[148:151], v[212:215]
v_xor_b32 v40, 0x10000, v40
v_xor_b32 v41, 0x10000, v41
v_mfma_f32_16x16x32_bf16 v[208:211], a[8:11], a[128:131], v[208:211]
s_waitcnt vmcnt(39) lgkmcnt(0)
s_barrier
v_mfma_f32_16x16x32_bf16 v[208:211], a[12:15], a[144:147], v[208:211]
s_waitcnt lgkmcnt(7)
ds_read_b64_tr_b16 a[0:1], v40 offset:0
ds_read_b64_tr_b16 a[2:3], v40 offset:4096
v_mfma_f32_16x16x32_bf16 v[224:227], a[16:19], a[128:131], v[224:227]
buffer_store_dwordx4 a[40:43], v1, s[32:35], s72 offen offset:2048 sc0 sc1
v_mfma_f32_16x16x32_bf16 v[224:227], a[20:23], a[144:147], v[224:227]
v_fma_f32 v76, -v18, v106, v76
v_fma_f32 v77, -v18, v107, v77
v_mfma_f32_16x16x32_bf16 v[228:231], a[16:19], a[132:135], v[228:231]
v_fma_f32 v92, -v19, v122, v92
v_fma_f32 v93, -v19, v123, v93
v_mfma_f32_16x16x32_bf16 v[228:231], a[20:23], a[148:151], v[228:231]
s_waitcnt lgkmcnt(9)
ds_read_b64_tr_b16 a[4:5], v40 offset:8192
ds_read_b64_tr_b16 a[6:7], v40 offset:12288
v_mfma_f32_16x16x32_bf16 v[232:235], a[16:19], a[136:139], v[232:235]
v_fmac_f32 v108, v18, v74
v_fmac_f32 v109, v18, v75
v_mfma_f32_16x16x32_bf16 v[232:235], a[20:23], a[152:155], v[232:235]
v_fmac_f32 v124, v19, v90
v_fmac_f32 v125, v19, v91
v_mfma_f32_16x16x32_bf16 v[236:239], a[16:19], a[140:143], v[236:239]
v_fmac_f32 v78, v16, v76
v_fmac_f32 v79, v16, v77
v_mfma_f32_16x16x32_bf16 v[236:239], a[20:23], a[156:159], v[236:239]
s_waitcnt lgkmcnt(4)
ds_read_b64_tr_b16 a[8:9], v41 offset:0
ds_read_b64_tr_b16 a[10:11], v41 offset:4096
v_mfma_f32_16x16x32_bf16 v[252:255], a[24:27], a[140:143], v[252:255]
v_fmac_f32 v94, v17, v92
v_fmac_f32 v95, v17, v93
v_mfma_f32_16x16x32_bf16 v[252:255], a[28:31], a[156:159], v[252:255]
v_fmac_f32 v110, v16, v108
v_fmac_f32 v111, v16, v109
v_mfma_f32_16x16x32_bf16 v[248:251], a[24:27], a[136:139], v[248:251]
buffer_load_dwordx2 a[70:71], v10, s[32:35], s56 offen offset:1536 sc1
v_mfma_f32_16x16x32_bf16 v[248:251], a[28:31], a[152:155], v[248:251]
s_waitcnt lgkmcnt(6)
ds_read_b64_tr_b16 a[12:13], v41 offset:8192
ds_read_b64_tr_b16 a[14:15], v41 offset:12288
v_mfma_f32_16x16x32_bf16 v[244:247], a[24:27], a[132:135], v[244:247]
buffer_load_dwordx2 a[72:73], v10, s[32:35], s56 offen offset:2048 sc1
v_mfma_f32_16x16x32_bf16 v[244:247], a[28:31], a[148:151], v[244:247]
v_fmac_f32 v126, v17, v124
v_fmac_f32 v127, v17, v125
v_mfma_f32_16x16x32_bf16 v[240:243], a[24:27], a[128:131], v[240:243]
buffer_load_dwordx2 a[74:75], v10, s[32:35], s56 offen offset:2560 sc1
v_mfma_f32_16x16x32_bf16 v[240:243], a[28:31], a[144:147], v[240:243]
s_waitcnt vmcnt(35) lgkmcnt(4)
ds_read_b64_tr_b16 a[16:17], v42 offset:0
ds_read_b64_tr_b16 a[18:19], v42 offset:4096
v_mfma_f32_16x16x32_bf16 v[128:131], a[0:3], a[192:195], v[128:131]
v_fma_f32 v78, -v18, v108, v78
v_fma_f32 v79, -v18, v109, v79
v_mfma_f32_16x16x32_bf16 v[128:131], a[4:7], a[208:211], v[128:131]
buffer_load_dwordx2 a[76:77], v10, s[32:35], s56 offen offset:3072 sc1
v_mfma_f32_16x16x32_bf16 v[132:135], a[0:3], a[196:199], v[132:135]
v_fma_f32 v94, -v19, v124, v94
v_fma_f32 v95, -v19, v125, v95
v_mfma_f32_16x16x32_bf16 v[132:135], a[4:7], a[212:215], v[132:135]
s_waitcnt lgkmcnt(6)
ds_read_b64_tr_b16 a[20:21], v42 offset:8192
ds_read_b64_tr_b16 a[22:23], v42 offset:12288
v_mfma_f32_16x16x32_bf16 v[136:139], a[0:3], a[200:203], v[136:139]
buffer_load_dwordx2 a[78:79], v10, s[32:35], s56 offen offset:3584 sc1
v_mfma_f32_16x16x32_bf16 v[136:139], a[4:7], a[216:219], v[136:139]
s_add_u32 s56, s48, 8192
v_fmac_f32 v110, v18, v76
v_fmac_f32 v111, v18, v77
v_mfma_f32_16x16x32_bf16 v[140:143], a[0:3], a[204:207], v[140:143]
v_fmac_f32 v126, v19, v92
v_fmac_f32 v127, v19, v93
v_mfma_f32_16x16x32_bf16 v[140:143], a[4:7], a[220:223], v[140:143]
s_waitcnt lgkmcnt(4)
ds_read_b64_tr_b16 a[24:25], v43 offset:0
ds_read_b64_tr_b16 a[26:27], v43 offset:4096
v_mfma_f32_16x16x32_bf16 v[156:159], a[8:11], a[204:207], v[156:159]
buffer_load_dwordx4 a[80:83], v1, s[32:35], s56 offen offset:0 sc1
v_mfma_f32_16x16x32_bf16 v[156:159], a[12:15], a[220:223], v[156:159]
v_cvt_pk_bf16_f32 v56, v76, v77
v_cvt_pk_bf16_f32 v57, v78, v79
v_mfma_f32_16x16x32_bf16 v[152:155], a[8:11], a[200:203], v[152:155]
ds_write_b64 v6, v[56:57] offset:2048
v_mfma_f32_16x16x32_bf16 v[152:155], a[12:15], a[216:219], v[152:155]
s_waitcnt lgkmcnt(7)
ds_read_b64_tr_b16 a[28:29], v43 offset:8192
ds_read_b64_tr_b16 a[30:31], v43 offset:12288
v_mfma_f32_16x16x32_bf16 v[148:151], a[8:11], a[196:199], v[148:151]
buffer_store_dwordx4 a[56:59], v1, s[32:35], s73 offen offset:2048 sc0 sc1
v_mfma_f32_16x16x32_bf16 v[148:151], a[12:15], a[212:215], v[148:151]
v_cvt_pk_bf16_f32 v58, v92, v93
v_cvt_pk_bf16_f32 v59, v94, v95
v_mfma_f32_16x16x32_bf16 v[144:147], a[8:11], a[192:195], v[144:147]
ds_write_b64 v6, v[58:59] offset:2560
v_mfma_f32_16x16x32_bf16 v[144:147], a[12:15], a[208:211], v[144:147]
s_waitcnt lgkmcnt(6)
ds_read_b64_tr_b16 a[0:1], v44 offset:0
ds_read_b64_tr_b16 a[2:3], v44 offset:4096
v_mfma_f32_16x16x32_bf16 v[160:163], a[16:19], a[192:195], v[160:163]
s_waitcnt lgkmcnt(15)
ds_read_b64_tr_b16 a[44:45], v7 offset:2048
ds_read_b64_tr_b16 a[46:47], v52 offset:2304
v_mfma_f32_16x16x32_bf16 v[160:163], a[20:23], a[208:211], v[160:163]
v_cvt_pk_bf16_f32 v60, v108, v109
v_cvt_pk_bf16_f32 v61, v110, v111
v_mfma_f32_16x16x32_bf16 v[164:167], a[16:19], a[196:199], v[164:167]
ds_write_b64 v6, v[60:61] offset:3072
v_mfma_f32_16x16x32_bf16 v[164:167], a[20:23], a[212:215], v[164:167]
s_waitcnt lgkmcnt(11)
ds_read_b64_tr_b16 a[4:5], v44 offset:8192
ds_read_b64_tr_b16 a[6:7], v44 offset:12288
v_mfma_f32_16x16x32_bf16 v[168:171], a[16:19], a[200:203], v[168:171]
v_cvt_pk_bf16_f32 v62, v124, v125
v_cvt_pk_bf16_f32 v63, v126, v127
v_mfma_f32_16x16x32_bf16 v[168:171], a[20:23], a[216:219], v[168:171]
ds_write_b64 v6, v[62:63] offset:3584
v_mfma_f32_16x16x32_bf16 v[172:175], a[16:19], a[204:207], v[172:175]
buffer_load_dwordx4 a[84:87], v1, s[32:35], s56 offen offset:1024 sc1
v_mfma_f32_16x16x32_bf16 v[172:175], a[20:23], a[220:223], v[172:175]
s_waitcnt lgkmcnt(9)
ds_read_b64_tr_b16 a[8:9], v45 offset:0
ds_read_b64_tr_b16 a[10:11], v45 offset:4096
v_mfma_f32_16x16x32_bf16 v[188:191], a[24:27], a[204:207], v[188:191]
s_waitcnt lgkmcnt(15)
ds_read_b64_tr_b16 a[60:61], v7 offset:3072
ds_read_b64_tr_b16 a[62:63], v52 offset:3328
v_mfma_f32_16x16x32_bf16 v[188:191], a[28:31], a[220:223], v[188:191]
v_accvgpr_read_b32 v48, a252
v_accvgpr_read_b32 v20, a253
v_mfma_f32_16x16x32_bf16 v[184:187], a[24:27], a[200:203], v[184:187]
s_waitcnt lgkmcnt(8)
s_xor_b32 s65, s52, 0
s_lshl_b32 s65, s65, 16
v_mfma_f32_16x16x32_bf16 v[184:187], a[28:31], a[216:219], v[184:187]
s_waitcnt lgkmcnt(13)
ds_read_b64_tr_b16 a[12:13], v45 offset:8192
ds_read_b64_tr_b16 a[14:15], v45 offset:12288
v_mfma_f32_16x16x32_bf16 v[180:183], a[24:27], a[196:199], v[180:183]
buffer_store_dwordx4 a[44:47], v1, s[32:35], s72 offen offset:3072 sc0 sc1
v_mfma_f32_16x16x32_bf16 v[180:183], a[28:31], a[212:215], v[180:183]
v_add_u32 v16, s65, v48
s_xor_b32 s65, s52, 1
v_mfma_f32_16x16x32_bf16 v[176:179], a[24:27], a[192:195], v[176:179]
s_lshl_b32 s65, s65, 16
v_add_u32 v17, s65, v48
s_xor_b32 s65, s52, 2
v_mfma_f32_16x16x32_bf16 v[176:179], a[28:31], a[208:211], v[176:179]
s_waitcnt lgkmcnt(7)
ds_read_b64_tr_b16 a[16:17], v46 offset:0
ds_read_b64_tr_b16 a[18:19], v46 offset:4096
v_mfma_f32_16x16x32_bf16 v[192:195], a[0:3], a[192:195], v[192:195]
s_lshl_b32 s65, s65, 16
v_add_u32 v18, s65, v48
s_xor_b32 s65, s52, 3
v_mfma_f32_16x16x32_bf16 v[192:195], a[4:7], a[208:211], v[192:195]
s_lshl_b32 s65, s65, 16
v_add_u32 v19, s65, v48
s_and_b32 s65, s53, 1
v_mfma_f32_16x16x32_bf16 v[196:199], a[0:3], a[196:199], v[196:199]
s_waitcnt lgkmcnt(4)
s_lshl_b32 s65, s65, 6
v_xor_b32 v20, s65, v20
v_mfma_f32_16x16x32_bf16 v[196:199], a[4:7], a[212:215], v[196:199]
s_waitcnt lgkmcnt(9)
ds_read_b64_tr_b16 a[20:21], v46 offset:8192
ds_read_b64_tr_b16 a[22:23], v46 offset:12288
v_mfma_f32_16x16x32_bf16 v[200:203], a[0:3], a[200:203], v[200:203]
v_xor_b32 v21, 64, v20
v_add_u32 v22, 0x10000, v20
v_mfma_f32_16x16x32_bf16 v[200:203], a[4:7], a[216:219], v[200:203]
v_xor_b32 v23, 64, v22
v_accvgpr_read_b32 v24, a254
v_mfma_f32_16x16x32_bf16 v[204:207], a[0:3], a[204:207], v[204:207]
v_accvgpr_read_b32 v25, a255
v_lshlrev_b32 v25, 2, v25
v_mfma_f32_16x16x32_bf16 v[204:207], a[4:7], a[220:223], v[204:207]
s_waitcnt lgkmcnt(4)
ds_read_b64_tr_b16 a[24:25], v47 offset:0
ds_read_b64_tr_b16 a[26:27], v47 offset:4096
v_mfma_f32_16x16x32_bf16 v[220:223], a[8:11], a[204:207], v[220:223]
buffer_store_dwordx4 a[60:63], v1, s[32:35], s73 offen offset:3072 sc0 sc1
v_mfma_f32_16x16x32_bf16 v[220:223], a[12:15], a[220:223], v[220:223]
v_lshl_add_u32 v28, v24, 12, v25
v_mfma_f32_16x16x32_bf16 v[216:219], a[8:11], a[200:203], v[216:219]
v_mfma_f32_16x16x32_bf16 v[216:219], a[12:15], a[216:219], v[216:219]
s_waitcnt lgkmcnt(6)
ds_read_b64_tr_b16 a[28:29], v47 offset:8192
ds_read_b64_tr_b16 a[30:31], v47 offset:12288
v_mfma_f32_16x16x32_bf16 v[212:215], a[8:11], a[196:199], v[212:215]
v_mfma_f32_16x16x32_bf16 v[212:215], a[12:15], a[212:215], v[212:215]
v_mfma_f32_16x16x32_bf16 v[208:211], a[8:11], a[192:195], v[208:211]
v_mfma_f32_16x16x32_bf16 v[208:211], a[12:15], a[208:211], v[208:211]
s_waitcnt lgkmcnt(4)
ds_read_b64_tr_b16 a[0:1], v40 offset:16384
ds_read_b64_tr_b16 a[2:3], v40 offset:20480
v_mfma_f32_16x16x32_bf16 v[224:227], a[16:19], a[192:195], v[224:227]
v_mfma_f32_16x16x32_bf16 v[224:227], a[20:23], a[208:211], v[224:227]
v_mfma_f32_16x16x32_bf16 v[228:231], a[16:19], a[196:199], v[228:231]
v_mfma_f32_16x16x32_bf16 v[228:231], a[20:23], a[212:215], v[228:231]
s_waitcnt lgkmcnt(6)
ds_read_b64_tr_b16 a[4:5], v40 offset:24576
ds_read_b64_tr_b16 a[6:7], v40 offset:28672
v_mfma_f32_16x16x32_bf16 v[232:235], a[16:19], a[200:203], v[232:235]
v_mfma_f32_16x16x32_bf16 v[232:235], a[20:23], a[216:219], v[232:235]
buffer_load_dwordx4 a[88:91], v1, s[32:35], s56 offen offset:2048 sc1
v_mfma_f32_16x16x32_bf16 v[236:239], a[16:19], a[204:207], v[236:239]
v_mfma_f32_16x16x32_bf16 v[236:239], a[20:23], a[220:223], v[236:239]
s_waitcnt lgkmcnt(4)
ds_read_b64_tr_b16 a[8:9], v41 offset:16384
ds_read_b64_tr_b16 a[10:11], v41 offset:20480
v_mfma_f32_16x16x32_bf16 v[252:255], a[24:27], a[204:207], v[252:255]
v_mfma_f32_16x16x32_bf16 v[252:255], a[28:31], a[220:223], v[252:255]
buffer_load_dwordx4 a[92:95], v1, s[32:35], s56 offen offset:3072 sc1
v_mfma_f32_16x16x32_bf16 v[248:251], a[24:27], a[200:203], v[248:251]
s_add_u32 s56, s49, 8192
v_mfma_f32_16x16x32_bf16 v[248:251], a[28:31], a[216:219], v[248:251]
s_waitcnt lgkmcnt(6)
ds_read_b64_tr_b16 a[12:13], v41 offset:24576
ds_read_b64_tr_b16 a[14:15], v41 offset:28672
v_mfma_f32_16x16x32_bf16 v[244:247], a[24:27], a[196:199], v[244:247]
v_mfma_f32_16x16x32_bf16 v[244:247], a[28:31], a[212:215], v[244:247]
v_mfma_f32_16x16x32_bf16 v[240:243], a[24:27], a[192:195], v[240:243]
buffer_load_dwordx4 a[112:115], v1, s[32:35], s56 offen offset:0 sc1
v_mfma_f32_16x16x32_bf16 v[240:243], a[28:31], a[208:211], v[240:243]
s_waitcnt vmcnt(33) lgkmcnt(4)
ds_read_b64_tr_b16 a[16:17], v42 offset:16384
ds_read_b64_tr_b16 a[18:19], v42 offset:20480
v_mfma_f32_16x16x32_bf16 v[128:131], a[0:3], a[224:227], v[128:131]
v_mfma_f32_16x16x32_bf16 v[128:131], a[4:7], a[160:163], v[128:131]
s_waitcnt lgkmcnt(15)
ds_read_b64_tr_b16 a[20:21], v42 offset:24576
ds_read_b64_tr_b16 a[22:23], v42 offset:28672
v_mfma_f32_16x16x32_bf16 v[132:135], a[0:3], a[228:231], v[132:135]
buffer_load_dwordx4 a[116:119], v1, s[32:35], s56 offen offset:1024 sc1
v_mfma_f32_16x16x32_bf16 v[132:135], a[4:7], a[164:167], v[132:135]
s_waitcnt lgkmcnt(8)
ds_read_b64_tr_b16 a[24:25], v43 offset:16384
ds_read_b64_tr_b16 a[26:27], v43 offset:20480
v_mfma_f32_16x16x32_bf16 v[136:139], a[0:3], a[232:235], v[136:139]
v_mfma_f32_16x16x32_bf16 v[136:139], a[4:7], a[168:171], v[136:139]
v_mfma_f32_16x16x32_bf16 v[140:143], a[0:3], a[236:239], v[140:143]
v_mfma_f32_16x16x32_bf16 v[140:143], a[4:7], a[172:175], v[140:143]
s_waitcnt lgkmcnt(6)
ds_read_b64_tr_b16 a[28:29], v43 offset:24576
ds_read_b64_tr_b16 a[30:31], v43 offset:28672
v_mfma_f32_16x16x32_bf16 v[156:159], a[8:11], a[236:239], v[156:159]
buffer_load_dwordx4 a[120:123], v1, s[32:35], s56 offen offset:2048 sc1
v_mfma_f32_16x16x32_bf16 v[156:159], a[12:15], a[172:175], v[156:159]
v_mfma_f32_16x16x32_bf16 v[152:155], a[8:11], a[232:235], v[152:155]
v_mfma_f32_16x16x32_bf16 v[152:155], a[12:15], a[168:171], v[152:155]
s_waitcnt lgkmcnt(8)
ds_read_b64_tr_b16 a[0:1], v44 offset:16384
ds_read_b64_tr_b16 a[2:3], v44 offset:20480
v_mfma_f32_16x16x32_bf16 v[148:151], a[8:11], a[228:231], v[148:151]
buffer_load_dwordx4 a[124:127], v1, s[32:35], s56 offen offset:3072 sc1
v_mfma_f32_16x16x32_bf16 v[148:151], a[12:15], a[164:167], v[148:151]
s_mov_b32 s56, s78
v_mfma_f32_16x16x32_bf16 v[144:147], a[8:11], a[224:227], v[144:147]
v_mfma_f32_16x16x32_bf16 v[144:147], a[12:15], a[160:163], v[144:147]
s_waitcnt lgkmcnt(6)
ds_read_b64_tr_b16 a[4:5], v44 offset:24576
ds_read_b64_tr_b16 a[6:7], v44 offset:28672
v_mfma_f32_16x16x32_bf16 v[160:163], a[16:19], a[224:227], v[160:163]
buffer_load_dwordx4 v14, s[12:15], s55 offen lds
v_mfma_f32_16x16x32_bf16 v[160:163], a[20:23], a[160:163], v[160:163]
s_add_u32 m0, s54, 69632
v_mfma_f32_16x16x32_bf16 v[164:167], a[16:19], a[228:231], v[164:167]
v_mfma_f32_16x16x32_bf16 v[164:167], a[20:23], a[164:167], v[164:167]
s_waitcnt lgkmcnt(8)
ds_read_b64_tr_b16 a[8:9], v45 offset:16384
ds_read_b64_tr_b16 a[10:11], v45 offset:20480
v_mfma_f32_16x16x32_bf16 v[168:171], a[16:19], a[232:235], v[168:171]
buffer_load_dwordx4 v11, s[12:15], s55 offen lds
v_mfma_f32_16x16x32_bf16 v[168:171], a[20:23], a[168:171], v[168:171]
s_waitcnt lgkmcnt(15)
ds_read_b64_tr_b16 a[12:13], v45 offset:24576
ds_read_b64_tr_b16 a[14:15], v45 offset:28672
v_mfma_f32_16x16x32_bf16 v[172:175], a[16:19], a[236:239], v[172:175]
s_add_u32 s55, s50, 8192
s_lshl_b32 s55, s55, 4
s_add_u32 m0, s54, 73728
v_mfma_f32_16x16x32_bf16 v[172:175], a[20:23], a[172:175], v[172:175]
s_waitcnt lgkmcnt(8)
ds_read_b64_tr_b16 a[16:17], v46 offset:16384
ds_read_b64_tr_b16 a[18:19], v46 offset:20480
v_mfma_f32_16x16x32_bf16 v[188:191], a[24:27], a[236:239], v[188:191]
buffer_load_dwordx4 v14, s[12:15], s55 offen lds
v_mfma_f32_16x16x32_bf16 v[188:191], a[28:31], a[172:175], v[188:191]
s_add_u32 m0, s54, 77824
v_mfma_f32_16x16x32_bf16 v[184:187], a[24:27], a[232:235], v[184:187]
v_mfma_f32_16x16x32_bf16 v[184:187], a[28:31], a[168:171], v[184:187]
s_waitcnt lgkmcnt(10)
ds_read_b64_tr_b16 a[20:21], v46 offset:24576
ds_read_b64_tr_b16 a[22:23], v46 offset:28672
v_mfma_f32_16x16x32_bf16 v[180:183], a[24:27], a[228:231], v[180:183]
buffer_load_dwordx4 v11, s[12:15], s55 offen lds
v_mfma_f32_16x16x32_bf16 v[180:183], a[28:31], a[164:167], v[180:183]
s_add_u32 s55, s51, 8192
s_lshl_b32 s55, s55, 4
s_add_u32 m0, s54, 81920
v_mfma_f32_16x16x32_bf16 v[176:179], a[24:27], a[224:227], v[176:179]
v_mfma_f32_16x16x32_bf16 v[176:179], a[28:31], a[160:163], v[176:179]
s_waitcnt lgkmcnt(8)
ds_read_b64_tr_b16 a[24:25], v47 offset:16384
ds_read_b64_tr_b16 a[26:27], v47 offset:20480
v_mfma_f32_16x16x32_bf16 v[192:195], a[0:3], a[224:227], v[192:195]
v_mfma_f32_16x16x32_bf16 v[192:195], a[4:7], a[160:163], v[192:195]
buffer_load_dwordx4 v14, s[12:15], s55 offen lds
v_mfma_f32_16x16x32_bf16 v[196:199], a[0:3], a[228:231], v[196:199]
s_add_u32 m0, s54, 86016
v_mfma_f32_16x16x32_bf16 v[196:199], a[4:7], a[164:167], v[196:199]
s_waitcnt lgkmcnt(10)
ds_read_b64_tr_b16 a[28:29], v47 offset:24576
ds_read_b64_tr_b16 a[30:31], v47 offset:28672
v_mfma_f32_16x16x32_bf16 v[200:203], a[0:3], a[232:235], v[200:203]
s_waitcnt vmcnt(11)
v_mfma_f32_16x16x32_bf16 v[200:203], a[4:7], a[168:171], v[200:203]
s_mov_b64 exec, 1
buffer_store_dword v4, v1, s[36:39], s81 offen offset:64 sc0 sc1
s_mov_b64 exec, -1
v_mfma_f32_16x16x32_bf16 v[204:207], a[0:3], a[236:239], v[204:207]
s_lshl_b32 s65, s61, 3
s_add_u32 s65, s65, s53
s_lshl_b32 s66, s65, 18
v_mfma_f32_16x16x32_bf16 v[204:207], a[4:7], a[172:175], v[204:207]
s_waitcnt lgkmcnt(8)
s_lshl_b32 s67, s62, 14
s_add_u32 s66, s66, s67
v_mfma_f32_16x16x32_bf16 v[220:223], a[8:11], a[236:239], v[220:223]
buffer_load_dwordx2 a[96:97], v10, s[32:35], s56 offen offset:0 sc1
v_mfma_f32_16x16x32_bf16 v[220:223], a[12:15], a[172:175], v[220:223]
s_add_u32 s66, s66, 0x2000000
s_add_u32 s40, s6, s66
s_addc_u32 s41, s7, 0
v_mfma_f32_16x16x32_bf16 v[216:219], a[8:11], a[232:235], v[216:219]
buffer_load_dwordx2 a[98:99], v10, s[32:35], s56 offen offset:512 sc1
v_mfma_f32_16x16x32_bf16 v[216:219], a[12:15], a[168:171], v[216:219]
s_and_b32 s41, s41, 0xffff
s_mov_b32 s42, 0x34000
s_mov_b32 s43, 0x20000
v_mfma_f32_16x16x32_bf16 v[212:215], a[8:11], a[228:231], v[212:215]
buffer_load_dwordx2 a[100:101], v10, s[32:35], s56 offen offset:1024 sc1
v_mfma_f32_16x16x32_bf16 v[212:215], a[12:15], a[164:167], v[212:215]
s_lshl_b32 s69, s65, 2
s_add_u32 s69, s69, s62
s_lshl_b32 s69, s69, 10
v_mfma_f32_16x16x32_bf16 v[208:211], a[8:11], a[224:227], v[208:211]
s_waitcnt lgkmcnt(0)
s_barrier
s_add_u32 s69, s69, 0xb0000
v_mfma_f32_16x16x32_bf16 v[208:211], a[12:15], a[160:163], v[208:211]
s_waitcnt lgkmcnt(4)
ds_read_b64_tr_b16 a[0:1], v40 offset:32768
ds_read_b64_tr_b16 a[2:3], v40 offset:36864
v_mfma_f32_16x16x32_bf16 v[224:227], a[16:19], a[224:227], v[224:227]
buffer_load_dwordx4 v11, s[12:15], s55 offen lds
v_mfma_f32_16x16x32_bf16 v[224:227], a[20:23], a[160:163], v[224:227]
L_tr14:
s_cbranch_execz L_trret2
s_lshl_b32 s55, s80, 4
s_add_u32 m0, s54, 90112
s_xor_b32 s67, s52, 1
v_mfma_f32_16x16x32_bf16 v[228:231], a[16:19], a[228:231], v[228:231]
buffer_load_dwordx2 a[102:103], v10, s[32:35], s56 offen offset:1536 sc1
v_mfma_f32_16x16x32_bf16 v[228:231], a[20:23], a[164:167], v[228:231]
s_waitcnt lgkmcnt(6)
ds_read_b64_tr_b16 a[4:5], v40 offset:40960
ds_read_b64_tr_b16 a[6:7], v40 offset:45056
v_mfma_f32_16x16x32_bf16 v[232:235], a[16:19], a[232:235], v[232:235]
buffer_load_dwordx2 a[104:105], v10, s[32:35], s56 offen offset:2048 sc1
v_mfma_f32_16x16x32_bf16 v[232:235], a[20:23], a[168:171], v[232:235]
s_lshl_b32 s66, s67, 16
s_add_u32 s73, s66, 0
s_lshl_b32 s67, s67, 8
v_mfma_f32_16x16x32_bf16 v[236:239], a[16:19], a[236:239], v[236:239]
buffer_load_dwordx2 a[106:107], v10, s[32:35], s56 offen offset:2560 sc1
v_mfma_f32_16x16x32_bf16 v[236:239], a[20:23], a[172:175], v[236:239]
s_waitcnt lgkmcnt(4)
ds_read_b64_tr_b16 a[8:9], v41 offset:32768
ds_read_b64_tr_b16 a[10:11], v41 offset:36864
v_mfma_f32_16x16x32_bf16 v[252:255], a[24:27], a[236:239], v[252:255]
buffer_load_dwordx2 a[108:109], v10, s[32:35], s56 offen offset:3072 sc1
v_mfma_f32_16x16x32_bf16 v[252:255], a[28:31], a[172:175], v[252:255]
v_add_u32 v29, s67, v1
s_lshl_b32 s67, s52, 16
v_mfma_f32_16x16x32_bf16 v[248:251], a[24:27], a[232:235], v[248:251]
buffer_load_dwordx2 a[110:111], v10, s[32:35], s56 offen offset:3584 sc1
v_mfma_f32_16x16x32_bf16 v[248:251], a[28:31], a[168:171], v[248:251]
s_waitcnt lgkmcnt(6)
ds_read_b64_tr_b16 a[12:13], v41 offset:40960
ds_read_b64_tr_b16 a[14:15], v41 offset:45056
v_mfma_f32_16x16x32_bf16 v[244:247], a[24:27], a[228:231], v[244:247]
s_add_u32 s56, s50, 8192
s_add_u32 s70, s67, 0
s_xor_b32 s67, s52, 2
v_mfma_f32_16x16x32_bf16 v[244:247], a[28:31], a[164:167], v[244:247]
s_lshl_b32 s66, s67, 16
s_add_u32 s74, s66, 4096
s_lshl_b32 s67, s67, 8
v_mfma_f32_16x16x32_bf16 v[240:243], a[24:27], a[224:227], v[240:243]
buffer_load_dwordx4 v14, s[12:15], s55 offen lds
v_mfma_f32_16x16x32_bf16 v[240:243], a[28:31], a[160:163], v[240:243]
s_waitcnt vmcnt(27) lgkmcnt(4)
ds_read_b64_tr_b16 a[16:17], v42 offset:32768
ds_read_b64_tr_b16 a[18:19], v42 offset:36864
v_mfma_f32_16x16x32_bf16 v[128:131], a[0:3], a[176:179], v[128:131]
s_add_u32 m0, s54, 94208
v_add_u32 v30, s67, v1
s_lshl_b32 s67, s52, 16
v_mfma_f32_16x16x32_bf16 v[128:131], a[4:7], a[64:67], v[128:131]
s_add_u32 s71, s67, 4096
s_xor_b32 s67, s52, 3
s_lshl_b32 s66, s67, 16
v_mfma_f32_16x16x32_bf16 v[132:135], a[0:3], a[180:183], v[132:135]
buffer_load_dwordx4 v11, s[12:15], s55 offen lds
v_mfma_f32_16x16x32_bf16 v[132:135], a[4:7], a[68:71], v[132:135]
s_waitcnt lgkmcnt(6)
ds_read_b64_tr_b16 a[20:21], v42 offset:40960
ds_read_b64_tr_b16 a[22:23], v42 offset:45056
v_mfma_f32_16x16x32_bf16 v[136:139], a[0:3], a[184:187], v[136:139]
s_lshr_b32 s55, s24, 6
s_add_u32 m0, s54, 98304
s_add_u32 s75, s66, 8192
v_mfma_f32_16x16x32_bf16 v[136:139], a[4:7], a[72:75], v[136:139]
s_lshl_b32 s67, s67, 8
v_add_u32 v31, s67, v1
s_lshl_b32 s67, s52, 16
v_mfma_f32_16x16x32_bf16 v[140:143], a[0:3], a[188:191], v[140:143]
buffer_load_dwordx4 a[128:131], v1, s[32:35], s56 offen offset:0 sc1
v_mfma_f32_16x16x32_bf16 v[140:143], a[4:7], a[76:79], v[140:143]
s_waitcnt lgkmcnt(4)
ds_read_b64_tr_b16 a[24:25], v43 offset:32768
ds_read_b64_tr_b16 a[26:27], v43 offset:36864
v_mfma_f32_16x16x32_bf16 v[156:159], a[8:11], a[188:191], v[156:159]
s_add_u32 s72, s67, 8192
s_lshl_b32 s67, s52, 8
v_and_b32 v32, 3, v0
v_mfma_f32_16x16x32_bf16 v[156:159], a[12:15], a[76:79], v[156:159]
v_lshl_add_u32 v32, v32, 2, s67
s_mov_b32 s57, 0
v_mfma_f32_16x16x32_bf16 v[152:155], a[8:11], a[184:187], v[152:155]
buffer_load_dwordx4 a[132:135], v1, s[32:35], s56 offen offset:1024 sc1
v_mfma_f32_16x16x32_bf16 v[152:155], a[12:15], a[72:75], v[152:155]
s_waitcnt lgkmcnt(6)
ds_read_b64_tr_b16 a[28:29], v43 offset:40960
ds_read_b64_tr_b16 a[30:31], v43 offset:45056
v_mfma_f32_16x16x32_bf16 v[148:151], a[8:11], a[180:183], v[148:151]
s_movk_i32 s58, 8192
s_movk_i32 s59, 16384
s_movk_i32 s64, 24576
v_mfma_f32_16x16x32_bf16 v[148:151], a[12:15], a[68:71], v[148:151]
v_mov_b32 v34, 0x3f80
v_mov_b32 v35, 0x3f800000
v_mfma_f32_16x16x32_bf16 v[144:147], a[8:11], a[176:179], v[144:147]
buffer_load_dwordx4 a[136:139], v1, s[32:35], s56 offen offset:2048 sc1
v_mfma_f32_16x16x32_bf16 v[144:147], a[12:15], a[64:67], v[144:147]
s_waitcnt lgkmcnt(4)
ds_read_b64_tr_b16 a[0:1], v44 offset:32768
ds_read_b64_tr_b16 a[2:3], v44 offset:36864
v_mfma_f32_16x16x32_bf16 v[160:163], a[16:19], a[176:179], v[160:163]
v_mfma_f32_16x16x32_bf16 v[160:163], a[20:23], a[64:67], v[160:163]
v_mfma_f32_16x16x32_bf16 v[164:167], a[16:19], a[180:183], v[164:167]
buffer_load_dwordx4 a[140:143], v1, s[32:35], s56 offen offset:3072 sc1
v_mfma_f32_16x16x32_bf16 v[164:167], a[20:23], a[68:71], v[164:167]
s_waitcnt lgkmcnt(6)
ds_read_b64_tr_b16 a[4:5], v44 offset:40960
ds_read_b64_tr_b16 a[6:7], v44 offset:45056
v_mfma_f32_16x16x32_bf16 v[168:171], a[16:19], a[184:187], v[168:171]
s_add_u32 s56, s51, 8192
v_mfma_f32_16x16x32_bf16 v[168:171], a[20:23], a[72:75], v[168:171]
v_mfma_f32_16x16x32_bf16 v[172:175], a[16:19], a[188:191], v[172:175]
v_mfma_f32_16x16x32_bf16 v[172:175], a[20:23], a[76:79], v[172:175]
s_waitcnt lgkmcnt(4)
ds_read_b64_tr_b16 a[8:9], v45 offset:32768
ds_read_b64_tr_b16 a[10:11], v45 offset:36864
v_mfma_f32_16x16x32_bf16 v[188:191], a[24:27], a[188:191], v[188:191]
buffer_load_dwordx4 a[144:147], v1, s[32:35], s56 offen offset:0 sc1
v_mfma_f32_16x16x32_bf16 v[188:191], a[28:31], a[76:79], v[188:191]
v_mfma_f32_16x16x32_bf16 v[184:187], a[24:27], a[184:187], v[184:187]
v_mfma_f32_16x16x32_bf16 v[184:187], a[28:31], a[72:75], v[184:187]
s_waitcnt lgkmcnt(6)
ds_read_b64_tr_b16 a[12:13], v45 offset:40960
ds_read_b64_tr_b16 a[14:15], v45 offset:45056
v_mfma_f32_16x16x32_bf16 v[180:183], a[24:27], a[180:183], v[180:183]
buffer_load_dwordx4 a[148:151], v1, s[32:35], s56 offen offset:1024 sc1
v_mfma_f32_16x16x32_bf16 v[180:183], a[28:31], a[68:71], v[180:183]
v_mfma_f32_16x16x32_bf16 v[176:179], a[24:27], a[176:179], v[176:179]
v_mfma_f32_16x16x32_bf16 v[176:179], a[28:31], a[64:67], v[176:179]
s_waitcnt lgkmcnt(4)
ds_read_b64_tr_b16 a[16:17], v46 offset:32768
ds_read_b64_tr_b16 a[18:19], v46 offset:36864
v_mfma_f32_16x16x32_bf16 v[192:195], a[0:3], a[176:179], v[192:195]
buffer_load_dwordx4 a[152:155], v1, s[32:35], s56 offen offset:2048 sc1
v_mfma_f32_16x16x32_bf16 v[192:195], a[4:7], a[64:67], v[192:195]
v_mfma_f32_16x16x32_bf16 v[196:199], a[0:3], a[180:183], v[196:199]
v_mfma_f32_16x16x32_bf16 v[196:199], a[4:7], a[68:71], v[196:199]
s_waitcnt lgkmcnt(6)
ds_read_b64_tr_b16 a[20:21], v46 offset:40960
ds_read_b64_tr_b16 a[22:23], v46 offset:45056
v_mfma_f32_16x16x32_bf16 v[200:203], a[0:3], a[184:187], v[200:203]
buffer_load_dwordx4 a[156:159], v1, s[32:35], s56 offen offset:3072 sc1
v_mfma_f32_16x16x32_bf16 v[200:203], a[4:7], a[72:75], v[200:203]
s_mov_b32 s56, s80
v_mfma_f32_16x16x32_bf16 v[204:207], a[0:3], a[188:191], v[204:207]
v_mfma_f32_16x16x32_bf16 v[204:207], a[4:7], a[76:79], v[204:207]
s_waitcnt lgkmcnt(4)
ds_read_b64_tr_b16 a[24:25], v47 offset:32768
ds_read_b64_tr_b16 a[26:27], v47 offset:36864
v_mfma_f32_16x16x32_bf16 v[220:223], a[8:11], a[188:191], v[220:223]
buffer_load_dwordx2 a[192:193], v10, s[32:35], s56 offen offset:0 sc1
v_mfma_f32_16x16x32_bf16 v[220:223], a[12:15], a[76:79], v[220:223]
v_mfma_f32_16x16x32_bf16 v[216:219], a[8:11], a[184:187], v[216:219]
buffer_load_dwordx2 a[194:195], v10, s[32:35], s56 offen offset:512 sc1
v_mfma_f32_16x16x32_bf16 v[216:219], a[12:15], a[72:75], v[216:219]
s_waitcnt lgkmcnt(6)
ds_read_b64_tr_b16 a[28:29], v47 offset:40960
ds_read_b64_tr_b16 a[30:31], v47 offset:45056
v_mfma_f32_16x16x32_bf16 v[212:215], a[8:11], a[180:183], v[212:215]
buffer_load_dwordx2 a[196:197], v10, s[32:35], s56 offen offset:1024 sc1
v_mfma_f32_16x16x32_bf16 v[212:215], a[12:15], a[68:71], v[212:215]
v_mfma_f32_16x16x32_bf16 v[208:211], a[8:11], a[176:179], v[208:211]
v_mfma_f32_16x16x32_bf16 v[208:211], a[12:15], a[64:67], v[208:211]
s_waitcnt lgkmcnt(4)
ds_read_b64_tr_b16 a[0:1], v40 offset:49152
ds_read_b64_tr_b16 a[2:3], v40 offset:53248
v_mfma_f32_16x16x32_bf16 v[224:227], a[16:19], a[176:179], v[224:227]
buffer_load_dwordx2 a[198:199], v10, s[32:35], s56 offen offset:1536 sc1
v_mfma_f32_16x16x32_bf16 v[224:227], a[20:23], a[64:67], v[224:227]
v_mfma_f32_16x16x32_bf16 v[228:231], a[16:19], a[180:183], v[228:231]
buffer_load_dwordx2 a[200:201], v10, s[32:35], s56 offen offset:2048 sc1
v_mfma_f32_16x16x32_bf16 v[228:231], a[20:23], a[68:71], v[228:231]
s_waitcnt lgkmcnt(6)
ds_read_b64_tr_b16 a[4:5], v40 offset:57344
ds_read_b64_tr_b16 a[6:7], v40 offset:61440
v_mfma_f32_16x16x32_bf16 v[232:235], a[16:19], a[184:187], v[232:235]
buffer_load_dwordx2 a[202:203], v10, s[32:35], s56 offen offset:2560 sc1
v_mfma_f32_16x16x32_bf16 v[232:235], a[20:23], a[72:75], v[232:235]
v_mfma_f32_16x16x32_bf16 v[236:239], a[16:19], a[188:191], v[236:239]
buffer_load_dwordx2 a[204:205], v10, s[32:35], s56 offen offset:3072 sc1
v_mfma_f32_16x16x32_bf16 v[236:239], a[20:23], a[76:79], v[236:239]
s_waitcnt lgkmcnt(4)
ds_read_b64_tr_b16 a[8:9], v41 offset:49152
ds_read_b64_tr_b16 a[10:11], v41 offset:53248
v_mfma_f32_16x16x32_bf16 v[252:255], a[24:27], a[188:191], v[252:255]
buffer_load_dwordx2 a[206:207], v10, s[32:35], s56 offen offset:3584 sc1
v_mfma_f32_16x16x32_bf16 v[252:255], a[28:31], a[76:79], v[252:255]
v_mfma_f32_16x16x32_bf16 v[248:251], a[24:27], a[184:187], v[248:251]
buffer_load_dword v13, v12, s[36:39], s68 offen offset:64 sc0 sc1
v_mfma_f32_16x16x32_bf16 v[248:251], a[28:31], a[72:75], v[248:251]
s_waitcnt lgkmcnt(6)
ds_read_b64_tr_b16 a[12:13], v41 offset:57344
ds_read_b64_tr_b16 a[14:15], v41 offset:61440
v_mfma_f32_16x16x32_bf16 v[244:247], a[24:27], a[180:183], v[244:247]
v_mfma_f32_16x16x32_bf16 v[244:247], a[28:31], a[68:71], v[244:247]
v_mfma_f32_16x16x32_bf16 v[240:243], a[24:27], a[176:179], v[240:243]
buffer_load_dwordx4 v16, s[16:19], s55 offen lds
v_mfma_f32_16x16x32_bf16 v[240:243], a[28:31], a[64:67], v[240:243]
s_waitcnt vmcnt(35) lgkmcnt(4)
ds_read_b64_tr_b16 a[16:17], v42 offset:49152
ds_read_b64_tr_b16 a[18:19], v42 offset:53248
v_mfma_f32_16x16x32_bf16 v[128:131], a[0:3], a[80:83], v[128:131]
s_add_u32 m0, s54, 102400
v_mfma_f32_16x16x32_bf16 v[128:131], a[4:7], a[112:115], v[128:131]
s_waitcnt lgkmcnt(15)
ds_read_b64_tr_b16 a[20:21], v42 offset:57344
ds_read_b64_tr_b16 a[22:23], v42 offset:61440
v_mfma_f32_16x16x32_bf16 v[132:135], a[0:3], a[84:87], v[132:135]
buffer_load_dwordx4 v17, s[16:19], s55 offen lds
v_mfma_f32_16x16x32_bf16 v[132:135], a[4:7], a[116:119], v[132:135]
s_waitcnt lgkmcnt(8)
ds_read_b64_tr_b16 a[24:25], v43 offset:49152
ds_read_b64_tr_b16 a[26:27], v43 offset:53248
v_mfma_f32_16x16x32_bf16 v[136:139], a[0:3], a[88:91], v[136:139]
s_add_u32 m0, s54, 106496
v_mfma_f32_16x16x32_bf16 v[136:139], a[4:7], a[120:123], v[136:139]
v_mfma_f32_16x16x32_bf16 v[140:143], a[0:3], a[92:95], v[140:143]
buffer_load_dwordx4 v18, s[16:19], s55 offen lds
v_mfma_f32_16x16x32_bf16 v[140:143], a[4:7], a[124:127], v[140:143]
s_waitcnt lgkmcnt(6)
ds_read_b64_tr_b16 a[28:29], v43 offset:57344
ds_read_b64_tr_b16 a[30:31], v43 offset:61440
v_mfma_f32_16x16x32_bf16 v[156:159], a[8:11], a[92:95], v[156:159]
s_add_u32 m0, s54, 110592
v_mfma_f32_16x16x32_bf16 v[156:159], a[12:15], a[124:127], v[156:159]
v_mfma_f32_16x16x32_bf16 v[152:155], a[8:11], a[88:91], v[152:155]
buffer_load_dwordx4 v19, s[16:19], s55 offen lds
v_mfma_f32_16x16x32_bf16 v[152:155], a[12:15], a[120:123], v[152:155]
s_waitcnt lgkmcnt(8)
ds_read_b64_tr_b16 a[0:1], v44 offset:49152
ds_read_b64_tr_b16 a[2:3], v44 offset:53248
v_mfma_f32_16x16x32_bf16 v[148:151], a[8:11], a[84:87], v[148:151]
s_lshr_b32 s55, s24, 6
s_add_u32 m0, s54, 114688
v_mfma_f32_16x16x32_bf16 v[148:151], a[12:15], a[116:119], v[148:151]
v_mfma_f32_16x16x32_bf16 v[144:147], a[8:11], a[80:83], v[144:147]
buffer_load_dwordx4 v16, s[20:23], s55 offen lds
v_mfma_f32_16x16x32_bf16 v[144:147], a[12:15], a[112:115], v[144:147]
s_waitcnt lgkmcnt(6)
ds_read_b64_tr_b16 a[4:5], v44 offset:57344
ds_read_b64_tr_b16 a[6:7], v44 offset:61440
v_mfma_f32_16x16x32_bf16 v[160:163], a[16:19], a[80:83], v[160:163]
s_add_u32 m0, s54, 118784
v_mfma_f32_16x16x32_bf16 v[160:163], a[20:23], a[112:115], v[160:163]
v_mfma_f32_16x16x32_bf16 v[164:167], a[16:19], a[84:87], v[164:167]
buffer_load_dwordx4 v17, s[20:23], s55 offen lds
v_mfma_f32_16x16x32_bf16 v[164:167], a[20:23], a[116:119], v[164:167]
s_waitcnt lgkmcnt(8)
ds_read_b64_tr_b16 a[8:9], v45 offset:49152
ds_read_b64_tr_b16 a[10:11], v45 offset:53248
v_mfma_f32_16x16x32_bf16 v[168:171], a[16:19], a[88:91], v[168:171]
s_add_u32 m0, s54, 122880
v_mfma_f32_16x16x32_bf16 v[168:171], a[20:23], a[120:123], v[168:171]
s_waitcnt lgkmcnt(15)
ds_read_b64_tr_b16 a[12:13], v45 offset:57344
ds_read_b64_tr_b16 a[14:15], v45 offset:61440
v_mfma_f32_16x16x32_bf16 v[172:175], a[16:19], a[92:95], v[172:175]
buffer_load_dwordx4 v18, s[20:23], s55 offen lds
v_mfma_f32_16x16x32_bf16 v[172:175], a[20:23], a[124:127], v[172:175]
s_waitcnt lgkmcnt(8)
ds_read_b64_tr_b16 a[16:17], v46 offset:49152
ds_read_b64_tr_b16 a[18:19], v46 offset:53248
v_mfma_f32_16x16x32_bf16 v[188:191], a[24:27], a[92:95], v[188:191]
s_add_u32 m0, s54, 126976
v_mfma_f32_16x16x32_bf16 v[188:191], a[28:31], a[124:127], v[188:191]
v_mfma_f32_16x16x32_bf16 v[184:187], a[24:27], a[88:91], v[184:187]
buffer_load_dwordx4 v19, s[20:23], s55 offen lds
v_mfma_f32_16x16x32_bf16 v[184:187], a[28:31], a[120:123], v[184:187]
s_waitcnt lgkmcnt(10)
ds_read_b64_tr_b16 a[20:21], v46 offset:57344
ds_read_b64_tr_b16 a[22:23], v46 offset:61440
v_mfma_f32_16x16x32_bf16 v[180:183], a[24:27], a[84:87], v[180:183]
s_lshr_b32 s55, s25, 6
s_add_u32 m0, s54, 0
v_mfma_f32_16x16x32_bf16 v[180:183], a[28:31], a[116:119], v[180:183]
v_mfma_f32_16x16x32_bf16 v[176:179], a[24:27], a[80:83], v[176:179]
buffer_load_dwordx4 v16, s[16:19], s55 offen lds
v_mfma_f32_16x16x32_bf16 v[176:179], a[28:31], a[112:115], v[176:179]
s_waitcnt lgkmcnt(8)
ds_read_b64_tr_b16 a[24:25], v47 offset:49152
ds_read_b64_tr_b16 a[26:27], v47 offset:53248
v_mfma_f32_16x16x32_bf16 v[192:195], a[0:3], a[80:83], v[192:195]
s_add_u32 m0, s54, 4096
v_mfma_f32_16x16x32_bf16 v[192:195], a[4:7], a[112:115], v[192:195]
v_mfma_f32_16x16x32_bf16 v[196:199], a[0:3], a[84:87], v[196:199]
buffer_load_dwordx4 v17, s[16:19], s55 offen lds
v_mfma_f32_16x16x32_bf16 v[196:199], a[4:7], a[116:119], v[196:199]
s_waitcnt lgkmcnt(10)
ds_read_b64_tr_b16 a[28:29], v47 offset:57344
ds_read_b64_tr_b16 a[30:31], v47 offset:61440
v_mfma_f32_16x16x32_bf16 v[200:203], a[0:3], a[88:91], v[200:203]
s_add_u32 m0, s54, 8192
v_mfma_f32_16x16x32_bf16 v[200:203], a[4:7], a[120:123], v[200:203]
v_mfma_f32_16x16x32_bf16 v[204:207], a[0:3], a[92:95], v[204:207]
s_waitcnt vmcnt(10)
v_mfma_f32_16x16x32_bf16 v[204:207], a[4:7], a[124:127], v[204:207]
s_waitcnt lgkmcnt(8)
v_mfma_f32_16x16x32_bf16 v[220:223], a[8:11], a[92:95], v[220:223]
buffer_load_dwordx4 v18, s[16:19], s55 offen lds
v_mfma_f32_16x16x32_bf16 v[220:223], a[12:15], a[124:127], v[220:223]
v_xor_b32 v46, 0x10000, v46
v_xor_b32 v47, 0x10000, v47
v_mfma_f32_16x16x32_bf16 v[216:219], a[8:11], a[88:91], v[216:219]
v_xor_b32 v44, 0x10000, v44
v_xor_b32 v45, 0x10000, v45
v_mfma_f32_16x16x32_bf16 v[216:219], a[12:15], a[120:123], v[216:219]
P3c_chk:
v_cmp_ne_u32 vcc, s3, v13
s_nop 0
s_and_b64 vcc, vcc, exec
s_cbranch_scc1 P3c_retry
P3c_ok:
v_mfma_f32_16x16x32_bf16 v[212:215], a[8:11], a[84:87], v[212:215]
v_xor_b32 v42, 0x10000, v42
v_xor_b32 v43, 0x10000, v43
v_mfma_f32_16x16x32_bf16 v[212:215], a[12:15], a[116:119], v[212:215]
v_xor_b32 v40, 0x10000, v40
v_xor_b32 v41, 0x10000, v41
v_mfma_f32_16x16x32_bf16 v[208:211], a[8:11], a[80:83], v[208:211]
s_waitcnt lgkmcnt(0)
s_barrier
s_xor_b32 s56, s45, 118784
v_mfma_f32_16x16x32_bf16 v[208:211], a[12:15], a[112:115], v[208:211]
s_waitcnt lgkmcnt(4)
ds_read_b64_tr_b16 a[0:1], v40 offset:0
ds_read_b64_tr_b16 a[2:3], v40 offset:4096
v_mfma_f32_16x16x32_bf16 v[224:227], a[16:19], a[80:83], v[224:227]
s_add_u32 s56, s56, s24
s_add_u32 m0, s54, 12288
v_mfma_f32_16x16x32_bf16 v[224:227], a[20:23], a[112:115], v[224:227]
buffer_load_dwordx4 v19, s[16:19], s55 offen lds
v_mfma_f32_16x16x32_bf16 v[228:231], a[16:19], a[84:87], v[228:231]
s_lshr_b32 s55, s26, 6
s_add_u32 m0, s54, 16384
v_mfma_f32_16x16x32_bf16 v[228:231], a[20:23], a[116:119], v[228:231]
s_waitcnt lgkmcnt(6)
ds_read_b64_tr_b16 a[4:5], v40 offset:8192
ds_read_b64_tr_b16 a[6:7], v40 offset:12288
v_mfma_f32_16x16x32_bf16 v[232:235], a[16:19], a[88:91], v[232:235]
v_mfma_f32_16x16x32_bf16 v[232:235], a[20:23], a[120:123], v[232:235]
buffer_load_dwordx4 v16, s[16:19], s55 offen lds
v_mfma_f32_16x16x32_bf16 v[236:239], a[16:19], a[92:95], v[236:239]
s_add_u32 m0, s54, 20480
v_mfma_f32_16x16x32_bf16 v[236:239], a[20:23], a[124:127], v[236:239]
s_waitcnt lgkmcnt(4)
ds_read_b64_tr_b16 a[8:9], v41 offset:0
ds_read_b64_tr_b16 a[10:11], v41 offset:4096
v_mfma_f32_16x16x32_bf16 v[252:255], a[24:27], a[92:95], v[252:255]
v_mfma_f32_16x16x32_bf16 v[252:255], a[28:31], a[124:127], v[252:255]
buffer_load_dwordx4 v17, s[16:19], s55 offen lds
v_mfma_f32_16x16x32_bf16 v[248:251], a[24:27], a[88:91], v[248:251]
s_add_u32 m0, s54, 24576
v_mfma_f32_16x16x32_bf16 v[248:251], a[28:31], a[120:123], v[248:251]
s_waitcnt lgkmcnt(6)
ds_read_b64_tr_b16 a[12:13], v41 offset:8192
ds_read_b64_tr_b16 a[14:15], v41 offset:12288
v_mfma_f32_16x16x32_bf16 v[244:247], a[24:27], a[84:87], v[244:247]
v_mfma_f32_16x16x32_bf16 v[244:247], a[28:31], a[116:119], v[244:247]
buffer_load_dwordx4 v18, s[16:19], s55 offen lds
v_mfma_f32_16x16x32_bf16 v[240:243], a[24:27], a[80:83], v[240:243]
s_add_u32 m0, s54, 28672
v_mfma_f32_16x16x32_bf16 v[240:243], a[28:31], a[112:115], v[240:243]
s_waitcnt vmcnt(28) lgkmcnt(4)
ds_read_b64_tr_b16 a[16:17], v42 offset:0
ds_read_b64_tr_b16 a[18:19], v42 offset:4096
v_mfma_f32_16x16x32_bf16 v[128:131], a[0:3], a[96:99], v[128:131]
v_mfma_f32_16x16x32_bf16 v[128:131], a[4:7], a[128:131], v[128:131]
buffer_load_dwordx4 v19, s[16:19], s55 offen lds
v_mfma_f32_16x16x32_bf16 v[132:135], a[0:3], a[100:103], v[132:135]
s_lshr_b32 s55, s27, 6
s_add_u32 m0, s54, 32768
v_mfma_f32_16x16x32_bf16 v[132:135], a[4:7], a[132:135], v[132:135]
s_waitcnt lgkmcnt(6)
ds_read_b64_tr_b16 a[20:21], v42 offset:8192
ds_read_b64_tr_b16 a[22:23], v42 offset:12288
v_mfma_f32_16x16x32_bf16 v[136:139], a[0:3], a[104:107], v[136:139]
v_mfma_f32_16x16x32_bf16 v[136:139], a[4:7], a[136:139], v[136:139]
buffer_load_dwordx4 a[208:211], v1, s[32:35], s56 offen offset:0 sc1
v_mfma_f32_16x16x32_bf16 v[140:143], a[0:3], a[108:111], v[140:143]
v_mfma_f32_16x16x32_bf16 v[140:143], a[4:7], a[140:143], v[140:143]
s_waitcnt lgkmcnt(4)
ds_read_b64_tr_b16 a[24:25], v43 offset:0
ds_read_b64_tr_b16 a[26:27], v43 offset:4096
v_mfma_f32_16x16x32_bf16 v[156:159], a[8:11], a[108:111], v[156:159]
v_mfma_f32_16x16x32_bf16 v[156:159], a[12:15], a[140:143], v[156:159]
buffer_load_dwordx4 a[212:215], v1, s[32:35], s56 offen offset:1024 sc1
v_mfma_f32_16x16x32_bf16 v[152:155], a[8:11], a[104:107], v[152:155]
v_mfma_f32_16x16x32_bf16 v[152:155], a[12:15], a[136:139], v[152:155]
s_waitcnt lgkmcnt(6)
ds_read_b64_tr_b16 a[28:29], v43 offset:8192
ds_read_b64_tr_b16 a[30:31], v43 offset:12288
v_mfma_f32_16x16x32_bf16 v[148:151], a[8:11], a[100:103], v[148:151]
v_mfma_f32_16x16x32_bf16 v[148:151], a[12:15], a[132:135], v[148:151]
buffer_load_dwordx4 a[216:219], v1, s[32:35], s56 offen offset:2048 sc1
v_mfma_f32_16x16x32_bf16 v[144:147], a[8:11], a[96:99], v[144:147]
v_mfma_f32_16x16x32_bf16 v[144:147], a[12:15], a[128:131], v[144:147]
s_waitcnt lgkmcnt(4)
ds_read_b64_tr_b16 a[0:1], v44 offset:0
ds_read_b64_tr_b16 a[2:3], v44 offset:4096
v_mfma_f32_16x16x32_bf16 v[160:163], a[16:19], a[96:99], v[160:163]
v_mfma_f32_16x16x32_bf16 v[160:163], a[20:23], a[128:131], v[160:163]
buffer_load_dwordx4 a[220:223], v1, s[32:35], s56 offen offset:3072 sc1
v_mfma_f32_16x16x32_bf16 v[164:167], a[16:19], a[100:103], v[164:167]
s_xor_b32 s56, s45, 151552
s_add_u32 s56, s56, s24
v_mfma_f32_16x16x32_bf16 v[164:167], a[20:23], a[132:135], v[164:167]
s_waitcnt lgkmcnt(6)
ds_read_b64_tr_b16 a[4:5], v44 offset:8192
ds_read_b64_tr_b16 a[6:7], v44 offset:12288
v_mfma_f32_16x16x32_bf16 v[168:171], a[16:19], a[104:107], v[168:171]
v_mfma_f32_16x16x32_bf16 v[168:171], a[20:23], a[136:139], v[168:171]
buffer_load_dwordx4 a[224:227], v1, s[32:35], s56 offen offset:0 sc1
v_mfma_f32_16x16x32_bf16 v[172:175], a[16:19], a[108:111], v[172:175]
v_mfma_f32_16x16x32_bf16 v[172:175], a[20:23], a[140:143], v[172:175]
s_waitcnt lgkmcnt(4)
ds_read_b64_tr_b16 a[8:9], v45 offset:0
ds_read_b64_tr_b16 a[10:11], v45 offset:4096
v_mfma_f32_16x16x32_bf16 v[188:191], a[24:27], a[108:111], v[188:191]
v_mfma_f32_16x16x32_bf16 v[188:191], a[28:31], a[140:143], v[188:191]
buffer_load_dwordx4 a[228:231], v1, s[32:35], s56 offen offset:1024 sc1
v_mfma_f32_16x16x32_bf16 v[184:187], a[24:27], a[104:107], v[184:187]
v_mfma_f32_16x16x32_bf16 v[184:187], a[28:31], a[136:139], v[184:187]
s_waitcnt lgkmcnt(6)
ds_read_b64_tr_b16 a[12:13], v45 offset:8192
ds_read_b64_tr_b16 a[14:15], v45 offset:12288
v_mfma_f32_16x16x32_bf16 v[180:183], a[24:27], a[100:103], v[180:183]
v_mfma_f32_16x16x32_bf16 v[180:183], a[28:31], a[132:135], v[180:183]
buffer_load_dwordx4 a[232:235], v1, s[32:35], s56 offen offset:2048 sc1
v_mfma_f32_16x16x32_bf16 v[176:179], a[24:27], a[96:99], v[176:179]
v_mfma_f32_16x16x32_bf16 v[176:179], a[28:31], a[128:131], v[176:179]
s_waitcnt lgkmcnt(4)
ds_read_b64_tr_b16 a[16:17], v46 offset:0
ds_read_b64_tr_b16 a[18:19], v46 offset:4096
v_mfma_f32_16x16x32_bf16 v[192:195], a[0:3], a[96:99], v[192:195]
v_mfma_f32_16x16x32_bf16 v[192:195], a[4:7], a[128:131], v[192:195]
buffer_load_dwordx4 a[236:239], v1, s[32:35], s56 offen offset:3072 sc1
v_mfma_f32_16x16x32_bf16 v[196:199], a[0:3], a[100:103], v[196:199]
s_xor_b32 s56, s45, 114688
s_add_u32 s56, s56, s25
v_mfma_f32_16x16x32_bf16 v[196:199], a[4:7], a[132:135], v[196:199]
s_waitcnt lgkmcnt(6)
ds_read_b64_tr_b16 a[20:21], v46 offset:8192
ds_read_b64_tr_b16 a[22:23], v46 offset:12288
v_mfma_f32_16x16x32_bf16 v[200:203], a[0:3], a[104:107], v[200:203]
v_mfma_f32_16x16x32_bf16 v[200:203], a[4:7], a[136:139], v[200:203]
buffer_load_dwordx4 a[160:163], v1, s[32:35], s56 offen offset:0 sc1
v_mfma_f32_16x16x32_bf16 v[204:207], a[0:3], a[108:111], v[204:207]
v_mfma_f32_16x16x32_bf16 v[204:207], a[4:7], a[140:143], v[204:207]
s_waitcnt lgkmcnt(4)
ds_read_b64_tr_b16 a[24:25], v47 offset:0
ds_read_b64_tr_b16 a[26:27], v47 offset:4096
v_mfma_f32_16x16x32_bf16 v[220:223], a[8:11], a[108:111], v[220:223]
v_mfma_f32_16x16x32_bf16 v[220:223], a[12:15], a[140:143], v[220:223]
buffer_load_dwordx4 a[164:167], v1, s[32:35], s56 offen offset:1024 sc1
v_mfma_f32_16x16x32_bf16 v[216:219], a[8:11], a[104:107], v[216:219]
v_mfma_f32_16x16x32_bf16 v[216:219], a[12:15], a[136:139], v[216:219]
s_waitcnt lgkmcnt(6)
ds_read_b64_tr_b16 a[28:29], v47 offset:8192
ds_read_b64_tr_b16 a[30:31], v47 offset:12288
v_mfma_f32_16x16x32_bf16 v[212:215], a[8:11], a[100:103], v[212:215]
v_mfma_f32_16x16x32_bf16 v[212:215], a[12:15], a[132:135], v[212:215]
buffer_load_dwordx4 a[168:171], v1, s[32:35], s56 offen offset:2048 sc1
v_mfma_f32_16x16x32_bf16 v[208:211], a[8:11], a[96:99], v[208:211]
v_mfma_f32_16x16x32_bf16 v[208:211], a[12:15], a[128:131], v[208:211]
s_waitcnt lgkmcnt(4)
ds_read_b64_tr_b16 a[0:1], v40 offset:16384
ds_read_b64_tr_b16 a[2:3], v40 offset:20480
v_mfma_f32_16x16x32_bf16 v[224:227], a[16:19], a[96:99], v[224:227]
v_mfma_f32_16x16x32_bf16 v[224:227], a[20:23], a[128:131], v[224:227]
buffer_load_dwordx4 a[172:175], v1, s[32:35], s56 offen offset:3072 sc1
v_mfma_f32_16x16x32_bf16 v[228:231], a[16:19], a[100:103], v[228:231]
s_xor_b32 s56, s45, 118784
s_add_u32 s56, s56, s25
v_mfma_f32_16x16x32_bf16 v[228:231], a[20:23], a[132:135], v[228:231]
s_waitcnt lgkmcnt(6)
ds_read_b64_tr_b16 a[4:5], v40 offset:24576
ds_read_b64_tr_b16 a[6:7], v40 offset:28672
v_mfma_f32_16x16x32_bf16 v[232:235], a[16:19], a[104:107], v[232:235]
v_mfma_f32_16x16x32_bf16 v[232:235], a[20:23], a[136:139], v[232:235]
buffer_load_dwordx4 v[64:67], v1, s[32:35], s56 offen offset:0 sc1
v_mfma_f32_16x16x32_bf16 v[236:239], a[16:19], a[108:111], v[236:239]
v_mfma_f32_16x16x32_bf16 v[236:239], a[20:23], a[140:143], v[236:239]
s_waitcnt lgkmcnt(4)
ds_read_b64_tr_b16 a[8:9], v41 offset:16384
ds_read_b64_tr_b16 a[10:11], v41 offset:20480
v_mfma_f32_16x16x32_bf16 v[252:255], a[24:27], a[108:111], v[252:255]
v_mfma_f32_16x16x32_bf16 v[252:255], a[28:31], a[140:143], v[252:255]
v_mfma_f32_16x16x32_bf16 v[248:251], a[24:27], a[104:107], v[248:251]
buffer_load_dwordx4 v[68:71], v1, s[32:35], s56 offen offset:1024 sc1
v_mfma_f32_16x16x32_bf16 v[248:251], a[28:31], a[136:139], v[248:251]
s_waitcnt lgkmcnt(6)
ds_read_b64_tr_b16 a[12:13], v41 offset:24576
ds_read_b64_tr_b16 a[14:15], v41 offset:28672
v_mfma_f32_16x16x32_bf16 v[244:247], a[24:27], a[100:103], v[244:247]
v_mfma_f32_16x16x32_bf16 v[244:247], a[28:31], a[132:135], v[244:247]
v_mfma_f32_16x16x32_bf16 v[240:243], a[24:27], a[96:99], v[240:243]
buffer_load_dwordx4 v[72:75], v1, s[32:35], s56 offen offset:2048 sc1
v_mfma_f32_16x16x32_bf16 v[240:243], a[28:31], a[128:131], v[240:243]
s_waitcnt vmcnt(32) lgkmcnt(4)
ds_read_b64_tr_b16 a[16:17], v42 offset:16384
ds_read_b64_tr_b16 a[18:19], v42 offset:20480
v_mfma_f32_16x16x32_bf16 v[128:131], a[0:3], a[144:147], v[128:131]
v_mfma_f32_16x16x32_bf16 v[128:131], a[4:7], a[192:195], v[128:131]
s_waitcnt lgkmcnt(15)
ds_read_b64_tr_b16 a[20:21], v42 offset:24576
ds_read_b64_tr_b16 a[22:23], v42 offset:28672
v_mfma_f32_16x16x32_bf16 v[132:135], a[0:3], a[148:151], v[132:135]
v_mfma_f32_16x16x32_bf16 v[132:135], a[4:7], a[196:199], v[132:135]
s_waitcnt lgkmcnt(8)
ds_read_b64_tr_b16 a[24:25], v43 offset:16384
ds_read_b64_tr_b16 a[26:27], v43 offset:20480
v_mfma_f32_16x16x32_bf16 v[136:139], a[0:3], a[152:155], v[136:139]
buffer_load_dwordx4 v[76:79], v1, s[32:35], s56 offen offset:3072 sc1
v_mfma_f32_16x16x32_bf16 v[136:139], a[4:7], a[200:203], v[136:139]
s_xor_b32 s56, s45, 114688
s_add_u32 s56, s56, s26
v_mfma_f32_16x16x32_bf16 v[140:143], a[0:3], a[156:159], v[140:143]
v_mfma_f32_16x16x32_bf16 v[140:143], a[4:7], a[204:207], v[140:143]
s_waitcnt lgkmcnt(6)
ds_read_b64_tr_b16 a[28:29], v43 offset:24576
ds_read_b64_tr_b16 a[30:31], v43 offset:28672
v_mfma_f32_16x16x32_bf16 v[156:159], a[8:11], a[156:159], v[156:159]
buffer_load_dwordx4 v[80:83], v1, s[32:35], s56 offen offset:0 sc1
v_mfma_f32_16x16x32_bf16 v[156:159], a[12:15], a[204:207], v[156:159]
v_mfma_f32_16x16x32_bf16 v[152:155], a[8:11], a[152:155], v[152:155]
v_mfma_f32_16x16x32_bf16 v[152:155], a[12:15], a[200:203], v[152:155]
s_waitcnt lgkmcnt(8)
ds_read_b64_tr_b16 a[0:1], v44 offset:16384
ds_read_b64_tr_b16 a[2:3], v44 offset:20480
v_mfma_f32_16x16x32_bf16 v[148:151], a[8:11], a[148:151], v[148:151]
buffer_load_dwordx4 v[84:87], v1, s[32:35], s56 offen offset:1024 sc1
v_mfma_f32_16x16x32_bf16 v[148:151], a[12:15], a[196:199], v[148:151]
v_mfma_f32_16x16x32_bf16 v[144:147], a[8:11], a[144:147], v[144:147]
v_mfma_f32_16x16x32_bf16 v[144:147], a[12:15], a[192:195], v[144:147]
s_waitcnt lgkmcnt(6)
ds_read_b64_tr_b16 a[4:5], v44 offset:24576
ds_read_b64_tr_b16 a[6:7], v44 offset:28672
v_mfma_f32_16x16x32_bf16 v[160:163], a[16:19], a[144:147], v[160:163]
buffer_load_dwordx4 v[88:91], v1, s[32:35], s56 offen offset:2048 sc1
v_mfma_f32_16x16x32_bf16 v[160:163], a[20:23], a[192:195], v[160:163]
v_mfma_f32_16x16x32_bf16 v[164:167], a[16:19], a[148:151], v[164:167]
v_mfma_f32_16x16x32_bf16 v[164:167], a[20:23], a[196:199], v[164:167]
s_waitcnt lgkmcnt(8)
ds_read_b64_tr_b16 a[8:9], v45 offset:16384
ds_read_b64_tr_b16 a[10:11], v45 offset:20480
v_mfma_f32_16x16x32_bf16 v[168:171], a[16:19], a[152:155], v[168:171]
buffer_load_dwordx4 v[92:95], v1, s[32:35], s56 offen offset:3072 sc1
v_mfma_f32_16x16x32_bf16 v[168:171], a[20:23], a[200:203], v[168:171]
s_waitcnt lgkmcnt(15)
ds_read_b64_tr_b16 a[12:13], v45 offset:24576
ds_read_b64_tr_b16 a[14:15], v45 offset:28672
v_mfma_f32_16x16x32_bf16 v[172:175], a[16:19], a[156:159], v[172:175]
s_xor_b32 s56, s45, 118784
s_add_u32 s56, s56, s26
v_mfma_f32_16x16x32_bf16 v[172:175], a[20:23], a[204:207], v[172:175]
s_waitcnt lgkmcnt(8)
ds_read_b64_tr_b16 a[16:17], v46 offset:16384
ds_read_b64_tr_b16 a[18:19], v46 offset:20480
v_mfma_f32_16x16x32_bf16 v[188:191], a[24:27], a[156:159], v[188:191]
buffer_load_dwordx4 v[96:99], v1, s[32:35], s56 offen offset:0 sc1
v_mfma_f32_16x16x32_bf16 v[188:191], a[28:31], a[204:207], v[188:191]
L_tr15:
s_cbranch_execz L_trret2
v_mfma_f32_16x16x32_bf16 v[184:187], a[24:27], a[152:155], v[184:187]
v_mfma_f32_16x16x32_bf16 v[184:187], a[28:31], a[200:203], v[184:187]
s_waitcnt lgkmcnt(10)
ds_read_b64_tr_b16 a[20:21], v46 offset:24576
ds_read_b64_tr_b16 a[22:23], v46 offset:28672
v_mfma_f32_16x16x32_bf16 v[180:183], a[24:27], a[148:151], v[180:183]
v_mfma_f32_16x16x32_bf16 v[180:183], a[28:31], a[196:199], v[180:183]
buffer_load_dwordx4 v[100:103], v1, s[32:35], s56 offen offset:1024 sc1
v_mfma_f32_16x16x32_bf16 v[176:179], a[24:27], a[144:147], v[176:179]
v_mfma_f32_16x16x32_bf16 v[176:179], a[28:31], a[192:195], v[176:179]
s_waitcnt lgkmcnt(8)
ds_read_b64_tr_b16 a[24:25], v47 offset:16384
ds_read_b64_tr_b16 a[26:27], v47 offset:20480
v_mfma_f32_16x16x32_bf16 v[192:195], a[0:3], a[144:147], v[192:195]
v_mfma_f32_16x16x32_bf16 v[192:195], a[4:7], a[192:195], v[192:195]
buffer_load_dwordx4 v[104:107], v1, s[32:35], s56 offen offset:2048 sc1
v_mfma_f32_16x16x32_bf16 v[196:199], a[0:3], a[148:151], v[196:199]
v_mfma_f32_16x16x32_bf16 v[196:199], a[4:7], a[196:199], v[196:199]
s_waitcnt lgkmcnt(10)
ds_read_b64_tr_b16 a[28:29], v47 offset:24576
ds_read_b64_tr_b16 a[30:31], v47 offset:28672
v_mfma_f32_16x16x32_bf16 v[200:203], a[0:3], a[152:155], v[200:203]
v_mfma_f32_16x16x32_bf16 v[200:203], a[4:7], a[200:203], v[200:203]
v_mfma_f32_16x16x32_bf16 v[204:207], a[0:3], a[156:159], v[204:207]
buffer_load_dwordx4 v[108:111], v1, s[32:35], s56 offen offset:3072 sc1
v_mfma_f32_16x16x32_bf16 v[204:207], a[4:7], a[204:207], v[204:207]
s_waitcnt lgkmcnt(8)
s_xor_b32 s56, s45, 114688
s_add_u32 s56, s56, s27
v_mfma_f32_16x16x32_bf16 v[220:223], a[8:11], a[156:159], v[220:223]
v_mfma_f32_16x16x32_bf16 v[220:223], a[12:15], a[204:207], v[220:223]
v_mfma_f32_16x16x32_bf16 v[216:219], a[8:11], a[152:155], v[216:219]
buffer_load_dwordx4 v16, s[16:19], s55 offen lds
v_mfma_f32_16x16x32_bf16 v[216:219], a[12:15], a[200:203], v[216:219]
s_add_u32 m0, s54, 36864
v_mfma_f32_16x16x32_bf16 v[212:215], a[8:11], a[148:151], v[212:215]
v_mfma_f32_16x16x32_bf16 v[212:215], a[12:15], a[196:199], v[212:215]
v_mfma_f32_16x16x32_bf16 v[208:211], a[8:11], a[144:147], v[208:211]
s_waitcnt vmcnt(25) lgkmcnt(0)
s_barrier
v_mfma_f32_16x16x32_bf16 v[208:211], a[12:15], a[192:195], v[208:211]
ds_read_b128 a[0:3], v22 offset:36864
v_mfma_f32_16x16x32_bf16 v[224:227], a[16:19], a[144:147], v[224:227]
buffer_load_dwordx4 v17, s[16:19], s55 offen lds
v_mfma_f32_16x16x32_bf16 v[224:227], a[20:23], a[192:195], v[224:227]
s_add_u32 m0, s54, 40960
v_mfma_f32_16x16x32_bf16 v[228:231], a[16:19], a[148:151], v[228:231]
v_mfma_f32_16x16x32_bf16 v[228:231], a[20:23], a[196:199], v[228:231]
ds_read_b128 a[4:7], v22 offset:53248
v_mfma_f32_16x16x32_bf16 v[232:235], a[16:19], a[152:155], v[232:235]
buffer_load_dwordx4 v18, s[16:19], s55 offen lds
v_mfma_f32_16x16x32_bf16 v[232:235], a[20:23], a[200:203], v[232:235]
s_add_u32 m0, s54, 45056
v_mfma_f32_16x16x32_bf16 v[236:239], a[16:19], a[156:159], v[236:239]
v_mfma_f32_16x16x32_bf16 v[236:239], a[20:23], a[204:207], v[236:239]
ds_read_b128 a[8:11], v22 offset:38912
v_mfma_f32_16x16x32_bf16 v[252:255], a[24:27], a[156:159], v[252:255]
buffer_load_dwordx4 v19, s[16:19], s55 offen lds
v_mfma_f32_16x16x32_bf16 v[252:255], a[28:31], a[204:207], v[252:255]
s_lshr_b32 s55, s25, 6
s_add_u32 m0, s54, 49152
v_mfma_f32_16x16x32_bf16 v[248:251], a[24:27], a[152:155], v[248:251]
v_mfma_f32_16x16x32_bf16 v[248:251], a[28:31], a[200:203], v[248:251]
ds_read_b128 a[12:15], v22 offset:55296
v_mfma_f32_16x16x32_bf16 v[244:247], a[24:27], a[148:151], v[244:247]
buffer_load_dwordx4 v16, s[20:23], s55 offen lds
v_mfma_f32_16x16x32_bf16 v[244:247], a[28:31], a[196:199], v[244:247]
s_add_u32 m0, s54, 53248
v_mfma_f32_16x16x32_bf16 v[240:243], a[24:27], a[144:147], v[240:243]
v_mfma_f32_16x16x32_bf16 v[240:243], a[28:31], a[192:195], v[240:243]
s_waitcnt lgkmcnt(2)
ds_read_b128 a[16:19], v22 offset:40960
v_mfma_f32_16x16x32_bf16 v[160:163], a[0:3], a[32:35], v[160:163]
buffer_load_dwordx4 v17, s[20:23], s55 offen lds
v_mfma_f32_16x16x32_bf16 v[160:163], a[4:7], a[48:51], v[160:163]
s_add_u32 m0, s54, 57344
v_mfma_f32_16x16x32_bf16 v[164:167], a[0:3], a[36:39], v[164:167]
v_mfma_f32_16x16x32_bf16 v[164:167], a[4:7], a[52:55], v[164:167]
ds_read_b128 a[20:23], v22 offset:57344
v_mfma_f32_16x16x32_bf16 v[168:171], a[0:3], a[40:43], v[168:171]
buffer_load_dwordx4 v18, s[20:23], s55 offen lds
v_mfma_f32_16x16x32_bf16 v[168:171], a[4:7], a[56:59], v[168:171]
s_add_u32 m0, s54, 61440
v_mfma_f32_16x16x32_bf16 v[172:175], a[0:3], a[44:47], v[172:175]
v_mfma_f32_16x16x32_bf16 v[172:175], a[4:7], a[60:63], v[172:175]
s_waitcnt lgkmcnt(2)
ds_read_b128 a[24:27], v22 offset:43008
v_mfma_f32_16x16x32_bf16 v[188:191], a[8:11], a[44:47], v[188:191]
v_mfma_f32_16x16x32_bf16 v[188:191], a[12:15], a[60:63], v[188:191]
buffer_load_dwordx4 v19, s[20:23], s55 offen lds
v_mfma_f32_16x16x32_bf16 v[184:187], a[8:11], a[40:43], v[184:187]
s_lshr_b32 s55, s26, 6
s_add_u32 m0, s54, 65536
v_mfma_f32_16x16x32_bf16 v[184:187], a[12:15], a[56:59], v[184:187]
ds_read_b128 a[28:31], v22 offset:59392
v_mfma_f32_16x16x32_bf16 v[180:183], a[8:11], a[36:39], v[180:183]
v_mfma_f32_16x16x32_bf16 v[180:183], a[12:15], a[52:55], v[180:183]
buffer_load_dwordx4 v16, s[20:23], s55 offen lds
v_mfma_f32_16x16x32_bf16 v[176:179], a[8:11], a[32:35], v[176:179]
s_add_u32 m0, s54, 69632
v_mfma_f32_16x16x32_bf16 v[176:179], a[12:15], a[48:51], v[176:179]
s_waitcnt lgkmcnt(2)
ds_read_b128 a[0:3], v22 offset:45056
v_mfma_f32_16x16x32_bf16 v[192:195], a[16:19], a[32:35], v[192:195]
v_mfma_f32_16x16x32_bf16 v[192:195], a[20:23], a[48:51], v[192:195]
buffer_load_dwordx4 v17, s[20:23], s55 offen lds
v_mfma_f32_16x16x32_bf16 v[196:199], a[16:19], a[36:39], v[196:199]
s_add_u32 m0, s54, 73728
v_mfma_f32_16x16x32_bf16 v[196:199], a[20:23], a[52:55], v[196:199]
ds_read_b128 a[4:7], v22 offset:61440
v_mfma_f32_16x16x32_bf16 v[200:203], a[16:19], a[40:43], v[200:203]
v_mfma_f32_16x16x32_bf16 v[200:203], a[20:23], a[56:59], v[200:203]
v_mfma_f32_16x16x32_bf16 v[204:207], a[16:19], a[44:47], v[204:207]
buffer_load_dwordx4 v18, s[20:23], s55 offen lds
v_mfma_f32_16x16x32_bf16 v[204:207], a[20:23], a[60:63], v[204:207]
s_waitcnt lgkmcnt(2)
ds_read_b128 a[8:11], v22 offset:47104
s_add_u32 m0, s54, 77824
v_mfma_f32_16x16x32_bf16 v[220:223], a[24:27], a[44:47], v[220:223]
v_mfma_f32_16x16x32_bf16 v[220:223], a[28:31], a[60:63], v[220:223]
v_mfma_f32_16x16x32_bf16 v[216:219], a[24:27], a[40:43], v[216:219]
buffer_load_dwordx4 v19, s[20:23], s55 offen lds
v_mfma_f32_16x16x32_bf16 v[216:219], a[28:31], a[56:59], v[216:219]
ds_read_b128 a[12:15], v22 offset:63488
s_lshr_b32 s55, s27, 6
v_mfma_f32_16x16x32_bf16 v[212:215], a[24:27], a[36:39], v[212:215]
s_add_u32 m0, s54, 81920
v_mfma_f32_16x16x32_bf16 v[212:215], a[28:31], a[52:55], v[212:215]
v_mfma_f32_16x16x32_bf16 v[208:211], a[24:27], a[32:35], v[208:211]
buffer_load_dwordx4 v16, s[20:23], s55 offen lds
v_mfma_f32_16x16x32_bf16 v[208:211], a[28:31], a[48:51], v[208:211]
s_waitcnt lgkmcnt(2)
ds_read_b128 a[16:19], v23 offset:36864
s_add_u32 m0, s54, 86016
v_mfma_f32_16x16x32_bf16 v[224:227], a[0:3], a[32:35], v[224:227]
v_mfma_f32_16x16x32_bf16 v[224:227], a[4:7], a[48:51], v[224:227]
v_mfma_f32_16x16x32_bf16 v[228:231], a[0:3], a[36:39], v[228:231]
v_mfma_f32_16x16x32_bf16 v[228:231], a[4:7], a[52:55], v[228:231]
ds_read_b128 a[20:23], v23 offset:53248
v_mfma_f32_16x16x32_bf16 v[232:235], a[0:3], a[40:43], v[232:235]
buffer_load_dwordx4 v17, s[20:23], s55 offen lds
v_mfma_f32_16x16x32_bf16 v[232:235], a[4:7], a[56:59], v[232:235]
s_add_u32 m0, s54, 90112
v_mfma_f32_16x16x32_bf16 v[236:239], a[0:3], a[44:47], v[236:239]
v_mfma_f32_16x16x32_bf16 v[236:239], a[4:7], a[60:63], v[236:239]
s_waitcnt lgkmcnt(2)
ds_read_b128 a[24:27], v23 offset:38912
v_mfma_f32_16x16x32_bf16 v[252:255], a[8:11], a[44:47], v[252:255]
buffer_load_dwordx4 v18, s[20:23], s55 offen lds
v_mfma_f32_16x16x32_bf16 v[252:255], a[12:15], a[60:63], v[252:255]
s_add_u32 m0, s54, 94208
v_mfma_f32_16x16x32_bf16 v[248:251], a[8:11], a[40:43], v[248:251]
v_mfma_f32_16x16x32_bf16 v[248:251], a[12:15], a[56:59], v[248:251]
ds_read_b128 a[28:31], v23 offset:55296
v_mfma_f32_16x16x32_bf16 v[244:247], a[8:11], a[36:39], v[244:247]
buffer_load_dwordx4 v19, s[20:23], s55 offen lds
v_mfma_f32_16x16x32_bf16 v[244:247], a[12:15], a[52:55], v[244:247]
v_mfma_f32_16x16x32_bf16 v[240:243], a[8:11], a[32:35], v[240:243]
v_mfma_f32_16x16x32_bf16 v[240:243], a[12:15], a[48:51], v[240:243]
s_waitcnt vmcnt(32) lgkmcnt(2)
ds_read_b128 a[0:3], v23 offset:40960
v_mfma_f32_16x16x32_bf16 v[160:163], a[16:19], a[208:211], v[160:163]
buffer_load_dwordx4 v[112:115], v1, s[32:35], s56 offen offset:0 sc1
v_mfma_f32_16x16x32_bf16 v[160:163], a[20:23], a[224:227], v[160:163]
v_mfma_f32_16x16x32_bf16 v[164:167], a[16:19], a[212:215], v[164:167]
v_mfma_f32_16x16x32_bf16 v[164:167], a[20:23], a[228:231], v[164:167]
ds_read_b128 a[4:7], v23 offset:57344
v_mfma_f32_16x16x32_bf16 v[168:171], a[16:19], a[216:219], v[168:171]
buffer_load_dwordx4 v[116:119], v1, s[32:35], s56 offen offset:1024 sc1
v_mfma_f32_16x16x32_bf16 v[168:171], a[20:23], a[232:235], v[168:171]
v_mfma_f32_16x16x32_bf16 v[172:175], a[16:19], a[220:223], v[172:175]
v_mfma_f32_16x16x32_bf16 v[172:175], a[20:23], a[236:239], v[172:175]
s_waitcnt lgkmcnt(2)
ds_read_b128 a[8:11], v23 offset:43008
v_mfma_f32_16x16x32_bf16 v[188:191], a[24:27], a[220:223], v[188:191]
v_mfma_f32_16x16x32_bf16 v[188:191], a[28:31], a[236:239], v[188:191]
buffer_load_dwordx4 v[120:123], v1, s[32:35], s56 offen offset:2048 sc1
v_mfma_f32_16x16x32_bf16 v[184:187], a[24:27], a[216:219], v[184:187]
v_mfma_f32_16x16x32_bf16 v[184:187], a[28:31], a[232:235], v[184:187]
ds_read_b128 a[12:15], v23 offset:59392
v_mfma_f32_16x16x32_bf16 v[180:183], a[24:27], a[212:215], v[180:183]
v_mfma_f32_16x16x32_bf16 v[180:183], a[28:31], a[228:231], v[180:183]
buffer_load_dwordx4 v[124:127], v1, s[32:35], s56 offen offset:3072 sc1
v_mfma_f32_16x16x32_bf16 v[176:179], a[24:27], a[208:211], v[176:179]
s_xor_b32 s56, s45, 118784
s_add_u32 s56, s56, s27
v_mfma_f32_16x16x32_bf16 v[176:179], a[28:31], a[224:227], v[176:179]
s_waitcnt lgkmcnt(2)
ds_read_b128 a[16:19], v23 offset:45056
v_mfma_f32_16x16x32_bf16 v[192:195], a[0:3], a[208:211], v[192:195]
v_mfma_f32_16x16x32_bf16 v[192:195], a[4:7], a[224:227], v[192:195]
buffer_load_dwordx4 a[176:179], v1, s[32:35], s56 offen offset:0 sc1
v_mfma_f32_16x16x32_bf16 v[196:199], a[0:3], a[212:215], v[196:199]
v_mfma_f32_16x16x32_bf16 v[196:199], a[4:7], a[228:231], v[196:199]
ds_read_b128 a[20:23], v23 offset:61440
v_mfma_f32_16x16x32_bf16 v[200:203], a[0:3], a[216:219], v[200:203]
v_mfma_f32_16x16x32_bf16 v[200:203], a[4:7], a[232:235], v[200:203]
v_mfma_f32_16x16x32_bf16 v[204:207], a[0:3], a[220:223], v[204:207]
buffer_load_dwordx4 a[180:183], v1, s[32:35], s56 offen offset:1024 sc1
v_mfma_f32_16x16x32_bf16 v[204:207], a[4:7], a[236:239], v[204:207]
s_waitcnt lgkmcnt(2)
ds_read_b128 a[24:27], v23 offset:47104
v_mfma_f32_16x16x32_bf16 v[220:223], a[8:11], a[220:223], v[220:223]
v_mfma_f32_16x16x32_bf16 v[220:223], a[12:15], a[236:239], v[220:223]
v_mfma_f32_16x16x32_bf16 v[216:219], a[8:11], a[216:219], v[216:219]
buffer_load_dwordx4 a[184:187], v1, s[32:35], s56 offen offset:2048 sc1
v_mfma_f32_16x16x32_bf16 v[216:219], a[12:15], a[232:235], v[216:219]
ds_read_b128 a[28:31], v23 offset:63488
v_mfma_f32_16x16x32_bf16 v[212:215], a[8:11], a[212:215], v[212:215]
v_mfma_f32_16x16x32_bf16 v[212:215], a[12:15], a[228:231], v[212:215]
v_mfma_f32_16x16x32_bf16 v[208:211], a[8:11], a[208:211], v[208:211]
v_mfma_f32_16x16x32_bf16 v[208:211], a[12:15], a[224:227], v[208:211]
s_waitcnt lgkmcnt(2)
ds_read_b128 a[0:3], v20 offset:4096
v_mfma_f32_16x16x32_bf16 v[224:227], a[16:19], a[208:211], v[224:227]
buffer_load_dwordx4 a[188:191], v1, s[32:35], s56 offen offset:3072 sc1
v_mfma_f32_16x16x32_bf16 v[224:227], a[20:23], a[224:227], v[224:227]
s_xor_b32 s56, s45, 147456
s_add_u32 s56, s56, s25
v_mfma_f32_16x16x32_bf16 v[228:231], a[16:19], a[212:215], v[228:231]
v_mfma_f32_16x16x32_bf16 v[228:231], a[20:23], a[228:231], v[228:231]
ds_read_b128 a[4:7], v21 offset:4096
v_mfma_f32_16x16x32_bf16 v[232:235], a[16:19], a[216:219], v[232:235]
buffer_load_dwordx4 a[64:67], v1, s[32:35], s56 offen offset:0 sc1
v_mfma_f32_16x16x32_bf16 v[232:235], a[20:23], a[232:235], v[232:235]
v_mfma_f32_16x16x32_bf16 v[236:239], a[16:19], a[220:223], v[236:239]
v_mfma_f32_16x16x32_bf16 v[236:239], a[20:23], a[236:239], v[236:239]
s_waitcnt lgkmcnt(2)
ds_read_b128 a[8:11], v20 offset:6144
v_mfma_f32_16x16x32_bf16 v[252:255], a[24:27], a[220:223], v[252:255]
buffer_load_dwordx4 a[68:71], v1, s[32:35], s56 offen offset:1024 sc1
v_mfma_f32_16x16x32_bf16 v[252:255], a[28:31], a[236:239], v[252:255]
v_mfma_f32_16x16x32_bf16 v[248:251], a[24:27], a[216:219], v[248:251]
v_mfma_f32_16x16x32_bf16 v[248:251], a[28:31], a[232:235], v[248:251]
ds_read_b128 a[12:15], v21 offset:6144
v_mfma_f32_16x16x32_bf16 v[244:247], a[24:27], a[212:215], v[244:247]
buffer_load_dwordx4 a[72:75], v1, s[32:35], s56 offen offset:2048 sc1
v_mfma_f32_16x16x32_bf16 v[244:247], a[28:31], a[228:231], v[244:247]
v_mfma_f32_16x16x32_bf16 v[240:243], a[24:27], a[208:211], v[240:243]
v_mfma_f32_16x16x32_bf16 v[240:243], a[28:31], a[224:227], v[240:243]
s_waitcnt vmcnt(35) lgkmcnt(2)
ds_read_b128 a[16:19], v20 offset:8192
v_mfma_f32_16x16x32_bf16 v[160:163], a[0:3], a[160:163], v[160:163]
buffer_load_dwordx4 a[76:79], v1, s[32:35], s56 offen offset:3072 sc1
v_mfma_f32_16x16x32_bf16 v[160:163], a[4:7], v[64:67], v[160:163]
s_xor_b32 s56, s45, 151552
s_add_u32 s56, s56, s25
v_mfma_f32_16x16x32_bf16 v[164:167], a[0:3], a[164:167], v[164:167]
v_mfma_f32_16x16x32_bf16 v[164:167], a[4:7], v[68:71], v[164:167]
ds_read_b128 a[20:23], v21 offset:8192
v_mfma_f32_16x16x32_bf16 v[168:171], a[0:3], a[168:171], v[168:171]
buffer_load_dwordx4 a[80:83], v1, s[32:35], s56 offen offset:0 sc1
v_mfma_f32_16x16x32_bf16 v[168:171], a[4:7], v[72:75], v[168:171]
v_mfma_f32_16x16x32_bf16 v[172:175], a[0:3], a[172:175], v[172:175]
v_mfma_f32_16x16x32_bf16 v[172:175], a[4:7], v[76:79], v[172:175]
s_waitcnt lgkmcnt(2)
ds_read_b128 a[24:27], v20 offset:10240
v_mfma_f32_16x16x32_bf16 v[188:191], a[8:11], a[172:175], v[188:191]
v_mfma_f32_16x16x32_bf16 v[188:191], a[12:15], v[76:79], v[188:191]
buffer_load_dwordx4 a[84:87], v1, s[32:35], s56 offen offset:1024 sc1
v_mfma_f32_16x16x32_bf16 v[184:187], a[8:11], a[168:171], v[184:187]
v_mfma_f32_16x16x32_bf16 v[184:187], a[12:15], v[72:75], v[184:187]
ds_read_b128 a[28:31], v21 offset:10240
v_mfma_f32_16x16x32_bf16 v[180:183], a[8:11], a[164:167], v[180:183]
v_mfma_f32_16x16x32_bf16 v[180:183], a[12:15], v[68:71], v[180:183]
buffer_load_dwordx4 a[88:91], v1, s[32:35], s56 offen offset:2048 sc1
v_mfma_f32_16x16x32_bf16 v[176:179], a[8:11], a[160:163], v[176:179]
v_mfma_f32_16x16x32_bf16 v[176:179], a[12:15], v[64:67], v[176:179]
s_waitcnt lgkmcnt(2)
ds_read_b128 a[0:3], v20 offset:12288
v_mfma_f32_16x16x32_bf16 v[192:195], a[16:19], a[160:163], v[192:195]
v_mfma_f32_16x16x32_bf16 v[192:195], a[20:23], v[64:67], v[192:195]
v_mfma_f32_16x16x32_bf16 v[196:199], a[16:19], a[164:167], v[196:199]
buffer_load_dwordx4 a[92:95], v1, s[32:35], s56 offen offset:3072 sc1
v_mfma_f32_16x16x32_bf16 v[196:199], a[20:23], v[68:71], v[196:199]
ds_read_b128 a[4:7], v21 offset:12288
s_xor_b32 s56, s45, 147456
v_mfma_f32_16x16x32_bf16 v[200:203], a[16:19], a[168:171], v[200:203]
s_add_u32 s56, s56, s26
v_mfma_f32_16x16x32_bf16 v[200:203], a[20:23], v[72:75], v[200:203]
v_mfma_f32_16x16x32_bf16 v[204:207], a[16:19], a[172:175], v[204:207]
buffer_load_dwordx4 a[112:115], v1, s[32:35], s56 offen offset:0 sc1
v_mfma_f32_16x16x32_bf16 v[204:207], a[20:23], v[76:79], v[204:207]
s_waitcnt lgkmcnt(2)
ds_read_b128 a[8:11], v20 offset:14336
v_mfma_f32_16x16x32_bf16 v[220:223], a[24:27], a[172:175], v[220:223]
v_mfma_f32_16x16x32_bf16 v[220:223], a[28:31], v[76:79], v[220:223]
v_mfma_f32_16x16x32_bf16 v[216:219], a[24:27], a[168:171], v[216:219]
buffer_load_dwordx4 a[116:119], v1, s[32:35], s56 offen offset:1024 sc1
v_mfma_f32_16x16x32_bf16 v[216:219], a[28:31], v[72:75], v[216:219]
ds_read_b128 a[12:15], v21 offset:14336
v_mfma_f32_16x16x32_bf16 v[212:215], a[24:27], a[164:167], v[212:215]
v_mfma_f32_16x16x32_bf16 v[212:215], a[28:31], v[68:71], v[212:215]
v_mfma_f32_16x16x32_bf16 v[208:211], a[24:27], a[160:163], v[208:211]
v_mfma_f32_16x16x32_bf16 v[208:211], a[28:31], v[64:67], v[208:211]
s_waitcnt lgkmcnt(2)
ds_read_b128 a[16:19], v20 offset:20480
v_mfma_f32_16x16x32_bf16 v[224:227], a[0:3], a[160:163], v[224:227]
buffer_load_dwordx4 a[120:123], v1, s[32:35], s56 offen offset:2048 sc1
v_mfma_f32_16x16x32_bf16 v[224:227], a[4:7], v[64:67], v[224:227]
v_mfma_f32_16x16x32_bf16 v[228:231], a[0:3], a[164:167], v[228:231]
v_mfma_f32_16x16x32_bf16 v[228:231], a[4:7], v[68:71], v[228:231]
ds_read_b128 a[20:23], v21 offset:20480
v_mfma_f32_16x16x32_bf16 v[232:235], a[0:3], a[168:171], v[232:235]
buffer_load_dwordx4 a[124:127], v1, s[32:35], s56 offen offset:3072 sc1
v_mfma_f32_16x16x32_bf16 v[232:235], a[4:7], v[72:75], v[232:235]
s_xor_b32 s56, s45, 151552
s_add_u32 s56, s56, s26
v_mfma_f32_16x16x32_bf16 v[236:239], a[0:3], a[172:175], v[236:239]
v_mfma_f32_16x16x32_bf16 v[236:239], a[4:7], v[76:79], v[236:239]
s_waitcnt lgkmcnt(2)
ds_read_b128 a[24:27], v20 offset:22528
v_mfma_f32_16x16x32_bf16 v[252:255], a[8:11], a[172:175], v[252:255]
buffer_load_dwordx4 a[96:99], v1, s[32:35], s56 offen offset:0 sc1
v_mfma_f32_16x16x32_bf16 v[252:255], a[12:15], v[76:79], v[252:255]
v_mfma_f32_16x16x32_bf16 v[248:251], a[8:11], a[168:171], v[248:251]
v_mfma_f32_16x16x32_bf16 v[248:251], a[12:15], v[72:75], v[248:251]
ds_read_b128 a[28:31], v21 offset:22528
v_mfma_f32_16x16x32_bf16 v[244:247], a[8:11], a[164:167], v[244:247]
buffer_load_dwordx4 a[100:103], v1, s[32:35], s56 offen offset:1024 sc1
v_mfma_f32_16x16x32_bf16 v[244:247], a[12:15], v[68:71], v[244:247]
v_mfma_f32_16x16x32_bf16 v[240:243], a[8:11], a[160:163], v[240:243]
v_mfma_f32_16x16x32_bf16 v[240:243], a[12:15], v[64:67], v[240:243]
s_waitcnt vmcnt(38) lgkmcnt(2)
ds_read_b128 a[0:3], v20 offset:28672
v_mfma_f32_16x16x32_bf16 v[160:163], a[16:19], v[80:83], v[160:163]
buffer_load_dwordx4 a[104:107], v1, s[32:35], s56 offen offset:2048 sc1
v_mfma_f32_16x16x32_bf16 v[160:163], a[20:23], v[96:99], v[160:163]
v_mfma_f32_16x16x32_bf16 v[164:167], a[16:19], v[84:87], v[164:167]
v_mfma_f32_16x16x32_bf16 v[164:167], a[20:23], v[100:103], v[164:167]
ds_read_b128 a[4:7], v21 offset:28672
v_mfma_f32_16x16x32_bf16 v[168:171], a[16:19], v[88:91], v[168:171]
v_mfma_f32_16x16x32_bf16 v[168:171], a[20:23], v[104:107], v[168:171]
buffer_load_dwordx4 a[108:111], v1, s[32:35], s56 offen offset:3072 sc1
v_mfma_f32_16x16x32_bf16 v[172:175], a[16:19], v[92:95], v[172:175]
s_xor_b32 s56, s45, 147456
s_add_u32 s56, s56, s27
v_mfma_f32_16x16x32_bf16 v[172:175], a[20:23], v[108:111], v[172:175]
s_waitcnt lgkmcnt(2)
ds_read_b128 a[8:11], v20 offset:30720
v_mfma_f32_16x16x32_bf16 v[188:191], a[24:27], v[92:95], v[188:191]
v_mfma_f32_16x16x32_bf16 v[188:191], a[28:31], v[108:111], v[188:191]
buffer_load_dwordx4 a[128:131], v1, s[32:35], s56 offen offset:0 sc1
v_mfma_f32_16x16x32_bf16 v[184:187], a[24:27], v[88:91], v[184:187]
v_mfma_f32_16x16x32_bf16 v[184:187], a[28:31], v[104:107], v[184:187]
ds_read_b128 a[12:15], v21 offset:30720
v_mfma_f32_16x16x32_bf16 v[180:183], a[24:27], v[84:87], v[180:183]
v_mfma_f32_16x16x32_bf16 v[180:183], a[28:31], v[100:103], v[180:183]
buffer_load_dwordx4 a[132:135], v1, s[32:35], s56 offen offset:1024 sc1
v_mfma_f32_16x16x32_bf16 v[176:179], a[24:27], v[80:83], v[176:179]
s_waitcnt vmcnt(26)
s_barrier
v_mfma_f32_16x16x32_bf16 v[176:179], a[28:31], v[96:99], v[176:179]
s_waitcnt lgkmcnt(2)
ds_read_b128 a[16:19], v20 offset:36864
v_mfma_f32_16x16x32_bf16 v[224:227], a[0:3], v[80:83], v[224:227]
v_mfma_f32_16x16x32_bf16 v[224:227], a[4:7], v[96:99], v[224:227]
v_mfma_f32_16x16x32_bf16 v[228:231], a[0:3], v[84:87], v[228:231]
buffer_load_dwordx4 a[136:139], v1, s[32:35], s56 offen offset:2048 sc1
v_mfma_f32_16x16x32_bf16 v[228:231], a[4:7], v[100:103], v[228:231]
ds_read_b128 a[20:23], v21 offset:36864
v_mfma_f32_16x16x32_bf16 v[232:235], a[0:3], v[88:91], v[232:235]
v_mfma_f32_16x16x32_bf16 v[232:235], a[4:7], v[104:107], v[232:235]
v_mfma_f32_16x16x32_bf16 v[236:239], a[0:3], v[92:95], v[236:239]
buffer_load_dwordx4 a[140:143], v1, s[32:35], s56 offen offset:3072 sc1
v_mfma_f32_16x16x32_bf16 v[236:239], a[4:7], v[108:111], v[236:239]
s_waitcnt lgkmcnt(2)
ds_read_b128 a[24:27], v20 offset:38912
s_xor_b32 s56, s45, 151552
v_mfma_f32_16x16x32_bf16 v[252:255], a[8:11], v[92:95], v[252:255]
s_add_u32 s56, s56, s27
v_mfma_f32_16x16x32_bf16 v[252:255], a[12:15], v[108:111], v[252:255]
v_mfma_f32_16x16x32_bf16 v[248:251], a[8:11], v[88:91], v[248:251]
buffer_load_dwordx4 a[144:147], v1, s[32:35], s56 offen offset:0 sc1
v_mfma_f32_16x16x32_bf16 v[248:251], a[12:15], v[104:107], v[248:251]
ds_read_b128 a[28:31], v21 offset:38912
v_mfma_f32_16x16x32_bf16 v[244:247], a[8:11], v[84:87], v[244:247]
v_mfma_f32_16x16x32_bf16 v[244:247], a[12:15], v[100:103], v[244:247]
v_mfma_f32_16x16x32_bf16 v[240:243], a[8:11], v[80:83], v[240:243]
v_mfma_f32_16x16x32_bf16 v[240:243], a[12:15], v[96:99], v[240:243]
s_waitcnt vmcnt(21) lgkmcnt(2)
ds_read_b128 a[0:3], v20 offset:53248
v_mfma_f32_16x16x32_bf16 v[160:163], a[16:19], v[112:115], v[160:163]
buffer_load_dwordx4 a[148:151], v1, s[32:35], s56 offen offset:1024 sc1
v_mfma_f32_16x16x32_bf16 v[160:163], a[20:23], a[176:179], v[160:163]
v_mfma_f32_16x16x32_bf16 v[164:167], a[16:19], v[116:119], v[164:167]
v_mfma_f32_16x16x32_bf16 v[164:167], a[20:23], a[180:183], v[164:167]
ds_read_b128 a[4:7], v21 offset:53248
v_mfma_f32_16x16x32_bf16 v[168:171], a[16:19], v[120:123], v[168:171]
buffer_load_dwordx4 a[152:155], v1, s[32:35], s56 offen offset:2048 sc1
v_mfma_f32_16x16x32_bf16 v[168:171], a[20:23], a[184:187], v[168:171]
v_mfma_f32_16x16x32_bf16 v[172:175], a[16:19], v[124:127], v[172:175]
v_mfma_f32_16x16x32_bf16 v[172:175], a[20:23], a[188:191], v[172:175]
s_waitcnt lgkmcnt(2)
ds_read_b128 a[8:11], v20 offset:55296
v_mfma_f32_16x16x32_bf16 v[188:191], a[24:27], v[124:127], v[188:191]
buffer_load_dwordx4 a[156:159], v1, s[32:35], s56 offen offset:3072 sc1
v_mfma_f32_16x16x32_bf16 v[188:191], a[28:31], a[188:191], v[188:191]
v_mfma_f32_16x16x32_bf16 v[184:187], a[24:27], v[120:123], v[184:187]
v_mfma_f32_16x16x32_bf16 v[184:187], a[28:31], a[184:187], v[184:187]
ds_read_b128 a[12:15], v21 offset:55296
v_mfma_f32_16x16x32_bf16 v[180:183], a[24:27], v[116:119], v[180:183]
v_mfma_f32_16x16x32_bf16 v[180:183], a[28:31], a[180:183], v[180:183]
v_mfma_f32_16x16x32_bf16 v[176:179], a[24:27], v[112:115], v[176:179]
v_mfma_f32_16x16x32_bf16 v[176:179], a[28:31], a[176:179], v[176:179]
s_waitcnt vmcnt(16) lgkmcnt(2)
ds_read_b128 a[16:19], v22 offset:4096
v_mfma_f32_16x16x32_bf16 v[160:163], a[0:3], a[64:67], v[160:163]
v_mfma_f32_16x16x32_bf16 v[160:163], a[4:7], a[80:83], v[160:163]
v_mfma_f32_16x16x32_bf16 v[164:167], a[0:3], a[68:71], v[164:167]
v_mfma_f32_16x16x32_bf16 v[164:167], a[4:7], a[84:87], v[164:167]
ds_read_b128 a[20:23], v23 offset:4096
v_mfma_f32_16x16x32_bf16 v[168:171], a[0:3], a[72:75], v[168:171]
v_mfma_f32_16x16x32_bf16 v[168:171], a[4:7], a[88:91], v[168:171]
v_mfma_f32_16x16x32_bf16 v[172:175], a[0:3], a[76:79], v[172:175]
v_mfma_f32_16x16x32_bf16 v[172:175], a[4:7], a[92:95], v[172:175]
s_waitcnt lgkmcnt(2)
ds_read_b128 a[24:27], v22 offset:6144
v_mfma_f32_16x16x32_bf16 v[188:191], a[8:11], a[76:79], v[188:191]
v_mfma_f32_16x16x32_bf16 v[188:191], a[12:15], a[92:95], v[188:191]
v_mfma_f32_16x16x32_bf16 v[184:187], a[8:11], a[72:75], v[184:187]
v_mfma_f32_16x16x32_bf16 v[184:187], a[12:15], a[88:91], v[184:187]
ds_read_b128 a[28:31], v23 offset:6144
v_mfma_f32_16x16x32_bf16 v[180:183], a[8:11], a[68:71], v[180:183]
v_mfma_f32_16x16x32_bf16 v[180:183], a[12:15], a[84:87], v[180:183]
v_mfma_f32_16x16x32_bf16 v[176:179], a[8:11], a[64:67], v[176:179]
v_mfma_f32_16x16x32_bf16 v[176:179], a[12:15], a[80:83], v[176:179]
s_waitcnt vmcnt(8) lgkmcnt(2)
ds_read_b128 a[0:3], v22 offset:20480
v_mfma_f32_16x16x32_bf16 v[160:163], a[16:19], a[112:115], v[160:163]
v_mfma_f32_16x16x32_bf16 v[160:163], a[20:23], a[96:99], v[160:163]
v_mfma_f32_16x16x32_bf16 v[164:167], a[16:19], a[116:119], v[164:167]
v_mfma_f32_16x16x32_bf16 v[164:167], a[20:23], a[100:103], v[164:167]
ds_read_b128 a[4:7], v23 offset:20480
v_mfma_f32_16x16x32_bf16 v[168:171], a[16:19], a[120:123], v[168:171]
v_mfma_f32_16x16x32_bf16 v[168:171], a[20:23], a[104:107], v[168:171]
v_mfma_f32_16x16x32_bf16 v[172:175], a[16:19], a[124:127], v[172:175]
v_mfma_f32_16x16x32_bf16 v[172:175], a[20:23], a[108:111], v[172:175]
s_waitcnt lgkmcnt(2)
ds_read_b128 a[8:11], v22 offset:22528
v_mfma_f32_16x16x32_bf16 v[188:191], a[24:27], a[124:127], v[188:191]
v_mfma_f32_16x16x32_bf16 v[188:191], a[28:31], a[108:111], v[188:191]
v_mfma_f32_16x16x32_bf16 v[184:187], a[24:27], a[120:123], v[184:187]
v_mfma_f32_16x16x32_bf16 v[184:187], a[28:31], a[104:107], v[184:187]
ds_read_b128 a[12:15], v23 offset:22528
v_mfma_f32_16x16x32_bf16 v[180:183], a[24:27], a[116:119], v[180:183]
v_mfma_f32_16x16x32_bf16 v[180:183], a[28:31], a[100:103], v[180:183]
v_mfma_f32_16x16x32_bf16 v[176:179], a[24:27], a[112:115], v[176:179]
v_mfma_f32_16x16x32_bf16 v[176:179], a[28:31], a[96:99], v[176:179]
s_waitcnt vmcnt(0) lgkmcnt(2)
ds_read_b128 a[16:19], v20 offset:24576
v_mfma_f32_16x16x32_bf16 v[160:163], a[0:3], a[128:131], v[160:163]
v_mfma_f32_16x16x32_bf16 v[160:163], a[4:7], a[144:147], v[160:163]
v_mfma_f32_16x16x32_bf16 v[164:167], a[0:3], a[132:135], v[164:167]
v_mfma_f32_16x16x32_bf16 v[164:167], a[4:7], a[148:151], v[164:167]
ds_read_b128 a[20:23], v21 offset:24576
v_mfma_f32_16x16x32_bf16 v[168:171], a[0:3], a[136:139], v[168:171]
v_mfma_f32_16x16x32_bf16 v[168:171], a[4:7], a[152:155], v[168:171]
v_mfma_f32_16x16x32_bf16 v[172:175], a[0:3], a[140:143], v[172:175]
v_mfma_f32_16x16x32_bf16 v[172:175], a[4:7], a[156:159], v[172:175]
s_waitcnt lgkmcnt(2)
ds_read_b128 a[24:27], v20 offset:40960
v_mfma_f32_16x16x32_bf16 v[188:191], a[8:11], a[140:143], v[188:191]
v_mfma_f32_16x16x32_bf16 v[188:191], a[12:15], a[156:159], v[188:191]
v_mfma_f32_16x16x32_bf16 v[184:187], a[8:11], a[136:139], v[184:187]
v_cvt_pk_bf16_f32 v160, v160, v161
v_cvt_pk_bf16_f32 v161, v162, v163
v_mfma_f32_16x16x32_bf16 v[184:187], a[12:15], a[152:155], v[184:187]
ds_read_b128 a[28:31], v21 offset:40960
v_cvt_pk_bf16_f32 v162, v164, v165
v_mfma_f32_16x16x32_bf16 v[180:183], a[8:11], a[132:135], v[180:183]
v_cvt_pk_bf16_f32 v163, v166, v167
v_cvt_pk_bf16_f32 v168, v168, v169
v_mfma_f32_16x16x32_bf16 v[180:183], a[12:15], a[148:151], v[180:183]
buffer_store_dwordx4 v[160:163], v1, s[40:43], s73 offen offset:0 sc0 sc1
v_mfma_f32_16x16x32_bf16 v[176:179], a[8:11], a[128:131], v[176:179]
v_cvt_pk_bf16_f32 v169, v170, v171
v_cvt_pk_bf16_f32 v170, v172, v173
v_mfma_f32_16x16x32_bf16 v[176:179], a[12:15], a[144:147], v[176:179]
s_waitcnt lgkmcnt(2)
ds_read_b128 a[0:3], v20 offset:57344
v_cvt_pk_bf16_f32 v171, v174, v175
v_mfma_f32_16x16x32_bf16 v[192:195], a[16:19], v[80:83], v[192:195]
v_mfma_f32_16x16x32_bf16 v[192:195], a[20:23], v[96:99], v[192:195]
buffer_store_dwordx4 v[168:171], v1, s[40:43], s73 offen offset:1024 sc0 sc1
v_mfma_f32_16x16x32_bf16 v[196:199], a[16:19], v[84:87], v[196:199]
s_nop 0
v_cvt_pk_bf16_f32 v176, v176, v177
v_cvt_pk_bf16_f32 v177, v178, v179
v_mfma_f32_16x16x32_bf16 v[196:199], a[20:23], v[100:103], v[196:199]
ds_read_b128 a[4:7], v21 offset:57344
v_cvt_pk_bf16_f32 v178, v180, v181
v_mfma_f32_16x16x32_bf16 v[200:203], a[16:19], v[88:91], v[200:203]
v_cvt_pk_bf16_f32 v179, v182, v183
v_cvt_pk_bf16_f32 v184, v184, v185
v_mfma_f32_16x16x32_bf16 v[200:203], a[20:23], v[104:107], v[200:203]
v_cvt_pk_bf16_f32 v185, v186, v187
v_cvt_pk_bf16_f32 v186, v188, v189
v_mfma_f32_16x16x32_bf16 v[204:207], a[16:19], v[92:95], v[204:207]
v_cvt_pk_bf16_f32 v187, v190, v191
v_mfma_f32_16x16x32_bf16 v[204:207], a[20:23], v[108:111], v[204:207]
s_waitcnt lgkmcnt(2)
ds_read_b128 a[8:11], v22 offset:8192
v_mfma_f32_16x16x32_bf16 v[204:207], a[24:27], v[124:127], v[204:207]
v_mfma_f32_16x16x32_bf16 v[204:207], a[28:31], a[188:191], v[204:207]
v_mfma_f32_16x16x32_bf16 v[200:203], a[24:27], v[120:123], v[200:203]
v_mfma_f32_16x16x32_bf16 v[200:203], a[28:31], a[184:187], v[200:203]
ds_read_b128 a[12:15], v23 offset:8192
v_mfma_f32_16x16x32_bf16 v[196:199], a[24:27], v[116:119], v[196:199]
v_mfma_f32_16x16x32_bf16 v[196:199], a[28:31], a[180:183], v[196:199]
v_mfma_f32_16x16x32_bf16 v[192:195], a[24:27], v[112:115], v[192:195]
buffer_store_dwordx4 v[176:179], v1, s[40:43], s73 offen offset:2048 sc0 sc1
v_mfma_f32_16x16x32_bf16 v[192:195], a[28:31], a[176:179], v[192:195]
s_waitcnt lgkmcnt(2)
ds_read_b128 a[16:19], v22 offset:24576
v_mfma_f32_16x16x32_bf16 v[192:195], a[0:3], a[64:67], v[192:195]
v_mfma_f32_16x16x32_bf16 v[192:195], a[4:7], a[80:83], v[192:195]
v_mfma_f32_16x16x32_bf16 v[196:199], a[0:3], a[68:71], v[196:199]
v_mfma_f32_16x16x32_bf16 v[196:199], a[4:7], a[84:87], v[196:199]
ds_read_b128 a[20:23], v23 offset:24576
v_mfma_f32_16x16x32_bf16 v[200:203], a[0:3], a[72:75], v[200:203]
v_mfma_f32_16x16x32_bf16 v[200:203], a[4:7], a[88:91], v[200:203]
v_mfma_f32_16x16x32_bf16 v[204:207], a[0:3], a[76:79], v[204:207]
v_mfma_f32_16x16x32_bf16 v[204:207], a[4:7], a[92:95], v[204:207]
s_waitcnt lgkmcnt(2)
ds_read_b128 a[24:27], v20 offset:26624
v_mfma_f32_16x16x32_bf16 v[204:207], a[8:11], a[124:127], v[204:207]
v_mfma_f32_16x16x32_bf16 v[204:207], a[12:15], a[108:111], v[204:207]
v_mfma_f32_16x16x32_bf16 v[200:203], a[8:11], a[120:123], v[200:203]
v_mfma_f32_16x16x32_bf16 v[200:203], a[12:15], a[104:107], v[200:203]
ds_read_b128 a[28:31], v21 offset:26624
v_mfma_f32_16x16x32_bf16 v[196:199], a[8:11], a[116:119], v[196:199]
buffer_store_dwordx4 v[184:187], v1, s[40:43], s73 offen offset:3072 sc0 sc1
v_mfma_f32_16x16x32_bf16 v[196:199], a[12:15], a[100:103], v[196:199]
v_mfma_f32_16x16x32_bf16 v[192:195], a[8:11], a[112:115], v[192:195]
v_mfma_f32_16x16x32_bf16 v[192:195], a[12:15], a[96:99], v[192:195]
s_waitcnt lgkmcnt(2)
ds_read_b128 a[0:3], v20 offset:43008
v_mfma_f32_16x16x32_bf16 v[192:195], a[16:19], a[128:131], v[192:195]
L_tr16:
s_cbranch_execz L_trret2
v_mfma_f32_16x16x32_bf16 v[192:195], a[20:23], a[144:147], v[192:195]
v_mfma_f32_16x16x32_bf16 v[196:199], a[16:19], a[132:135], v[196:199]
v_mfma_f32_16x16x32_bf16 v[196:199], a[20:23], a[148:151], v[196:199]
ds_read_b128 a[4:7], v21 offset:43008
v_mfma_f32_16x16x32_bf16 v[200:203], a[16:19], a[136:139], v[200:203]
v_mfma_f32_16x16x32_bf16 v[200:203], a[20:23], a[152:155], v[200:203]
v_mfma_f32_16x16x32_bf16 v[204:207], a[16:19], a[140:143], v[204:207]
v_mfma_f32_16x16x32_bf16 v[204:207], a[20:23], a[156:159], v[204:207]
s_waitcnt lgkmcnt(2)
ds_read_b128 a[8:11], v20 offset:59392
v_mfma_f32_16x16x32_bf16 v[220:223], a[24:27], v[92:95], v[220:223]
v_mfma_f32_16x16x32_bf16 v[220:223], a[28:31], v[108:111], v[220:223]
v_mfma_f32_16x16x32_bf16 v[216:219], a[24:27], v[88:91], v[216:219]
v_cvt_pk_bf16_f32 v192, v192, v193
v_cvt_pk_bf16_f32 v193, v194, v195
v_mfma_f32_16x16x32_bf16 v[216:219], a[28:31], v[104:107], v[216:219]
ds_read_b128 a[12:15], v21 offset:59392
v_cvt_pk_bf16_f32 v194, v196, v197
v_mfma_f32_16x16x32_bf16 v[212:215], a[24:27], v[84:87], v[212:215]
v_cvt_pk_bf16_f32 v195, v198, v199
v_cvt_pk_bf16_f32 v200, v200, v201
v_mfma_f32_16x16x32_bf16 v[212:215], a[28:31], v[100:103], v[212:215]
buffer_store_dwordx4 v[192:195], v1, s[40:43], s74 offen offset:0 sc0 sc1
v_mfma_f32_16x16x32_bf16 v[208:211], a[24:27], v[80:83], v[208:211]
v_cvt_pk_bf16_f32 v201, v202, v203
v_cvt_pk_bf16_f32 v202, v204, v205
v_mfma_f32_16x16x32_bf16 v[208:211], a[28:31], v[96:99], v[208:211]
s_waitcnt lgkmcnt(2)
ds_read_b128 a[16:19], v22 offset:10240
v_cvt_pk_bf16_f32 v203, v206, v207
v_mfma_f32_16x16x32_bf16 v[208:211], a[0:3], v[112:115], v[208:211]
v_mfma_f32_16x16x32_bf16 v[208:211], a[4:7], a[176:179], v[208:211]
v_mfma_f32_16x16x32_bf16 v[212:215], a[0:3], v[116:119], v[212:215]
v_mfma_f32_16x16x32_bf16 v[212:215], a[4:7], a[180:183], v[212:215]
ds_read_b128 a[20:23], v23 offset:10240
v_mfma_f32_16x16x32_bf16 v[216:219], a[0:3], v[120:123], v[216:219]
v_mfma_f32_16x16x32_bf16 v[216:219], a[4:7], a[184:187], v[216:219]
v_mfma_f32_16x16x32_bf16 v[220:223], a[0:3], v[124:127], v[220:223]
buffer_store_dwordx4 v[200:203], v1, s[40:43], s74 offen offset:1024 sc0 sc1
v_mfma_f32_16x16x32_bf16 v[220:223], a[4:7], a[188:191], v[220:223]
s_waitcnt lgkmcnt(2)
ds_read_b128 a[24:27], v22 offset:26624
v_mfma_f32_16x16x32_bf16 v[220:223], a[8:11], a[76:79], v[220:223]
v_mfma_f32_16x16x32_bf16 v[220:223], a[12:15], a[92:95], v[220:223]
v_mfma_f32_16x16x32_bf16 v[216:219], a[8:11], a[72:75], v[216:219]
v_mfma_f32_16x16x32_bf16 v[216:219], a[12:15], a[88:91], v[216:219]
ds_read_b128 a[28:31], v23 offset:26624
v_mfma_f32_16x16x32_bf16 v[212:215], a[8:11], a[68:71], v[212:215]
v_mfma_f32_16x16x32_bf16 v[212:215], a[12:15], a[84:87], v[212:215]
v_mfma_f32_16x16x32_bf16 v[208:211], a[8:11], a[64:67], v[208:211]
v_mfma_f32_16x16x32_bf16 v[208:211], a[12:15], a[80:83], v[208:211]
s_waitcnt lgkmcnt(2)
ds_read_b128 a[0:3], v20 offset:45056
v_mfma_f32_16x16x32_bf16 v[208:211], a[16:19], a[112:115], v[208:211]
v_mfma_f32_16x16x32_bf16 v[208:211], a[20:23], a[96:99], v[208:211]
v_mfma_f32_16x16x32_bf16 v[212:215], a[16:19], a[116:119], v[212:215]
v_mfma_f32_16x16x32_bf16 v[212:215], a[20:23], a[100:103], v[212:215]
ds_read_b128 a[4:7], v21 offset:45056
v_mfma_f32_16x16x32_bf16 v[216:219], a[16:19], a[120:123], v[216:219]
v_mfma_f32_16x16x32_bf16 v[216:219], a[20:23], a[104:107], v[216:219]
v_mfma_f32_16x16x32_bf16 v[220:223], a[16:19], a[124:127], v[220:223]
v_mfma_f32_16x16x32_bf16 v[220:223], a[20:23], a[108:111], v[220:223]
s_waitcnt lgkmcnt(2)
ds_read_b128 a[8:11], v20 offset:61440
v_mfma_f32_16x16x32_bf16 v[220:223], a[24:27], a[140:143], v[220:223]
s_waitcnt vmcnt(2)
v_mfma_f32_16x16x32_bf16 v[220:223], a[28:31], a[156:159], v[220:223]
s_mov_b64 exec, 1
buffer_store_dword v4, v29, s[36:39], s69 offen offset:4 sc0 sc1
s_mov_b64 exec, -1
v_mfma_f32_16x16x32_bf16 v[216:219], a[24:27], a[136:139], v[216:219]
v_mfma_f32_16x16x32_bf16 v[216:219], a[28:31], a[152:155], v[216:219]
ds_read_b128 a[12:15], v21 offset:61440
v_mfma_f32_16x16x32_bf16 v[212:215], a[24:27], a[132:135], v[212:215]
v_mfma_f32_16x16x32_bf16 v[212:215], a[28:31], a[148:151], v[212:215]
v_mfma_f32_16x16x32_bf16 v[208:211], a[24:27], a[128:131], v[208:211]
v_mfma_f32_16x16x32_bf16 v[208:211], a[28:31], a[144:147], v[208:211]
s_waitcnt lgkmcnt(2)
ds_read_b128 a[16:19], v22 offset:12288
v_mfma_f32_16x16x32_bf16 v[224:227], a[0:3], v[112:115], v[224:227]
v_mfma_f32_16x16x32_bf16 v[224:227], a[4:7], a[176:179], v[224:227]
v_mfma_f32_16x16x32_bf16 v[228:231], a[0:3], v[116:119], v[228:231]
s_nop 2
v_cvt_pk_bf16_f32 v208, v208, v209
v_cvt_pk_bf16_f32 v209, v210, v211
v_mfma_f32_16x16x32_bf16 v[228:231], a[4:7], a[180:183], v[228:231]
ds_read_b128 a[20:23], v23 offset:12288
v_cvt_pk_bf16_f32 v210, v212, v213
v_mfma_f32_16x16x32_bf16 v[232:235], a[0:3], v[120:123], v[232:235]
v_cvt_pk_bf16_f32 v211, v214, v215
v_cvt_pk_bf16_f32 v216, v216, v217
v_mfma_f32_16x16x32_bf16 v[232:235], a[4:7], a[184:187], v[232:235]
buffer_store_dwordx4 v[208:211], v1, s[40:43], s74 offen offset:2048 sc0 sc1
v_mfma_f32_16x16x32_bf16 v[236:239], a[0:3], v[124:127], v[236:239]
v_cvt_pk_bf16_f32 v217, v218, v219
v_cvt_pk_bf16_f32 v218, v220, v221
v_mfma_f32_16x16x32_bf16 v[236:239], a[4:7], a[188:191], v[236:239]
s_waitcnt lgkmcnt(2)
ds_read_b128 a[24:27], v22 offset:28672
v_cvt_pk_bf16_f32 v219, v222, v223
v_mfma_f32_16x16x32_bf16 v[236:239], a[8:11], a[76:79], v[236:239]
v_mfma_f32_16x16x32_bf16 v[236:239], a[12:15], a[92:95], v[236:239]
buffer_store_dwordx4 v[216:219], v1, s[40:43], s74 offen offset:3072 sc0 sc1
v_mfma_f32_16x16x32_bf16 v[232:235], a[8:11], a[72:75], v[232:235]
v_mfma_f32_16x16x32_bf16 v[232:235], a[12:15], a[88:91], v[232:235]
ds_read_b128 a[28:31], v23 offset:28672
v_mfma_f32_16x16x32_bf16 v[228:231], a[8:11], a[68:71], v[228:231]
v_mfma_f32_16x16x32_bf16 v[228:231], a[12:15], a[84:87], v[228:231]
v_mfma_f32_16x16x32_bf16 v[224:227], a[8:11], a[64:67], v[224:227]
v_mfma_f32_16x16x32_bf16 v[224:227], a[12:15], a[80:83], v[224:227]
s_waitcnt lgkmcnt(2)
ds_read_b128 a[0:3], v20 offset:47104
v_mfma_f32_16x16x32_bf16 v[224:227], a[16:19], a[112:115], v[224:227]
v_mfma_f32_16x16x32_bf16 v[224:227], a[20:23], a[96:99], v[224:227]
v_mfma_f32_16x16x32_bf16 v[228:231], a[16:19], a[116:119], v[228:231]
v_mfma_f32_16x16x32_bf16 v[228:231], a[20:23], a[100:103], v[228:231]
ds_read_b128 a[4:7], v21 offset:47104
v_mfma_f32_16x16x32_bf16 v[232:235], a[16:19], a[120:123], v[232:235]
v_mfma_f32_16x16x32_bf16 v[232:235], a[20:23], a[104:107], v[232:235]
v_mfma_f32_16x16x32_bf16 v[236:239], a[16:19], a[124:127], v[236:239]
v_mfma_f32_16x16x32_bf16 v[236:239], a[20:23], a[108:111], v[236:239]
s_waitcnt lgkmcnt(2)
ds_read_b128 a[8:11], v20 offset:63488
v_mfma_f32_16x16x32_bf16 v[236:239], a[24:27], a[140:143], v[236:239]
v_mfma_f32_16x16x32_bf16 v[236:239], a[28:31], a[156:159], v[236:239]
v_mfma_f32_16x16x32_bf16 v[232:235], a[24:27], a[136:139], v[232:235]
v_mfma_f32_16x16x32_bf16 v[232:235], a[28:31], a[152:155], v[232:235]
ds_read_b128 a[12:15], v21 offset:63488
v_mfma_f32_16x16x32_bf16 v[228:231], a[24:27], a[132:135], v[228:231]
v_mfma_f32_16x16x32_bf16 v[228:231], a[28:31], a[148:151], v[228:231]
v_mfma_f32_16x16x32_bf16 v[224:227], a[24:27], a[128:131], v[224:227]
v_mfma_f32_16x16x32_bf16 v[224:227], a[28:31], a[144:147], v[224:227]
s_waitcnt lgkmcnt(2)
ds_read_b128 a[16:19], v22 offset:14336
v_mfma_f32_16x16x32_bf16 v[240:243], a[0:3], v[112:115], v[240:243]
v_mfma_f32_16x16x32_bf16 v[240:243], a[4:7], a[176:179], v[240:243]
buffer_load_dword v37, v32, s[36:39], s69 offen sc0 sc1
v_mfma_f32_16x16x32_bf16 v[244:247], a[0:3], v[116:119], v[244:247]
s_nop 1
v_cvt_pk_bf16_f32 v224, v224, v225
v_cvt_pk_bf16_f32 v225, v226, v227
v_mfma_f32_16x16x32_bf16 v[244:247], a[4:7], a[180:183], v[244:247]
ds_read_b128 a[20:23], v23 offset:14336
v_cvt_pk_bf16_f32 v226, v228, v229
v_mfma_f32_16x16x32_bf16 v[248:251], a[0:3], v[120:123], v[248:251]
v_cvt_pk_bf16_f32 v227, v230, v231
v_cvt_pk_bf16_f32 v232, v232, v233
v_mfma_f32_16x16x32_bf16 v[248:251], a[4:7], a[184:187], v[248:251]
buffer_store_dwordx4 v[224:227], v1, s[40:43], s75 offen offset:0 sc0 sc1
v_mfma_f32_16x16x32_bf16 v[252:255], a[0:3], v[124:127], v[252:255]
v_cvt_pk_bf16_f32 v233, v234, v235
v_cvt_pk_bf16_f32 v234, v236, v237
v_mfma_f32_16x16x32_bf16 v[252:255], a[4:7], a[188:191], v[252:255]
s_waitcnt lgkmcnt(2)
ds_read_b128 a[24:27], v22 offset:30720
v_cvt_pk_bf16_f32 v235, v238, v239
v_mfma_f32_16x16x32_bf16 v[252:255], a[8:11], a[76:79], v[252:255]
v_mfma_f32_16x16x32_bf16 v[252:255], a[12:15], a[92:95], v[252:255]
buffer_store_dwordx4 v[232:235], v1, s[40:43], s75 offen offset:1024 sc0 sc1
v_mfma_f32_16x16x32_bf16 v[248:251], a[8:11], a[72:75], v[248:251]
v_mfma_f32_16x16x32_bf16 v[248:251], a[12:15], a[88:91], v[248:251]
ds_read_b128 a[28:31], v23 offset:30720
v_mfma_f32_16x16x32_bf16 v[244:247], a[8:11], a[68:71], v[244:247]
v_mfma_f32_16x16x32_bf16 v[244:247], a[12:15], a[84:87], v[244:247]
v_mfma_f32_16x16x32_bf16 v[240:243], a[8:11], a[64:67], v[240:243]
v_mfma_f32_16x16x32_bf16 v[240:243], a[12:15], a[80:83], v[240:243]
s_waitcnt lgkmcnt(2)
ds_read_b128 a[0:3], v22 offset:32768
v_mfma_f32_16x16x32_bf16 v[240:243], a[16:19], a[112:115], v[240:243]
v_mfma_f32_16x16x32_bf16 v[240:243], a[20:23], a[96:99], v[240:243]
v_mfma_f32_16x16x32_bf16 v[244:247], a[16:19], a[116:119], v[244:247]
v_mfma_f32_16x16x32_bf16 v[244:247], a[20:23], a[100:103], v[244:247]
ds_read_b128 a[4:7], v22 offset:49152
v_mfma_f32_16x16x32_bf16 v[248:251], a[16:19], a[120:123], v[248:251]
v_mfma_f32_16x16x32_bf16 v[248:251], a[20:23], a[104:107], v[248:251]
s_waitcnt vmcnt(3)
v_mfma_f32_16x16x32_bf16 v[252:255], a[16:19], a[124:127], v[252:255]
s_mov_b64 exec, 1
buffer_store_dword v4, v30, s[36:39], s69 offen offset:8 sc0 sc1
s_mov_b64 exec, -1
v_mfma_f32_16x16x32_bf16 v[252:255], a[20:23], a[108:111], v[252:255]
s_waitcnt lgkmcnt(2)
ds_read_b128 a[8:11], v23 offset:32768
v_mfma_f32_16x16x32_bf16 v[252:255], a[24:27], a[140:143], v[252:255]
v_mfma_f32_16x16x32_bf16 v[252:255], a[28:31], a[156:159], v[252:255]
v_mfma_f32_16x16x32_bf16 v[248:251], a[24:27], a[136:139], v[248:251]
v_mfma_f32_16x16x32_bf16 v[248:251], a[28:31], a[152:155], v[248:251]
ds_read_b128 a[12:15], v23 offset:49152
v_mfma_f32_16x16x32_bf16 v[244:247], a[24:27], a[132:135], v[244:247]
v_mfma_f32_16x16x32_bf16 v[244:247], a[28:31], a[148:151], v[244:247]
v_mfma_f32_16x16x32_bf16 v[240:243], a[24:27], a[128:131], v[240:243]
v_mfma_f32_16x16x32_bf16 v[240:243], a[28:31], a[144:147], v[240:243]
s_waitcnt lgkmcnt(2)
ds_read_b128 a[16:19], v20 offset:0
v_mfma_f32_16x16x32_bf16 v[128:131], a[0:3], a[32:35], v[128:131]
v_mfma_f32_16x16x32_bf16 v[128:131], a[4:7], a[48:51], v[128:131]
v_mfma_f32_16x16x32_bf16 v[132:135], a[0:3], a[36:39], v[132:135]
s_nop 2
v_cvt_pk_bf16_f32 v240, v240, v241
v_cvt_pk_bf16_f32 v241, v242, v243
v_mfma_f32_16x16x32_bf16 v[132:135], a[4:7], a[52:55], v[132:135]
ds_read_b128 a[20:23], v21 offset:0
v_cvt_pk_bf16_f32 v242, v244, v245
v_mfma_f32_16x16x32_bf16 v[136:139], a[0:3], a[40:43], v[136:139]
v_cvt_pk_bf16_f32 v243, v246, v247
v_cvt_pk_bf16_f32 v248, v248, v249
v_mfma_f32_16x16x32_bf16 v[136:139], a[4:7], a[56:59], v[136:139]
s_waitcnt vmcnt(3)
v_cmp_ne_u32 s[82:83], s3, v37
v_cvt_pk_bf16_f32 v249, v250, v251
v_mfma_f32_16x16x32_bf16 v[140:143], a[0:3], a[44:47], v[140:143]
buffer_store_dwordx4 v[240:243], v1, s[40:43], s75 offen offset:2048 sc0 sc1
v_mfma_f32_16x16x32_bf16 v[140:143], a[4:7], a[60:63], v[140:143]
s_waitcnt lgkmcnt(2)
ds_read_b128 a[24:27], v20 offset:16384
v_cvt_pk_bf16_f32 v250, v252, v253
v_mfma_f32_16x16x32_bf16 v[140:143], a[8:11], a[220:223], v[140:143]
s_and_b32 s29, s82, 2
s_cselect_b32 s47, 0x40000000, s70
s_mov_b32 s28, s29
v_mfma_f32_16x16x32_bf16 v[140:143], a[12:15], a[236:239], v[140:143]
v_cvt_pk_bf16_f32 v251, v254, v255
v_mfma_f32_16x16x32_bf16 v[136:139], a[8:11], a[216:219], v[136:139]
buffer_load_dwordx4 v[164:167], v1, s[40:43], s47 offen offset:0 sc0 sc1
v_mfma_f32_16x16x32_bf16 v[136:139], a[12:15], a[232:235], v[136:139]
ds_read_b128 a[28:31], v21 offset:16384
v_mfma_f32_16x16x32_bf16 v[132:135], a[8:11], a[212:215], v[132:135]
v_mfma_f32_16x16x32_bf16 v[132:135], a[12:15], a[228:231], v[132:135]
v_mfma_f32_16x16x32_bf16 v[128:131], a[8:11], a[208:211], v[128:131]
v_mfma_f32_16x16x32_bf16 v[128:131], a[12:15], a[224:227], v[128:131]
s_waitcnt lgkmcnt(2)
ds_read_b128 a[0:3], v20 offset:32768
v_mfma_f32_16x16x32_bf16 v[128:131], a[16:19], a[160:163], v[128:131]
buffer_store_dwordx4 v[248:251], v1, s[40:43], s75 offen offset:3072 sc0 sc1
v_mfma_f32_16x16x32_bf16 v[128:131], a[20:23], v[64:67], v[128:131]
v_mfma_f32_16x16x32_bf16 v[132:135], a[16:19], a[164:167], v[132:135]
v_mfma_f32_16x16x32_bf16 v[132:135], a[20:23], v[68:71], v[132:135]
ds_read_b128 a[4:7], v21 offset:32768
v_mfma_f32_16x16x32_bf16 v[136:139], a[16:19], a[168:171], v[136:139]
v_mfma_f32_16x16x32_bf16 v[136:139], a[20:23], v[72:75], v[136:139]
s_waitcnt vmcnt(4)
v_mfma_f32_16x16x32_bf16 v[140:143], a[16:19], a[172:175], v[140:143]
s_mov_b64 exec, 1
buffer_store_dword v4, v31, s[36:39], s69 offen offset:0 sc0 sc1
s_mov_b64 exec, -1
v_mfma_f32_16x16x32_bf16 v[140:143], a[20:23], v[76:79], v[140:143]
s_waitcnt lgkmcnt(2)
ds_read_b128 a[8:11], v20 offset:49152
v_mfma_f32_16x16x32_bf16 v[140:143], a[24:27], v[92:95], v[140:143]
v_mfma_f32_16x16x32_bf16 v[140:143], a[28:31], v[108:111], v[140:143]
v_mfma_f32_16x16x32_bf16 v[136:139], a[24:27], v[88:91], v[136:139]
v_mfma_f32_16x16x32_bf16 v[136:139], a[28:31], v[104:107], v[136:139]
ds_read_b128 a[12:15], v21 offset:49152
v_mfma_f32_16x16x32_bf16 v[132:135], a[24:27], v[84:87], v[132:135]
v_mfma_f32_16x16x32_bf16 v[132:135], a[28:31], v[100:103], v[132:135]
buffer_load_dwordx4 v[172:175], v1, s[40:43], s47 offen offset:1024 sc0 sc1
v_mfma_f32_16x16x32_bf16 v[128:131], a[24:27], v[80:83], v[128:131]
v_mfma_f32_16x16x32_bf16 v[128:131], a[28:31], v[96:99], v[128:131]
s_waitcnt lgkmcnt(2)
ds_read_b128 a[16:19], v22 offset:0
v_mfma_f32_16x16x32_bf16 v[128:131], a[0:3], v[112:115], v[128:131]
buffer_load_dword v38, v32, s[36:39], s69 offen sc0 sc1
v_mfma_f32_16x16x32_bf16 v[128:131], a[4:7], a[176:179], v[128:131]
v_mfma_f32_16x16x32_bf16 v[132:135], a[0:3], v[116:119], v[132:135]
v_mfma_f32_16x16x32_bf16 v[132:135], a[4:7], a[180:183], v[132:135]
ds_read_b128 a[20:23], v23 offset:0
v_mfma_f32_16x16x32_bf16 v[136:139], a[0:3], v[120:123], v[136:139]
v_mfma_f32_16x16x32_bf16 v[136:139], a[4:7], a[184:187], v[136:139]
buffer_load_dwordx4 v[180:183], v1, s[40:43], s47 offen offset:2048 sc0 sc1
v_mfma_f32_16x16x32_bf16 v[140:143], a[0:3], v[124:127], v[140:143]
v_mfma_f32_16x16x32_bf16 v[140:143], a[4:7], a[188:191], v[140:143]
s_waitcnt lgkmcnt(2)
ds_read_b128 a[24:27], v22 offset:16384
v_mfma_f32_16x16x32_bf16 v[140:143], a[8:11], a[76:79], v[140:143]
v_mfma_f32_16x16x32_bf16 v[140:143], a[12:15], a[92:95], v[140:143]
v_mfma_f32_16x16x32_bf16 v[136:139], a[8:11], a[72:75], v[136:139]
v_mfma_f32_16x16x32_bf16 v[136:139], a[12:15], a[88:91], v[136:139]
ds_read_b128 a[28:31], v23 offset:16384
v_mfma_f32_16x16x32_bf16 v[132:135], a[8:11], a[68:71], v[132:135]
v_mfma_f32_16x16x32_bf16 v[132:135], a[12:15], a[84:87], v[132:135]
buffer_load_dwordx4 v[188:191], v1, s[40:43], s47 offen offset:3072 sc0 sc1
v_mfma_f32_16x16x32_bf16 v[128:131], a[8:11], a[64:67], v[128:131]
v_mfma_f32_16x16x32_bf16 v[128:131], a[12:15], a[80:83], v[128:131]
s_waitcnt lgkmcnt(2)
ds_read_b128 a[0:3], v22 offset:34816
v_mfma_f32_16x16x32_bf16 v[128:131], a[16:19], a[112:115], v[128:131]
v_mfma_f32_16x16x32_bf16 v[128:131], a[20:23], a[96:99], v[128:131]
v_mfma_f32_16x16x32_bf16 v[132:135], a[16:19], a[116:119], v[132:135]
v_mfma_f32_16x16x32_bf16 v[132:135], a[20:23], a[100:103], v[132:135]
ds_read_b128 a[4:7], v22 offset:51200
v_mfma_f32_16x16x32_bf16 v[136:139], a[16:19], a[120:123], v[136:139]
v_mfma_f32_16x16x32_bf16 v[136:139], a[20:23], a[104:107], v[136:139]
v_mfma_f32_16x16x32_bf16 v[140:143], a[16:19], a[124:127], v[140:143]
v_mfma_f32_16x16x32_bf16 v[140:143], a[20:23], a[108:111], v[140:143]
s_waitcnt lgkmcnt(2)
ds_read_b128 a[8:11], v23 offset:34816
v_mfma_f32_16x16x32_bf16 v[140:143], a[24:27], a[140:143], v[140:143]
v_mfma_f32_16x16x32_bf16 v[140:143], a[28:31], a[156:159], v[140:143]
v_mfma_f32_16x16x32_bf16 v[136:139], a[24:27], a[136:139], v[136:139]
v_mfma_f32_16x16x32_bf16 v[136:139], a[28:31], a[152:155], v[136:139]
ds_read_b128 a[12:15], v23 offset:51200
v_mfma_f32_16x16x32_bf16 v[132:135], a[24:27], a[132:135], v[132:135]
s_waitcnt vmcnt(5)
v_mfma_f32_16x16x32_bf16 v[132:135], a[28:31], a[148:151], v[132:135]
s_mov_b64 exec, 1
buffer_store_dword v4, v31, s[36:39], s69 offen offset:12 sc0 sc1
s_mov_b64 exec, -1
v_mfma_f32_16x16x32_bf16 v[128:131], a[24:27], a[128:131], v[128:131]
v_mfma_f32_16x16x32_bf16 v[128:131], a[28:31], a[144:147], v[128:131]
s_waitcnt lgkmcnt(2)
ds_read_b128 a[16:19], v20 offset:2048
v_mfma_f32_16x16x32_bf16 v[144:147], a[0:3], a[32:35], v[144:147]
buffer_load_dword v36, v32, s[36:39], s69 offen sc0 sc1
v_mfma_f32_16x16x32_bf16 v[144:147], a[4:7], a[48:51], v[144:147]
v_mfma_f32_16x16x32_bf16 v[148:151], a[0:3], a[36:39], v[148:151]
v_mfma_f32_16x16x32_bf16 v[148:151], a[4:7], a[52:55], v[148:151]
ds_read_b128 a[20:23], v21 offset:2048
v_mfma_f32_16x16x32_bf16 v[152:155], a[0:3], a[40:43], v[152:155]
s_waitcnt vmcnt(4)
v_cmp_ne_u32 s[82:83], s3, v38
v_mfma_f32_16x16x32_bf16 v[152:155], a[4:7], a[56:59], v[152:155]
s_and_b32 s29, s82, 4
s_cselect_b32 s47, 0x40000000, s71
s_or_b32 s28, s28, s29
v_mfma_f32_16x16x32_bf16 v[156:159], a[0:3], a[44:47], v[156:159]
buffer_load_dwordx4 v[196:199], v1, s[40:43], s47 offen offset:0 sc0 sc1
v_mfma_f32_16x16x32_bf16 v[156:159], a[4:7], a[60:63], v[156:159]
s_waitcnt lgkmcnt(2)
ds_read_b128 a[24:27], v20 offset:18432
v_mfma_f32_16x16x32_bf16 v[156:159], a[8:11], a[220:223], v[156:159]
v_mfma_f32_16x16x32_bf16 v[156:159], a[12:15], a[236:239], v[156:159]
v_mfma_f32_16x16x32_bf16 v[152:155], a[8:11], a[216:219], v[152:155]
v_mfma_f32_16x16x32_bf16 v[152:155], a[12:15], a[232:235], v[152:155]
ds_read_b128 a[28:31], v21 offset:18432
v_mfma_f32_16x16x32_bf16 v[148:151], a[8:11], a[212:215], v[148:151]
v_mfma_f32_16x16x32_bf16 v[148:151], a[12:15], a[228:231], v[148:151]
v_mfma_f32_16x16x32_bf16 v[144:147], a[8:11], a[208:211], v[144:147]
buffer_load_dwordx4 v[204:207], v1, s[40:43], s47 offen offset:1024 sc0 sc1
v_mfma_f32_16x16x32_bf16 v[144:147], a[12:15], a[224:227], v[144:147]
s_waitcnt lgkmcnt(2)
ds_read_b128 a[0:3], v20 offset:34816
v_mfma_f32_16x16x32_bf16 v[144:147], a[16:19], a[160:163], v[144:147]
v_mfma_f32_16x16x32_bf16 v[144:147], a[20:23], v[64:67], v[144:147]
v_mfma_f32_16x16x32_bf16 v[148:151], a[16:19], a[164:167], v[148:151]
v_mfma_f32_16x16x32_bf16 v[148:151], a[20:23], v[68:71], v[148:151]
ds_read_b128 a[4:7], v21 offset:34816
v_mfma_f32_16x16x32_bf16 v[152:155], a[16:19], a[168:171], v[152:155]
v_mfma_f32_16x16x32_bf16 v[152:155], a[20:23], v[72:75], v[152:155]
v_mfma_f32_16x16x32_bf16 v[156:159], a[16:19], a[172:175], v[156:159]
buffer_load_dwordx4 v[212:215], v1, s[40:43], s47 offen offset:2048 sc0 sc1
v_mfma_f32_16x16x32_bf16 v[156:159], a[20:23], v[76:79], v[156:159]
s_waitcnt lgkmcnt(2)
ds_read_b128 a[8:11], v20 offset:51200
v_mfma_f32_16x16x32_bf16 v[156:159], a[24:27], v[92:95], v[156:159]
v_mfma_f32_16x16x32_bf16 v[156:159], a[28:31], v[108:111], v[156:159]
v_mfma_f32_16x16x32_bf16 v[152:155], a[24:27], v[88:91], v[152:155]
v_mfma_f32_16x16x32_bf16 v[152:155], a[28:31], v[104:107], v[152:155]
ds_read_b128 a[12:15], v21 offset:51200
v_mfma_f32_16x16x32_bf16 v[148:151], a[24:27], v[84:87], v[148:151]
v_mfma_f32_16x16x32_bf16 v[148:151], a[28:31], v[100:103], v[148:151]
v_mfma_f32_16x16x32_bf16 v[144:147], a[24:27], v[80:83], v[144:147]
buffer_load_dwordx4 v[220:223], v1, s[40:43], s47 offen offset:3072 sc0 sc1
v_mfma_f32_16x16x32_bf16 v[144:147], a[28:31], v[96:99], v[144:147]
s_waitcnt lgkmcnt(2)
ds_read_b128 a[16:19], v22 offset:2048
v_mfma_f32_16x16x32_bf16 v[144:147], a[0:3], v[112:115], v[144:147]
v_mfma_f32_16x16x32_bf16 v[144:147], a[4:7], a[176:179], v[144:147]
v_mfma_f32_16x16x32_bf16 v[148:151], a[0:3], v[116:119], v[148:151]
v_mfma_f32_16x16x32_bf16 v[148:151], a[4:7], a[180:183], v[148:151]
ds_read_b128 a[20:23], v23 offset:2048
v_mfma_f32_16x16x32_bf16 v[152:155], a[0:3], v[120:123], v[152:155]
v_mfma_f32_16x16x32_bf16 v[152:155], a[4:7], a[184:187], v[152:155]
buffer_load_dword v39, v32, s[36:39], s69 offen sc0 sc1
v_mfma_f32_16x16x32_bf16 v[156:159], a[0:3], v[124:127], v[156:159]
s_waitcnt vmcnt(5)
v_cmp_ne_u32 s[82:83], s3, v36
v_mfma_f32_16x16x32_bf16 v[156:159], a[4:7], a[188:191], v[156:159]
s_waitcnt lgkmcnt(2)
ds_read_b128 a[24:27], v22 offset:18432
v_mfma_f32_16x16x32_bf16 v[156:159], a[8:11], a[76:79], v[156:159]
s_and_b32 s29, s82, 1
s_cselect_b32 s47, 0x40000000, s72
s_or_b32 s28, s28, s29
v_mfma_f32_16x16x32_bf16 v[156:159], a[12:15], a[92:95], v[156:159]
buffer_load_dwordx4 v[228:231], v1, s[40:43], s47 offen offset:0 sc0 sc1
v_mfma_f32_16x16x32_bf16 v[152:155], a[8:11], a[72:75], v[152:155]
v_mfma_f32_16x16x32_bf16 v[152:155], a[12:15], a[88:91], v[152:155]
ds_read_b128 a[28:31], v23 offset:18432
v_mfma_f32_16x16x32_bf16 v[148:151], a[8:11], a[68:71], v[148:151]
v_mfma_f32_16x16x32_bf16 v[148:151], a[12:15], a[84:87], v[148:151]
v_mfma_f32_16x16x32_bf16 v[144:147], a[8:11], a[64:67], v[144:147]
v_mfma_f32_16x16x32_bf16 v[144:147], a[12:15], a[80:83], v[144:147]
s_waitcnt lgkmcnt(2)
v_mfma_f32_16x16x32_bf16 v[144:147], a[16:19], a[112:115], v[144:147]
v_mfma_f32_16x16x32_bf16 v[144:147], a[20:23], a[96:99], v[144:147]
buffer_load_dwordx4 v[236:239], v1, s[40:43], s47 offen offset:1024 sc0 sc1
v_mfma_f32_16x16x32_bf16 v[148:151], a[16:19], a[116:119], v[148:151]
v_mfma_f32_16x16x32_bf16 v[148:151], a[20:23], a[100:103], v[148:151]
v_mfma_f32_16x16x32_bf16 v[152:155], a[16:19], a[120:123], v[152:155]
v_mfma_f32_16x16x32_bf16 v[152:155], a[20:23], a[104:107], v[152:155]
v_mfma_f32_16x16x32_bf16 v[156:159], a[16:19], a[124:127], v[156:159]
v_mfma_f32_16x16x32_bf16 v[156:159], a[20:23], a[108:111], v[156:159]
s_waitcnt lgkmcnt(0)
v_mfma_f32_16x16x32_bf16 v[156:159], a[24:27], a[140:143], v[156:159]
v_mfma_f32_16x16x32_bf16 v[156:159], a[28:31], a[156:159], v[156:159]
v_mfma_f32_16x16x32_bf16 v[152:155], a[24:27], a[136:139], v[152:155]
v_mfma_f32_16x16x32_bf16 v[152:155], a[28:31], a[152:155], v[152:155]
v_mfma_f32_16x16x32_bf16 v[148:151], a[24:27], a[132:135], v[148:151]
v_mfma_f32_16x16x32_bf16 v[148:151], a[28:31], a[148:151], v[148:151]
v_mfma_f32_16x16x32_bf16 v[144:147], a[24:27], a[128:131], v[144:147]
v_mfma_f32_16x16x32_bf16 v[144:147], a[28:31], a[144:147], v[144:147]
s_cmp_lg_u32 s28, 0
s_cbranch_scc1 FX
FX_ret:
s_waitcnt vmcnt(2)
P43_chk:
v_cmp_ne_u32 vcc, s3, v39
s_nop 0
s_and_b64 vcc, vcc, 8
s_cbranch_scc1 P43_retry
P43_ok:
buffer_load_dwordx4 v[244:247], v1, s[40:43], s72 offen offset:2048 sc0 sc1
buffer_load_dwordx4 v[252:255], v1, s[40:43], s72 offen offset:3072 sc0 sc1
v_dot2_f32_bf16 v128, v164, v34, v128
v_dot2_f32_bf16 v129, v164, v35, v129
v_dot2_f32_bf16 v130, v165, v34, v130
v_dot2_f32_bf16 v131, v165, v35, v131
v_dot2_f32_bf16 v132, v166, v34, v132
v_dot2_f32_bf16 v133, v166, v35, v133
v_dot2_f32_bf16 v134, v167, v34, v134
v_dot2_f32_bf16 v135, v167, v35, v135
v_dot2_f32_bf16 v128, v196, v34, v128
v_dot2_f32_bf16 v129, v196, v35, v129
v_dot2_f32_bf16 v130, v197, v34, v130
v_dot2_f32_bf16 v131, v197, v35, v131
v_dot2_f32_bf16 v132, v198, v34, v132
v_dot2_f32_bf16 v133, v198, v35, v133
v_dot2_f32_bf16 v134, v199, v34, v134
v_dot2_f32_bf16 v135, v199, v35, v135
s_waitcnt vmcnt(3)
v_dot2_f32_bf16 v128, v228, v34, v128
v_dot2_f32_bf16 v129, v228, v35, v129
v_dot2_f32_bf16 v130, v229, v34, v130
v_dot2_f32_bf16 v131, v229, v35, v131
v_dot2_f32_bf16 v132, v230, v34, v132
v_dot2_f32_bf16 v133, v230, v35, v133
v_dot2_f32_bf16 v134, v231, v34, v134
v_dot2_f32_bf16 v135, v231, v35, v135
buffer_store_dwordx4 v[128:131], v28, s[8:11], s57 offen offset:0 sc0 sc1
s_nop 1
buffer_store_dwordx4 v[132:135], v28, s[8:11], s58 offen offset:0 sc0 sc1
v_dot2_f32_bf16 v136, v172, v34, v136
v_dot2_f32_bf16 v137, v172, v35, v137
v_dot2_f32_bf16 v138, v173, v34, v138
v_dot2_f32_bf16 v139, v173, v35, v139
v_dot2_f32_bf16 v140, v174, v34, v140
v_dot2_f32_bf16 v141, v174, v35, v141
v_dot2_f32_bf16 v142, v175, v34, v142
v_dot2_f32_bf16 v143, v175, v35, v143
v_dot2_f32_bf16 v136, v204, v34, v136
v_dot2_f32_bf16 v137, v204, v35, v137
v_dot2_f32_bf16 v138, v205, v34, v138
v_dot2_f32_bf16 v139, v205, v35, v139
v_dot2_f32_bf16 v140, v206, v34, v140
v_dot2_f32_bf16 v141, v206, v35, v141
v_dot2_f32_bf16 v142, v207, v34, v142
v_dot2_f32_bf16 v143, v207, v35, v143
s_waitcnt vmcnt(4)
v_dot2_f32_bf16 v136, v236, v34, v136
v_dot2_f32_bf16 v137, v236, v35, v137
v_dot2_f32_bf16 v138, v237, v34, v138
v_dot2_f32_bf16 v139, v237, v35, v139
v_dot2_f32_bf16 v140, v238, v34, v140
v_dot2_f32_bf16 v141, v238, v35, v141
v_dot2_f32_bf16 v142, v239, v34, v142
v_dot2_f32_bf16 v143, v239, v35, v143
buffer_store_dwordx4 v[136:139], v28, s[8:11], s59 offen offset:0 sc0 sc1
s_nop 1
buffer_store_dwordx4 v[140:143], v28, s[8:11], s64 offen offset:0 sc0 sc1
v_dot2_f32_bf16 v144, v180, v34, v144
v_dot2_f32_bf16 v145, v180, v35, v145
v_dot2_f32_bf16 v146, v181, v34, v146
v_dot2_f32_bf16 v147, v181, v35, v147
v_dot2_f32_bf16 v148, v182, v34, v148
v_dot2_f32_bf16 v149, v182, v35, v149
v_dot2_f32_bf16 v150, v183, v34, v150
v_dot2_f32_bf16 v151, v183, v35, v151
v_dot2_f32_bf16 v144, v212, v34, v144
v_dot2_f32_bf16 v145, v212, v35, v145
v_dot2_f32_bf16 v146, v213, v34, v146
v_dot2_f32_bf16 v147, v213, v35, v147
v_dot2_f32_bf16 v148, v214, v34, v148
v_dot2_f32_bf16 v149, v214, v35, v149
v_dot2_f32_bf16 v150, v215, v34, v150
v_dot2_f32_bf16 v151, v215, v35, v151
s_waitcnt vmcnt(5)
v_dot2_f32_bf16 v144, v244, v34, v144
v_dot2_f32_bf16 v145, v244, v35, v145
v_dot2_f32_bf16 v146, v245, v34, v146
v_dot2_f32_bf16 v147, v245, v35, v147
v_dot2_f32_bf16 v148, v246, v34, v148
v_dot2_f32_bf16 v149, v246, v35, v149
v_dot2_f32_bf16 v150, v247, v34, v150
v_dot2_f32_bf16 v151, v247, v35, v151
buffer_store_dwordx4 v[144:147], v28, s[8:11], s57 offen offset:64 sc0 sc1
s_nop 1
buffer_store_dwordx4 v[148:151], v28, s[8:11], s58 offen offset:64 sc0 sc1
v_dot2_f32_bf16 v152, v188, v34, v152
v_dot2_f32_bf16 v153, v188, v35, v153
v_dot2_f32_bf16 v154, v189, v34, v154
v_dot2_f32_bf16 v155, v189, v35, v155
v_dot2_f32_bf16 v156, v190, v34, v156
v_dot2_f32_bf16 v157, v190, v35, v157
v_dot2_f32_bf16 v158, v191, v34, v158
v_dot2_f32_bf16 v159, v191, v35, v159
v_dot2_f32_bf16 v152, v220, v34, v152
v_dot2_f32_bf16 v153, v220, v35, v153
v_dot2_f32_bf16 v154, v221, v34, v154
v_dot2_f32_bf16 v155, v221, v35, v155
v_dot2_f32_bf16 v156, v222, v34, v156
v_dot2_f32_bf16 v157, v222, v35, v157
v_dot2_f32_bf16 v158, v223, v34, v158
v_dot2_f32_bf16 v159, v223, v35, v159
s_waitcnt vmcnt(6)
v_dot2_f32_bf16 v152, v252, v34, v152
v_dot2_f32_bf16 v153, v252, v35, v153
v_dot2_f32_bf16 v154, v253, v34, v154
v_dot2_f32_bf16 v155, v253, v35, v155
v_dot2_f32_bf16 v156, v254, v34, v156
v_dot2_f32_bf16 v157, v254, v35, v157
v_dot2_f32_bf16 v158, v255, v34, v158
v_dot2_f32_bf16 v159, v255, v35, v159
buffer_store_dwordx4 v[152:155], v28, s[8:11], s59 offen offset:64 sc0 sc1
s_nop 1
buffer_store_dwordx4 v[156:159], v28, s[8:11], s64 offen offset:64 sc0 sc1
s_cmp_eq_u32 s63, 31
s_cbranch_scc0 L_noep
s_cmp_eq_u32 s60, 0
s_cbranch_scc0 L_noep
v_mov_b32 v40, 0x48000
s_mov_b64 exec, 1
buffer_store_dword v4, v40, s[36:39], 0 offen sc0 sc1
s_mov_b64 exec, -1
L_noep:
L_end:
s_endpgm
L_codeend:
.section .rodata,"a"
.p2align 6
.amdhsa_kernel parallel_sum__ssm_conv_s5__glu_gated_geglu__prompt_kernel
.amdhsa_next_free_vgpr 512
.amdhsa_next_free_sgpr 102
.amdhsa_accum_offset 256
.amdhsa_group_segment_fixed_size 0
.amdhsa_kernarg_size 128
.amdhsa_user_sgpr_count 2
.amdhsa_user_sgpr_kernarg_segment_ptr 1
.amdhsa_system_sgpr_workgroup_id_x 1
.end_amdhsa_kernel
```
